```python
import torch

def _softmax(x, axis=-1):
    return torch.softmax(x, dim=axis)
def _gelu(x):
    return torch.nn.functional.gelu(x, approximate="tanh")
def _silu(x):
    return torch.nn.functional.silu(x)
def _sigmoid(x):
    return torch.sigmoid(x)
def _layernorm(x, axis=-1, eps=1e-5):
    m = x.mean(dim=axis, keepdim=True)
    v = x.var(dim=axis, keepdim=True, unbiased=False)
    return (x - m) / torch.sqrt(v + eps)
def _scatter_add(tgt, idx, src, axis=0):
    return tgt.clone().index_add_(axis, idx, src)
def _segment_sum(src, seg, n):
    out = torch.zeros((n,) + src.shape[1:], dtype=src.dtype)
    return out.index_add_(0, seg, src)
def _pad(x, pw):
    flat = tuple(v for pair in reversed(pw) for v in pair)
    return torch.nn.functional.pad(x, flat)

kernel_name = 'recurrent_scan__softmax_full_mha__glu_gated_glu__prompt'

def setup_inputs():

    _w = (lambda a: (lambda t: t.to(torch.bfloat16) if t.is_floating_point() else t)(torch.as_tensor(a)))
    def _A_setup():
        B, S, D = 1, 2048, 1024
        return {
            "x": _w((lambda *s: torch.randn(*s, dtype=torch.bfloat16) * 0.05)(B, S, D)),
            "wqkv": _w((lambda *s: torch.randn(*s, dtype=torch.bfloat16) * 0.05)(D, 3 * D)),
            "wo": _w((lambda *s: torch.randn(*s, dtype=torch.bfloat16) * 0.05)(D, D)),
        }
    _A_in = _A_setup()

    def _B_setup():
        B, S, D, F = 1, 2048, 1024, 3584
        return {
            "x": _w((lambda *s: torch.randn(*s, dtype=torch.bfloat16) * 0.05)(B, S, D)),
            "w_gate": _w((lambda *s: torch.randn(*s, dtype=torch.bfloat16) * 0.05)(D, F)),
            "w_up": _w((lambda *s: torch.randn(*s, dtype=torch.bfloat16) * 0.05)(D, F)),
            "w_down": _w((lambda *s: torch.randn(*s, dtype=torch.bfloat16) * 0.05)(F, D)),
        }
    _B_in = _B_setup()

    return {
        "A_x": _A_in["x"],
        "A_wqkv": _A_in["wqkv"],
        "A_wo": _A_in["wo"],
        "B_x": _B_in["x"],
        "B_w_gate": _B_in["w_gate"],
        "B_w_up": _B_in["w_up"],
        "B_w_down": _B_in["w_down"],
    }

def reference(A_x, A_wqkv, A_wo, B_x, B_w_gate, B_w_up, B_w_down):
    def _A_ref(x, wqkv, wo):
        B, S, D = x.shape
        H = 32; Dh = D // H
        qkv = (lambda x, *d: x.permute(*d))((x @ wqkv).reshape(B, S, 3, H, Dh), 2, 0, 3, 1, 4)
        q, k, v = qkv[0], qkv[1], qkv[2]
        scale = Dh ** -0.5
        scores = torch.einsum("bhqd,bhkd->bhqk", q, k) * scale
        p = _softmax(scores, axis=-1)
        o = torch.einsum("bhqk,bhkd->bhqd", p, v)
        return (lambda x, *d: x.permute(*d))(o, 0, 2, 1, 3).reshape(B, S, D) @ wo

    def _B_ref(x, w_gate, w_up, w_down):
        g = torch.einsum("bsd,df->bsf", x, w_gate)
        u = torch.einsum("bsd,df->bsf", x, w_up)
        h = _sigmoid(g) * u
        return torch.einsum("bsf,fd->bsd", h, w_down)

    x = A_x
    xn = _layernorm(x, axis=-1)
    s = _A_ref(xn, A_wqkv, A_wo)
    g = _silu(_B_ref(xn, B_w_gate, B_w_up, B_w_down))
    return x + s * g
```

```asm
; @launch grid=(256,1,1) block=(256,1,1) lds=163840
.amdgcn_target "amdgcn-amd-amdhsa--gfx950"
.text
.globl recurrent_scan__softmax_full_mha__glu_gated_glu__prompt_kernel
.p2align 8
.type recurrent_scan__softmax_full_mha__glu_gated_glu__prompt_kernel,@function
recurrent_scan__softmax_full_mha__glu_gated_glu__prompt_kernel:
    s_cmp_ge_u32 s2, 256
    s_cbranch_scc1 L_end
    s_load_dwordx4 s[20:23], s[0:1], 0
    s_load_dwordx2 s[4:5], s[0:1], 72
    s_load_dwordx4 s[48:51], s[0:1], 32
    s_load_dwordx2 s[76:77], s[0:1], 16
    s_load_dwordx4 s[52:55], s[0:1], 48
    v_and_b32 v19, 63, v0
    v_lshrrev_b32 v20, 6, v0
    v_lshlrev_b32 v1, 4, v19
    v_readfirstlane_b32 s46, v20
    s_getpc_b64 s[34:35]
L_pc1:
    s_sub_u32 s34, s34, L_pc1-recurrent_scan__softmax_full_mha__glu_gated_glu__prompt_kernel
    s_subb_u32 s35, s35, 0
    s_lshr_b32 s3, s2, 3
    s_lshl_b32 s3, s3, 2
    s_add_u32 s3, s3, s46
    s_mul_i32 s3, s3, 1024
    v_lshlrev_b32 v17, 3, v1
    v_and_b32 v17, 1023, v17
    v_add_u32 v17, s3, v17
    v_min_u32 v17, L_end-recurrent_scan__softmax_full_mha__glu_gated_glu__prompt_kernel, v17
    global_load_dword v18, v17, s[34:35]
    s_and_b32 s56, s2, 7
    s_lshl_b32 s56, s56, 2
    s_bfe_u32 s3, s2, 0x20003
    s_add_u32 s56, s56, s3
    s_lshr_b32 s57, s2, 5
    s_lshr_b32 s47, s46, 1
    v_bfe_u32 v21, v19, 2, 1
    v_lshrrev_b32 v22, 3, v19
    v_and_b32 v23, 3, v19
    v_lshlrev_b32 v24, 11, v21
    v_lshl_add_u32 v24, v22, 6, v24
    v_lshl_add_u32 v24, v23, 4, v24
    s_lshl_b32 s3, s57, 5
    s_add_u32 s3, s3, s56
    s_lshl_b32 s3, s3, 2
    s_add_u32 s3, s3, s46
    s_lshl_b32 s60, s3, 12
    s_waitcnt lgkmcnt(0)
    s_mov_b32 s8, s22
    s_mov_b32 s9, s23
    s_mov_b32 s22, 4194304
    s_mov_b32 s23, 0x00020000
    buffer_load_dwordx4 v[32:35], v24, s[20:23], s60 offen offset:0
    buffer_load_dwordx4 v[36:39], v24, s[20:23], s60 offen offset:512
    buffer_load_dwordx4 v[40:43], v24, s[20:23], s60 offen offset:1024
    buffer_load_dwordx4 v[44:47], v24, s[20:23], s60 offen offset:1536
    s_add_u32 s66, s4, 62914560
    s_addc_u32 s67, s5, 0
    s_load_dword s72, s[66:67], 0
    s_mov_b32 s6, 268435456
    s_mov_b32 s7, 0x00020000
    s_mov_b32 s10, 6291456
    s_mov_b32 s11, 0x00020000
    s_mov_b32 s12, s48
    s_mov_b32 s13, s49
    s_mov_b32 s14, 7340032
    s_mov_b32 s15, 0x00020000
    s_mov_b32 s16, s50
    s_mov_b32 s17, s51
    s_mov_b32 s18, 7340032
    s_mov_b32 s19, 0x00020000
    s_mov_b32 s74, s52
    s_mov_b32 s75, s53
    s_mov_b32 s78, s54
    s_mov_b32 s79, s55
    s_lshl_b32 s58, s56, 6
    s_mul_i32 s59, s56, 224
    s_and_b32 s45, s56, 1
    s_lshl_b32 s45, s45, 1
    s_mov_b32 s43, 0
    s_mov_b32 s44, 0
    s_add_u32 s3, s45, s47
    s_lshl_b32 s3, s3, 1
    s_lshr_b32 s3, 0x78, s3
    s_and_b32 s3, s3, 3
    v_xor_b32 v23, s3, v23
    v_mul_u32_u24 v25, 16384, v22
    v_lshl_add_u32 v25, v21, 6, v25
    v_lshl_add_u32 v25, v23, 4, v25
    s_mul_i32 s61, s57, 524288
    s_lshl_b32 s3, s56, 9
    s_add_u32 s61, s61, s3
    s_lshl_b32 s3, s46, 7
    s_add_u32 s61, s61, s3
    s_cmp_eq_u32 s47, 0
    s_cselect_b32 s24, s48, s50
    s_cselect_b32 s25, s49, s51
    s_mov_b32 s26, 7340032
    s_mov_b32 s27, 0x00020000
    s_lshl_b32 s36, s46, 12
    s_bitcmp1_b32 s46, 0
    s_cbranch_scc1 L_p0_wc1
L_p0_wc0:
    s_lshr_b32 s3, s2, 3
    s_and_b32 s33, s2, 7
    v_bfe_u32 v28, v19, 3, 2
    v_bfe_u32 v31, v19, 3, 2
    v_and_b32 v29, 7, v19
    s_cmp_eq_u32 s47, 0
    s_cbranch_scc1 L_lpf0_b
    s_mov_b32 s48, s16
    s_mov_b32 s49, s17
    s_mov_b32 s50, 7340032
    s_mov_b32 s51, 0x00020000
    v_min_u32 v29, 6, v29
    v_lshlrev_b32 v29, 7, v29
    v_mul_u32_u24 v31, 7168, v31
    v_add_u32 v31, v31, v29
    s_mul_i32 s33, s33, 896
    s_mul_i32 s42, s3, 28672
    s_add_u32 s42, s42, s33
    buffer_load_dword v16, v31, s[48:51], s42 offen
    v_mul_u32_u24 v15, 7168, v28
    v_add_u32 v15, v15, v29
    s_mul_i32 s42, s3, 28672
    s_add_u32 s42, s42, s33
    s_add_u32 s42, s42, 917504
    s_mov_b32 s62, 917504
    s_branch L_lpf0_e
L_lpf0_b:
    s_mov_b32 s48, s8
    s_mov_b32 s49, s9
    s_mov_b32 s50, 6291456
    s_mov_b32 s51, 0x00020000
    v_min_u32 v29, 5, v29
    v_lshrrev_b32 v30, 1, v29
    v_and_b32 v29, 1, v29
    v_lshlrev_b32 v29, 7, v29
    v_lshl_add_u32 v29, v30, 11, v29
    v_mul_u32_u24 v31, 6144, v31
    v_add_u32 v31, v31, v29
    s_mul_i32 s33, s33, 256
    s_mul_i32 s42, s3, 24576
    s_add_u32 s42, s42, s33
    buffer_load_dword v16, v31, s[48:51], s42 offen
    v_mul_u32_u24 v15, 6144, v28
    v_add_u32 v15, v15, v29
    s_mul_i32 s42, s3, 24576
    s_add_u32 s42, s42, s33
    s_add_u32 s42, s42, 786432
    s_mov_b32 s62, 786432
L_lpf0_e:
    s_cmp_eq_u32 s47, 0
    s_mov_b32 s3, 192
    s_cselect_b32 s3, 0, s3
    s_mov_b32 s28, 19456
    s_cselect_b32 s28, 16384, s28
    v_add_u32 v28, s3, v19
    v_mul_u32_u24 v29, 5462, v28
    v_lshrrev_b32 v29, 16, v29
    v_mul_u32_u24 v30, 12, v29
    v_sub_u32 v30, v28, v30
    v_lshrrev_b32 v31, 1, v29
    v_and_b32 v31, 2, v31
    v_xor_b32 v30, v30, v31
    v_and_b32 v31, 12, v29
    v_add_u32 v31, v31, v29
    v_lshrrev_b32 v29, 4, v29
    v_mul_u32_u24 v29, 12, v29
    v_sub_u32 v29, v31, v29
    v_mul_u32_u24 v29, 6144, v29
    v_lshrrev_b32 v31, 2, v30
    v_lshl_add_u32 v29, v31, 11, v29
    v_and_b32 v30, 3, v30
    v_lshl_add_u32 v29, v30, 4, v29
    v_add_u32 v2, s58, v29
    s_cmp_eq_u32 s47, 0
    s_mov_b32 s3, 256
    s_cselect_b32 s3, 64, s3
    s_mov_b32 s29, 20480
    s_cselect_b32 s29, 17408, s29
    v_add_u32 v28, s3, v19
    v_mul_u32_u24 v29, 5462, v28
    v_lshrrev_b32 v29, 16, v29
    v_mul_u32_u24 v30, 12, v29
    v_sub_u32 v30, v28, v30
    v_lshrrev_b32 v31, 1, v29
    v_and_b32 v31, 2, v31
    v_xor_b32 v30, v30, v31
    v_and_b32 v31, 12, v29
    v_add_u32 v31, v31, v29
    v_lshrrev_b32 v29, 4, v29
    v_mul_u32_u24 v29, 12, v29
    v_sub_u32 v29, v31, v29
    v_mul_u32_u24 v29, 6144, v29
    v_lshrrev_b32 v31, 2, v30
    v_lshl_add_u32 v29, v31, 11, v29
    v_and_b32 v30, 3, v30
    v_lshl_add_u32 v29, v30, 4, v29
    v_add_u32 v3, s58, v29
    s_cmp_eq_u32 s47, 0
    s_mov_b32 s3, 320
    s_cselect_b32 s3, 128, s3
    s_mov_b32 s30, 21504
    s_cselect_b32 s30, 18432, s30
    v_add_u32 v28, s3, v19
    v_mul_u32_u24 v29, 5462, v28
    v_lshrrev_b32 v29, 16, v29
    v_mul_u32_u24 v30, 12, v29
    v_sub_u32 v30, v28, v30
    v_lshrrev_b32 v31, 1, v29
    v_and_b32 v31, 2, v31
    v_xor_b32 v30, v30, v31
    v_and_b32 v31, 12, v29
    v_add_u32 v31, v31, v29
    v_lshrrev_b32 v29, 4, v29
    v_mul_u32_u24 v29, 12, v29
    v_sub_u32 v29, v31, v29
    v_mul_u32_u24 v29, 6144, v29
    v_lshrrev_b32 v31, 2, v30
    v_lshl_add_u32 v29, v31, 11, v29
    v_and_b32 v30, 3, v30
    v_lshl_add_u32 v29, v30, 4, v29
    v_add_u32 v4, s58, v29
    s_cmp_eq_u32 s47, 0
    s_mov_b32 s3, 128
    s_cselect_b32 s3, 0, s3
    s_mov_b32 s31, 24576
    s_cselect_b32 s31, 22528, s31
    v_add_u32 v28, s3, v19
    v_mul_u32_u24 v29, 4682, v28
    v_lshrrev_b32 v29, 16, v29
    v_mul_u32_u24 v30, 14, v29
    v_sub_u32 v30, v28, v30
    v_add_u32 v30, s45, v30
    v_subrev_u32 v31, 14, v30
    v_min_u32 v30, v30, v31
    v_and_b32 v31, 12, v29
    v_add_u32 v31, v31, v29
    v_lshrrev_b32 v29, 4, v29
    v_mul_u32_u24 v29, 12, v29
    v_sub_u32 v29, v31, v29
    v_mul_u32_u24 v29, 7168, v29
    v_lshl_add_u32 v29, v30, 4, v29
    v_add_u32 v5, s59, v29
    s_cmp_eq_u32 s47, 0
    s_mov_b32 s3, 192
    s_cselect_b32 s3, 64, s3
    s_mov_b32 s32, 25600
    s_cselect_b32 s32, 23552, s32
    v_add_u32 v28, s3, v19
    v_mul_u32_u24 v29, 4682, v28
    v_lshrrev_b32 v29, 16, v29
    v_mul_u32_u24 v30, 14, v29
    v_sub_u32 v30, v28, v30
    v_add_u32 v30, s45, v30
    v_subrev_u32 v31, 14, v30
    v_min_u32 v30, v30, v31
    v_and_b32 v31, 12, v29
    v_add_u32 v31, v31, v29
    v_lshrrev_b32 v29, 4, v29
    v_mul_u32_u24 v29, 12, v29
    v_sub_u32 v29, v31, v29
    v_mul_u32_u24 v29, 7168, v29
    v_lshl_add_u32 v29, v30, 4, v29
    v_add_u32 v6, s59, v29
    s_mov_b32 s24, s8
    s_mov_b32 s25, s9
    s_mov_b32 s26, 6291456
    s_mov_b32 s16, s12
    s_mov_b32 s17, s13
    s_mov_b32 s39, 196608
    s_branch L_p0_ln
L_p0_wc1:
    s_lshr_b32 s3, s2, 3
    s_and_b32 s33, s2, 7
    v_bfe_u32 v28, v19, 3, 2
    v_bfe_u32 v31, v19, 3, 2
    v_and_b32 v29, 7, v19
    s_cmp_eq_u32 s47, 0
    s_cbranch_scc0 L_lpf1_b
    s_mov_b32 s48, s12
    s_mov_b32 s49, s13
    s_mov_b32 s50, 7340032
    s_mov_b32 s51, 0x00020000
    v_min_u32 v29, 6, v29
    v_lshlrev_b32 v29, 7, v29
    v_mul_u32_u24 v31, 7168, v31
    v_add_u32 v31, v31, v29
    s_mul_i32 s33, s33, 896
    s_mul_i32 s42, s3, 28672
    s_add_u32 s42, s42, s33
    buffer_load_dword v16, v31, s[48:51], s42 offen
    v_mul_u32_u24 v15, 7168, v28
    v_add_u32 v15, v15, v29
    s_mul_i32 s42, s3, 28672
    s_add_u32 s42, s42, s33
    s_add_u32 s42, s42, 917504
    s_mov_b32 s62, 917504
    s_branch L_lpf1_e
L_lpf1_b:
    s_mov_b32 s48, s74
    s_mov_b32 s49, s75
    s_mov_b32 s50, 7340032
    s_mov_b32 s51, 0x00020000
    v_and_b32 v15, 15, v19
    v_lshlrev_b32 v15, 7, v15
    s_lshl_b32 s42, s2, 11
    s_mov_b32 s62, 524288
    buffer_load_dword v16, v15, s[48:51], s50 offen
L_lpf1_e:
    s_cmp_eq_u32 s47, 0
    s_mov_b32 s3, 128
    s_cselect_b32 s3, 256, s3
    s_mov_b32 s28, 31744
    s_cselect_b32 s28, 26624, s28
    v_add_u32 v28, s3, v19
    v_mul_u32_u24 v29, 4682, v28
    v_lshrrev_b32 v29, 16, v29
    v_mul_u32_u24 v30, 14, v29
    v_sub_u32 v30, v28, v30
    v_add_u32 v30, s45, v30
    v_subrev_u32 v31, 14, v30
    v_min_u32 v30, v30, v31
    v_and_b32 v31, 12, v29
    v_add_u32 v31, v31, v29
    v_lshrrev_b32 v29, 4, v29
    v_mul_u32_u24 v29, 12, v29
    v_sub_u32 v29, v31, v29
    v_mul_u32_u24 v29, 7168, v29
    v_lshl_add_u32 v29, v30, 4, v29
    v_add_u32 v2, s59, v29
    s_cmp_eq_u32 s47, 0
    s_mov_b32 s3, 192
    s_cselect_b32 s3, 320, s3
    s_mov_b32 s29, 32768
    s_cselect_b32 s29, 27648, s29
    v_add_u32 v28, s3, v19
    v_mul_u32_u24 v29, 4682, v28
    v_lshrrev_b32 v29, 16, v29
    v_mul_u32_u24 v30, 14, v29
    v_sub_u32 v30, v28, v30
    v_add_u32 v30, s45, v30
    v_subrev_u32 v31, 14, v30
    v_min_u32 v30, v30, v31
    v_and_b32 v31, 12, v29
    v_add_u32 v31, v31, v29
    v_lshrrev_b32 v29, 4, v29
    v_mul_u32_u24 v29, 12, v29
    v_sub_u32 v29, v31, v29
    v_mul_u32_u24 v29, 7168, v29
    v_lshl_add_u32 v29, v30, 4, v29
    v_add_u32 v3, s59, v29
    s_cmp_eq_u32 s47, 0
    s_mov_b32 s3, 256
    s_cselect_b32 s3, 384, s3
    s_mov_b32 s30, 33792
    s_cselect_b32 s30, 28672, s30
    v_add_u32 v28, s3, v19
    v_mul_u32_u24 v29, 4682, v28
    v_lshrrev_b32 v29, 16, v29
    v_mul_u32_u24 v30, 14, v29
    v_sub_u32 v30, v28, v30
    v_add_u32 v30, s45, v30
    v_subrev_u32 v31, 14, v30
    v_min_u32 v30, v30, v31
    v_and_b32 v31, 12, v29
    v_add_u32 v31, v31, v29
    v_lshrrev_b32 v29, 4, v29
    v_mul_u32_u24 v29, 12, v29
    v_sub_u32 v29, v31, v29
    v_mul_u32_u24 v29, 7168, v29
    v_lshl_add_u32 v29, v30, 4, v29
    v_add_u32 v4, s59, v29
    s_cmp_eq_u32 s47, 0
    s_mov_b32 s3, 320
    s_cselect_b32 s3, 0, s3
    s_mov_b32 s31, 34816
    s_cselect_b32 s31, 29696, s31
    v_add_u32 v28, s3, v19
    v_mul_u32_u24 v29, 4682, v28
    v_lshrrev_b32 v29, 16, v29
    v_mul_u32_u24 v30, 14, v29
    v_sub_u32 v30, v28, v30
    v_add_u32 v30, s45, v30
    v_subrev_u32 v31, 14, v30
    v_min_u32 v30, v30, v31
    v_and_b32 v31, 12, v29
    v_add_u32 v31, v31, v29
    v_lshrrev_b32 v29, 4, v29
    v_mul_u32_u24 v29, 12, v29
    v_sub_u32 v29, v31, v29
    v_mul_u32_u24 v29, 7168, v29
    v_lshl_add_u32 v29, v30, 4, v29
    v_add_u32 v5, s59, v29
    s_cmp_eq_u32 s47, 0
    s_mov_b32 s3, 384
    s_cselect_b32 s3, 64, s3
    s_mov_b32 s32, 35840
    s_cselect_b32 s32, 30720, s32
    v_add_u32 v28, s3, v19
    v_mul_u32_u24 v29, 4682, v28
    v_lshrrev_b32 v29, 16, v29
    v_mul_u32_u24 v30, 14, v29
    v_sub_u32 v30, v28, v30
    v_add_u32 v30, s45, v30
    v_subrev_u32 v31, 14, v30
    v_min_u32 v30, v30, v31
    v_and_b32 v31, 12, v29
    v_add_u32 v31, v31, v29
    v_lshrrev_b32 v29, 4, v29
    v_mul_u32_u24 v29, 12, v29
    v_sub_u32 v29, v31, v29
    v_mul_u32_u24 v29, 7168, v29
    v_lshl_add_u32 v29, v30, 4, v29
    v_add_u32 v6, s59, v29
    s_mov_b32 s39, 229376
L_p0_ln:
    s_waitcnt vmcnt(1)
    v_lshlrev_b32 v64, 16, v32
    v_and_b32 v65, 0xffff0000, v32
    v_lshlrev_b32 v66, 16, v33
    v_and_b32 v67, 0xffff0000, v33
    v_lshlrev_b32 v68, 16, v34
    v_and_b32 v69, 0xffff0000, v34
    v_lshlrev_b32 v70, 16, v35
    v_and_b32 v71, 0xffff0000, v35
    v_lshlrev_b32 v72, 16, v36
    v_and_b32 v73, 0xffff0000, v36
    v_lshlrev_b32 v74, 16, v37
    v_and_b32 v75, 0xffff0000, v37
    v_lshlrev_b32 v76, 16, v38
    v_and_b32 v77, 0xffff0000, v38
    v_lshlrev_b32 v78, 16, v39
    v_and_b32 v79, 0xffff0000, v39
    v_lshlrev_b32 v80, 16, v40
    v_and_b32 v81, 0xffff0000, v40
    v_lshlrev_b32 v82, 16, v41
    v_and_b32 v83, 0xffff0000, v41
    v_lshlrev_b32 v84, 16, v42
    v_and_b32 v85, 0xffff0000, v42
    v_lshlrev_b32 v86, 16, v43
    v_and_b32 v87, 0xffff0000, v43
    v_lshlrev_b32 v88, 16, v44
    v_and_b32 v89, 0xffff0000, v44
    v_lshlrev_b32 v90, 16, v45
    v_and_b32 v91, 0xffff0000, v45
    v_lshlrev_b32 v92, 16, v46
    v_and_b32 v93, 0xffff0000, v46
    v_lshlrev_b32 v94, 16, v47
    v_and_b32 v95, 0xffff0000, v47
    v_pk_add_f32 v[48:49], v[64:65], v[66:67]
    v_pk_add_f32 v[50:51], v[68:69], v[70:71]
    v_pk_add_f32 v[48:49], v[48:49], v[72:73]
    v_pk_add_f32 v[50:51], v[50:51], v[74:75]
    v_pk_add_f32 v[48:49], v[48:49], v[76:77]
    v_pk_add_f32 v[50:51], v[50:51], v[78:79]
    v_pk_add_f32 v[48:49], v[48:49], v[80:81]
    v_pk_add_f32 v[50:51], v[50:51], v[82:83]
    v_pk_add_f32 v[48:49], v[48:49], v[84:85]
    v_pk_add_f32 v[50:51], v[50:51], v[86:87]
    v_pk_add_f32 v[48:49], v[48:49], v[88:89]
    v_pk_add_f32 v[50:51], v[50:51], v[90:91]
    v_pk_add_f32 v[48:49], v[48:49], v[92:93]
    v_pk_add_f32 v[50:51], v[50:51], v[94:95]
    v_pk_add_f32 v[48:49], v[48:49], v[50:51]
    v_add_f32 v48, v48, v49
    s_nop 1
    v_add_f32_dpp v52, v48, v48 quad_perm:[1,0,3,2] row_mask:0xf bank_mask:0xf
    s_nop 1
    v_add_f32_dpp v52, v52, v52 quad_perm:[2,3,0,1] row_mask:0xf bank_mask:0xf
    s_nop 1
    v_add_f32_dpp v52, v52, v52 row_ror:8 row_mask:0xf bank_mask:0xf
    v_mov_b32 v53, v52
    s_nop 1
    v_permlane16_swap_b32 v52, v53
    v_add_f32 v52, v52, v53
    v_mov_b32 v53, v52
    s_nop 1
    v_permlane32_swap_b32 v52, v53
    v_add_f32 v52, v52, v53
    v_mul_f32 v54, 0xba800000, v52
    v_pk_add_f32 v[96:97], v[64:65], v[54:55] op_sel_hi:[1,0]
    v_pk_add_f32 v[98:99], v[66:67], v[54:55] op_sel_hi:[1,0]
    v_pk_add_f32 v[100:101], v[68:69], v[54:55] op_sel_hi:[1,0]
    v_pk_add_f32 v[102:103], v[70:71], v[54:55] op_sel_hi:[1,0]
    v_pk_add_f32 v[104:105], v[72:73], v[54:55] op_sel_hi:[1,0]
    v_pk_add_f32 v[106:107], v[74:75], v[54:55] op_sel_hi:[1,0]
    v_pk_add_f32 v[108:109], v[76:77], v[54:55] op_sel_hi:[1,0]
    v_pk_add_f32 v[110:111], v[78:79], v[54:55] op_sel_hi:[1,0]
    v_pk_add_f32 v[112:113], v[80:81], v[54:55] op_sel_hi:[1,0]
    v_pk_add_f32 v[114:115], v[82:83], v[54:55] op_sel_hi:[1,0]
    v_pk_add_f32 v[116:117], v[84:85], v[54:55] op_sel_hi:[1,0]
    v_pk_add_f32 v[118:119], v[86:87], v[54:55] op_sel_hi:[1,0]
    v_pk_add_f32 v[120:121], v[88:89], v[54:55] op_sel_hi:[1,0]
    v_pk_add_f32 v[122:123], v[90:91], v[54:55] op_sel_hi:[1,0]
    v_pk_add_f32 v[124:125], v[92:93], v[54:55] op_sel_hi:[1,0]
    v_pk_add_f32 v[126:127], v[94:95], v[54:55] op_sel_hi:[1,0]
    v_pk_mul_f32 v[48:49], v[96:97], v[96:97]
    v_pk_mul_f32 v[50:51], v[98:99], v[98:99]
    v_pk_fma_f32 v[48:49], v[100:101], v[100:101], v[48:49]
    v_pk_fma_f32 v[50:51], v[102:103], v[102:103], v[50:51]
    v_pk_fma_f32 v[48:49], v[104:105], v[104:105], v[48:49]
    v_pk_fma_f32 v[50:51], v[106:107], v[106:107], v[50:51]
    v_pk_fma_f32 v[48:49], v[108:109], v[108:109], v[48:49]
    v_pk_fma_f32 v[50:51], v[110:111], v[110:111], v[50:51]
    v_pk_fma_f32 v[48:49], v[112:113], v[112:113], v[48:49]
    v_pk_fma_f32 v[50:51], v[114:115], v[114:115], v[50:51]
    v_pk_fma_f32 v[48:49], v[116:117], v[116:117], v[48:49]
    v_pk_fma_f32 v[50:51], v[118:119], v[118:119], v[50:51]
    v_pk_fma_f32 v[48:49], v[120:121], v[120:121], v[48:49]
    v_pk_fma_f32 v[50:51], v[122:123], v[122:123], v[50:51]
    v_pk_fma_f32 v[48:49], v[124:125], v[124:125], v[48:49]
    v_pk_fma_f32 v[50:51], v[126:127], v[126:127], v[50:51]
    v_pk_add_f32 v[48:49], v[48:49], v[50:51]
    v_add_f32 v48, v48, v49
    s_nop 1
    v_add_f32_dpp v52, v48, v48 quad_perm:[1,0,3,2] row_mask:0xf bank_mask:0xf
    s_nop 1
    v_add_f32_dpp v52, v52, v52 quad_perm:[2,3,0,1] row_mask:0xf bank_mask:0xf
    s_nop 1
    v_add_f32_dpp v52, v52, v52 row_ror:8 row_mask:0xf bank_mask:0xf
    v_mov_b32 v53, v52
    s_nop 1
    v_permlane16_swap_b32 v52, v53
    v_add_f32 v52, v52, v53
    v_mov_b32 v53, v52
    s_nop 1
    v_permlane32_swap_b32 v52, v53
    v_add_f32 v52, v52, v53
    v_mul_f32 v55, 0x3a800000, v52
    v_cvt_pk_bf16_f32 v53, v54, v55
    v_lshlrev_b32 v54, 16, v53
    v_and_b32 v56, 0xffff0000, v53
    v_add_f32 v56, 0x3727c5ac, v56
    v_cvt_pk_bf16_f32 v53, v56, v56
    v_lshlrev_b32 v56, 16, v53
    v_sqrt_f32 v56, v56
    s_nop 0
    v_cvt_pk_bf16_f32 v53, v56, v56
    v_lshlrev_b32 v56, 16, v53
    v_rcp_f32 v56, v56
    v_pk_add_f32 v[96:97], v[64:65], v[54:55] op_sel_hi:[1,0]
    v_pk_add_f32 v[98:99], v[66:67], v[54:55] op_sel_hi:[1,0]
    v_pk_add_f32 v[100:101], v[68:69], v[54:55] op_sel_hi:[1,0]
    v_pk_add_f32 v[102:103], v[70:71], v[54:55] op_sel_hi:[1,0]
    v_pk_add_f32 v[104:105], v[72:73], v[54:55] op_sel_hi:[1,0]
    v_pk_add_f32 v[106:107], v[74:75], v[54:55] op_sel_hi:[1,0]
    v_pk_add_f32 v[108:109], v[76:77], v[54:55] op_sel_hi:[1,0]
    v_pk_add_f32 v[110:111], v[78:79], v[54:55] op_sel_hi:[1,0]
    v_pk_add_f32 v[112:113], v[80:81], v[54:55] op_sel_hi:[1,0]
    v_pk_add_f32 v[114:115], v[82:83], v[54:55] op_sel_hi:[1,0]
    v_pk_add_f32 v[116:117], v[84:85], v[54:55] op_sel_hi:[1,0]
    v_pk_add_f32 v[118:119], v[86:87], v[54:55] op_sel_hi:[1,0]
    v_pk_add_f32 v[120:121], v[88:89], v[54:55] op_sel_hi:[1,0]
    v_pk_add_f32 v[122:123], v[90:91], v[54:55] op_sel_hi:[1,0]
    v_pk_add_f32 v[124:125], v[92:93], v[54:55] op_sel_hi:[1,0]
    v_pk_add_f32 v[126:127], v[94:95], v[54:55] op_sel_hi:[1,0]
    v_cvt_pk_bf16_f32 v32, v96, v97
    v_cvt_pk_bf16_f32 v33, v98, v99
    v_cvt_pk_bf16_f32 v34, v100, v101
    v_cvt_pk_bf16_f32 v35, v102, v103
    v_cvt_pk_bf16_f32 v36, v104, v105
    v_cvt_pk_bf16_f32 v37, v106, v107
    v_cvt_pk_bf16_f32 v38, v108, v109
    v_cvt_pk_bf16_f32 v39, v110, v111
    v_cvt_pk_bf16_f32 v40, v112, v113
    v_cvt_pk_bf16_f32 v41, v114, v115
    v_cvt_pk_bf16_f32 v42, v116, v117
    v_cvt_pk_bf16_f32 v43, v118, v119
    v_cvt_pk_bf16_f32 v44, v120, v121
    v_cvt_pk_bf16_f32 v45, v122, v123
    v_cvt_pk_bf16_f32 v46, v124, v125
    v_cvt_pk_bf16_f32 v47, v126, v127
    v_lshlrev_b32 v64, 16, v32
    v_and_b32 v65, 0xffff0000, v32
    v_lshlrev_b32 v66, 16, v33
    v_and_b32 v67, 0xffff0000, v33
    v_lshlrev_b32 v68, 16, v34
    v_and_b32 v69, 0xffff0000, v34
    v_lshlrev_b32 v70, 16, v35
    v_and_b32 v71, 0xffff0000, v35
    v_lshlrev_b32 v72, 16, v36
    v_and_b32 v73, 0xffff0000, v36
    v_lshlrev_b32 v74, 16, v37
    v_and_b32 v75, 0xffff0000, v37
    v_lshlrev_b32 v76, 16, v38
    v_and_b32 v77, 0xffff0000, v38
    v_lshlrev_b32 v78, 16, v39
    v_and_b32 v79, 0xffff0000, v39
    v_lshlrev_b32 v80, 16, v40
    v_and_b32 v81, 0xffff0000, v40
    v_lshlrev_b32 v82, 16, v41
    v_and_b32 v83, 0xffff0000, v41
    v_lshlrev_b32 v84, 16, v42
    v_and_b32 v85, 0xffff0000, v42
    v_lshlrev_b32 v86, 16, v43
    v_and_b32 v87, 0xffff0000, v43
    v_lshlrev_b32 v88, 16, v44
    v_and_b32 v89, 0xffff0000, v44
    v_lshlrev_b32 v90, 16, v45
    v_and_b32 v91, 0xffff0000, v45
    v_lshlrev_b32 v92, 16, v46
    v_and_b32 v93, 0xffff0000, v46
    v_lshlrev_b32 v94, 16, v47
    v_and_b32 v95, 0xffff0000, v47
    v_pk_mul_f32 v[64:65], v[64:65], v[56:57] op_sel_hi:[1,0]
    v_pk_mul_f32 v[66:67], v[66:67], v[56:57] op_sel_hi:[1,0]
    v_pk_mul_f32 v[68:69], v[68:69], v[56:57] op_sel_hi:[1,0]
    v_pk_mul_f32 v[70:71], v[70:71], v[56:57] op_sel_hi:[1,0]
    v_pk_mul_f32 v[72:73], v[72:73], v[56:57] op_sel_hi:[1,0]
    v_pk_mul_f32 v[74:75], v[74:75], v[56:57] op_sel_hi:[1,0]
    v_pk_mul_f32 v[76:77], v[76:77], v[56:57] op_sel_hi:[1,0]
    v_pk_mul_f32 v[78:79], v[78:79], v[56:57] op_sel_hi:[1,0]
    v_pk_mul_f32 v[80:81], v[80:81], v[56:57] op_sel_hi:[1,0]
    v_pk_mul_f32 v[82:83], v[82:83], v[56:57] op_sel_hi:[1,0]
    v_pk_mul_f32 v[84:85], v[84:85], v[56:57] op_sel_hi:[1,0]
    v_pk_mul_f32 v[86:87], v[86:87], v[56:57] op_sel_hi:[1,0]
    v_pk_mul_f32 v[88:89], v[88:89], v[56:57] op_sel_hi:[1,0]
    v_pk_mul_f32 v[90:91], v[90:91], v[56:57] op_sel_hi:[1,0]
    v_pk_mul_f32 v[92:93], v[92:93], v[56:57] op_sel_hi:[1,0]
    v_pk_mul_f32 v[94:95], v[94:95], v[56:57] op_sel_hi:[1,0]
    v_cvt_pk_bf16_f32 v32, v64, v65
    v_cvt_pk_bf16_f32 v33, v66, v67
    v_cvt_pk_bf16_f32 v34, v68, v69
    v_cvt_pk_bf16_f32 v35, v70, v71
    buffer_store_dwordx4 v[32:35], v25, s[4:7], s61 offen sc1
    s_add_u32 s61, s61, 131072
    v_cvt_pk_bf16_f32 v36, v72, v73
    v_cvt_pk_bf16_f32 v37, v74, v75
    v_cvt_pk_bf16_f32 v38, v76, v77
    v_cvt_pk_bf16_f32 v39, v78, v79
    buffer_store_dwordx4 v[36:39], v25, s[4:7], s61 offen sc1
    s_add_u32 s61, s61, 131072
    v_cvt_pk_bf16_f32 v40, v80, v81
    v_cvt_pk_bf16_f32 v41, v82, v83
    v_cvt_pk_bf16_f32 v42, v84, v85
    v_cvt_pk_bf16_f32 v43, v86, v87
    buffer_store_dwordx4 v[40:43], v25, s[4:7], s61 offen sc1
    s_add_u32 s61, s61, 131072
    v_cvt_pk_bf16_f32 v44, v88, v89
    v_cvt_pk_bf16_f32 v45, v90, v91
    v_cvt_pk_bf16_f32 v46, v92, v93
    v_cvt_pk_bf16_f32 v47, v94, v95
    buffer_store_dwordx4 v[44:47], v25, s[4:7], s61 offen sc1
    s_waitcnt lgkmcnt(0)
    s_add_u32 s72, s72, 1
    s_lshl_b32 s64, s57, 14
    s_add_u32 s64, s64, 63176704
    s_lshl_b32 s3, s56, 4
    s_add_u32 s65, s64, s3
    s_mul_i32 s41, s57, 524288
    s_add_u32 s41, s41, s36
    s_mov_b32 s40, s41
    s_mov_b32 s38, 4
    s_and_b32 s37, s56, 3
    s_lshl_b32 s37, s37, 1
    s_add_u32 s37, s37, s57
    s_bitcmp1_b32 s46, 0
    s_cbranch_scc1 L_g1_wc1
L_g1_wc0:
    s_add_u32 m0, s28, 0
    s_nop 0
    buffer_load_dwordx4 v2, s[24:27], s43 offen  lds
    s_add_u32 m0, s29, 0
    s_nop 0
    buffer_load_dwordx4 v3, s[24:27], s43 offen  lds
    s_add_u32 m0, s30, 0
    s_nop 0
    buffer_load_dwordx4 v4, s[24:27], s43 offen  lds
    s_add_u32 s43, s43, s39
    s_add_u32 m0, s31, 0
    s_nop 0
    buffer_load_dwordx4 v5, s[16:19], s44 offen  lds
    s_add_u32 m0, s32, 0
    s_nop 0
    buffer_load_dwordx4 v6, s[16:19], s44 offen  lds
    s_add_u32 s44, s44, 229376
    v_bfe_u32 v20, v19, 2, 1
    v_bfe_u32 v21, v19, 3, 1
    v_xor_b32 v20, v20, v21
    v_lshl_add_u32 v20, v20, 1, v21
    v_lshrrev_b32 v21, 4, v19
    v_xor_b32 v20, v20, v21
    v_and_b32 v21, 15, v19
    v_lshlrev_b32 v21, 6, v21
    v_lshl_add_u32 v20, v20, 4, v21
    s_lshl_b32 s3, s47, 13
    v_add_u32 v7, s3, v20
    v_lshrrev_b32 v20, 2, v19
    v_and_b32 v21, 3, v19
    v_lshlrev_b32 v21, 3, v21
    v_bfe_u32 v22, v19, 4, 1
    v_lshlrev_b32 v22, 5, v22
    v_mul_u32_u24 v23, 192, v20
    v_add_u32 v23, v23, v21
    v_add_u32 v23, 16384, v23
    v_add_u32 v9, v23, v22
    v_sub_u32 v11, v23, v22
    v_mul_u32_u24 v23, 224, v20
    v_add_u32 v23, v23, v21
    v_add_u32 v13, 22528, v23
    v_add_u32 v8, 73728, v7
    v_add_u32 v10, 73728, v9
    v_add_u32 v12, 73728, v11
    v_add_u32 v14, 73728, v13
    v_lshlrev_b32 v22, 2, v19
    v_mov_b32 v32, 0
    v_mov_b32 v33, 0
    v_mov_b32 v34, 0
    v_mov_b32 v35, 0
    v_mov_b32 v36, 0
    v_mov_b32 v37, 0
    v_mov_b32 v38, 0
    v_mov_b32 v39, 0
    v_mov_b32 v40, 0
    v_mov_b32 v41, 0
    v_mov_b32 v42, 0
    v_mov_b32 v43, 0
    v_mov_b32 v44, 0
    v_mov_b32 v45, 0
    v_mov_b32 v46, 0
    v_mov_b32 v47, 0
    v_mov_b32 v48, 0
    v_mov_b32 v49, 0
    v_mov_b32 v50, 0
    v_mov_b32 v51, 0
    v_mov_b32 v52, 0
    v_mov_b32 v53, 0
    v_mov_b32 v54, 0
    v_mov_b32 v55, 0
    v_mov_b32 v56, 0
    v_mov_b32 v57, 0
    v_mov_b32 v58, 0
    v_mov_b32 v59, 0
    v_mov_b32 v60, 0
    v_mov_b32 v61, 0
    v_mov_b32 v62, 0
    v_mov_b32 v63, 0
    v_mov_b32 v64, 0
    v_mov_b32 v65, 0
    v_mov_b32 v66, 0
    v_mov_b32 v67, 0
    v_mov_b32 v68, 0
    v_mov_b32 v69, 0
    v_mov_b32 v70, 0
    v_mov_b32 v71, 0
    v_mov_b32 v72, 0
    v_mov_b32 v73, 0
    v_mov_b32 v74, 0
    v_mov_b32 v75, 0
    v_mov_b32 v76, 0
    v_mov_b32 v77, 0
    v_mov_b32 v78, 0
    v_mov_b32 v79, 0
    v_mov_b32 v80, 0
    v_mov_b32 v81, 0
    v_mov_b32 v82, 0
    v_mov_b32 v83, 0
    v_mov_b32 v84, 0
    v_mov_b32 v85, 0
    v_mov_b32 v86, 0
    v_mov_b32 v87, 0
    v_mov_b32 v88, 0
    v_mov_b32 v89, 0
    v_mov_b32 v90, 0
    v_mov_b32 v91, 0
    v_mov_b32 v92, 0
    v_mov_b32 v93, 0
    v_mov_b32 v94, 0
    v_mov_b32 v95, 0
    s_waitcnt vmcnt(5)
    s_barrier
    s_cmp_lg_u32 s46, 0
    s_cbranch_scc1 L_p1_noflag
    v_mov_b32 v20, s72
    v_mov_b32 v21, 0
    s_mov_b64 exec, 1
    buffer_store_dword v20, v21, s[4:7], s65 offen sc1
    s_mov_b64 exec, -1
L_p1_noflag:
    s_add_u32 m0, s28, 36864
    v_mov_b32 v96, 0
    buffer_load_dwordx4 v2, s[24:27], s43 offen  lds
    v_mov_b32 v97, 0
    v_mov_b32 v98, 0
    v_mov_b32 v99, 0
    v_mov_b32 v100, 0
    v_mov_b32 v101, 0
    v_mov_b32 v102, 0
    v_mov_b32 v103, 0
    v_mov_b32 v104, 0
    v_mov_b32 v105, 0
    v_mov_b32 v106, 0
    v_mov_b32 v107, 0
    v_mov_b32 v108, 0
    v_mov_b32 v109, 0
    v_mov_b32 v110, 0
    v_mov_b32 v111, 0
    v_mov_b32 v112, 0
    s_add_u32 m0, s29, 36864
    v_mov_b32 v113, 0
    buffer_load_dwordx4 v3, s[24:27], s43 offen  lds
    v_mov_b32 v114, 0
    v_mov_b32 v115, 0
    v_mov_b32 v116, 0
    v_mov_b32 v117, 0
    v_mov_b32 v118, 0
    v_mov_b32 v119, 0
    v_mov_b32 v120, 0
    v_mov_b32 v121, 0
    v_mov_b32 v122, 0
    v_mov_b32 v123, 0
    v_mov_b32 v124, 0
    v_mov_b32 v125, 0
    v_mov_b32 v126, 0
    v_mov_b32 v127, 0
    v_mov_b32 v128, 0
    v_mov_b32 v129, 0
    s_add_u32 m0, s30, 36864
    v_mov_b32 v130, 0
    buffer_load_dwordx4 v4, s[24:27], s43 offen  lds
    v_mov_b32 v131, 0
    v_mov_b32 v132, 0
    v_mov_b32 v133, 0
    v_mov_b32 v134, 0
    v_mov_b32 v135, 0
    v_mov_b32 v136, 0
    v_mov_b32 v137, 0
    v_mov_b32 v138, 0
    v_mov_b32 v139, 0
    v_mov_b32 v140, 0
    v_mov_b32 v141, 0
    v_mov_b32 v142, 0
    v_mov_b32 v143, 0
    v_mov_b32 v144, 0
    v_mov_b32 v145, 0
    v_mov_b32 v146, 0
    s_add_u32 s43, s43, s39
    s_add_u32 m0, s31, 36864
    v_mov_b32 v147, 0
    buffer_load_dwordx4 v5, s[16:19], s44 offen  lds
    v_mov_b32 v148, 0
    v_mov_b32 v149, 0
    v_mov_b32 v150, 0
    v_mov_b32 v151, 0
    v_mov_b32 v152, 0
    v_mov_b32 v153, 0
    v_mov_b32 v154, 0
    v_mov_b32 v155, 0
    v_mov_b32 v156, 0
    v_mov_b32 v157, 0
    v_mov_b32 v158, 0
    v_mov_b32 v159, 0
    v_mov_b32 v160, 0
    v_mov_b32 v161, 0
    v_mov_b32 v162, 0
    v_mov_b32 v163, 0
    s_add_u32 m0, s32, 36864
    v_mov_b32 v164, 0
    buffer_load_dwordx4 v6, s[16:19], s44 offen  lds
    v_mov_b32 v165, 0
    v_mov_b32 v166, 0
    v_mov_b32 v167, 0
    v_mov_b32 v168, 0
    v_mov_b32 v169, 0
    v_mov_b32 v170, 0
    v_mov_b32 v171, 0
    v_mov_b32 v172, 0
    v_mov_b32 v173, 0
    v_mov_b32 v174, 0
    v_mov_b32 v175, 0
    v_mov_b32 v176, 0
    v_mov_b32 v177, 0
    v_mov_b32 v178, 0
    v_mov_b32 v179, 0
    v_mov_b32 v180, 0
    s_add_u32 s44, s44, 229376
    s_add_u32 m0, s28, 73728
    v_mov_b32 v181, 0
    buffer_load_dwordx4 v2, s[24:27], s43 offen  lds
    v_mov_b32 v182, 0
    v_mov_b32 v183, 0
    v_mov_b32 v184, 0
    v_mov_b32 v185, 0
    v_mov_b32 v186, 0
    v_mov_b32 v187, 0
    v_mov_b32 v188, 0
    v_mov_b32 v189, 0
    v_mov_b32 v190, 0
    v_mov_b32 v191, 0
    v_mov_b32 v192, 0
    v_mov_b32 v193, 0
    v_mov_b32 v194, 0
    v_mov_b32 v195, 0
    v_mov_b32 v196, 0
    v_mov_b32 v197, 0
    s_add_u32 m0, s29, 73728
    v_mov_b32 v198, 0
    buffer_load_dwordx4 v3, s[24:27], s43 offen  lds
    v_mov_b32 v199, 0
    v_mov_b32 v200, 0
    v_mov_b32 v201, 0
    v_mov_b32 v202, 0
    v_mov_b32 v203, 0
    v_mov_b32 v204, 0
    v_mov_b32 v205, 0
    v_mov_b32 v206, 0
    v_mov_b32 v207, 0
    v_mov_b32 v208, 0
    v_mov_b32 v209, 0
    v_mov_b32 v210, 0
    v_mov_b32 v211, 0
    v_mov_b32 v212, 0
    v_mov_b32 v213, 0
    v_mov_b32 v214, 0
    s_add_u32 m0, s30, 73728
    v_mov_b32 v215, 0
    buffer_load_dwordx4 v4, s[24:27], s43 offen  lds
    v_mov_b32 v216, 0
    v_mov_b32 v217, 0
    v_mov_b32 v218, 0
    v_mov_b32 v219, 0
    v_mov_b32 v220, 0
    v_mov_b32 v221, 0
    v_mov_b32 v222, 0
    v_mov_b32 v223, 0
    v_mov_b32 v224, 0
    v_mov_b32 v225, 0
    v_mov_b32 v226, 0
    v_mov_b32 v227, 0
    v_mov_b32 v228, 0
    v_mov_b32 v229, 0
    v_mov_b32 v230, 0
    v_mov_b32 v231, 0
    s_add_u32 s43, s43, s39
    s_add_u32 m0, s31, 73728
    v_mov_b32 v232, 0
    buffer_load_dwordx4 v5, s[16:19], s44 offen  lds
    v_mov_b32 v233, 0
    v_mov_b32 v234, 0
    v_mov_b32 v235, 0
    v_mov_b32 v236, 0
    v_mov_b32 v237, 0
    v_mov_b32 v238, 0
    v_mov_b32 v239, 0
    v_mov_b32 v240, 0
    v_mov_b32 v241, 0
    v_mov_b32 v242, 0
    v_mov_b32 v243, 0
    v_mov_b32 v244, 0
    v_mov_b32 v245, 0
    v_mov_b32 v246, 0
    v_mov_b32 v247, 0
    v_mov_b32 v248, 0
    s_add_u32 m0, s32, 73728
    v_mov_b32 v249, 0
    buffer_load_dwordx4 v6, s[16:19], s44 offen  lds
    v_mov_b32 v250, 0
    v_mov_b32 v251, 0
    v_mov_b32 v252, 0
    v_mov_b32 v253, 0
    v_mov_b32 v254, 0
    v_mov_b32 v255, 0
    v_accvgpr_write_b32 a0, 0
    v_accvgpr_write_b32 a1, 0
    v_accvgpr_write_b32 a2, 0
    v_accvgpr_write_b32 a3, 0
    v_accvgpr_write_b32 a4, 0
    v_accvgpr_write_b32 a5, 0
    v_accvgpr_write_b32 a6, 0
    v_accvgpr_write_b32 a7, 0
    v_accvgpr_write_b32 a8, 0
    v_accvgpr_write_b32 a9, 0
    s_add_u32 s44, s44, 229376
    s_add_u32 m0, s28, 110592
    v_accvgpr_write_b32 a10, 0
    buffer_load_dwordx4 v2, s[24:27], s43 offen  lds
    v_accvgpr_write_b32 a11, 0
    v_accvgpr_write_b32 a12, 0
    v_accvgpr_write_b32 a13, 0
    v_accvgpr_write_b32 a14, 0
    v_accvgpr_write_b32 a15, 0
    v_accvgpr_write_b32 a16, 0
    v_accvgpr_write_b32 a17, 0
    v_accvgpr_write_b32 a18, 0
    v_accvgpr_write_b32 a19, 0
    v_accvgpr_write_b32 a20, 0
    v_accvgpr_write_b32 a21, 0
    v_accvgpr_write_b32 a22, 0
    v_accvgpr_write_b32 a23, 0
    v_accvgpr_write_b32 a24, 0
    v_accvgpr_write_b32 a25, 0
    v_accvgpr_write_b32 a26, 0
    s_add_u32 m0, s29, 110592
    v_accvgpr_write_b32 a27, 0
    buffer_load_dwordx4 v3, s[24:27], s43 offen  lds
    v_accvgpr_write_b32 a28, 0
    v_accvgpr_write_b32 a29, 0
    v_accvgpr_write_b32 a30, 0
    v_accvgpr_write_b32 a31, 0
    v_accvgpr_write_b32 a32, 0
    v_accvgpr_write_b32 a33, 0
    v_accvgpr_write_b32 a34, 0
    v_accvgpr_write_b32 a35, 0
    v_accvgpr_write_b32 a36, 0
    v_accvgpr_write_b32 a37, 0
    v_accvgpr_write_b32 a38, 0
    v_accvgpr_write_b32 a39, 0
    v_accvgpr_write_b32 a40, 0
    v_accvgpr_write_b32 a41, 0
    v_accvgpr_write_b32 a42, 0
    v_accvgpr_write_b32 a43, 0
    s_add_u32 m0, s30, 110592
    v_accvgpr_write_b32 a44, 0
    buffer_load_dwordx4 v4, s[24:27], s43 offen  lds
    v_accvgpr_write_b32 a45, 0
    v_accvgpr_write_b32 a46, 0
    v_accvgpr_write_b32 a47, 0
    v_accvgpr_write_b32 a48, 0
    v_accvgpr_write_b32 a49, 0
    v_accvgpr_write_b32 a50, 0
    v_accvgpr_write_b32 a51, 0
    v_accvgpr_write_b32 a52, 0
    v_accvgpr_write_b32 a53, 0
    v_accvgpr_write_b32 a54, 0
    v_accvgpr_write_b32 a55, 0
    v_accvgpr_write_b32 a56, 0
    v_accvgpr_write_b32 a57, 0
    v_accvgpr_write_b32 a58, 0
    v_accvgpr_write_b32 a59, 0
    v_accvgpr_write_b32 a60, 0
    s_add_u32 s43, s43, s39
    s_add_u32 m0, s31, 110592
    v_accvgpr_write_b32 a61, 0
    buffer_load_dwordx4 v5, s[16:19], s44 offen  lds
    v_accvgpr_write_b32 a62, 0
    v_accvgpr_write_b32 a63, 0
    v_accvgpr_write_b32 a64, 0
    v_accvgpr_write_b32 a65, 0
    v_accvgpr_write_b32 a66, 0
    v_accvgpr_write_b32 a67, 0
    v_accvgpr_write_b32 a68, 0
    v_accvgpr_write_b32 a69, 0
    v_accvgpr_write_b32 a70, 0
    v_accvgpr_write_b32 a71, 0
    v_accvgpr_write_b32 a72, 0
    v_accvgpr_write_b32 a73, 0
    v_accvgpr_write_b32 a74, 0
    v_accvgpr_write_b32 a75, 0
    v_accvgpr_write_b32 a76, 0
    v_accvgpr_write_b32 a77, 0
    s_add_u32 m0, s32, 110592
    v_accvgpr_write_b32 a78, 0
    buffer_load_dwordx4 v6, s[16:19], s44 offen  lds
    v_accvgpr_write_b32 a79, 0
    v_accvgpr_write_b32 a80, 0
    v_accvgpr_write_b32 a81, 0
    v_accvgpr_write_b32 a82, 0
    v_accvgpr_write_b32 a83, 0
    v_accvgpr_write_b32 a84, 0
    v_accvgpr_write_b32 a85, 0
    v_accvgpr_write_b32 a86, 0
    v_accvgpr_write_b32 a87, 0
    v_accvgpr_write_b32 a88, 0
    v_accvgpr_write_b32 a89, 0
    v_accvgpr_write_b32 a90, 0
    v_accvgpr_write_b32 a91, 0
    v_accvgpr_write_b32 a92, 0
    v_accvgpr_write_b32 a93, 0
    v_accvgpr_write_b32 a94, 0
    s_add_u32 s44, s44, 229376
    v_accvgpr_write_b32 a95, 0
    s_cmp_lg_u32 s46, 0
    s_cbranch_scc1 L_p1_nopoll
    v_and_b32 v20, 127, v22
    v_lshlrev_b32 v20, 2, v20
    s_mov_b32 s73, 0x40000
L_poll2:
    buffer_load_dword v21, v20, s[4:7], s64 offen sc1
    s_waitcnt vmcnt(0)
    v_cmp_ne_u32 vcc, s72, v21
    s_cmp_eq_u64 vcc, 0
    s_cbranch_scc1 L_poll2_done
    s_sub_u32 s73, s73, 1
    s_cbranch_scc1 L_poll2_done
    s_sleep 1
    s_branch L_poll2
L_poll2_done:
L_p1_nopoll:
    s_waitcnt vmcnt(0)
    s_barrier
    s_add_u32 m0, s36, 0
    s_nop 0
    buffer_load_dwordx4 v1, s[4:7], s41 offen offset:0 sc1 lds
    buffer_load_dwordx4 v1, s[4:7], s41 offen offset:1024 sc1 lds
    buffer_load_dwordx4 v1, s[4:7], s41 offen offset:2048 sc1 lds
    buffer_load_dwordx4 v1, s[4:7], s41 offen offset:3072 sc1 lds
    s_add_u32 s41, s41, 16384
    s_add_u32 m0, s36, 36864
    s_nop 0
    buffer_load_dwordx4 v1, s[4:7], s41 offen offset:0 sc1 lds
    buffer_load_dwordx4 v1, s[4:7], s41 offen offset:1024 sc1 lds
    buffer_load_dwordx4 v1, s[4:7], s41 offen offset:2048 sc1 lds
    buffer_load_dwordx4 v1, s[4:7], s41 offen offset:3072 sc1 lds
    s_add_u32 s41, s41, 16384
    ds_read_b64_tr_b16 a[128:129], v9 offset:0
    ds_read_b64_tr_b16 a[130:131], v9 offset:3072
    ds_read_b64_tr_b16 a[200:201], v9 offset:36864
    ds_read_b64_tr_b16 a[202:203], v9 offset:39936
    ds_read_b64_tr_b16 a[132:133], v11 offset:32
    ds_read_b64_tr_b16 a[134:135], v11 offset:3104
    ds_read_b64_tr_b16 a[204:205], v11 offset:36896
    ds_read_b64_tr_b16 a[206:207], v11 offset:39968
    ds_read_b64_tr_b16 a[136:137], v9 offset:128
    ds_read_b64_tr_b16 a[138:139], v9 offset:3200
    ds_read_b64_tr_b16 a[208:209], v9 offset:36992
    ds_read_b64_tr_b16 a[210:211], v9 offset:40064
    ds_read_b64_tr_b16 a[140:141], v11 offset:160
    ds_read_b64_tr_b16 a[142:143], v11 offset:3232
    ds_read_b64_tr_b16 a[212:213], v11 offset:37024
    ds_read_b64_tr_b16 a[214:215], v11 offset:40096
    ds_read_b64_tr_b16 a[144:145], v13 offset:128
    ds_read_b64_tr_b16 a[146:147], v13 offset:3712
    ds_read_b64_tr_b16 a[216:217], v13 offset:36992
    ds_read_b64_tr_b16 a[218:219], v13 offset:40576
    ds_read_b64_tr_b16 a[148:149], v13 offset:7296
    ds_read_b64_tr_b16 a[150:151], v13 offset:10880
    ds_read_b64_tr_b16 a[220:221], v13 offset:44160
    ds_read_b64_tr_b16 a[222:223], v13 offset:47744
    ds_read_b64_tr_b16 a[152:153], v13 offset:160
    ds_read_b64_tr_b16 a[154:155], v13 offset:3744
    ds_read_b64_tr_b16 a[224:225], v13 offset:37024
    ds_read_b64_tr_b16 a[226:227], v13 offset:40608
    s_add_u32 m0, s36, 73728
    s_nop 0
    buffer_load_dwordx4 v1, s[4:7], s41 offen offset:0 sc1 lds
    buffer_load_dwordx4 v1, s[4:7], s41 offen offset:1024 sc1 lds
    buffer_load_dwordx4 v1, s[4:7], s41 offen offset:2048 sc1 lds
    buffer_load_dwordx4 v1, s[4:7], s41 offen offset:3072 sc1 lds
    s_add_u32 s41, s41, 16384
    s_add_u32 m0, s36, 110592
    s_nop 0
    buffer_load_dwordx4 v1, s[4:7], s41 offen offset:0 sc1 lds
    buffer_load_dwordx4 v1, s[4:7], s41 offen offset:1024 sc1 lds
    buffer_load_dwordx4 v1, s[4:7], s41 offen offset:2048 sc1 lds
    buffer_load_dwordx4 v1, s[4:7], s41 offen offset:3072 sc1 lds
    s_add_u32 s41, s41, 16384
    buffer_load_dword v16, v15, s[48:51], s42 offen
    s_add_u32 s42, s42, s62
    s_mov_b32 s60, 7
    s_waitcnt vmcnt(9)
    s_barrier
    ds_read_b128 a[96:99], v7 offset:0
    ds_read_b128 a[168:171], v7 offset:36864
    ds_read_b128 a[100:103], v7 offset:1024
    ds_read_b128 a[172:175], v7 offset:37888
    ds_read_b128 a[104:107], v7 offset:2048
    ds_read_b128 a[176:179], v7 offset:38912
    ds_read_b128 a[108:111], v7 offset:3072
    ds_read_b128 a[180:183], v7 offset:39936
    ds_read_b128 a[112:115], v7 offset:4096
    ds_read_b128 a[184:187], v7 offset:40960
    ds_read_b128 a[116:119], v7 offset:5120
    ds_read_b128 a[188:191], v7 offset:41984
    ds_read_b128 a[120:123], v7 offset:6144
    ds_read_b128 a[192:195], v7 offset:43008
.p2align 6
L_g1_loop0:
    s_waitcnt lgkmcnt(2)
    v_mfma_f32_16x16x32_bf16 a[0:3], a[128:131], a[96:99], a[0:3]
    ds_read_b128 a[124:127], v7 offset:7168
    v_mfma_f32_16x16x32_bf16 a[0:3], a[200:203], a[168:171], a[0:3]
    ds_read_b128 a[196:199], v7 offset:44032
    v_mfma_f32_16x16x32_bf16 a[32:35], a[204:207], a[168:171], a[32:35]
    ds_read_b64_tr_b16 a[156:157], v13 offset:7328
    v_mfma_f32_16x16x32_bf16 a[32:35], a[132:135], a[96:99], a[32:35]
    ds_read_b64_tr_b16 a[158:159], v13 offset:10912
    v_mfma_f32_16x16x32_bf16 a[64:67], a[96:99], a[136:139], a[64:67]
    ds_read_b64_tr_b16 a[228:229], v13 offset:44192
    v_mfma_f32_16x16x32_bf16 a[64:67], a[168:171], a[208:211], a[64:67]
    ds_read_b64_tr_b16 a[230:231], v13 offset:47776
    v_mfma_f32_16x16x32_bf16 a[4:7], a[200:203], a[172:175], a[4:7]
    ds_read_b64_tr_b16 a[160:161], v13 offset:192
    v_mfma_f32_16x16x32_bf16 a[4:7], a[128:131], a[100:103], a[4:7]
    ds_read_b64_tr_b16 a[162:163], v13 offset:3776
    v_mfma_f32_16x16x32_bf16 a[36:39], a[132:135], a[100:103], a[36:39]
    ds_read_b64_tr_b16 a[232:233], v13 offset:37056
    v_mfma_f32_16x16x32_bf16 a[36:39], a[204:207], a[172:175], a[36:39]
    ds_read_b64_tr_b16 a[234:235], v13 offset:40640
    v_mfma_f32_16x16x32_bf16 a[68:71], a[172:175], a[208:211], a[68:71]
    ds_read_b64_tr_b16 a[164:165], v13 offset:7360
    v_mfma_f32_16x16x32_bf16 a[68:71], a[100:103], a[136:139], a[68:71]
    ds_read_b64_tr_b16 a[166:167], v13 offset:10944
    v_mfma_f32_16x16x32_bf16 a[8:11], a[128:131], a[104:107], a[8:11]
    ds_read_b64_tr_b16 a[236:237], v13 offset:44224
    v_mfma_f32_16x16x32_bf16 a[8:11], a[200:203], a[176:179], a[8:11]
    ds_read_b64_tr_b16 a[238:239], v13 offset:47808
    v_mfma_f32_16x16x32_bf16 a[40:43], a[204:207], a[176:179], a[40:43]
    s_cmp_ge_u32 s38, 8
    s_cselect_b32 s3, s37, 0
    v_mfma_f32_16x16x32_bf16 a[40:43], a[132:135], a[104:107], a[40:43]
    s_add_u32 s3, s3, s38
    v_mfma_f32_16x16x32_bf16 a[72:75], a[104:107], a[136:139], a[72:75]
    s_and_b32 s3, s3, 7
    v_mfma_f32_16x16x32_bf16 a[72:75], a[176:179], a[208:211], a[72:75]
    s_and_b32 s33, s38, 24
    v_mfma_f32_16x16x32_bf16 a[12:15], a[200:203], a[180:183], a[12:15]
    s_or_b32 s3, s3, s33
    v_mfma_f32_16x16x32_bf16 a[12:15], a[128:131], a[108:111], a[12:15]
    s_add_u32 s38, s38, 1
    v_mfma_f32_16x16x32_bf16 a[44:47], a[132:135], a[108:111], a[44:47]
    s_mul_i32 s44, s3, 229376
    v_mfma_f32_16x16x32_bf16 a[44:47], a[204:207], a[180:183], a[44:47]
    s_mul_i32 s43, s3, s39
    v_mfma_f32_16x16x32_bf16 a[76:79], a[180:183], a[208:211], a[76:79]
    s_mul_i32 s3, s3, 16384
    v_mfma_f32_16x16x32_bf16 a[76:79], a[108:111], a[136:139], a[76:79]
    s_add_u32 s41, s40, s3
    v_mfma_f32_16x16x32_bf16 a[16:19], a[128:131], a[112:115], a[16:19]
    s_add_u32 m0, s28, 0
    v_mfma_f32_16x16x32_bf16 a[16:19], a[200:203], a[184:187], a[16:19]
    s_waitcnt lgkmcnt(0)
    s_barrier
    v_mfma_f32_16x16x32_bf16 a[48:51], a[204:207], a[184:187], a[48:51]
    buffer_load_dwordx4 v2, s[24:27], s43 offen  lds
    v_mfma_f32_16x16x32_bf16 a[48:51], a[132:135], a[112:115], a[48:51]
    v_mfma_f32_16x16x32_bf16 a[80:83], a[112:115], a[136:139], a[80:83]
    v_mfma_f32_16x16x32_bf16 a[80:83], a[184:187], a[208:211], a[80:83]
    v_mfma_f32_16x16x32_bf16 a[20:23], a[200:203], a[188:191], a[20:23]
    v_mfma_f32_16x16x32_bf16 a[20:23], a[128:131], a[116:119], a[20:23]
    s_add_u32 m0, s29, 0
    v_mfma_f32_16x16x32_bf16 a[52:55], a[132:135], a[116:119], a[52:55]
    buffer_load_dwordx4 v3, s[24:27], s43 offen  lds
    v_mfma_f32_16x16x32_bf16 a[52:55], a[204:207], a[188:191], a[52:55]
    v_mfma_f32_16x16x32_bf16 a[84:87], a[188:191], a[208:211], a[84:87]
    v_mfma_f32_16x16x32_bf16 a[84:87], a[116:119], a[136:139], a[84:87]
    v_mfma_f32_16x16x32_bf16 a[24:27], a[128:131], a[120:123], a[24:27]
    v_mfma_f32_16x16x32_bf16 a[24:27], a[200:203], a[192:195], a[24:27]
    s_add_u32 m0, s30, 0
    v_mfma_f32_16x16x32_bf16 a[56:59], a[204:207], a[192:195], a[56:59]
    buffer_load_dwordx4 v4, s[24:27], s43 offen  lds
    v_mfma_f32_16x16x32_bf16 a[56:59], a[132:135], a[120:123], a[56:59]
    v_mfma_f32_16x16x32_bf16 a[88:91], a[120:123], a[136:139], a[88:91]
    v_mfma_f32_16x16x32_bf16 a[88:91], a[192:195], a[208:211], a[88:91]
    v_mfma_f32_16x16x32_bf16 a[28:31], a[200:203], a[196:199], a[28:31]
    v_mfma_f32_16x16x32_bf16 a[28:31], a[128:131], a[124:127], a[28:31]
    s_add_u32 m0, s31, 0
    v_mfma_f32_16x16x32_bf16 a[60:63], a[132:135], a[124:127], a[60:63]
    buffer_load_dwordx4 v5, s[16:19], s44 offen  lds
    v_mfma_f32_16x16x32_bf16 a[60:63], a[204:207], a[196:199], a[60:63]
    v_mfma_f32_16x16x32_bf16 a[92:95], a[196:199], a[208:211], a[92:95]
    v_mfma_f32_16x16x32_bf16 a[92:95], a[124:127], a[136:139], a[92:95]
    v_mfma_f32_16x16x32_bf16 v[32:35], a[96:99], a[140:143], v[32:35]
    v_mfma_f32_16x16x32_bf16 v[32:35], a[168:171], a[212:215], v[32:35]
    s_add_u32 m0, s32, 0
    v_mfma_f32_16x16x32_bf16 v[36:39], a[172:175], a[212:215], v[36:39]
    buffer_load_dwordx4 v6, s[16:19], s44 offen  lds
    v_mfma_f32_16x16x32_bf16 v[36:39], a[100:103], a[140:143], v[36:39]
    v_mfma_f32_16x16x32_bf16 v[40:43], a[104:107], a[140:143], v[40:43]
    v_mfma_f32_16x16x32_bf16 v[40:43], a[176:179], a[212:215], v[40:43]
    v_mfma_f32_16x16x32_bf16 v[44:47], a[180:183], a[212:215], v[44:47]
    v_mfma_f32_16x16x32_bf16 v[44:47], a[108:111], a[140:143], v[44:47]
    s_add_u32 m0, s36, 0
    v_mfma_f32_16x16x32_bf16 v[48:51], a[112:115], a[140:143], v[48:51]
    buffer_load_dwordx4 v1, s[4:7], s41 offen offset:0 sc1 lds
    v_mfma_f32_16x16x32_bf16 v[48:51], a[184:187], a[212:215], v[48:51]
    v_mfma_f32_16x16x32_bf16 v[52:55], a[188:191], a[212:215], v[52:55]
    v_mfma_f32_16x16x32_bf16 v[52:55], a[116:119], a[140:143], v[52:55]
    v_mfma_f32_16x16x32_bf16 v[56:59], a[120:123], a[140:143], v[56:59]
    v_mfma_f32_16x16x32_bf16 v[56:59], a[192:195], a[212:215], v[56:59]
    v_mfma_f32_16x16x32_bf16 v[60:63], a[196:199], a[212:215], v[60:63]
    buffer_load_dwordx4 v1, s[4:7], s41 offen offset:1024 sc1 lds
    v_mfma_f32_16x16x32_bf16 v[60:63], a[124:127], a[140:143], v[60:63]
    v_mfma_f32_16x16x32_bf16 v[92:95], a[144:147], a[124:127], v[92:95]
    v_mfma_f32_16x16x32_bf16 v[92:95], a[216:219], a[196:199], v[92:95]
    v_mfma_f32_16x16x32_bf16 v[88:91], a[216:219], a[192:195], v[88:91]
    v_mfma_f32_16x16x32_bf16 v[88:91], a[144:147], a[120:123], v[88:91]
    v_mfma_f32_16x16x32_bf16 v[84:87], a[144:147], a[116:119], v[84:87]
    buffer_load_dwordx4 v1, s[4:7], s41 offen offset:2048 sc1 lds
    v_mfma_f32_16x16x32_bf16 v[84:87], a[216:219], a[188:191], v[84:87]
    v_mfma_f32_16x16x32_bf16 v[80:83], a[216:219], a[184:187], v[80:83]
    v_mfma_f32_16x16x32_bf16 v[80:83], a[144:147], a[112:115], v[80:83]
    v_mfma_f32_16x16x32_bf16 v[76:79], a[144:147], a[108:111], v[76:79]
    v_mfma_f32_16x16x32_bf16 v[76:79], a[216:219], a[180:183], v[76:79]
    v_mfma_f32_16x16x32_bf16 v[72:75], a[216:219], a[176:179], v[72:75]
    buffer_load_dwordx4 v1, s[4:7], s41 offen offset:3072 sc1 lds
    v_mfma_f32_16x16x32_bf16 v[72:75], a[144:147], a[104:107], v[72:75]
    s_cmp_ge_u32 s38, 8
    s_cselect_b32 s3, s37, 0
    s_add_u32 s3, s3, s38
    v_mfma_f32_16x16x32_bf16 v[68:71], a[144:147], a[100:103], v[68:71]
    s_and_b32 s3, s3, 7
    s_and_b32 s33, s38, 24
    v_mfma_f32_16x16x32_bf16 v[68:71], a[216:219], a[172:175], v[68:71]
    s_or_b32 s3, s3, s33
    v_mfma_f32_16x16x32_bf16 v[64:67], a[216:219], a[168:171], v[64:67]
    s_add_u32 s38, s38, 1
    s_mul_i32 s44, s3, 229376
    v_mfma_f32_16x16x32_bf16 v[64:67], a[144:147], a[96:99], v[64:67]
    s_waitcnt vmcnt(10)
    s_barrier
    v_mfma_f32_16x16x32_bf16 v[96:99], a[148:151], a[96:99], v[96:99]
    s_mul_i32 s43, s3, s39
    ds_read_b64_tr_b16 a[128:129], v10 offset:0
    v_mfma_f32_16x16x32_bf16 v[96:99], a[220:223], a[168:171], v[96:99]
    s_mul_i32 s3, s3, 16384
    s_add_u32 s41, s40, s3
    ds_read_b64_tr_b16 a[130:131], v10 offset:3072
    v_mfma_f32_16x16x32_bf16 v[100:103], a[220:223], a[172:175], v[100:103]
    s_add_u32 m0, s28, 36864
    ds_read_b64_tr_b16 a[200:201], v10 offset:36864
    v_mfma_f32_16x16x32_bf16 v[100:103], a[148:151], a[100:103], v[100:103]
    buffer_load_dwordx4 v2, s[24:27], s43 offen  lds
    v_mfma_f32_16x16x32_bf16 v[104:107], a[148:151], a[104:107], v[104:107]
    ds_read_b64_tr_b16 a[202:203], v10 offset:39936
    v_mfma_f32_16x16x32_bf16 v[104:107], a[220:223], a[176:179], v[104:107]
    ds_read_b64_tr_b16 a[132:133], v12 offset:32
    v_mfma_f32_16x16x32_bf16 v[108:111], a[220:223], a[180:183], v[108:111]
    s_add_u32 m0, s29, 36864
    ds_read_b64_tr_b16 a[134:135], v12 offset:3104
    v_mfma_f32_16x16x32_bf16 v[108:111], a[148:151], a[108:111], v[108:111]
    buffer_load_dwordx4 v3, s[24:27], s43 offen  lds
    v_mfma_f32_16x16x32_bf16 v[112:115], a[148:151], a[112:115], v[112:115]
    ds_read_b64_tr_b16 a[204:205], v12 offset:36896
    v_mfma_f32_16x16x32_bf16 v[112:115], a[220:223], a[184:187], v[112:115]
    ds_read_b64_tr_b16 a[206:207], v12 offset:39968
    v_mfma_f32_16x16x32_bf16 v[116:119], a[220:223], a[188:191], v[116:119]
    ds_read_b64_tr_b16 a[136:137], v10 offset:128
    v_mfma_f32_16x16x32_bf16 v[116:119], a[148:151], a[116:119], v[116:119]
    v_mfma_f32_16x16x32_bf16 v[120:123], a[148:151], a[120:123], v[120:123]
    ds_read_b64_tr_b16 a[138:139], v10 offset:3200
    v_mfma_f32_16x16x32_bf16 v[120:123], a[220:223], a[192:195], v[120:123]
    ds_read_b64_tr_b16 a[208:209], v10 offset:36992
    v_mfma_f32_16x16x32_bf16 v[124:127], a[220:223], a[196:199], v[124:127]
    s_add_u32 m0, s30, 36864
    ds_read_b64_tr_b16 a[210:211], v10 offset:40064
    v_mfma_f32_16x16x32_bf16 v[124:127], a[148:151], a[124:127], v[124:127]
    buffer_load_dwordx4 v4, s[24:27], s43 offen  lds
    v_mfma_f32_16x16x32_bf16 v[156:159], a[152:155], a[124:127], v[156:159]
    ds_read_b64_tr_b16 a[140:141], v12 offset:160
    v_mfma_f32_16x16x32_bf16 v[156:159], a[224:227], a[196:199], v[156:159]
    ds_read_b64_tr_b16 a[142:143], v12 offset:3232
    v_mfma_f32_16x16x32_bf16 v[152:155], a[224:227], a[192:195], v[152:155]
    s_add_u32 m0, s31, 36864
    ds_read_b64_tr_b16 a[212:213], v12 offset:37024
    v_mfma_f32_16x16x32_bf16 v[152:155], a[152:155], a[120:123], v[152:155]
    buffer_load_dwordx4 v5, s[16:19], s44 offen  lds
    v_mfma_f32_16x16x32_bf16 v[148:151], a[152:155], a[116:119], v[148:151]
    ds_read_b64_tr_b16 a[214:215], v12 offset:40096
    v_mfma_f32_16x16x32_bf16 v[148:151], a[224:227], a[188:191], v[148:151]
    ds_read_b64_tr_b16 a[144:145], v14 offset:128
    v_mfma_f32_16x16x32_bf16 v[144:147], a[224:227], a[184:187], v[144:147]
    ds_read_b64_tr_b16 a[146:147], v14 offset:3712
    v_mfma_f32_16x16x32_bf16 v[144:147], a[152:155], a[112:115], v[144:147]
    v_mfma_f32_16x16x32_bf16 v[140:143], a[152:155], a[108:111], v[140:143]
    ds_read_b64_tr_b16 a[216:217], v14 offset:36992
    v_mfma_f32_16x16x32_bf16 v[140:143], a[224:227], a[180:183], v[140:143]
    ds_read_b64_tr_b16 a[218:219], v14 offset:40576
    v_mfma_f32_16x16x32_bf16 v[136:139], a[224:227], a[176:179], v[136:139]
    s_add_u32 m0, s32, 36864
    ds_read_b64_tr_b16 a[148:149], v14 offset:7296
    v_mfma_f32_16x16x32_bf16 v[136:139], a[152:155], a[104:107], v[136:139]
    buffer_load_dwordx4 v6, s[16:19], s44 offen  lds
    v_mfma_f32_16x16x32_bf16 v[132:135], a[152:155], a[100:103], v[132:135]
    ds_read_b64_tr_b16 a[150:151], v14 offset:10880
    v_mfma_f32_16x16x32_bf16 v[132:135], a[224:227], a[172:175], v[132:135]
    ds_read_b64_tr_b16 a[220:221], v14 offset:44160
    v_mfma_f32_16x16x32_bf16 v[128:131], a[224:227], a[168:171], v[128:131]
    s_add_u32 m0, s36, 36864
    ds_read_b64_tr_b16 a[222:223], v14 offset:47744
    v_mfma_f32_16x16x32_bf16 v[128:131], a[152:155], a[96:99], v[128:131]
    buffer_load_dwordx4 v1, s[4:7], s41 offen offset:0 sc1 lds
    v_mfma_f32_16x16x32_bf16 v[160:163], a[156:159], a[96:99], v[160:163]
    ds_read_b64_tr_b16 a[152:153], v14 offset:160
    v_mfma_f32_16x16x32_bf16 v[160:163], a[228:231], a[168:171], v[160:163]
    ds_read_b64_tr_b16 a[154:155], v14 offset:3744
    v_mfma_f32_16x16x32_bf16 v[192:195], a[232:235], a[168:171], v[192:195]
    ds_read_b64_tr_b16 a[224:225], v14 offset:37024
    v_mfma_f32_16x16x32_bf16 v[192:195], a[160:163], a[96:99], v[192:195]
    ds_read_b64_tr_b16 a[226:227], v14 offset:40608
    v_mfma_f32_16x16x32_bf16 v[224:227], a[164:167], a[96:99], v[224:227]
    buffer_load_dwordx4 v1, s[4:7], s41 offen offset:1024 sc1 lds
    v_mfma_f32_16x16x32_bf16 v[224:227], a[236:239], a[168:171], v[224:227]
    ds_read_b128 a[96:99], v8 offset:0
    v_mfma_f32_16x16x32_bf16 v[164:167], a[228:231], a[172:175], v[164:167]
    ds_read_b128 a[168:171], v8 offset:36864
    v_mfma_f32_16x16x32_bf16 v[164:167], a[156:159], a[100:103], v[164:167]
    v_mfma_f32_16x16x32_bf16 v[196:199], a[160:163], a[100:103], v[196:199]
    v_mfma_f32_16x16x32_bf16 v[196:199], a[232:235], a[172:175], v[196:199]
    v_mfma_f32_16x16x32_bf16 v[228:231], a[236:239], a[172:175], v[228:231]
    buffer_load_dwordx4 v1, s[4:7], s41 offen offset:2048 sc1 lds
    v_mfma_f32_16x16x32_bf16 v[228:231], a[164:167], a[100:103], v[228:231]
    ds_read_b128 a[100:103], v8 offset:1024
    v_mfma_f32_16x16x32_bf16 v[168:171], a[156:159], a[104:107], v[168:171]
    ds_read_b128 a[172:175], v8 offset:37888
    v_mfma_f32_16x16x32_bf16 v[168:171], a[228:231], a[176:179], v[168:171]
    v_mfma_f32_16x16x32_bf16 v[200:203], a[232:235], a[176:179], v[200:203]
    v_mfma_f32_16x16x32_bf16 v[200:203], a[160:163], a[104:107], v[200:203]
    v_mfma_f32_16x16x32_bf16 v[232:235], a[164:167], a[104:107], v[232:235]
    buffer_load_dwordx4 v1, s[4:7], s41 offen offset:3072 sc1 lds
    v_mfma_f32_16x16x32_bf16 v[232:235], a[236:239], a[176:179], v[232:235]
    ds_read_b128 a[104:107], v8 offset:2048
    v_mfma_f32_16x16x32_bf16 v[172:175], a[228:231], a[180:183], v[172:175]
    ds_read_b128 a[176:179], v8 offset:38912
    v_mfma_f32_16x16x32_bf16 v[172:175], a[156:159], a[108:111], v[172:175]
    v_mfma_f32_16x16x32_bf16 v[204:207], a[160:163], a[108:111], v[204:207]
    v_mfma_f32_16x16x32_bf16 v[204:207], a[232:235], a[180:183], v[204:207]
    v_mfma_f32_16x16x32_bf16 v[236:239], a[236:239], a[180:183], v[236:239]
    buffer_load_dword v16, v15, s[48:51], s42 offen
    v_mfma_f32_16x16x32_bf16 v[236:239], a[164:167], a[108:111], v[236:239]
    s_add_u32 s42, s42, s62
    ds_read_b128 a[108:111], v8 offset:3072
    v_mfma_f32_16x16x32_bf16 v[176:179], a[156:159], a[112:115], v[176:179]
    ds_read_b128 a[180:183], v8 offset:39936
    v_mfma_f32_16x16x32_bf16 v[176:179], a[228:231], a[184:187], v[176:179]
    v_mfma_f32_16x16x32_bf16 v[208:211], a[232:235], a[184:187], v[208:211]
    v_mfma_f32_16x16x32_bf16 v[208:211], a[160:163], a[112:115], v[208:211]
    v_mfma_f32_16x16x32_bf16 v[240:243], a[164:167], a[112:115], v[240:243]
    v_mfma_f32_16x16x32_bf16 v[240:243], a[236:239], a[184:187], v[240:243]
    ds_read_b128 a[112:115], v8 offset:4096
    v_mfma_f32_16x16x32_bf16 v[180:183], a[228:231], a[188:191], v[180:183]
    ds_read_b128 a[184:187], v8 offset:40960
    v_mfma_f32_16x16x32_bf16 v[180:183], a[156:159], a[116:119], v[180:183]
    v_mfma_f32_16x16x32_bf16 v[212:215], a[160:163], a[116:119], v[212:215]
    v_mfma_f32_16x16x32_bf16 v[212:215], a[232:235], a[188:191], v[212:215]
    v_mfma_f32_16x16x32_bf16 v[244:247], a[236:239], a[188:191], v[244:247]
    v_mfma_f32_16x16x32_bf16 v[244:247], a[164:167], a[116:119], v[244:247]
    ds_read_b128 a[116:119], v8 offset:5120
    v_mfma_f32_16x16x32_bf16 v[184:187], a[156:159], a[120:123], v[184:187]
    ds_read_b128 a[188:191], v8 offset:41984
    v_mfma_f32_16x16x32_bf16 v[184:187], a[228:231], a[192:195], v[184:187]
    v_mfma_f32_16x16x32_bf16 v[216:219], a[232:235], a[192:195], v[216:219]
    v_mfma_f32_16x16x32_bf16 v[216:219], a[160:163], a[120:123], v[216:219]
    v_mfma_f32_16x16x32_bf16 v[248:251], a[164:167], a[120:123], v[248:251]
    v_mfma_f32_16x16x32_bf16 v[248:251], a[236:239], a[192:195], v[248:251]
    ds_read_b128 a[120:123], v8 offset:6144
    v_mfma_f32_16x16x32_bf16 v[188:191], a[228:231], a[196:199], v[188:191]
    ds_read_b128 a[192:195], v8 offset:43008
    v_mfma_f32_16x16x32_bf16 v[188:191], a[156:159], a[124:127], v[188:191]
    v_mfma_f32_16x16x32_bf16 v[220:223], a[160:163], a[124:127], v[220:223]
    v_mfma_f32_16x16x32_bf16 v[220:223], a[232:235], a[196:199], v[220:223]
    v_mfma_f32_16x16x32_bf16 v[252:255], a[236:239], a[196:199], v[252:255]
    v_mfma_f32_16x16x32_bf16 v[252:255], a[164:167], a[124:127], v[252:255]
    s_waitcnt lgkmcnt(2)
    v_mfma_f32_16x16x32_bf16 a[0:3], a[128:131], a[96:99], a[0:3]
    ds_read_b128 a[124:127], v8 offset:7168
    v_mfma_f32_16x16x32_bf16 a[0:3], a[200:203], a[168:171], a[0:3]
    ds_read_b128 a[196:199], v8 offset:44032
    v_mfma_f32_16x16x32_bf16 a[32:35], a[204:207], a[168:171], a[32:35]
    ds_read_b64_tr_b16 a[156:157], v14 offset:7328
    v_mfma_f32_16x16x32_bf16 a[32:35], a[132:135], a[96:99], a[32:35]
    ds_read_b64_tr_b16 a[158:159], v14 offset:10912
    v_mfma_f32_16x16x32_bf16 a[64:67], a[96:99], a[136:139], a[64:67]
    ds_read_b64_tr_b16 a[228:229], v14 offset:44192
    v_mfma_f32_16x16x32_bf16 a[64:67], a[168:171], a[208:211], a[64:67]
    ds_read_b64_tr_b16 a[230:231], v14 offset:47776
    v_mfma_f32_16x16x32_bf16 a[4:7], a[200:203], a[172:175], a[4:7]
    ds_read_b64_tr_b16 a[160:161], v14 offset:192
    v_mfma_f32_16x16x32_bf16 a[4:7], a[128:131], a[100:103], a[4:7]
    ds_read_b64_tr_b16 a[162:163], v14 offset:3776
    v_mfma_f32_16x16x32_bf16 a[36:39], a[132:135], a[100:103], a[36:39]
    ds_read_b64_tr_b16 a[232:233], v14 offset:37056
    v_mfma_f32_16x16x32_bf16 a[36:39], a[204:207], a[172:175], a[36:39]
    ds_read_b64_tr_b16 a[234:235], v14 offset:40640
    v_mfma_f32_16x16x32_bf16 a[68:71], a[172:175], a[208:211], a[68:71]
    ds_read_b64_tr_b16 a[164:165], v14 offset:7360
    v_mfma_f32_16x16x32_bf16 a[68:71], a[100:103], a[136:139], a[68:71]
    ds_read_b64_tr_b16 a[166:167], v14 offset:10944
    v_mfma_f32_16x16x32_bf16 a[8:11], a[128:131], a[104:107], a[8:11]
    ds_read_b64_tr_b16 a[236:237], v14 offset:44224
    v_mfma_f32_16x16x32_bf16 a[8:11], a[200:203], a[176:179], a[8:11]
    ds_read_b64_tr_b16 a[238:239], v14 offset:47808
    v_mfma_f32_16x16x32_bf16 a[40:43], a[204:207], a[176:179], a[40:43]
    s_cmp_ge_u32 s38, 8
    s_cselect_b32 s3, s37, 0
    v_mfma_f32_16x16x32_bf16 a[40:43], a[132:135], a[104:107], a[40:43]
    s_add_u32 s3, s3, s38
    v_mfma_f32_16x16x32_bf16 a[72:75], a[104:107], a[136:139], a[72:75]
    s_and_b32 s3, s3, 7
    v_mfma_f32_16x16x32_bf16 a[72:75], a[176:179], a[208:211], a[72:75]
    s_and_b32 s33, s38, 24
    v_mfma_f32_16x16x32_bf16 a[12:15], a[200:203], a[180:183], a[12:15]
    s_or_b32 s3, s3, s33
    v_mfma_f32_16x16x32_bf16 a[12:15], a[128:131], a[108:111], a[12:15]
    s_add_u32 s38, s38, 1
    v_mfma_f32_16x16x32_bf16 a[44:47], a[132:135], a[108:111], a[44:47]
    s_mul_i32 s44, s3, 229376
    v_mfma_f32_16x16x32_bf16 a[44:47], a[204:207], a[180:183], a[44:47]
    s_mul_i32 s43, s3, s39
    v_mfma_f32_16x16x32_bf16 a[76:79], a[180:183], a[208:211], a[76:79]
    s_mul_i32 s3, s3, 16384
    v_mfma_f32_16x16x32_bf16 a[76:79], a[108:111], a[136:139], a[76:79]
    s_add_u32 s41, s40, s3
    v_mfma_f32_16x16x32_bf16 a[16:19], a[128:131], a[112:115], a[16:19]
    s_add_u32 m0, s28, 73728
    v_mfma_f32_16x16x32_bf16 a[16:19], a[200:203], a[184:187], a[16:19]
    s_waitcnt lgkmcnt(0)
    s_barrier
    v_mfma_f32_16x16x32_bf16 a[48:51], a[204:207], a[184:187], a[48:51]
    buffer_load_dwordx4 v2, s[24:27], s43 offen  lds
    v_mfma_f32_16x16x32_bf16 a[48:51], a[132:135], a[112:115], a[48:51]
    v_mfma_f32_16x16x32_bf16 a[80:83], a[112:115], a[136:139], a[80:83]
    v_mfma_f32_16x16x32_bf16 a[80:83], a[184:187], a[208:211], a[80:83]
    v_mfma_f32_16x16x32_bf16 a[20:23], a[200:203], a[188:191], a[20:23]
    v_mfma_f32_16x16x32_bf16 a[20:23], a[128:131], a[116:119], a[20:23]
    s_add_u32 m0, s29, 73728
    v_mfma_f32_16x16x32_bf16 a[52:55], a[132:135], a[116:119], a[52:55]
    buffer_load_dwordx4 v3, s[24:27], s43 offen  lds
    v_mfma_f32_16x16x32_bf16 a[52:55], a[204:207], a[188:191], a[52:55]
    v_mfma_f32_16x16x32_bf16 a[84:87], a[188:191], a[208:211], a[84:87]
    v_mfma_f32_16x16x32_bf16 a[84:87], a[116:119], a[136:139], a[84:87]
    v_mfma_f32_16x16x32_bf16 a[24:27], a[128:131], a[120:123], a[24:27]
    v_mfma_f32_16x16x32_bf16 a[24:27], a[200:203], a[192:195], a[24:27]
    s_add_u32 m0, s30, 73728
    v_mfma_f32_16x16x32_bf16 a[56:59], a[204:207], a[192:195], a[56:59]
    buffer_load_dwordx4 v4, s[24:27], s43 offen  lds
    v_mfma_f32_16x16x32_bf16 a[56:59], a[132:135], a[120:123], a[56:59]
    v_mfma_f32_16x16x32_bf16 a[88:91], a[120:123], a[136:139], a[88:91]
    v_mfma_f32_16x16x32_bf16 a[88:91], a[192:195], a[208:211], a[88:91]
    v_mfma_f32_16x16x32_bf16 a[28:31], a[200:203], a[196:199], a[28:31]
    v_mfma_f32_16x16x32_bf16 a[28:31], a[128:131], a[124:127], a[28:31]
    s_add_u32 m0, s31, 73728
    v_mfma_f32_16x16x32_bf16 a[60:63], a[132:135], a[124:127], a[60:63]
    buffer_load_dwordx4 v5, s[16:19], s44 offen  lds
    v_mfma_f32_16x16x32_bf16 a[60:63], a[204:207], a[196:199], a[60:63]
    v_mfma_f32_16x16x32_bf16 a[92:95], a[196:199], a[208:211], a[92:95]
    v_mfma_f32_16x16x32_bf16 a[92:95], a[124:127], a[136:139], a[92:95]
    v_mfma_f32_16x16x32_bf16 v[32:35], a[96:99], a[140:143], v[32:35]
    v_mfma_f32_16x16x32_bf16 v[32:35], a[168:171], a[212:215], v[32:35]
    s_add_u32 m0, s32, 73728
    v_mfma_f32_16x16x32_bf16 v[36:39], a[172:175], a[212:215], v[36:39]
    buffer_load_dwordx4 v6, s[16:19], s44 offen  lds
    v_mfma_f32_16x16x32_bf16 v[36:39], a[100:103], a[140:143], v[36:39]
    v_mfma_f32_16x16x32_bf16 v[40:43], a[104:107], a[140:143], v[40:43]
    v_mfma_f32_16x16x32_bf16 v[40:43], a[176:179], a[212:215], v[40:43]
    v_mfma_f32_16x16x32_bf16 v[44:47], a[180:183], a[212:215], v[44:47]
    v_mfma_f32_16x16x32_bf16 v[44:47], a[108:111], a[140:143], v[44:47]
    s_add_u32 m0, s36, 73728
    v_mfma_f32_16x16x32_bf16 v[48:51], a[112:115], a[140:143], v[48:51]
    buffer_load_dwordx4 v1, s[4:7], s41 offen offset:0 sc1 lds
    v_mfma_f32_16x16x32_bf16 v[48:51], a[184:187], a[212:215], v[48:51]
    v_mfma_f32_16x16x32_bf16 v[52:55], a[188:191], a[212:215], v[52:55]
    v_mfma_f32_16x16x32_bf16 v[52:55], a[116:119], a[140:143], v[52:55]
    v_mfma_f32_16x16x32_bf16 v[56:59], a[120:123], a[140:143], v[56:59]
    v_mfma_f32_16x16x32_bf16 v[56:59], a[192:195], a[212:215], v[56:59]
    v_mfma_f32_16x16x32_bf16 v[60:63], a[196:199], a[212:215], v[60:63]
    buffer_load_dwordx4 v1, s[4:7], s41 offen offset:1024 sc1 lds
    v_mfma_f32_16x16x32_bf16 v[60:63], a[124:127], a[140:143], v[60:63]
    v_mfma_f32_16x16x32_bf16 v[92:95], a[144:147], a[124:127], v[92:95]
    v_mfma_f32_16x16x32_bf16 v[92:95], a[216:219], a[196:199], v[92:95]
    v_mfma_f32_16x16x32_bf16 v[88:91], a[216:219], a[192:195], v[88:91]
    v_mfma_f32_16x16x32_bf16 v[88:91], a[144:147], a[120:123], v[88:91]
    v_mfma_f32_16x16x32_bf16 v[84:87], a[144:147], a[116:119], v[84:87]
    buffer_load_dwordx4 v1, s[4:7], s41 offen offset:2048 sc1 lds
    v_mfma_f32_16x16x32_bf16 v[84:87], a[216:219], a[188:191], v[84:87]
    v_mfma_f32_16x16x32_bf16 v[80:83], a[216:219], a[184:187], v[80:83]
    v_mfma_f32_16x16x32_bf16 v[80:83], a[144:147], a[112:115], v[80:83]
    v_mfma_f32_16x16x32_bf16 v[76:79], a[144:147], a[108:111], v[76:79]
    v_mfma_f32_16x16x32_bf16 v[76:79], a[216:219], a[180:183], v[76:79]
    v_mfma_f32_16x16x32_bf16 v[72:75], a[216:219], a[176:179], v[72:75]
    buffer_load_dwordx4 v1, s[4:7], s41 offen offset:3072 sc1 lds
    v_mfma_f32_16x16x32_bf16 v[72:75], a[144:147], a[104:107], v[72:75]
    s_cmp_ge_u32 s38, 8
    s_cselect_b32 s3, s37, 0
    s_add_u32 s3, s3, s38
    v_mfma_f32_16x16x32_bf16 v[68:71], a[144:147], a[100:103], v[68:71]
    s_and_b32 s3, s3, 7
    s_and_b32 s33, s38, 24
    v_mfma_f32_16x16x32_bf16 v[68:71], a[216:219], a[172:175], v[68:71]
    s_or_b32 s3, s3, s33
    v_mfma_f32_16x16x32_bf16 v[64:67], a[216:219], a[168:171], v[64:67]
    s_add_u32 s38, s38, 1
    s_mul_i32 s44, s3, 229376
    v_mfma_f32_16x16x32_bf16 v[64:67], a[144:147], a[96:99], v[64:67]
    s_waitcnt vmcnt(10)
    s_barrier
    v_mfma_f32_16x16x32_bf16 v[96:99], a[148:151], a[96:99], v[96:99]
    s_mul_i32 s43, s3, s39
    ds_read_b64_tr_b16 a[128:129], v9 offset:0
    v_mfma_f32_16x16x32_bf16 v[96:99], a[220:223], a[168:171], v[96:99]
    s_mul_i32 s3, s3, 16384
    s_add_u32 s41, s40, s3
    ds_read_b64_tr_b16 a[130:131], v9 offset:3072
    v_mfma_f32_16x16x32_bf16 v[100:103], a[220:223], a[172:175], v[100:103]
    s_add_u32 m0, s28, 110592
    ds_read_b64_tr_b16 a[200:201], v9 offset:36864
    v_mfma_f32_16x16x32_bf16 v[100:103], a[148:151], a[100:103], v[100:103]
    buffer_load_dwordx4 v2, s[24:27], s43 offen  lds
    v_mfma_f32_16x16x32_bf16 v[104:107], a[148:151], a[104:107], v[104:107]
    ds_read_b64_tr_b16 a[202:203], v9 offset:39936
    v_mfma_f32_16x16x32_bf16 v[104:107], a[220:223], a[176:179], v[104:107]
    ds_read_b64_tr_b16 a[132:133], v11 offset:32
    v_mfma_f32_16x16x32_bf16 v[108:111], a[220:223], a[180:183], v[108:111]
    s_add_u32 m0, s29, 110592
    ds_read_b64_tr_b16 a[134:135], v11 offset:3104
    v_mfma_f32_16x16x32_bf16 v[108:111], a[148:151], a[108:111], v[108:111]
    buffer_load_dwordx4 v3, s[24:27], s43 offen  lds
    v_mfma_f32_16x16x32_bf16 v[112:115], a[148:151], a[112:115], v[112:115]
    ds_read_b64_tr_b16 a[204:205], v11 offset:36896
    v_mfma_f32_16x16x32_bf16 v[112:115], a[220:223], a[184:187], v[112:115]
    ds_read_b64_tr_b16 a[206:207], v11 offset:39968
    v_mfma_f32_16x16x32_bf16 v[116:119], a[220:223], a[188:191], v[116:119]
    ds_read_b64_tr_b16 a[136:137], v9 offset:128
    v_mfma_f32_16x16x32_bf16 v[116:119], a[148:151], a[116:119], v[116:119]
    v_mfma_f32_16x16x32_bf16 v[120:123], a[148:151], a[120:123], v[120:123]
    ds_read_b64_tr_b16 a[138:139], v9 offset:3200
    v_mfma_f32_16x16x32_bf16 v[120:123], a[220:223], a[192:195], v[120:123]
    ds_read_b64_tr_b16 a[208:209], v9 offset:36992
    v_mfma_f32_16x16x32_bf16 v[124:127], a[220:223], a[196:199], v[124:127]
    s_add_u32 m0, s30, 110592
    ds_read_b64_tr_b16 a[210:211], v9 offset:40064
    v_mfma_f32_16x16x32_bf16 v[124:127], a[148:151], a[124:127], v[124:127]
    buffer_load_dwordx4 v4, s[24:27], s43 offen  lds
    v_mfma_f32_16x16x32_bf16 v[156:159], a[152:155], a[124:127], v[156:159]
    ds_read_b64_tr_b16 a[140:141], v11 offset:160
    v_mfma_f32_16x16x32_bf16 v[156:159], a[224:227], a[196:199], v[156:159]
    ds_read_b64_tr_b16 a[142:143], v11 offset:3232
    v_mfma_f32_16x16x32_bf16 v[152:155], a[224:227], a[192:195], v[152:155]
    s_add_u32 m0, s31, 110592
    ds_read_b64_tr_b16 a[212:213], v11 offset:37024
    v_mfma_f32_16x16x32_bf16 v[152:155], a[152:155], a[120:123], v[152:155]
    buffer_load_dwordx4 v5, s[16:19], s44 offen  lds
    v_mfma_f32_16x16x32_bf16 v[148:151], a[152:155], a[116:119], v[148:151]
    ds_read_b64_tr_b16 a[214:215], v11 offset:40096
    v_mfma_f32_16x16x32_bf16 v[148:151], a[224:227], a[188:191], v[148:151]
    ds_read_b64_tr_b16 a[144:145], v13 offset:128
    v_mfma_f32_16x16x32_bf16 v[144:147], a[224:227], a[184:187], v[144:147]
    ds_read_b64_tr_b16 a[146:147], v13 offset:3712
    v_mfma_f32_16x16x32_bf16 v[144:147], a[152:155], a[112:115], v[144:147]
    v_mfma_f32_16x16x32_bf16 v[140:143], a[152:155], a[108:111], v[140:143]
    ds_read_b64_tr_b16 a[216:217], v13 offset:36992
    v_mfma_f32_16x16x32_bf16 v[140:143], a[224:227], a[180:183], v[140:143]
    ds_read_b64_tr_b16 a[218:219], v13 offset:40576
    v_mfma_f32_16x16x32_bf16 v[136:139], a[224:227], a[176:179], v[136:139]
    s_add_u32 m0, s32, 110592
    ds_read_b64_tr_b16 a[148:149], v13 offset:7296
    v_mfma_f32_16x16x32_bf16 v[136:139], a[152:155], a[104:107], v[136:139]
    buffer_load_dwordx4 v6, s[16:19], s44 offen  lds
    v_mfma_f32_16x16x32_bf16 v[132:135], a[152:155], a[100:103], v[132:135]
    ds_read_b64_tr_b16 a[150:151], v13 offset:10880
    v_mfma_f32_16x16x32_bf16 v[132:135], a[224:227], a[172:175], v[132:135]
    ds_read_b64_tr_b16 a[220:221], v13 offset:44160
    v_mfma_f32_16x16x32_bf16 v[128:131], a[224:227], a[168:171], v[128:131]
    s_add_u32 m0, s36, 110592
    ds_read_b64_tr_b16 a[222:223], v13 offset:47744
    v_mfma_f32_16x16x32_bf16 v[128:131], a[152:155], a[96:99], v[128:131]
    buffer_load_dwordx4 v1, s[4:7], s41 offen offset:0 sc1 lds
    v_mfma_f32_16x16x32_bf16 v[160:163], a[156:159], a[96:99], v[160:163]
    ds_read_b64_tr_b16 a[152:153], v13 offset:160
    v_mfma_f32_16x16x32_bf16 v[160:163], a[228:231], a[168:171], v[160:163]
    ds_read_b64_tr_b16 a[154:155], v13 offset:3744
    v_mfma_f32_16x16x32_bf16 v[192:195], a[232:235], a[168:171], v[192:195]
    ds_read_b64_tr_b16 a[224:225], v13 offset:37024
    v_mfma_f32_16x16x32_bf16 v[192:195], a[160:163], a[96:99], v[192:195]
    ds_read_b64_tr_b16 a[226:227], v13 offset:40608
    v_mfma_f32_16x16x32_bf16 v[224:227], a[164:167], a[96:99], v[224:227]
    buffer_load_dwordx4 v1, s[4:7], s41 offen offset:1024 sc1 lds
    v_mfma_f32_16x16x32_bf16 v[224:227], a[236:239], a[168:171], v[224:227]
    ds_read_b128 a[96:99], v7 offset:0
    v_mfma_f32_16x16x32_bf16 v[164:167], a[228:231], a[172:175], v[164:167]
    ds_read_b128 a[168:171], v7 offset:36864
    v_mfma_f32_16x16x32_bf16 v[164:167], a[156:159], a[100:103], v[164:167]
    v_mfma_f32_16x16x32_bf16 v[196:199], a[160:163], a[100:103], v[196:199]
    v_mfma_f32_16x16x32_bf16 v[196:199], a[232:235], a[172:175], v[196:199]
    v_mfma_f32_16x16x32_bf16 v[228:231], a[236:239], a[172:175], v[228:231]
    buffer_load_dwordx4 v1, s[4:7], s41 offen offset:2048 sc1 lds
    v_mfma_f32_16x16x32_bf16 v[228:231], a[164:167], a[100:103], v[228:231]
    ds_read_b128 a[100:103], v7 offset:1024
    v_mfma_f32_16x16x32_bf16 v[168:171], a[156:159], a[104:107], v[168:171]
    ds_read_b128 a[172:175], v7 offset:37888
    v_mfma_f32_16x16x32_bf16 v[168:171], a[228:231], a[176:179], v[168:171]
    v_mfma_f32_16x16x32_bf16 v[200:203], a[232:235], a[176:179], v[200:203]
    v_mfma_f32_16x16x32_bf16 v[200:203], a[160:163], a[104:107], v[200:203]
    v_mfma_f32_16x16x32_bf16 v[232:235], a[164:167], a[104:107], v[232:235]
    buffer_load_dwordx4 v1, s[4:7], s41 offen offset:3072 sc1 lds
    v_mfma_f32_16x16x32_bf16 v[232:235], a[236:239], a[176:179], v[232:235]
    ds_read_b128 a[104:107], v7 offset:2048
    v_mfma_f32_16x16x32_bf16 v[172:175], a[228:231], a[180:183], v[172:175]
    ds_read_b128 a[176:179], v7 offset:38912
    v_mfma_f32_16x16x32_bf16 v[172:175], a[156:159], a[108:111], v[172:175]
    v_mfma_f32_16x16x32_bf16 v[204:207], a[160:163], a[108:111], v[204:207]
    v_mfma_f32_16x16x32_bf16 v[204:207], a[232:235], a[180:183], v[204:207]
    v_mfma_f32_16x16x32_bf16 v[236:239], a[236:239], a[180:183], v[236:239]
    buffer_load_dword v16, v15, s[48:51], s42 offen
    v_mfma_f32_16x16x32_bf16 v[236:239], a[164:167], a[108:111], v[236:239]
    s_add_u32 s42, s42, s62
    ds_read_b128 a[108:111], v7 offset:3072
    v_mfma_f32_16x16x32_bf16 v[176:179], a[156:159], a[112:115], v[176:179]
    s_sub_u32 s60, s60, 1
    ds_read_b128 a[180:183], v7 offset:39936
    v_mfma_f32_16x16x32_bf16 v[176:179], a[228:231], a[184:187], v[176:179]
    s_cmp_lg_u32 s60, 0
    v_mfma_f32_16x16x32_bf16 v[208:211], a[232:235], a[184:187], v[208:211]
    v_mfma_f32_16x16x32_bf16 v[208:211], a[160:163], a[112:115], v[208:211]
    v_mfma_f32_16x16x32_bf16 v[240:243], a[164:167], a[112:115], v[240:243]
    v_mfma_f32_16x16x32_bf16 v[240:243], a[236:239], a[184:187], v[240:243]
    ds_read_b128 a[112:115], v7 offset:4096
    v_mfma_f32_16x16x32_bf16 v[180:183], a[228:231], a[188:191], v[180:183]
    ds_read_b128 a[184:187], v7 offset:40960
    v_mfma_f32_16x16x32_bf16 v[180:183], a[156:159], a[116:119], v[180:183]
    v_mfma_f32_16x16x32_bf16 v[212:215], a[160:163], a[116:119], v[212:215]
    v_mfma_f32_16x16x32_bf16 v[212:215], a[232:235], a[188:191], v[212:215]
    v_mfma_f32_16x16x32_bf16 v[244:247], a[236:239], a[188:191], v[244:247]
    v_mfma_f32_16x16x32_bf16 v[244:247], a[164:167], a[116:119], v[244:247]
    ds_read_b128 a[116:119], v7 offset:5120
    v_mfma_f32_16x16x32_bf16 v[184:187], a[156:159], a[120:123], v[184:187]
    ds_read_b128 a[188:191], v7 offset:41984
    v_mfma_f32_16x16x32_bf16 v[184:187], a[228:231], a[192:195], v[184:187]
    v_mfma_f32_16x16x32_bf16 v[216:219], a[232:235], a[192:195], v[216:219]
    v_mfma_f32_16x16x32_bf16 v[216:219], a[160:163], a[120:123], v[216:219]
    v_mfma_f32_16x16x32_bf16 v[248:251], a[164:167], a[120:123], v[248:251]
    v_mfma_f32_16x16x32_bf16 v[248:251], a[236:239], a[192:195], v[248:251]
    ds_read_b128 a[120:123], v7 offset:6144
    v_mfma_f32_16x16x32_bf16 v[188:191], a[228:231], a[196:199], v[188:191]
    ds_read_b128 a[192:195], v7 offset:43008
    v_mfma_f32_16x16x32_bf16 v[188:191], a[156:159], a[124:127], v[188:191]
    v_mfma_f32_16x16x32_bf16 v[220:223], a[160:163], a[124:127], v[220:223]
    v_mfma_f32_16x16x32_bf16 v[220:223], a[232:235], a[196:199], v[220:223]
    v_mfma_f32_16x16x32_bf16 v[252:255], a[236:239], a[196:199], v[252:255]
    v_mfma_f32_16x16x32_bf16 v[252:255], a[164:167], a[124:127], v[252:255]
    s_cbranch_scc1 L_g1_loop0
    s_waitcnt lgkmcnt(2)
    v_mfma_f32_16x16x32_bf16 a[0:3], a[128:131], a[96:99], a[0:3]
    ds_read_b128 a[124:127], v7 offset:7168
    v_mfma_f32_16x16x32_bf16 a[0:3], a[200:203], a[168:171], a[0:3]
    ds_read_b128 a[196:199], v7 offset:44032
    v_mfma_f32_16x16x32_bf16 a[32:35], a[204:207], a[168:171], a[32:35]
    ds_read_b64_tr_b16 a[156:157], v13 offset:7328
    v_mfma_f32_16x16x32_bf16 a[32:35], a[132:135], a[96:99], a[32:35]
    ds_read_b64_tr_b16 a[158:159], v13 offset:10912
    v_mfma_f32_16x16x32_bf16 a[64:67], a[96:99], a[136:139], a[64:67]
    ds_read_b64_tr_b16 a[228:229], v13 offset:44192
    v_mfma_f32_16x16x32_bf16 a[64:67], a[168:171], a[208:211], a[64:67]
    ds_read_b64_tr_b16 a[230:231], v13 offset:47776
    v_mfma_f32_16x16x32_bf16 a[4:7], a[200:203], a[172:175], a[4:7]
    ds_read_b64_tr_b16 a[160:161], v13 offset:192
    v_mfma_f32_16x16x32_bf16 a[4:7], a[128:131], a[100:103], a[4:7]
    ds_read_b64_tr_b16 a[162:163], v13 offset:3776
    v_mfma_f32_16x16x32_bf16 a[36:39], a[132:135], a[100:103], a[36:39]
    ds_read_b64_tr_b16 a[232:233], v13 offset:37056
    v_mfma_f32_16x16x32_bf16 a[36:39], a[204:207], a[172:175], a[36:39]
    ds_read_b64_tr_b16 a[234:235], v13 offset:40640
    v_mfma_f32_16x16x32_bf16 a[68:71], a[172:175], a[208:211], a[68:71]
    ds_read_b64_tr_b16 a[164:165], v13 offset:7360
    v_mfma_f32_16x16x32_bf16 a[68:71], a[100:103], a[136:139], a[68:71]
    ds_read_b64_tr_b16 a[166:167], v13 offset:10944
    v_mfma_f32_16x16x32_bf16 a[8:11], a[128:131], a[104:107], a[8:11]
    ds_read_b64_tr_b16 a[236:237], v13 offset:44224
    v_mfma_f32_16x16x32_bf16 a[8:11], a[200:203], a[176:179], a[8:11]
    ds_read_b64_tr_b16 a[238:239], v13 offset:47808
    v_mfma_f32_16x16x32_bf16 a[40:43], a[204:207], a[176:179], a[40:43]
    s_getpc_b64 s[34:35]
L_pc3:
    v_mfma_f32_16x16x32_bf16 a[40:43], a[132:135], a[104:107], a[40:43]
    s_add_u32 s34, s34, L_p2-L_pc3
    s_addc_u32 s35, s35, 0
    v_mfma_f32_16x16x32_bf16 a[72:75], a[104:107], a[136:139], a[72:75]
    v_mfma_f32_16x16x32_bf16 a[72:75], a[176:179], a[208:211], a[72:75]
    s_lshr_b32 s3, s2, 3
    v_mfma_f32_16x16x32_bf16 a[12:15], a[200:203], a[180:183], a[12:15]
    v_mfma_f32_16x16x32_bf16 a[12:15], a[128:131], a[108:111], a[12:15]
    s_lshl_b32 s3, s3, 2
    v_mfma_f32_16x16x32_bf16 a[44:47], a[132:135], a[108:111], a[44:47]
    s_add_u32 s3, s3, s46
    v_mfma_f32_16x16x32_bf16 a[44:47], a[204:207], a[180:183], a[44:47]
    v_mfma_f32_16x16x32_bf16 a[76:79], a[180:183], a[208:211], a[76:79]
    s_mul_i32 s3, s3, 512
    v_mfma_f32_16x16x32_bf16 a[76:79], a[108:111], a[136:139], a[76:79]
    v_mfma_f32_16x16x32_bf16 a[16:19], a[128:131], a[112:115], a[16:19]
    v_lshlrev_b32 v20, 3, v1
    v_mfma_f32_16x16x32_bf16 a[16:19], a[200:203], a[184:187], a[16:19]
    s_waitcnt lgkmcnt(0)
    v_mfma_f32_16x16x32_bf16 a[48:51], a[204:207], a[184:187], a[48:51]
    v_and_b32 v20, 511, v20
    v_mfma_f32_16x16x32_bf16 a[48:51], a[132:135], a[112:115], a[48:51]
    v_mfma_f32_16x16x32_bf16 a[80:83], a[112:115], a[136:139], a[80:83]
    v_add_u32 v20, s3, v20
    v_mfma_f32_16x16x32_bf16 a[80:83], a[184:187], a[208:211], a[80:83]
    v_mfma_f32_16x16x32_bf16 a[20:23], a[200:203], a[188:191], a[20:23]
    v_min_u32 v20, L_at_after-L_p2, v20
    v_mfma_f32_16x16x32_bf16 a[20:23], a[128:131], a[116:119], a[20:23]
    v_mfma_f32_16x16x32_bf16 a[52:55], a[132:135], a[116:119], a[52:55]
    global_load_dword v21, v20, s[34:35]
    v_mfma_f32_16x16x32_bf16 a[52:55], a[204:207], a[188:191], a[52:55]
    s_lshl_b32 s61, s57, 4
    v_mfma_f32_16x16x32_bf16 a[84:87], a[188:191], a[208:211], a[84:87]
    v_mfma_f32_16x16x32_bf16 a[84:87], a[116:119], a[136:139], a[84:87]
    s_lshl_b32 s3, s47, 3
    v_mfma_f32_16x16x32_bf16 a[24:27], a[128:131], a[120:123], a[24:27]
    v_mfma_f32_16x16x32_bf16 a[24:27], a[200:203], a[192:195], a[24:27]
    s_add_u32 s61, s61, s3
    v_mfma_f32_16x16x32_bf16 a[56:59], a[204:207], a[192:195], a[56:59]
    s_lshl_b32 s62, s56, 7
    v_mfma_f32_16x16x32_bf16 a[56:59], a[132:135], a[120:123], a[56:59]
    v_mfma_f32_16x16x32_bf16 a[88:91], a[120:123], a[136:139], a[88:91]
    s_add_u32 s62, s62, s61
    v_mfma_f32_16x16x32_bf16 a[88:91], a[192:195], a[208:211], a[88:91]
    v_mfma_f32_16x16x32_bf16 a[28:31], a[200:203], a[196:199], a[28:31]
    s_lshl_b32 s64, s62, 11
    v_mfma_f32_16x16x32_bf16 a[28:31], a[128:131], a[124:127], a[28:31]
    v_mfma_f32_16x16x32_bf16 a[60:63], a[132:135], a[124:127], a[60:63]
    s_add_u32 s64, s64, 8388608
    v_mfma_f32_16x16x32_bf16 a[60:63], a[204:207], a[196:199], a[60:63]
    s_lshr_b32 s65, s61, 3
    v_mfma_f32_16x16x32_bf16 a[92:95], a[196:199], a[208:211], a[92:95]
    v_mfma_f32_16x16x32_bf16 a[92:95], a[124:127], a[136:139], a[92:95]
    s_mul_i32 s65, s65, 112
    v_mfma_f32_16x16x32_bf16 v[32:35], a[96:99], a[140:143], v[32:35]
    v_mfma_f32_16x16x32_bf16 v[32:35], a[168:171], a[212:215], v[32:35]
    s_mul_i32 s3, s56, 7
    v_mfma_f32_16x16x32_bf16 v[36:39], a[172:175], a[212:215], v[36:39]
    s_add_u32 s3, s3, 1
    v_mfma_f32_16x16x32_bf16 v[36:39], a[100:103], a[140:143], v[36:39]
    v_mfma_f32_16x16x32_bf16 v[40:43], a[104:107], a[140:143], v[40:43]
    s_lshr_b32 s3, s3, 1
    v_mfma_f32_16x16x32_bf16 v[40:43], a[176:179], a[212:215], v[40:43]
    v_mfma_f32_16x16x32_bf16 v[44:47], a[180:183], a[212:215], v[44:47]
    s_add_u32 s65, s65, s3
    v_mfma_f32_16x16x32_bf16 v[44:47], a[108:111], a[140:143], v[44:47]
    v_mfma_f32_16x16x32_bf16 v[48:51], a[112:115], a[140:143], v[48:51]
    s_lshl_b32 s65, s65, 13
    v_mfma_f32_16x16x32_bf16 v[48:51], a[184:187], a[212:215], v[48:51]
    s_add_u32 s65, s65, 16777216
    v_mfma_f32_16x16x32_bf16 v[52:55], a[188:191], a[212:215], v[52:55]
    v_mfma_f32_16x16x32_bf16 v[52:55], a[116:119], a[140:143], v[52:55]
    s_add_u32 s70, s65, 16384
    v_mfma_f32_16x16x32_bf16 v[56:59], a[120:123], a[140:143], v[56:59]
    v_mfma_f32_16x16x32_bf16 v[56:59], a[192:195], a[212:215], v[56:59]
    s_add_u32 s71, s65, 24576
    v_mfma_f32_16x16x32_bf16 v[60:63], a[196:199], a[212:215], v[60:63]
    s_sub_u32 s3, s65, 8184
    v_mfma_f32_16x16x32_bf16 v[60:63], a[124:127], a[140:143], v[60:63]
    v_mfma_f32_16x16x32_bf16 v[92:95], a[144:147], a[124:127], v[92:95]
    s_cmp_eq_u32 s45, 0
    v_mfma_f32_16x16x32_bf16 v[92:95], a[216:219], a[196:199], v[92:95]
    v_mfma_f32_16x16x32_bf16 v[88:91], a[216:219], a[192:195], v[88:91]
    s_cselect_b32 s55, s71, s3
    v_mfma_f32_16x16x32_bf16 v[88:91], a[144:147], a[120:123], v[88:91]
    s_mov_b32 s71, 0x20000000
    v_mfma_f32_16x16x32_bf16 v[84:87], a[144:147], a[116:119], v[84:87]
    v_mfma_f32_16x16x32_bf16 v[84:87], a[216:219], a[188:191], v[84:87]
    s_mov_b32 s66, 0xbfb8aa3b
    v_mfma_f32_16x16x32_bf16 v[80:83], a[216:219], a[184:187], v[80:83]
    v_mfma_f32_16x16x32_bf16 v[80:83], a[144:147], a[112:115], v[80:83]
    s_mov_b32 s67, 0xbfb8aa3b
    v_mfma_f32_16x16x32_bf16 v[76:79], a[144:147], a[108:111], v[76:79]
    v_mfma_f32_16x16x32_bf16 v[76:79], a[216:219], a[180:183], v[76:79]
    s_mov_b32 s68, 0x3e8293ee
    v_mfma_f32_16x16x32_bf16 v[72:75], a[216:219], a[176:179], v[72:75]
    s_mov_b32 s69, 0x3e8293ee
    v_mfma_f32_16x16x32_bf16 v[72:75], a[144:147], a[104:107], v[72:75]
    v_mfma_f32_16x16x32_bf16 v[68:71], a[144:147], a[100:103], v[68:71]
    s_lshl_b32 s3, s47, 14
    v_mfma_f32_16x16x32_bf16 v[68:71], a[216:219], a[172:175], v[68:71]
    v_mfma_f32_16x16x32_bf16 v[64:67], a[216:219], a[168:171], v[64:67]
    v_add_u32 v22, s3, v1
    v_mfma_f32_16x16x32_bf16 v[64:67], a[144:147], a[96:99], v[64:67]
    s_waitcnt vmcnt(1)
    s_barrier
    v_mfma_f32_16x16x32_bf16 v[96:99], a[148:151], a[96:99], v[96:99]
    ds_read_b64_tr_b16 a[128:129], v10 offset:0
    v_mfma_f32_16x16x32_bf16 v[96:99], a[220:223], a[168:171], v[96:99]
    ds_read_b64_tr_b16 a[130:131], v10 offset:3072
    v_mfma_f32_16x16x32_bf16 v[100:103], a[220:223], a[172:175], v[100:103]
    ds_read_b64_tr_b16 a[200:201], v10 offset:36864
    v_mfma_f32_16x16x32_bf16 v[100:103], a[148:151], a[100:103], v[100:103]
    s_lshl_b32 s3, s47, 13
    v_mfma_f32_16x16x32_bf16 v[104:107], a[148:151], a[104:107], v[104:107]
    ds_read_b64_tr_b16 a[202:203], v10 offset:39936
    v_mfma_f32_16x16x32_bf16 v[104:107], a[220:223], a[176:179], v[104:107]
    ds_read_b64_tr_b16 a[132:133], v12 offset:32
    v_mfma_f32_16x16x32_bf16 v[108:111], a[220:223], a[180:183], v[108:111]
    ds_read_b64_tr_b16 a[134:135], v12 offset:3104
    v_mfma_f32_16x16x32_bf16 v[108:111], a[148:151], a[108:111], v[108:111]
    v_mfma_f32_16x16x32_bf16 v[112:115], a[148:151], a[112:115], v[112:115]
    ds_read_b64_tr_b16 a[204:205], v12 offset:36896
    v_mfma_f32_16x16x32_bf16 v[112:115], a[220:223], a[184:187], v[112:115]
    ds_read_b64_tr_b16 a[206:207], v12 offset:39968
    v_mfma_f32_16x16x32_bf16 v[116:119], a[220:223], a[188:191], v[116:119]
    ds_read_b64_tr_b16 a[136:137], v10 offset:128
    v_mfma_f32_16x16x32_bf16 v[116:119], a[148:151], a[116:119], v[116:119]
    v_add_u32 v23, s3, v1
    v_mfma_f32_16x16x32_bf16 v[120:123], a[148:151], a[120:123], v[120:123]
    ds_read_b64_tr_b16 a[138:139], v10 offset:3200
    v_mfma_f32_16x16x32_bf16 v[120:123], a[220:223], a[192:195], v[120:123]
    ds_read_b64_tr_b16 a[208:209], v10 offset:36992
    v_mfma_f32_16x16x32_bf16 v[124:127], a[220:223], a[196:199], v[124:127]
    ds_read_b64_tr_b16 a[210:211], v10 offset:40064
    v_mfma_f32_16x16x32_bf16 v[124:127], a[148:151], a[124:127], v[124:127]
    v_mfma_f32_16x16x32_bf16 v[156:159], a[152:155], a[124:127], v[156:159]
    ds_read_b64_tr_b16 a[140:141], v12 offset:160
    v_mfma_f32_16x16x32_bf16 v[156:159], a[224:227], a[196:199], v[156:159]
    ds_read_b64_tr_b16 a[142:143], v12 offset:3232
    v_mfma_f32_16x16x32_bf16 v[152:155], a[224:227], a[192:195], v[152:155]
    ds_read_b64_tr_b16 a[212:213], v12 offset:37024
    v_mfma_f32_16x16x32_bf16 v[152:155], a[152:155], a[120:123], v[152:155]
    s_mov_b32 s12, s76
    v_mfma_f32_16x16x32_bf16 v[148:151], a[152:155], a[116:119], v[148:151]
    ds_read_b64_tr_b16 a[214:215], v12 offset:40096
    v_mfma_f32_16x16x32_bf16 v[148:151], a[224:227], a[188:191], v[148:151]
    ds_read_b64_tr_b16 a[144:145], v14 offset:128
    v_mfma_f32_16x16x32_bf16 v[144:147], a[224:227], a[184:187], v[144:147]
    ds_read_b64_tr_b16 a[146:147], v14 offset:3712
    v_mfma_f32_16x16x32_bf16 v[144:147], a[152:155], a[112:115], v[144:147]
    v_mfma_f32_16x16x32_bf16 v[140:143], a[152:155], a[108:111], v[140:143]
    ds_read_b64_tr_b16 a[216:217], v14 offset:36992
    v_mfma_f32_16x16x32_bf16 v[140:143], a[224:227], a[180:183], v[140:143]
    ds_read_b64_tr_b16 a[218:219], v14 offset:40576
    v_mfma_f32_16x16x32_bf16 v[136:139], a[224:227], a[176:179], v[136:139]
    ds_read_b64_tr_b16 a[148:149], v14 offset:7296
    v_mfma_f32_16x16x32_bf16 v[136:139], a[152:155], a[104:107], v[136:139]
    s_mov_b32 s13, s77
    v_mfma_f32_16x16x32_bf16 v[132:135], a[152:155], a[100:103], v[132:135]
    ds_read_b64_tr_b16 a[150:151], v14 offset:10880
    v_mfma_f32_16x16x32_bf16 v[132:135], a[224:227], a[172:175], v[132:135]
    ds_read_b64_tr_b16 a[220:221], v14 offset:44160
    v_mfma_f32_16x16x32_bf16 v[128:131], a[224:227], a[168:171], v[128:131]
    ds_read_b64_tr_b16 a[222:223], v14 offset:47744
    v_mfma_f32_16x16x32_bf16 v[128:131], a[152:155], a[96:99], v[128:131]
    s_mov_b32 s14, 2097152
    v_mfma_f32_16x16x32_bf16 v[160:163], a[156:159], a[96:99], v[160:163]
    ds_read_b64_tr_b16 a[152:153], v14 offset:160
    v_mfma_f32_16x16x32_bf16 v[160:163], a[228:231], a[168:171], v[160:163]
    ds_read_b64_tr_b16 a[154:155], v14 offset:3744
    v_mfma_f32_16x16x32_bf16 v[192:195], a[232:235], a[168:171], v[192:195]
    ds_read_b64_tr_b16 a[224:225], v14 offset:37024
    v_mfma_f32_16x16x32_bf16 v[192:195], a[160:163], a[96:99], v[192:195]
    ds_read_b64_tr_b16 a[226:227], v14 offset:40608
    v_mfma_f32_16x16x32_bf16 v[224:227], a[164:167], a[96:99], v[224:227]
    v_mfma_f32_16x16x32_bf16 v[224:227], a[236:239], a[168:171], v[224:227]
    ds_read_b128 a[96:99], v8 offset:0
    v_mfma_f32_16x16x32_bf16 v[164:167], a[228:231], a[172:175], v[164:167]
    ds_read_b128 a[168:171], v8 offset:36864
    v_mfma_f32_16x16x32_bf16 v[164:167], a[156:159], a[100:103], v[164:167]
    s_mov_b32 s15, 0x00020000
    v_mfma_f32_16x16x32_bf16 v[196:199], a[160:163], a[100:103], v[196:199]
    v_mfma_f32_16x16x32_bf16 v[196:199], a[232:235], a[172:175], v[196:199]
    s_mov_b32 s8, s74
    v_mfma_f32_16x16x32_bf16 v[228:231], a[236:239], a[172:175], v[228:231]
    s_mov_b32 s9, s75
    v_mfma_f32_16x16x32_bf16 v[228:231], a[164:167], a[100:103], v[228:231]
    ds_read_b128 a[100:103], v8 offset:1024
    v_mfma_f32_16x16x32_bf16 v[168:171], a[156:159], a[104:107], v[168:171]
    ds_read_b128 a[172:175], v8 offset:37888
    v_mfma_f32_16x16x32_bf16 v[168:171], a[228:231], a[176:179], v[168:171]
    v_mfma_f32_16x16x32_bf16 v[200:203], a[232:235], a[176:179], v[200:203]
    s_mov_b32 s10, 7340032
    v_mfma_f32_16x16x32_bf16 v[200:203], a[160:163], a[104:107], v[200:203]
    v_mfma_f32_16x16x32_bf16 v[232:235], a[164:167], a[104:107], v[232:235]
    s_mov_b32 s11, 0x00020000
    v_mfma_f32_16x16x32_bf16 v[232:235], a[236:239], a[176:179], v[232:235]
    ds_read_b128 a[104:107], v8 offset:2048
    v_mfma_f32_16x16x32_bf16 v[172:175], a[228:231], a[180:183], v[172:175]
    ds_read_b128 a[176:179], v8 offset:38912
    v_mfma_f32_16x16x32_bf16 v[172:175], a[156:159], a[108:111], v[172:175]
    v_mfma_f32_16x16x32_bf16 v[204:207], a[160:163], a[108:111], v[204:207]
    s_lshl_b32 s34, s2, 2
    v_mfma_f32_16x16x32_bf16 v[204:207], a[232:235], a[180:183], v[204:207]
    s_add_u32 s34, s34, s46
    v_mfma_f32_16x16x32_bf16 v[236:239], a[236:239], a[180:183], v[236:239]
    v_mfma_f32_16x16x32_bf16 v[236:239], a[164:167], a[108:111], v[236:239]
    ds_read_b128 a[108:111], v8 offset:3072
    v_mfma_f32_16x16x32_bf16 v[176:179], a[156:159], a[112:115], v[176:179]
    ds_read_b128 a[180:183], v8 offset:39936
    v_mfma_f32_16x16x32_bf16 v[176:179], a[228:231], a[184:187], v[176:179]
    s_mul_i32 s35, s34, 7168
    v_mfma_f32_16x16x32_bf16 v[208:211], a[232:235], a[184:187], v[208:211]
    v_mfma_f32_16x16x32_bf16 v[208:211], a[160:163], a[112:115], v[208:211]
    s_lshl_b32 s34, s34, 11
    v_mfma_f32_16x16x32_bf16 v[240:243], a[164:167], a[112:115], v[240:243]
    v_lshlrev_b32 v24, 3, v1
    v_mfma_f32_16x16x32_bf16 v[240:243], a[236:239], a[184:187], v[240:243]
    ds_read_b128 a[112:115], v8 offset:4096
    v_mfma_f32_16x16x32_bf16 v[180:183], a[228:231], a[188:191], v[180:183]
    ds_read_b128 a[184:187], v8 offset:40960
    v_mfma_f32_16x16x32_bf16 v[180:183], a[156:159], a[116:119], v[180:183]
    v_mfma_f32_16x16x32_bf16 v[212:215], a[160:163], a[116:119], v[212:215]
    v_and_b32 v25, 2047, v24
    v_mfma_f32_16x16x32_bf16 v[212:215], a[232:235], a[188:191], v[212:215]
    v_mfma_f32_16x16x32_bf16 v[244:247], a[236:239], a[188:191], v[244:247]
    buffer_load_dword v31, v25, s[12:15], s34 offen
    v_mfma_f32_16x16x32_bf16 v[244:247], a[164:167], a[116:119], v[244:247]
    ds_read_b128 a[116:119], v8 offset:5120
    v_mfma_f32_16x16x32_bf16 v[184:187], a[156:159], a[120:123], v[184:187]
    ds_read_b128 a[188:191], v8 offset:41984
    v_mfma_f32_16x16x32_bf16 v[184:187], a[228:231], a[192:195], v[184:187]
    v_mfma_f32_16x16x32_bf16 v[216:219], a[232:235], a[192:195], v[216:219]
    v_mfma_f32_16x16x32_bf16 v[216:219], a[160:163], a[120:123], v[216:219]
    v_mfma_f32_16x16x32_bf16 v[248:251], a[164:167], a[120:123], v[248:251]
    v_mfma_f32_16x16x32_bf16 v[248:251], a[236:239], a[192:195], v[248:251]
    ds_read_b128 a[120:123], v8 offset:6144
    v_mfma_f32_16x16x32_bf16 v[188:191], a[228:231], a[196:199], v[188:191]
    ds_read_b128 a[192:195], v8 offset:43008
    v_mfma_f32_16x16x32_bf16 v[188:191], a[156:159], a[124:127], v[188:191]
    v_mfma_f32_16x16x32_bf16 v[220:223], a[160:163], a[124:127], v[220:223]
    v_mfma_f32_16x16x32_bf16 v[220:223], a[232:235], a[196:199], v[220:223]
    v_mfma_f32_16x16x32_bf16 v[252:255], a[236:239], a[196:199], v[252:255]
    v_mfma_f32_16x16x32_bf16 v[252:255], a[164:167], a[124:127], v[252:255]
    s_waitcnt lgkmcnt(2)
    v_mfma_f32_16x16x32_bf16 a[0:3], a[128:131], a[96:99], a[0:3]
    ds_read_b128 a[124:127], v8 offset:7168
    v_mfma_f32_16x16x32_bf16 a[0:3], a[200:203], a[168:171], a[0:3]
    ds_read_b128 a[196:199], v8 offset:44032
    v_mfma_f32_16x16x32_bf16 a[32:35], a[204:207], a[168:171], a[32:35]
    ds_read_b64_tr_b16 a[156:157], v14 offset:7328
    v_mfma_f32_16x16x32_bf16 a[32:35], a[132:135], a[96:99], a[32:35]
    ds_read_b64_tr_b16 a[158:159], v14 offset:10912
    v_mfma_f32_16x16x32_bf16 a[64:67], a[96:99], a[136:139], a[64:67]
    ds_read_b64_tr_b16 a[228:229], v14 offset:44192
    v_mfma_f32_16x16x32_bf16 a[64:67], a[168:171], a[208:211], a[64:67]
    ds_read_b64_tr_b16 a[230:231], v14 offset:47776
    v_mfma_f32_16x16x32_bf16 a[4:7], a[200:203], a[172:175], a[4:7]
    ds_read_b64_tr_b16 a[160:161], v14 offset:192
    v_mfma_f32_16x16x32_bf16 a[4:7], a[128:131], a[100:103], a[4:7]
    ds_read_b64_tr_b16 a[162:163], v14 offset:3776
    v_mfma_f32_16x16x32_bf16 a[36:39], a[132:135], a[100:103], a[36:39]
    ds_read_b64_tr_b16 a[232:233], v14 offset:37056
    v_mfma_f32_16x16x32_bf16 a[36:39], a[204:207], a[172:175], a[36:39]
    ds_read_b64_tr_b16 a[234:235], v14 offset:40640
    v_mfma_f32_16x16x32_bf16 a[68:71], a[172:175], a[208:211], a[68:71]
    ds_read_b64_tr_b16 a[164:165], v14 offset:7360
    v_mfma_f32_16x16x32_bf16 a[68:71], a[100:103], a[136:139], a[68:71]
    ds_read_b64_tr_b16 a[166:167], v14 offset:10944
    v_mfma_f32_16x16x32_bf16 a[8:11], a[128:131], a[104:107], a[8:11]
    ds_read_b64_tr_b16 a[236:237], v14 offset:44224
    v_mfma_f32_16x16x32_bf16 a[8:11], a[200:203], a[176:179], a[8:11]
    ds_read_b64_tr_b16 a[238:239], v14 offset:47808
    v_mfma_f32_16x16x32_bf16 a[40:43], a[204:207], a[176:179], a[40:43]
    v_mfma_f32_16x16x32_bf16 a[40:43], a[132:135], a[104:107], a[40:43]
    v_mfma_f32_16x16x32_bf16 a[72:75], a[104:107], a[136:139], a[72:75]
    v_mfma_f32_16x16x32_bf16 a[72:75], a[176:179], a[208:211], a[72:75]
    v_mfma_f32_16x16x32_bf16 a[12:15], a[200:203], a[180:183], a[12:15]
    v_mfma_f32_16x16x32_bf16 a[12:15], a[128:131], a[108:111], a[12:15]
    v_mfma_f32_16x16x32_bf16 a[44:47], a[132:135], a[108:111], a[44:47]
    v_mfma_f32_16x16x32_bf16 a[44:47], a[204:207], a[180:183], a[44:47]
    v_mfma_f32_16x16x32_bf16 a[76:79], a[180:183], a[208:211], a[76:79]
    v_mfma_f32_16x16x32_bf16 a[76:79], a[108:111], a[136:139], a[76:79]
    v_mfma_f32_16x16x32_bf16 a[16:19], a[128:131], a[112:115], a[16:19]
    v_mfma_f32_16x16x32_bf16 a[16:19], a[200:203], a[184:187], a[16:19]
    s_waitcnt lgkmcnt(0)
    v_mfma_f32_16x16x32_bf16 a[48:51], a[204:207], a[184:187], a[48:51]
    v_mfma_f32_16x16x32_bf16 a[48:51], a[132:135], a[112:115], a[48:51]
    v_mfma_f32_16x16x32_bf16 a[80:83], a[112:115], a[136:139], a[80:83]
    v_mfma_f32_16x16x32_bf16 a[80:83], a[184:187], a[208:211], a[80:83]
    v_mfma_f32_16x16x32_bf16 a[20:23], a[200:203], a[188:191], a[20:23]
    v_mfma_f32_16x16x32_bf16 a[20:23], a[128:131], a[116:119], a[20:23]
    v_mfma_f32_16x16x32_bf16 a[52:55], a[132:135], a[116:119], a[52:55]
    v_mfma_f32_16x16x32_bf16 a[52:55], a[204:207], a[188:191], a[52:55]
    v_mfma_f32_16x16x32_bf16 a[84:87], a[188:191], a[208:211], a[84:87]
    v_mfma_f32_16x16x32_bf16 a[84:87], a[116:119], a[136:139], a[84:87]
    v_mfma_f32_16x16x32_bf16 a[24:27], a[128:131], a[120:123], a[24:27]
    v_mfma_f32_16x16x32_bf16 a[24:27], a[200:203], a[192:195], a[24:27]
    v_mfma_f32_16x16x32_bf16 a[56:59], a[204:207], a[192:195], a[56:59]
    v_mfma_f32_16x16x32_bf16 a[56:59], a[132:135], a[120:123], a[56:59]
    v_mfma_f32_16x16x32_bf16 a[88:91], a[120:123], a[136:139], a[88:91]
    v_mfma_f32_16x16x32_bf16 a[88:91], a[192:195], a[208:211], a[88:91]
    v_mfma_f32_16x16x32_bf16 a[28:31], a[200:203], a[196:199], a[28:31]
    v_mfma_f32_16x16x32_bf16 a[28:31], a[128:131], a[124:127], a[28:31]
    v_mfma_f32_16x16x32_bf16 a[60:63], a[132:135], a[124:127], a[60:63]
    v_mfma_f32_16x16x32_bf16 a[60:63], a[204:207], a[196:199], a[60:63]
    v_mfma_f32_16x16x32_bf16 a[92:95], a[196:199], a[208:211], a[92:95]
    v_mfma_f32_16x16x32_bf16 a[92:95], a[124:127], a[136:139], a[92:95]
    v_mfma_f32_16x16x32_bf16 v[32:35], a[96:99], a[140:143], v[32:35]
    v_mfma_f32_16x16x32_bf16 v[32:35], a[168:171], a[212:215], v[32:35]
    v_mfma_f32_16x16x32_bf16 v[36:39], a[172:175], a[212:215], v[36:39]
    v_mfma_f32_16x16x32_bf16 v[36:39], a[100:103], a[140:143], v[36:39]
    v_mfma_f32_16x16x32_bf16 v[40:43], a[104:107], a[140:143], v[40:43]
    v_mfma_f32_16x16x32_bf16 v[40:43], a[176:179], a[212:215], v[40:43]
    v_mfma_f32_16x16x32_bf16 v[44:47], a[180:183], a[212:215], v[44:47]
    v_accvgpr_read_b32 v2, a64
    v_accvgpr_read_b32 v3, a65
    v_mfma_f32_16x16x32_bf16 v[44:47], a[108:111], a[140:143], v[44:47]
    v_accvgpr_read_b32 v4, a66
    v_mfma_f32_16x16x32_bf16 v[48:51], a[112:115], a[140:143], v[48:51]
    v_accvgpr_read_b32 v5, a67
    v_mfma_f32_16x16x32_bf16 v[48:51], a[184:187], a[212:215], v[48:51]
    v_accvgpr_read_b32 v6, a68
    v_accvgpr_read_b32 v7, a69
    v_mfma_f32_16x16x32_bf16 v[52:55], a[188:191], a[212:215], v[52:55]
    v_accvgpr_read_b32 v8, a70
    v_mfma_f32_16x16x32_bf16 v[52:55], a[116:119], a[140:143], v[52:55]
    v_accvgpr_read_b32 v9, a71
    v_mfma_f32_16x16x32_bf16 v[56:59], a[120:123], a[140:143], v[56:59]
    v_cvt_pk_bf16_f32 v2, v2, v3
    v_cvt_pk_bf16_f32 v3, v4, v5
    v_mfma_f32_16x16x32_bf16 v[56:59], a[192:195], a[212:215], v[56:59]
    v_cvt_pk_bf16_f32 v4, v6, v7
    v_mfma_f32_16x16x32_bf16 v[60:63], a[196:199], a[212:215], v[60:63]
    v_cvt_pk_bf16_f32 v5, v8, v9
    v_mfma_f32_16x16x32_bf16 v[60:63], a[124:127], a[140:143], v[60:63]
    s_add_u32 s3, s64, 2048
    buffer_store_dwordx4 v[2:5], v1, s[4:7], s3 offen sc1
    v_mfma_f32_16x16x32_bf16 v[92:95], a[144:147], a[124:127], v[92:95]
    ds_write_b128 v22, v[2:5] offset:2048
    v_mfma_f32_16x16x32_bf16 v[92:95], a[216:219], a[196:199], v[92:95]
    v_accvgpr_read_b32 v10, a72
    v_mfma_f32_16x16x32_bf16 v[88:91], a[216:219], a[192:195], v[88:91]
    v_accvgpr_read_b32 v11, a73
    v_accvgpr_read_b32 v12, a74
    v_mfma_f32_16x16x32_bf16 v[88:91], a[144:147], a[120:123], v[88:91]
    v_accvgpr_read_b32 v13, a75
    v_mfma_f32_16x16x32_bf16 v[84:87], a[144:147], a[116:119], v[84:87]
    v_accvgpr_read_b32 v14, a76
    v_mfma_f32_16x16x32_bf16 v[84:87], a[216:219], a[188:191], v[84:87]
    v_accvgpr_read_b32 v15, a77
    v_accvgpr_read_b32 v16, a78
    v_mfma_f32_16x16x32_bf16 v[80:83], a[216:219], a[184:187], v[80:83]
    v_accvgpr_read_b32 v17, a79
    v_mfma_f32_16x16x32_bf16 v[80:83], a[144:147], a[112:115], v[80:83]
    v_cvt_pk_bf16_f32 v10, v10, v11
    v_mfma_f32_16x16x32_bf16 v[76:79], a[144:147], a[108:111], v[76:79]
    v_cvt_pk_bf16_f32 v11, v12, v13
    v_cvt_pk_bf16_f32 v12, v14, v15
    v_mfma_f32_16x16x32_bf16 v[76:79], a[216:219], a[180:183], v[76:79]
    v_cvt_pk_bf16_f32 v13, v16, v17
    v_mfma_f32_16x16x32_bf16 v[72:75], a[216:219], a[176:179], v[72:75]
    s_add_u32 s3, s64, 6144
    v_mfma_f32_16x16x32_bf16 v[72:75], a[144:147], a[104:107], v[72:75]
    buffer_store_dwordx4 v[10:13], v1, s[4:7], s3 offen sc1
    ds_write_b128 v22, v[10:13] offset:6144
    v_mfma_f32_16x16x32_bf16 v[68:71], a[144:147], a[100:103], v[68:71]
    v_accvgpr_read_b32 v2, a80
    v_mfma_f32_16x16x32_bf16 v[68:71], a[216:219], a[172:175], v[68:71]
    v_accvgpr_read_b32 v3, a81
    v_mfma_f32_16x16x32_bf16 v[64:67], a[216:219], a[168:171], v[64:67]
    v_accvgpr_read_b32 v4, a82
    v_accvgpr_read_b32 v5, a83
    v_mfma_f32_16x16x32_bf16 v[64:67], a[144:147], a[96:99], v[64:67]
    v_accvgpr_read_b32 v6, a84
    v_mfma_f32_16x16x32_bf16 v[96:99], a[148:151], a[96:99], v[96:99]
    v_accvgpr_read_b32 v7, a85
    v_mfma_f32_16x16x32_bf16 v[96:99], a[220:223], a[168:171], v[96:99]
    v_accvgpr_read_b32 v8, a86
    v_accvgpr_read_b32 v9, a87
    v_mfma_f32_16x16x32_bf16 v[100:103], a[220:223], a[172:175], v[100:103]
    v_cvt_pk_bf16_f32 v2, v2, v3
    v_mfma_f32_16x16x32_bf16 v[100:103], a[148:151], a[100:103], v[100:103]
    v_cvt_pk_bf16_f32 v3, v4, v5
    v_mfma_f32_16x16x32_bf16 v[104:107], a[148:151], a[104:107], v[104:107]
    v_cvt_pk_bf16_f32 v4, v6, v7
    v_cvt_pk_bf16_f32 v5, v8, v9
    v_mfma_f32_16x16x32_bf16 v[104:107], a[220:223], a[176:179], v[104:107]
    s_add_u32 s3, s64, 10240
    v_mfma_f32_16x16x32_bf16 v[108:111], a[220:223], a[180:183], v[108:111]
    buffer_store_dwordx4 v[2:5], v1, s[4:7], s3 offen sc1
    v_mfma_f32_16x16x32_bf16 v[108:111], a[148:151], a[108:111], v[108:111]
    ds_write_b128 v22, v[2:5] offset:10240
    v_accvgpr_read_b32 v10, a88
    v_mfma_f32_16x16x32_bf16 v[112:115], a[148:151], a[112:115], v[112:115]
    v_accvgpr_read_b32 v11, a89
    v_mfma_f32_16x16x32_bf16 v[112:115], a[220:223], a[184:187], v[112:115]
    v_accvgpr_read_b32 v12, a90
    v_mfma_f32_16x16x32_bf16 v[116:119], a[220:223], a[188:191], v[116:119]
    v_accvgpr_read_b32 v13, a91
    v_accvgpr_read_b32 v14, a92
    v_mfma_f32_16x16x32_bf16 v[116:119], a[148:151], a[116:119], v[116:119]
    v_accvgpr_read_b32 v15, a93
    v_mfma_f32_16x16x32_bf16 v[120:123], a[148:151], a[120:123], v[120:123]
    v_accvgpr_read_b32 v16, a94
    v_mfma_f32_16x16x32_bf16 v[120:123], a[220:223], a[192:195], v[120:123]
    v_accvgpr_read_b32 v17, a95
    v_cvt_pk_bf16_f32 v10, v10, v11
    v_mfma_f32_16x16x32_bf16 v[124:127], a[220:223], a[196:199], v[124:127]
    v_cvt_pk_bf16_f32 v11, v12, v13
    v_mfma_f32_16x16x32_bf16 v[124:127], a[148:151], a[124:127], v[124:127]
    v_cvt_pk_bf16_f32 v12, v14, v15
    v_mfma_f32_16x16x32_bf16 v[156:159], a[152:155], a[124:127], v[156:159]
    v_cvt_pk_bf16_f32 v13, v16, v17
    s_add_u32 s3, s64, 14336
    v_mfma_f32_16x16x32_bf16 v[156:159], a[224:227], a[196:199], v[156:159]
    buffer_store_dwordx4 v[10:13], v1, s[4:7], s3 offen sc1
    v_mfma_f32_16x16x32_bf16 v[152:155], a[224:227], a[192:195], v[152:155]
    ds_write_b128 v22, v[10:13] offset:14336
    v_mfma_f32_16x16x32_bf16 v[152:155], a[152:155], a[120:123], v[152:155]
    v_cvt_pk_bf16_f32 v32, v32, v33
    v_cvt_pk_bf16_f32 v33, v34, v35
    v_mfma_f32_16x16x32_bf16 v[148:151], a[152:155], a[116:119], v[148:151]
    v_cvt_pk_bf16_f32 v34, v36, v37
    v_mfma_f32_16x16x32_bf16 v[148:151], a[224:227], a[188:191], v[148:151]
    v_cvt_pk_bf16_f32 v35, v38, v39
    v_mfma_f32_16x16x32_bf16 v[144:147], a[224:227], a[184:187], v[144:147]
    s_add_u32 s3, s64, 3072
    buffer_store_dwordx4 v[32:35], v1, s[4:7], s3 offen sc1
    v_mfma_f32_16x16x32_bf16 v[144:147], a[152:155], a[112:115], v[144:147]
    ds_write_b128 v22, v[32:35] offset:3072
    v_mfma_f32_16x16x32_bf16 v[140:143], a[152:155], a[108:111], v[140:143]
    v_cvt_pk_bf16_f32 v40, v40, v41
    v_mfma_f32_16x16x32_bf16 v[140:143], a[224:227], a[180:183], v[140:143]
    v_cvt_pk_bf16_f32 v41, v42, v43
    v_cvt_pk_bf16_f32 v42, v44, v45
    v_mfma_f32_16x16x32_bf16 v[136:139], a[224:227], a[176:179], v[136:139]
    v_cvt_pk_bf16_f32 v43, v46, v47
    v_mfma_f32_16x16x32_bf16 v[136:139], a[152:155], a[104:107], v[136:139]
    s_add_u32 s3, s64, 7168
    v_mfma_f32_16x16x32_bf16 v[132:135], a[152:155], a[100:103], v[132:135]
    buffer_store_dwordx4 v[40:43], v1, s[4:7], s3 offen sc1
    ds_write_b128 v22, v[40:43] offset:7168
    v_mfma_f32_16x16x32_bf16 v[132:135], a[224:227], a[172:175], v[132:135]
    v_cvt_pk_bf16_f32 v48, v48, v49
    v_mfma_f32_16x16x32_bf16 v[128:131], a[224:227], a[168:171], v[128:131]
    v_cvt_pk_bf16_f32 v49, v50, v51
    v_mfma_f32_16x16x32_bf16 v[128:131], a[152:155], a[96:99], v[128:131]
    v_cvt_pk_bf16_f32 v50, v52, v53
    v_cvt_pk_bf16_f32 v51, v54, v55
    v_mfma_f32_16x16x32_bf16 v[160:163], a[156:159], a[96:99], v[160:163]
    s_add_u32 s3, s64, 11264
    v_mfma_f32_16x16x32_bf16 v[160:163], a[228:231], a[168:171], v[160:163]
    buffer_store_dwordx4 v[48:51], v1, s[4:7], s3 offen sc1
    v_mfma_f32_16x16x32_bf16 v[192:195], a[232:235], a[168:171], v[192:195]
    ds_write_b128 v22, v[48:51] offset:11264
    v_cvt_pk_bf16_f32 v56, v56, v57
    v_mfma_f32_16x16x32_bf16 v[192:195], a[160:163], a[96:99], v[192:195]
    v_cvt_pk_bf16_f32 v57, v58, v59
    v_mfma_f32_16x16x32_bf16 v[224:227], a[164:167], a[96:99], v[224:227]
    v_cvt_pk_bf16_f32 v58, v60, v61
    v_mfma_f32_16x16x32_bf16 v[224:227], a[236:239], a[168:171], v[224:227]
    v_cvt_pk_bf16_f32 v59, v62, v63
    s_add_u32 s3, s64, 15360
    v_mfma_f32_16x16x32_bf16 v[164:167], a[228:231], a[172:175], v[164:167]
    buffer_store_dwordx4 v[56:59], v1, s[4:7], s3 offen sc1
    v_mfma_f32_16x16x32_bf16 v[164:167], a[156:159], a[100:103], v[164:167]
    ds_write_b128 v22, v[56:59] offset:15360
    v_mfma_f32_16x16x32_bf16 v[196:199], a[160:163], a[100:103], v[196:199]
    v_accvgpr_read_b32 v2, a0
    v_accvgpr_read_b32 v3, a1
    v_mfma_f32_16x16x32_bf16 v[196:199], a[232:235], a[172:175], v[196:199]
    v_accvgpr_read_b32 v4, a2
    v_mfma_f32_16x16x32_bf16 v[228:231], a[236:239], a[172:175], v[228:231]
    v_accvgpr_read_b32 v5, a3
    v_mfma_f32_16x16x32_bf16 v[228:231], a[164:167], a[100:103], v[228:231]
    v_accvgpr_read_b32 v6, a32
    v_accvgpr_read_b32 v7, a33
    v_mfma_f32_16x16x32_bf16 v[168:171], a[156:159], a[104:107], v[168:171]
    v_accvgpr_read_b32 v8, a34
    v_mfma_f32_16x16x32_bf16 v[168:171], a[228:231], a[176:179], v[168:171]
    v_accvgpr_read_b32 v9, a35
    v_mfma_f32_16x16x32_bf16 v[200:203], a[232:235], a[176:179], v[200:203]
    v_pk_mul_f32 v[2:3], v[2:3], s[68:69]
    v_pk_mul_f32 v[4:5], v[4:5], s[68:69]
    v_mfma_f32_16x16x32_bf16 v[200:203], a[160:163], a[104:107], v[200:203]
    v_pk_mul_f32 v[6:7], v[6:7], s[68:69]
    v_mfma_f32_16x16x32_bf16 v[232:235], a[164:167], a[104:107], v[232:235]
    v_pk_mul_f32 v[8:9], v[8:9], s[68:69]
    v_mfma_f32_16x16x32_bf16 v[232:235], a[236:239], a[176:179], v[232:235]
    v_cvt_pk_bf16_f32 v2, v2, v3
    v_cvt_pk_bf16_f32 v3, v4, v5
    v_mfma_f32_16x16x32_bf16 v[172:175], a[228:231], a[180:183], v[172:175]
    v_cvt_pk_bf16_f32 v4, v6, v7
    v_mfma_f32_16x16x32_bf16 v[172:175], a[156:159], a[108:111], v[172:175]
    v_cvt_pk_bf16_f32 v5, v8, v9
    v_mfma_f32_16x16x32_bf16 v[204:207], a[160:163], a[108:111], v[204:207]
    ds_write_b128 v23, v[2:5] offset:49152
    v_accvgpr_read_b32 v10, a4
    v_mfma_f32_16x16x32_bf16 v[204:207], a[232:235], a[180:183], v[204:207]
    v_accvgpr_read_b32 v11, a5
    v_mfma_f32_16x16x32_bf16 v[236:239], a[236:239], a[180:183], v[236:239]
    v_accvgpr_read_b32 v12, a6
    v_mfma_f32_16x16x32_bf16 v[236:239], a[164:167], a[108:111], v[236:239]
    v_accvgpr_read_b32 v13, a7
    v_accvgpr_read_b32 v14, a36
    v_mfma_f32_16x16x32_bf16 v[176:179], a[156:159], a[112:115], v[176:179]
    v_accvgpr_read_b32 v15, a37
    v_mfma_f32_16x16x32_bf16 v[176:179], a[228:231], a[184:187], v[176:179]
    v_accvgpr_read_b32 v16, a38
    v_mfma_f32_16x16x32_bf16 v[208:211], a[232:235], a[184:187], v[208:211]
    v_accvgpr_read_b32 v17, a39
    v_pk_mul_f32 v[10:11], v[10:11], s[68:69]
    v_mfma_f32_16x16x32_bf16 v[208:211], a[160:163], a[112:115], v[208:211]
    v_pk_mul_f32 v[12:13], v[12:13], s[68:69]
    v_mfma_f32_16x16x32_bf16 v[240:243], a[164:167], a[112:115], v[240:243]
    v_pk_mul_f32 v[14:15], v[14:15], s[68:69]
    v_mfma_f32_16x16x32_bf16 v[240:243], a[236:239], a[184:187], v[240:243]
    v_pk_mul_f32 v[16:17], v[16:17], s[68:69]
    v_cvt_pk_bf16_f32 v10, v10, v11
    v_mfma_f32_16x16x32_bf16 v[180:183], a[228:231], a[188:191], v[180:183]
    v_cvt_pk_bf16_f32 v11, v12, v13
    v_mfma_f32_16x16x32_bf16 v[180:183], a[156:159], a[116:119], v[180:183]
    v_cvt_pk_bf16_f32 v12, v14, v15
    v_mfma_f32_16x16x32_bf16 v[212:215], a[160:163], a[116:119], v[212:215]
    v_cvt_pk_bf16_f32 v13, v16, v17
    ds_write_b128 v23, v[10:13] offset:50176
    v_mfma_f32_16x16x32_bf16 v[212:215], a[232:235], a[188:191], v[212:215]
    v_accvgpr_read_b32 v2, a8
    v_mfma_f32_16x16x32_bf16 v[244:247], a[236:239], a[188:191], v[244:247]
    v_accvgpr_read_b32 v3, a9
    v_mfma_f32_16x16x32_bf16 v[244:247], a[164:167], a[116:119], v[244:247]
    v_accvgpr_read_b32 v4, a10
    v_accvgpr_read_b32 v5, a11
    v_mfma_f32_16x16x32_bf16 v[184:187], a[156:159], a[120:123], v[184:187]
    v_accvgpr_read_b32 v6, a40
    v_mfma_f32_16x16x32_bf16 v[184:187], a[228:231], a[192:195], v[184:187]
    v_accvgpr_read_b32 v7, a41
    v_mfma_f32_16x16x32_bf16 v[216:219], a[232:235], a[192:195], v[216:219]
    v_accvgpr_read_b32 v8, a42
    v_accvgpr_read_b32 v9, a43
    v_mfma_f32_16x16x32_bf16 v[216:219], a[160:163], a[120:123], v[216:219]
    v_pk_mul_f32 v[2:3], v[2:3], s[68:69]
    v_mfma_f32_16x16x32_bf16 v[248:251], a[164:167], a[120:123], v[248:251]
    v_pk_mul_f32 v[4:5], v[4:5], s[68:69]
    v_mfma_f32_16x16x32_bf16 v[248:251], a[236:239], a[192:195], v[248:251]
    v_pk_mul_f32 v[6:7], v[6:7], s[68:69]
    v_pk_mul_f32 v[8:9], v[8:9], s[68:69]
    v_mfma_f32_16x16x32_bf16 v[188:191], a[228:231], a[196:199], v[188:191]
    v_cvt_pk_bf16_f32 v2, v2, v3
    v_mfma_f32_16x16x32_bf16 v[188:191], a[156:159], a[124:127], v[188:191]
    v_cvt_pk_bf16_f32 v3, v4, v5
    v_mfma_f32_16x16x32_bf16 v[220:223], a[160:163], a[124:127], v[220:223]
    v_cvt_pk_bf16_f32 v4, v6, v7
    v_cvt_pk_bf16_f32 v5, v8, v9
    v_mfma_f32_16x16x32_bf16 v[220:223], a[232:235], a[196:199], v[220:223]
    ds_write_b128 v23, v[2:5] offset:51200
    v_mfma_f32_16x16x32_bf16 v[252:255], a[236:239], a[196:199], v[252:255]
    v_accvgpr_read_b32 v10, a12
    v_mfma_f32_16x16x32_bf16 v[252:255], a[164:167], a[124:127], v[252:255]
    s_nop 4
    v_accvgpr_read_b32 v11, a13
    v_accvgpr_read_b32 v12, a14
    v_accvgpr_read_b32 v13, a15
    v_accvgpr_read_b32 v14, a44
    v_accvgpr_read_b32 v15, a45
    v_accvgpr_read_b32 v16, a46
    v_accvgpr_read_b32 v17, a47
    v_pk_mul_f32 v[10:11], v[10:11], s[68:69]
    v_pk_mul_f32 v[12:13], v[12:13], s[68:69]
    v_pk_mul_f32 v[14:15], v[14:15], s[68:69]
    v_pk_mul_f32 v[16:17], v[16:17], s[68:69]
    v_cvt_pk_bf16_f32 v10, v10, v11
    v_cvt_pk_bf16_f32 v11, v12, v13
    v_cvt_pk_bf16_f32 v12, v14, v15
    v_cvt_pk_bf16_f32 v13, v16, v17
    ds_write_b128 v23, v[10:13] offset:52224
    v_accvgpr_read_b32 v2, a16
    v_accvgpr_read_b32 v3, a17
    v_accvgpr_read_b32 v4, a18
    v_accvgpr_read_b32 v5, a19
    v_accvgpr_read_b32 v6, a48
    v_accvgpr_read_b32 v7, a49
    v_accvgpr_read_b32 v8, a50
    v_accvgpr_read_b32 v9, a51
    v_pk_mul_f32 v[2:3], v[2:3], s[68:69]
    v_pk_mul_f32 v[4:5], v[4:5], s[68:69]
    v_pk_mul_f32 v[6:7], v[6:7], s[68:69]
    v_pk_mul_f32 v[8:9], v[8:9], s[68:69]
    v_cvt_pk_bf16_f32 v2, v2, v3
    v_cvt_pk_bf16_f32 v3, v4, v5
    v_cvt_pk_bf16_f32 v4, v6, v7
    v_cvt_pk_bf16_f32 v5, v8, v9
    ds_write_b128 v23, v[2:5] offset:53248
    v_accvgpr_read_b32 v10, a20
    v_accvgpr_read_b32 v11, a21
    v_accvgpr_read_b32 v12, a22
    v_accvgpr_read_b32 v13, a23
    v_accvgpr_read_b32 v14, a52
    v_accvgpr_read_b32 v15, a53
    v_accvgpr_read_b32 v16, a54
    v_accvgpr_read_b32 v17, a55
    v_pk_mul_f32 v[10:11], v[10:11], s[68:69]
    v_pk_mul_f32 v[12:13], v[12:13], s[68:69]
    v_pk_mul_f32 v[14:15], v[14:15], s[68:69]
    v_pk_mul_f32 v[16:17], v[16:17], s[68:69]
    v_cvt_pk_bf16_f32 v10, v10, v11
    v_cvt_pk_bf16_f32 v11, v12, v13
    v_cvt_pk_bf16_f32 v12, v14, v15
    v_cvt_pk_bf16_f32 v13, v16, v17
    ds_write_b128 v23, v[10:13] offset:54272
    v_accvgpr_read_b32 v2, a24
    v_accvgpr_read_b32 v3, a25
    v_accvgpr_read_b32 v4, a26
    v_accvgpr_read_b32 v5, a27
    v_accvgpr_read_b32 v6, a56
    v_accvgpr_read_b32 v7, a57
    v_accvgpr_read_b32 v8, a58
    v_accvgpr_read_b32 v9, a59
    v_pk_mul_f32 v[2:3], v[2:3], s[68:69]
    v_pk_mul_f32 v[4:5], v[4:5], s[68:69]
    v_pk_mul_f32 v[6:7], v[6:7], s[68:69]
    v_pk_mul_f32 v[8:9], v[8:9], s[68:69]
    v_cvt_pk_bf16_f32 v2, v2, v3
    v_cvt_pk_bf16_f32 v3, v4, v5
    v_cvt_pk_bf16_f32 v4, v6, v7
    v_cvt_pk_bf16_f32 v5, v8, v9
    ds_write_b128 v23, v[2:5] offset:55296
    v_accvgpr_read_b32 v10, a28
    v_accvgpr_read_b32 v11, a29
    v_accvgpr_read_b32 v12, a30
    v_accvgpr_read_b32 v13, a31
    v_accvgpr_read_b32 v14, a60
    v_accvgpr_read_b32 v15, a61
    v_accvgpr_read_b32 v16, a62
    v_accvgpr_read_b32 v17, a63
    v_pk_mul_f32 v[10:11], v[10:11], s[68:69]
    v_pk_mul_f32 v[12:13], v[12:13], s[68:69]
    v_pk_mul_f32 v[14:15], v[14:15], s[68:69]
    v_pk_mul_f32 v[16:17], v[16:17], s[68:69]
    v_cvt_pk_bf16_f32 v10, v10, v11
    v_cvt_pk_bf16_f32 v11, v12, v13
    v_cvt_pk_bf16_f32 v12, v14, v15
    v_cvt_pk_bf16_f32 v13, v16, v17
    ds_write_b128 v23, v[10:13] offset:56320
    v_pk_mul_f32 v[192:193], v[192:193], s[66:67]
    v_pk_mul_f32 v[194:195], v[194:195], s[66:67]
    v_pk_mul_f32 v[196:197], v[196:197], s[66:67]
    v_pk_mul_f32 v[198:199], v[198:199], s[66:67]
    v_exp_f32 v192, v192
    v_exp_f32 v193, v193
    v_exp_f32 v194, v194
    v_exp_f32 v195, v195
    v_exp_f32 v196, v196
    v_exp_f32 v197, v197
    v_exp_f32 v198, v198
    v_exp_f32 v199, v199
    v_pk_add_f32 v[192:193], v[192:193], 1.0 op_sel_hi:[1,0]
    v_pk_add_f32 v[194:195], v[194:195], 1.0 op_sel_hi:[1,0]
    v_pk_add_f32 v[196:197], v[196:197], 1.0 op_sel_hi:[1,0]
    v_pk_add_f32 v[198:199], v[198:199], 1.0 op_sel_hi:[1,0]
    v_rcp_f32 v192, v192
    v_rcp_f32 v193, v193
    v_rcp_f32 v194, v194
    v_rcp_f32 v195, v195
    v_rcp_f32 v196, v196
    v_rcp_f32 v197, v197
    v_rcp_f32 v198, v198
    v_rcp_f32 v199, v199
    v_pk_mul_f32 v[192:193], v[192:193], v[224:225]
    v_pk_mul_f32 v[194:195], v[194:195], v[226:227]
    v_pk_mul_f32 v[196:197], v[196:197], v[228:229]
    v_pk_mul_f32 v[198:199], v[198:199], v[230:231]
    v_cvt_pk_bf16_f32 v224, v192, v193
    v_cvt_pk_bf16_f32 v225, v194, v195
    v_cvt_pk_bf16_f32 v228, v196, v197
    v_cvt_pk_bf16_f32 v229, v198, v199
    v_pk_mul_f32 v[200:201], v[200:201], s[66:67]
    v_pk_mul_f32 v[202:203], v[202:203], s[66:67]
    v_pk_mul_f32 v[204:205], v[204:205], s[66:67]
    v_pk_mul_f32 v[206:207], v[206:207], s[66:67]
    v_exp_f32 v200, v200
    v_exp_f32 v201, v201
    v_exp_f32 v202, v202
    v_exp_f32 v203, v203
    v_exp_f32 v204, v204
    v_exp_f32 v205, v205
    v_exp_f32 v206, v206
    v_exp_f32 v207, v207
    v_pk_add_f32 v[200:201], v[200:201], 1.0 op_sel_hi:[1,0]
    v_pk_add_f32 v[202:203], v[202:203], 1.0 op_sel_hi:[1,0]
    v_pk_add_f32 v[204:205], v[204:205], 1.0 op_sel_hi:[1,0]
    v_pk_add_f32 v[206:207], v[206:207], 1.0 op_sel_hi:[1,0]
    v_rcp_f32 v200, v200
    v_rcp_f32 v201, v201
    v_rcp_f32 v202, v202
    v_rcp_f32 v203, v203
    v_rcp_f32 v204, v204
    v_rcp_f32 v205, v205
    v_rcp_f32 v206, v206
    v_rcp_f32 v207, v207
    v_pk_mul_f32 v[200:201], v[200:201], v[232:233]
    v_pk_mul_f32 v[202:203], v[202:203], v[234:235]
    v_pk_mul_f32 v[204:205], v[204:205], v[236:237]
    v_pk_mul_f32 v[206:207], v[206:207], v[238:239]
    v_cvt_pk_bf16_f32 v232, v200, v201
    v_cvt_pk_bf16_f32 v233, v202, v203
    v_cvt_pk_bf16_f32 v236, v204, v205
    v_cvt_pk_bf16_f32 v237, v206, v207
    s_lshl_b32 s61, s56, 8
    s_lshl_b32 s3, s57, 2
    s_add_u32 s3, s3, s46
    s_lshl_b32 s3, s3, 2
    s_add_u32 s3, s3, s61
    s_add_u32 s3, s3, 62922752
    s_waitcnt vmcnt(0)
    v_mov_b32 v20, s72
    v_mov_b32 v21, 0
    s_mov_b64 exec, 1
    buffer_store_dword v20, v21, s[4:7], s3 offen sc1
    s_mov_b64 exec, -1
    v_pk_mul_f32 v[208:209], v[208:209], s[66:67]
    v_pk_mul_f32 v[210:211], v[210:211], s[66:67]
    v_pk_mul_f32 v[212:213], v[212:213], s[66:67]
    v_pk_mul_f32 v[214:215], v[214:215], s[66:67]
    v_exp_f32 v208, v208
    v_exp_f32 v209, v209
    v_exp_f32 v210, v210
    v_exp_f32 v211, v211
    v_exp_f32 v212, v212
    v_exp_f32 v213, v213
    v_exp_f32 v214, v214
    v_exp_f32 v215, v215
    v_pk_add_f32 v[208:209], v[208:209], 1.0 op_sel_hi:[1,0]
    v_pk_add_f32 v[210:211], v[210:211], 1.0 op_sel_hi:[1,0]
    v_pk_add_f32 v[212:213], v[212:213], 1.0 op_sel_hi:[1,0]
    v_pk_add_f32 v[214:215], v[214:215], 1.0 op_sel_hi:[1,0]
    v_rcp_f32 v208, v208
    v_rcp_f32 v209, v209
    v_rcp_f32 v210, v210
    v_rcp_f32 v211, v211
    v_rcp_f32 v212, v212
    v_rcp_f32 v213, v213
    v_rcp_f32 v214, v214
    v_rcp_f32 v215, v215
    v_pk_mul_f32 v[208:209], v[208:209], v[240:241]
    v_pk_mul_f32 v[210:211], v[210:211], v[242:243]
    v_pk_mul_f32 v[212:213], v[212:213], v[244:245]
    v_pk_mul_f32 v[214:215], v[214:215], v[246:247]
    v_cvt_pk_bf16_f32 v240, v208, v209
    v_cvt_pk_bf16_f32 v241, v210, v211
    v_cvt_pk_bf16_f32 v244, v212, v213
    v_cvt_pk_bf16_f32 v245, v214, v215
    v_pk_mul_f32 v[216:217], v[216:217], s[66:67]
    v_pk_mul_f32 v[218:219], v[218:219], s[66:67]
    v_pk_mul_f32 v[220:221], v[220:221], s[66:67]
    v_pk_mul_f32 v[222:223], v[222:223], s[66:67]
    v_exp_f32 v216, v216
    v_exp_f32 v217, v217
    v_exp_f32 v218, v218
    v_exp_f32 v219, v219
    v_exp_f32 v220, v220
    v_exp_f32 v221, v221
    v_exp_f32 v222, v222
    v_exp_f32 v223, v223
    v_pk_add_f32 v[216:217], v[216:217], 1.0 op_sel_hi:[1,0]
    v_pk_add_f32 v[218:219], v[218:219], 1.0 op_sel_hi:[1,0]
    v_pk_add_f32 v[220:221], v[220:221], 1.0 op_sel_hi:[1,0]
    v_pk_add_f32 v[222:223], v[222:223], 1.0 op_sel_hi:[1,0]
    v_rcp_f32 v216, v216
    v_rcp_f32 v217, v217
    v_rcp_f32 v218, v218
    v_rcp_f32 v219, v219
    v_rcp_f32 v220, v220
    v_rcp_f32 v221, v221
    v_rcp_f32 v222, v222
    v_rcp_f32 v223, v223
    v_pk_mul_f32 v[216:217], v[216:217], v[248:249]
    v_pk_mul_f32 v[218:219], v[218:219], v[250:251]
    v_pk_mul_f32 v[220:221], v[220:221], v[252:253]
    v_pk_mul_f32 v[222:223], v[222:223], v[254:255]
    v_cvt_pk_bf16_f32 v248, v216, v217
    v_cvt_pk_bf16_f32 v249, v218, v219
    v_cvt_pk_bf16_f32 v252, v220, v221
    v_cvt_pk_bf16_f32 v253, v222, v223
    v_pk_mul_f32 v[64:65], v[64:65], s[66:67]
    v_pk_mul_f32 v[66:67], v[66:67], s[66:67]
    v_pk_mul_f32 v[128:129], v[128:129], s[66:67]
    v_pk_mul_f32 v[130:131], v[130:131], s[66:67]
    v_exp_f32 v64, v64
    v_exp_f32 v65, v65
    v_exp_f32 v66, v66
    v_exp_f32 v67, v67
    v_exp_f32 v128, v128
    v_exp_f32 v129, v129
    v_exp_f32 v130, v130
    v_exp_f32 v131, v131
    v_pk_add_f32 v[64:65], v[64:65], 1.0 op_sel_hi:[1,0]
    v_pk_add_f32 v[66:67], v[66:67], 1.0 op_sel_hi:[1,0]
    v_pk_add_f32 v[128:129], v[128:129], 1.0 op_sel_hi:[1,0]
    v_pk_add_f32 v[130:131], v[130:131], 1.0 op_sel_hi:[1,0]
    v_rcp_f32 v64, v64
    v_rcp_f32 v65, v65
    v_rcp_f32 v66, v66
    v_rcp_f32 v67, v67
    v_rcp_f32 v128, v128
    v_rcp_f32 v129, v129
    v_rcp_f32 v130, v130
    v_rcp_f32 v131, v131
    v_pk_mul_f32 v[64:65], v[64:65], v[96:97]
    v_pk_mul_f32 v[66:67], v[66:67], v[98:99]
    v_pk_mul_f32 v[128:129], v[128:129], v[160:161]
    v_pk_mul_f32 v[130:131], v[130:131], v[162:163]
    v_cvt_pk_bf16_f32 v192, v64, v65
    v_cvt_pk_bf16_f32 v193, v66, v67
    v_cvt_pk_bf16_f32 v194, v128, v129
    v_cvt_pk_bf16_f32 v195, v130, v131
    v_pk_mul_f32 v[68:69], v[68:69], s[66:67]
    v_pk_mul_f32 v[70:71], v[70:71], s[66:67]
    v_pk_mul_f32 v[132:133], v[132:133], s[66:67]
    v_pk_mul_f32 v[134:135], v[134:135], s[66:67]
    v_exp_f32 v68, v68
    v_exp_f32 v69, v69
    v_exp_f32 v70, v70
    v_exp_f32 v71, v71
    v_exp_f32 v132, v132
    v_exp_f32 v133, v133
    v_exp_f32 v134, v134
    v_exp_f32 v135, v135
    v_pk_add_f32 v[68:69], v[68:69], 1.0 op_sel_hi:[1,0]
    v_pk_add_f32 v[70:71], v[70:71], 1.0 op_sel_hi:[1,0]
    v_pk_add_f32 v[132:133], v[132:133], 1.0 op_sel_hi:[1,0]
    v_pk_add_f32 v[134:135], v[134:135], 1.0 op_sel_hi:[1,0]
    v_rcp_f32 v68, v68
    v_rcp_f32 v69, v69
    v_rcp_f32 v70, v70
    v_rcp_f32 v71, v71
    v_rcp_f32 v132, v132
    v_rcp_f32 v133, v133
    v_rcp_f32 v134, v134
    v_rcp_f32 v135, v135
    v_pk_mul_f32 v[68:69], v[68:69], v[100:101]
    v_pk_mul_f32 v[70:71], v[70:71], v[102:103]
    v_pk_mul_f32 v[132:133], v[132:133], v[164:165]
    v_pk_mul_f32 v[134:135], v[134:135], v[166:167]
    v_cvt_pk_bf16_f32 v196, v68, v69
    v_cvt_pk_bf16_f32 v197, v70, v71
    v_cvt_pk_bf16_f32 v198, v132, v133
    v_cvt_pk_bf16_f32 v199, v134, v135
    v_pk_mul_f32 v[72:73], v[72:73], s[66:67]
    v_pk_mul_f32 v[74:75], v[74:75], s[66:67]
    v_pk_mul_f32 v[136:137], v[136:137], s[66:67]
    v_pk_mul_f32 v[138:139], v[138:139], s[66:67]
    v_exp_f32 v72, v72
    v_exp_f32 v73, v73
    v_exp_f32 v74, v74
    v_exp_f32 v75, v75
    v_exp_f32 v136, v136
    v_exp_f32 v137, v137
    v_exp_f32 v138, v138
    v_exp_f32 v139, v139
    v_pk_add_f32 v[72:73], v[72:73], 1.0 op_sel_hi:[1,0]
    v_pk_add_f32 v[74:75], v[74:75], 1.0 op_sel_hi:[1,0]
    v_pk_add_f32 v[136:137], v[136:137], 1.0 op_sel_hi:[1,0]
    v_pk_add_f32 v[138:139], v[138:139], 1.0 op_sel_hi:[1,0]
    v_rcp_f32 v72, v72
    v_rcp_f32 v73, v73
    v_rcp_f32 v74, v74
    v_rcp_f32 v75, v75
    v_rcp_f32 v136, v136
    v_rcp_f32 v137, v137
    v_rcp_f32 v138, v138
    v_rcp_f32 v139, v139
    v_pk_mul_f32 v[72:73], v[72:73], v[104:105]
    v_pk_mul_f32 v[74:75], v[74:75], v[106:107]
    v_pk_mul_f32 v[136:137], v[136:137], v[168:169]
    v_pk_mul_f32 v[138:139], v[138:139], v[170:171]
    v_cvt_pk_bf16_f32 v200, v72, v73
    v_cvt_pk_bf16_f32 v201, v74, v75
    v_cvt_pk_bf16_f32 v202, v136, v137
    v_cvt_pk_bf16_f32 v203, v138, v139
    v_pk_mul_f32 v[76:77], v[76:77], s[66:67]
    v_pk_mul_f32 v[78:79], v[78:79], s[66:67]
    v_pk_mul_f32 v[140:141], v[140:141], s[66:67]
    v_pk_mul_f32 v[142:143], v[142:143], s[66:67]
    v_exp_f32 v76, v76
    v_exp_f32 v77, v77
    v_exp_f32 v78, v78
    v_exp_f32 v79, v79
    v_exp_f32 v140, v140
    v_exp_f32 v141, v141
    v_exp_f32 v142, v142
    v_exp_f32 v143, v143
    v_pk_add_f32 v[76:77], v[76:77], 1.0 op_sel_hi:[1,0]
    v_pk_add_f32 v[78:79], v[78:79], 1.0 op_sel_hi:[1,0]
    v_pk_add_f32 v[140:141], v[140:141], 1.0 op_sel_hi:[1,0]
    v_pk_add_f32 v[142:143], v[142:143], 1.0 op_sel_hi:[1,0]
    v_rcp_f32 v76, v76
    v_rcp_f32 v77, v77
    v_rcp_f32 v78, v78
    v_rcp_f32 v79, v79
    v_rcp_f32 v140, v140
    v_rcp_f32 v141, v141
    v_rcp_f32 v142, v142
    v_rcp_f32 v143, v143
    v_pk_mul_f32 v[76:77], v[76:77], v[108:109]
    v_pk_mul_f32 v[78:79], v[78:79], v[110:111]
    v_pk_mul_f32 v[140:141], v[140:141], v[172:173]
    v_pk_mul_f32 v[142:143], v[142:143], v[174:175]
    v_cvt_pk_bf16_f32 v204, v76, v77
    v_cvt_pk_bf16_f32 v205, v78, v79
    v_cvt_pk_bf16_f32 v206, v140, v141
    v_cvt_pk_bf16_f32 v207, v142, v143
    v_pk_mul_f32 v[80:81], v[80:81], s[66:67]
    v_pk_mul_f32 v[82:83], v[82:83], s[66:67]
    v_pk_mul_f32 v[144:145], v[144:145], s[66:67]
    v_pk_mul_f32 v[146:147], v[146:147], s[66:67]
    v_exp_f32 v80, v80
    v_exp_f32 v81, v81
    v_exp_f32 v82, v82
    v_exp_f32 v83, v83
    v_exp_f32 v144, v144
    v_exp_f32 v145, v145
    v_exp_f32 v146, v146
    v_exp_f32 v147, v147
    v_pk_add_f32 v[80:81], v[80:81], 1.0 op_sel_hi:[1,0]
    v_pk_add_f32 v[82:83], v[82:83], 1.0 op_sel_hi:[1,0]
    v_pk_add_f32 v[144:145], v[144:145], 1.0 op_sel_hi:[1,0]
    v_pk_add_f32 v[146:147], v[146:147], 1.0 op_sel_hi:[1,0]
    v_rcp_f32 v80, v80
    v_rcp_f32 v81, v81
    v_rcp_f32 v82, v82
    v_rcp_f32 v83, v83
    v_rcp_f32 v144, v144
    v_rcp_f32 v145, v145
    v_rcp_f32 v146, v146
    v_rcp_f32 v147, v147
    v_pk_mul_f32 v[80:81], v[80:81], v[112:113]
    v_pk_mul_f32 v[82:83], v[82:83], v[114:115]
    v_pk_mul_f32 v[144:145], v[144:145], v[176:177]
    v_pk_mul_f32 v[146:147], v[146:147], v[178:179]
    v_cvt_pk_bf16_f32 v208, v80, v81
    v_cvt_pk_bf16_f32 v209, v82, v83
    v_cvt_pk_bf16_f32 v210, v144, v145
    v_cvt_pk_bf16_f32 v211, v146, v147
    v_pk_mul_f32 v[84:85], v[84:85], s[66:67]
    v_pk_mul_f32 v[86:87], v[86:87], s[66:67]
    v_pk_mul_f32 v[148:149], v[148:149], s[66:67]
    v_pk_mul_f32 v[150:151], v[150:151], s[66:67]
    v_exp_f32 v84, v84
    v_exp_f32 v85, v85
    v_exp_f32 v86, v86
    v_exp_f32 v87, v87
    v_exp_f32 v148, v148
    v_exp_f32 v149, v149
    v_exp_f32 v150, v150
    v_exp_f32 v151, v151
    v_pk_add_f32 v[84:85], v[84:85], 1.0 op_sel_hi:[1,0]
    v_pk_add_f32 v[86:87], v[86:87], 1.0 op_sel_hi:[1,0]
    v_pk_add_f32 v[148:149], v[148:149], 1.0 op_sel_hi:[1,0]
    v_pk_add_f32 v[150:151], v[150:151], 1.0 op_sel_hi:[1,0]
    v_rcp_f32 v84, v84
    v_rcp_f32 v85, v85
    v_rcp_f32 v86, v86
    v_rcp_f32 v87, v87
    v_rcp_f32 v148, v148
    v_rcp_f32 v149, v149
    v_rcp_f32 v150, v150
    v_rcp_f32 v151, v151
    v_pk_mul_f32 v[84:85], v[84:85], v[116:117]
    v_pk_mul_f32 v[86:87], v[86:87], v[118:119]
    v_pk_mul_f32 v[148:149], v[148:149], v[180:181]
    v_pk_mul_f32 v[150:151], v[150:151], v[182:183]
    v_cvt_pk_bf16_f32 v212, v84, v85
    v_cvt_pk_bf16_f32 v213, v86, v87
    v_cvt_pk_bf16_f32 v214, v148, v149
    v_cvt_pk_bf16_f32 v215, v150, v151
    v_pk_mul_f32 v[88:89], v[88:89], s[66:67]
    v_pk_mul_f32 v[90:91], v[90:91], s[66:67]
    v_pk_mul_f32 v[152:153], v[152:153], s[66:67]
    v_pk_mul_f32 v[154:155], v[154:155], s[66:67]
    v_exp_f32 v88, v88
    v_exp_f32 v89, v89
    v_exp_f32 v90, v90
    v_exp_f32 v91, v91
    v_exp_f32 v152, v152
    v_exp_f32 v153, v153
    v_exp_f32 v154, v154
    v_exp_f32 v155, v155
    v_pk_add_f32 v[88:89], v[88:89], 1.0 op_sel_hi:[1,0]
    v_pk_add_f32 v[90:91], v[90:91], 1.0 op_sel_hi:[1,0]
    v_pk_add_f32 v[152:153], v[152:153], 1.0 op_sel_hi:[1,0]
    v_pk_add_f32 v[154:155], v[154:155], 1.0 op_sel_hi:[1,0]
    v_rcp_f32 v88, v88
    v_rcp_f32 v89, v89
    v_rcp_f32 v90, v90
    v_rcp_f32 v91, v91
    v_rcp_f32 v152, v152
    v_rcp_f32 v153, v153
    v_rcp_f32 v154, v154
    v_rcp_f32 v155, v155
    v_pk_mul_f32 v[88:89], v[88:89], v[120:121]
    v_pk_mul_f32 v[90:91], v[90:91], v[122:123]
    v_pk_mul_f32 v[152:153], v[152:153], v[184:185]
    v_pk_mul_f32 v[154:155], v[154:155], v[186:187]
    v_cvt_pk_bf16_f32 v216, v88, v89
    v_cvt_pk_bf16_f32 v217, v90, v91
    v_cvt_pk_bf16_f32 v218, v152, v153
    v_cvt_pk_bf16_f32 v219, v154, v155
    v_pk_mul_f32 v[92:93], v[92:93], s[66:67]
    v_pk_mul_f32 v[94:95], v[94:95], s[66:67]
    v_pk_mul_f32 v[156:157], v[156:157], s[66:67]
    v_pk_mul_f32 v[158:159], v[158:159], s[66:67]
    v_exp_f32 v92, v92
    v_exp_f32 v93, v93
    v_exp_f32 v94, v94
    v_exp_f32 v95, v95
    v_exp_f32 v156, v156
    v_exp_f32 v157, v157
    v_exp_f32 v158, v158
    v_exp_f32 v159, v159
    v_pk_add_f32 v[92:93], v[92:93], 1.0 op_sel_hi:[1,0]
    v_pk_add_f32 v[94:95], v[94:95], 1.0 op_sel_hi:[1,0]
    v_pk_add_f32 v[156:157], v[156:157], 1.0 op_sel_hi:[1,0]
    v_pk_add_f32 v[158:159], v[158:159], 1.0 op_sel_hi:[1,0]
    v_rcp_f32 v92, v92
    v_rcp_f32 v93, v93
    v_rcp_f32 v94, v94
    v_rcp_f32 v95, v95
    v_rcp_f32 v156, v156
    v_rcp_f32 v157, v157
    v_rcp_f32 v158, v158
    v_rcp_f32 v159, v159
    v_pk_mul_f32 v[92:93], v[92:93], v[124:125]
    v_pk_mul_f32 v[94:95], v[94:95], v[126:127]
    v_pk_mul_f32 v[156:157], v[156:157], v[188:189]
    v_pk_mul_f32 v[158:159], v[158:159], v[190:191]
    v_cvt_pk_bf16_f32 v220, v92, v93
    v_cvt_pk_bf16_f32 v221, v94, v95
    v_cvt_pk_bf16_f32 v222, v156, v157
    v_cvt_pk_bf16_f32 v223, v158, v159
    s_branch L_p2
L_g1_wc1:
    s_add_u32 m0, s28, 0
    s_nop 0
    buffer_load_dwordx4 v2, s[24:27], s43 offen  lds
    s_add_u32 m0, s29, 0
    s_nop 0
    buffer_load_dwordx4 v3, s[24:27], s43 offen  lds
    s_add_u32 m0, s30, 0
    s_nop 0
    buffer_load_dwordx4 v4, s[24:27], s43 offen  lds
    s_add_u32 s43, s43, s39
    s_add_u32 m0, s31, 0
    s_nop 0
    buffer_load_dwordx4 v5, s[16:19], s44 offen  lds
    s_add_u32 m0, s32, 0
    s_nop 0
    buffer_load_dwordx4 v6, s[16:19], s44 offen  lds
    s_add_u32 s44, s44, 229376
    v_bfe_u32 v20, v19, 2, 1
    v_bfe_u32 v21, v19, 3, 1
    v_xor_b32 v20, v20, v21
    v_lshl_add_u32 v20, v20, 1, v21
    v_lshrrev_b32 v21, 4, v19
    v_xor_b32 v20, v20, v21
    v_and_b32 v21, 15, v19
    v_lshlrev_b32 v21, 6, v21
    v_lshl_add_u32 v20, v20, 4, v21
    s_lshl_b32 s3, s47, 13
    v_add_u32 v7, s3, v20
    v_lshrrev_b32 v20, 2, v19
    v_and_b32 v21, 3, v19
    v_lshlrev_b32 v21, 3, v21
    v_bfe_u32 v22, v19, 4, 1
    v_lshlrev_b32 v22, 5, v22
    v_mul_u32_u24 v23, 192, v20
    v_add_u32 v23, v23, v21
    v_add_u32 v23, 16384, v23
    v_add_u32 v9, v23, v22
    v_sub_u32 v11, v23, v22
    v_mul_u32_u24 v23, 224, v20
    v_add_u32 v23, v23, v21
    v_add_u32 v13, 22528, v23
    v_add_u32 v8, 73728, v7
    v_add_u32 v10, 73728, v9
    v_add_u32 v12, 73728, v11
    v_add_u32 v14, 73728, v13
    v_lshlrev_b32 v22, 2, v19
    v_mov_b32 v32, 0
    v_mov_b32 v33, 0
    v_mov_b32 v34, 0
    v_mov_b32 v35, 0
    v_mov_b32 v36, 0
    v_mov_b32 v37, 0
    v_mov_b32 v38, 0
    v_mov_b32 v39, 0
    v_mov_b32 v40, 0
    v_mov_b32 v41, 0
    v_mov_b32 v42, 0
    v_mov_b32 v43, 0
    v_mov_b32 v44, 0
    v_mov_b32 v45, 0
    v_mov_b32 v46, 0
    v_mov_b32 v47, 0
    v_mov_b32 v48, 0
    v_mov_b32 v49, 0
    v_mov_b32 v50, 0
    v_mov_b32 v51, 0
    v_mov_b32 v52, 0
    v_mov_b32 v53, 0
    v_mov_b32 v54, 0
    v_mov_b32 v55, 0
    v_mov_b32 v56, 0
    v_mov_b32 v57, 0
    v_mov_b32 v58, 0
    v_mov_b32 v59, 0
    v_mov_b32 v60, 0
    v_mov_b32 v61, 0
    v_mov_b32 v62, 0
    v_mov_b32 v63, 0
    v_mov_b32 v64, 0
    v_mov_b32 v65, 0
    v_mov_b32 v66, 0
    v_mov_b32 v67, 0
    v_mov_b32 v68, 0
    v_mov_b32 v69, 0
    v_mov_b32 v70, 0
    v_mov_b32 v71, 0
    v_mov_b32 v72, 0
    v_mov_b32 v73, 0
    v_mov_b32 v74, 0
    v_mov_b32 v75, 0
    v_mov_b32 v76, 0
    v_mov_b32 v77, 0
    v_mov_b32 v78, 0
    v_mov_b32 v79, 0
    v_mov_b32 v80, 0
    v_mov_b32 v81, 0
    v_mov_b32 v82, 0
    v_mov_b32 v83, 0
    v_mov_b32 v84, 0
    v_mov_b32 v85, 0
    v_mov_b32 v86, 0
    v_mov_b32 v87, 0
    v_mov_b32 v88, 0
    v_mov_b32 v89, 0
    v_mov_b32 v90, 0
    v_mov_b32 v91, 0
    v_mov_b32 v92, 0
    v_mov_b32 v93, 0
    v_mov_b32 v94, 0
    v_mov_b32 v95, 0
    s_waitcnt vmcnt(5)
    s_barrier
    s_add_u32 m0, s28, 36864
    v_mov_b32 v96, 0
    buffer_load_dwordx4 v2, s[24:27], s43 offen  lds
    v_mov_b32 v97, 0
    v_mov_b32 v98, 0
    v_mov_b32 v99, 0
    v_mov_b32 v100, 0
    v_mov_b32 v101, 0
    v_mov_b32 v102, 0
    v_mov_b32 v103, 0
    v_mov_b32 v104, 0
    v_mov_b32 v105, 0
    v_mov_b32 v106, 0
    v_mov_b32 v107, 0
    v_mov_b32 v108, 0
    v_mov_b32 v109, 0
    v_mov_b32 v110, 0
    v_mov_b32 v111, 0
    v_mov_b32 v112, 0
    s_add_u32 m0, s29, 36864
    v_mov_b32 v113, 0
    buffer_load_dwordx4 v3, s[24:27], s43 offen  lds
    v_mov_b32 v114, 0
    v_mov_b32 v115, 0
    v_mov_b32 v116, 0
    v_mov_b32 v117, 0
    v_mov_b32 v118, 0
    v_mov_b32 v119, 0
    v_mov_b32 v120, 0
    v_mov_b32 v121, 0
    v_mov_b32 v122, 0
    v_mov_b32 v123, 0
    v_mov_b32 v124, 0
    v_mov_b32 v125, 0
    v_mov_b32 v126, 0
    v_mov_b32 v127, 0
    v_mov_b32 v128, 0
    v_mov_b32 v129, 0
    s_add_u32 m0, s30, 36864
    v_mov_b32 v130, 0
    buffer_load_dwordx4 v4, s[24:27], s43 offen  lds
    v_mov_b32 v131, 0
    v_mov_b32 v132, 0
    v_mov_b32 v133, 0
    v_mov_b32 v134, 0
    v_mov_b32 v135, 0
    v_mov_b32 v136, 0
    v_mov_b32 v137, 0
    v_mov_b32 v138, 0
    v_mov_b32 v139, 0
    v_mov_b32 v140, 0
    v_mov_b32 v141, 0
    v_mov_b32 v142, 0
    v_mov_b32 v143, 0
    v_mov_b32 v144, 0
    v_mov_b32 v145, 0
    v_mov_b32 v146, 0
    s_add_u32 s43, s43, s39
    s_add_u32 m0, s31, 36864
    v_mov_b32 v147, 0
    buffer_load_dwordx4 v5, s[16:19], s44 offen  lds
    v_mov_b32 v148, 0
    v_mov_b32 v149, 0
    v_mov_b32 v150, 0
    v_mov_b32 v151, 0
    v_mov_b32 v152, 0
    v_mov_b32 v153, 0
    v_mov_b32 v154, 0
    v_mov_b32 v155, 0
    v_mov_b32 v156, 0
    v_mov_b32 v157, 0
    v_mov_b32 v158, 0
    v_mov_b32 v159, 0
    v_mov_b32 v160, 0
    v_mov_b32 v161, 0
    v_mov_b32 v162, 0
    v_mov_b32 v163, 0
    s_add_u32 m0, s32, 36864
    v_mov_b32 v164, 0
    buffer_load_dwordx4 v6, s[16:19], s44 offen  lds
    v_mov_b32 v165, 0
    v_mov_b32 v166, 0
    v_mov_b32 v167, 0
    v_mov_b32 v168, 0
    v_mov_b32 v169, 0
    v_mov_b32 v170, 0
    v_mov_b32 v171, 0
    v_mov_b32 v172, 0
    v_mov_b32 v173, 0
    v_mov_b32 v174, 0
    v_mov_b32 v175, 0
    v_mov_b32 v176, 0
    v_mov_b32 v177, 0
    v_mov_b32 v178, 0
    v_mov_b32 v179, 0
    v_mov_b32 v180, 0
    s_add_u32 s44, s44, 229376
    s_add_u32 m0, s28, 73728
    v_mov_b32 v181, 0
    buffer_load_dwordx4 v2, s[24:27], s43 offen  lds
    v_mov_b32 v182, 0
    v_mov_b32 v183, 0
    v_mov_b32 v184, 0
    v_mov_b32 v185, 0
    v_mov_b32 v186, 0
    v_mov_b32 v187, 0
    v_mov_b32 v188, 0
    v_mov_b32 v189, 0
    v_mov_b32 v190, 0
    v_mov_b32 v191, 0
    v_mov_b32 v192, 0
    v_mov_b32 v193, 0
    v_mov_b32 v194, 0
    v_mov_b32 v195, 0
    v_mov_b32 v196, 0
    v_mov_b32 v197, 0
    s_add_u32 m0, s29, 73728
    v_mov_b32 v198, 0
    buffer_load_dwordx4 v3, s[24:27], s43 offen  lds
    v_mov_b32 v199, 0
    v_mov_b32 v200, 0
    v_mov_b32 v201, 0
    v_mov_b32 v202, 0
    v_mov_b32 v203, 0
    v_mov_b32 v204, 0
    v_mov_b32 v205, 0
    v_mov_b32 v206, 0
    v_mov_b32 v207, 0
    v_mov_b32 v208, 0
    v_mov_b32 v209, 0
    v_mov_b32 v210, 0
    v_mov_b32 v211, 0
    v_mov_b32 v212, 0
    v_mov_b32 v213, 0
    v_mov_b32 v214, 0
    s_add_u32 m0, s30, 73728
    v_mov_b32 v215, 0
    buffer_load_dwordx4 v4, s[24:27], s43 offen  lds
    v_mov_b32 v216, 0
    v_mov_b32 v217, 0
    v_mov_b32 v218, 0
    v_mov_b32 v219, 0
    v_mov_b32 v220, 0
    v_mov_b32 v221, 0
    v_mov_b32 v222, 0
    v_mov_b32 v223, 0
    v_mov_b32 v224, 0
    v_mov_b32 v225, 0
    v_mov_b32 v226, 0
    v_mov_b32 v227, 0
    v_mov_b32 v228, 0
    v_mov_b32 v229, 0
    v_mov_b32 v230, 0
    v_mov_b32 v231, 0
    s_add_u32 s43, s43, s39
    s_add_u32 m0, s31, 73728
    v_mov_b32 v232, 0
    buffer_load_dwordx4 v5, s[16:19], s44 offen  lds
    v_mov_b32 v233, 0
    v_mov_b32 v234, 0
    v_mov_b32 v235, 0
    v_mov_b32 v236, 0
    v_mov_b32 v237, 0
    v_mov_b32 v238, 0
    v_mov_b32 v239, 0
    v_mov_b32 v240, 0
    v_mov_b32 v241, 0
    v_mov_b32 v242, 0
    v_mov_b32 v243, 0
    v_mov_b32 v244, 0
    v_mov_b32 v245, 0
    v_mov_b32 v246, 0
    v_mov_b32 v247, 0
    v_mov_b32 v248, 0
    s_add_u32 m0, s32, 73728
    v_mov_b32 v249, 0
    buffer_load_dwordx4 v6, s[16:19], s44 offen  lds
    v_mov_b32 v250, 0
    v_mov_b32 v251, 0
    v_mov_b32 v252, 0
    v_mov_b32 v253, 0
    v_mov_b32 v254, 0
    v_mov_b32 v255, 0
    v_accvgpr_write_b32 a0, 0
    v_accvgpr_write_b32 a1, 0
    v_accvgpr_write_b32 a2, 0
    v_accvgpr_write_b32 a3, 0
    v_accvgpr_write_b32 a4, 0
    v_accvgpr_write_b32 a5, 0
    v_accvgpr_write_b32 a6, 0
    v_accvgpr_write_b32 a7, 0
    v_accvgpr_write_b32 a8, 0
    v_accvgpr_write_b32 a9, 0
    s_add_u32 s44, s44, 229376
    s_add_u32 m0, s28, 110592
    v_accvgpr_write_b32 a10, 0
    buffer_load_dwordx4 v2, s[24:27], s43 offen  lds
    v_accvgpr_write_b32 a11, 0
    v_accvgpr_write_b32 a12, 0
    v_accvgpr_write_b32 a13, 0
    v_accvgpr_write_b32 a14, 0
    v_accvgpr_write_b32 a15, 0
    v_accvgpr_write_b32 a16, 0
    v_accvgpr_write_b32 a17, 0
    v_accvgpr_write_b32 a18, 0
    v_accvgpr_write_b32 a19, 0
    v_accvgpr_write_b32 a20, 0
    v_accvgpr_write_b32 a21, 0
    v_accvgpr_write_b32 a22, 0
    v_accvgpr_write_b32 a23, 0
    v_accvgpr_write_b32 a24, 0
    v_accvgpr_write_b32 a25, 0
    v_accvgpr_write_b32 a26, 0
    s_add_u32 m0, s29, 110592
    v_accvgpr_write_b32 a27, 0
    buffer_load_dwordx4 v3, s[24:27], s43 offen  lds
    v_accvgpr_write_b32 a28, 0
    v_accvgpr_write_b32 a29, 0
    v_accvgpr_write_b32 a30, 0
    v_accvgpr_write_b32 a31, 0
    v_accvgpr_write_b32 a32, 0
    v_accvgpr_write_b32 a33, 0
    v_accvgpr_write_b32 a34, 0
    v_accvgpr_write_b32 a35, 0
    v_accvgpr_write_b32 a36, 0
    v_accvgpr_write_b32 a37, 0
    v_accvgpr_write_b32 a38, 0
    v_accvgpr_write_b32 a39, 0
    v_accvgpr_write_b32 a40, 0
    v_accvgpr_write_b32 a41, 0
    v_accvgpr_write_b32 a42, 0
    v_accvgpr_write_b32 a43, 0
    s_add_u32 m0, s30, 110592
    v_accvgpr_write_b32 a44, 0
    buffer_load_dwordx4 v4, s[24:27], s43 offen  lds
    v_accvgpr_write_b32 a45, 0
    v_accvgpr_write_b32 a46, 0
    v_accvgpr_write_b32 a47, 0
    v_accvgpr_write_b32 a48, 0
    v_accvgpr_write_b32 a49, 0
    v_accvgpr_write_b32 a50, 0
    v_accvgpr_write_b32 a51, 0
    v_accvgpr_write_b32 a52, 0
    v_accvgpr_write_b32 a53, 0
    v_accvgpr_write_b32 a54, 0
    v_accvgpr_write_b32 a55, 0
    v_accvgpr_write_b32 a56, 0
    v_accvgpr_write_b32 a57, 0
    v_accvgpr_write_b32 a58, 0
    v_accvgpr_write_b32 a59, 0
    v_accvgpr_write_b32 a60, 0
    s_add_u32 s43, s43, s39
    s_add_u32 m0, s31, 110592
    v_accvgpr_write_b32 a61, 0
    buffer_load_dwordx4 v5, s[16:19], s44 offen  lds
    v_accvgpr_write_b32 a62, 0
    v_accvgpr_write_b32 a63, 0
    v_accvgpr_write_b32 a64, 0
    v_accvgpr_write_b32 a65, 0
    v_accvgpr_write_b32 a66, 0
    v_accvgpr_write_b32 a67, 0
    v_accvgpr_write_b32 a68, 0
    v_accvgpr_write_b32 a69, 0
    v_accvgpr_write_b32 a70, 0
    v_accvgpr_write_b32 a71, 0
    v_accvgpr_write_b32 a72, 0
    v_accvgpr_write_b32 a73, 0
    v_accvgpr_write_b32 a74, 0
    v_accvgpr_write_b32 a75, 0
    v_accvgpr_write_b32 a76, 0
    v_accvgpr_write_b32 a77, 0
    s_add_u32 m0, s32, 110592
    v_accvgpr_write_b32 a78, 0
    buffer_load_dwordx4 v6, s[16:19], s44 offen  lds
    v_accvgpr_write_b32 a79, 0
    v_accvgpr_write_b32 a80, 0
    v_accvgpr_write_b32 a81, 0
    v_accvgpr_write_b32 a82, 0
    v_accvgpr_write_b32 a83, 0
    v_accvgpr_write_b32 a84, 0
    v_accvgpr_write_b32 a85, 0
    v_accvgpr_write_b32 a86, 0
    v_accvgpr_write_b32 a87, 0
    v_accvgpr_write_b32 a88, 0
    v_accvgpr_write_b32 a89, 0
    v_accvgpr_write_b32 a90, 0
    v_accvgpr_write_b32 a91, 0
    v_accvgpr_write_b32 a92, 0
    v_accvgpr_write_b32 a93, 0
    v_accvgpr_write_b32 a94, 0
    s_add_u32 s44, s44, 229376
    v_accvgpr_write_b32 a95, 0
    s_waitcnt vmcnt(0)
    s_barrier
    s_add_u32 m0, s36, 0
    s_nop 0
    buffer_load_dwordx4 v1, s[4:7], s41 offen offset:0 sc1 lds
    buffer_load_dwordx4 v1, s[4:7], s41 offen offset:1024 sc1 lds
    buffer_load_dwordx4 v1, s[4:7], s41 offen offset:2048 sc1 lds
    buffer_load_dwordx4 v1, s[4:7], s41 offen offset:3072 sc1 lds
    s_add_u32 s41, s41, 16384
    s_add_u32 m0, s36, 36864
    s_nop 0
    buffer_load_dwordx4 v1, s[4:7], s41 offen offset:0 sc1 lds
    buffer_load_dwordx4 v1, s[4:7], s41 offen offset:1024 sc1 lds
    buffer_load_dwordx4 v1, s[4:7], s41 offen offset:2048 sc1 lds
    buffer_load_dwordx4 v1, s[4:7], s41 offen offset:3072 sc1 lds
    s_add_u32 s41, s41, 16384
    ds_read_b64_tr_b16 a[128:129], v9 offset:64
    ds_read_b64_tr_b16 a[130:131], v9 offset:3136
    ds_read_b64_tr_b16 a[200:201], v9 offset:36928
    ds_read_b64_tr_b16 a[202:203], v9 offset:40000
    ds_read_b64_tr_b16 a[132:133], v11 offset:96
    ds_read_b64_tr_b16 a[134:135], v11 offset:3168
    ds_read_b64_tr_b16 a[204:205], v11 offset:36960
    ds_read_b64_tr_b16 a[206:207], v11 offset:40032
    ds_read_b64_tr_b16 a[136:137], v13 offset:0
    ds_read_b64_tr_b16 a[138:139], v13 offset:3584
    ds_read_b64_tr_b16 a[208:209], v13 offset:36864
    ds_read_b64_tr_b16 a[210:211], v13 offset:40448
    ds_read_b64_tr_b16 a[140:141], v13 offset:7168
    ds_read_b64_tr_b16 a[142:143], v13 offset:10752
    ds_read_b64_tr_b16 a[212:213], v13 offset:44032
    ds_read_b64_tr_b16 a[214:215], v13 offset:47616
    ds_read_b64_tr_b16 a[144:145], v13 offset:32
    ds_read_b64_tr_b16 a[146:147], v13 offset:3616
    ds_read_b64_tr_b16 a[216:217], v13 offset:36896
    ds_read_b64_tr_b16 a[218:219], v13 offset:40480
    ds_read_b64_tr_b16 a[148:149], v13 offset:7200
    ds_read_b64_tr_b16 a[150:151], v13 offset:10784
    ds_read_b64_tr_b16 a[220:221], v13 offset:44064
    ds_read_b64_tr_b16 a[222:223], v13 offset:47648
    ds_read_b64_tr_b16 a[152:153], v13 offset:64
    ds_read_b64_tr_b16 a[154:155], v13 offset:3648
    ds_read_b64_tr_b16 a[224:225], v13 offset:36928
    ds_read_b64_tr_b16 a[226:227], v13 offset:40512
    s_add_u32 m0, s36, 73728
    s_nop 0
    buffer_load_dwordx4 v1, s[4:7], s41 offen offset:0 sc1 lds
    buffer_load_dwordx4 v1, s[4:7], s41 offen offset:1024 sc1 lds
    buffer_load_dwordx4 v1, s[4:7], s41 offen offset:2048 sc1 lds
    buffer_load_dwordx4 v1, s[4:7], s41 offen offset:3072 sc1 lds
    s_add_u32 s41, s41, 16384
    s_add_u32 m0, s36, 110592
    s_nop 0
    buffer_load_dwordx4 v1, s[4:7], s41 offen offset:0 sc1 lds
    buffer_load_dwordx4 v1, s[4:7], s41 offen offset:1024 sc1 lds
    buffer_load_dwordx4 v1, s[4:7], s41 offen offset:2048 sc1 lds
    buffer_load_dwordx4 v1, s[4:7], s41 offen offset:3072 sc1 lds
    s_add_u32 s41, s41, 16384
    buffer_load_dword v16, v15, s[48:51], s42 offen
    s_add_u32 s42, s42, s62
    s_mov_b32 s60, 7
    s_waitcnt vmcnt(9)
    s_barrier
    ds_read_b128 a[96:99], v7 offset:0
    ds_read_b128 a[168:171], v7 offset:36864
    ds_read_b128 a[100:103], v7 offset:1024
    ds_read_b128 a[172:175], v7 offset:37888
    ds_read_b128 a[104:107], v7 offset:2048
    ds_read_b128 a[176:179], v7 offset:38912
    ds_read_b128 a[108:111], v7 offset:3072
    ds_read_b128 a[180:183], v7 offset:39936
    ds_read_b128 a[112:115], v7 offset:4096
    ds_read_b128 a[184:187], v7 offset:40960
    ds_read_b128 a[116:119], v7 offset:5120
    ds_read_b128 a[188:191], v7 offset:41984
    ds_read_b128 a[120:123], v7 offset:6144
    ds_read_b128 a[192:195], v7 offset:43008
.p2align 6
L_g1_loop1:
    s_waitcnt lgkmcnt(2)
    v_mfma_f32_16x16x32_bf16 a[0:3], a[128:131], a[96:99], a[0:3]
    ds_read_b128 a[124:127], v7 offset:7168
    v_mfma_f32_16x16x32_bf16 a[0:3], a[200:203], a[168:171], a[0:3]
    ds_read_b128 a[196:199], v7 offset:44032
    v_mfma_f32_16x16x32_bf16 a[32:35], a[204:207], a[168:171], a[32:35]
    ds_read_b64_tr_b16 a[156:157], v13 offset:7232
    v_mfma_f32_16x16x32_bf16 a[32:35], a[132:135], a[96:99], a[32:35]
    ds_read_b64_tr_b16 a[158:159], v13 offset:10816
    v_mfma_f32_16x16x32_bf16 a[64:67], a[136:139], a[96:99], a[64:67]
    ds_read_b64_tr_b16 a[228:229], v13 offset:44096
    v_mfma_f32_16x16x32_bf16 a[64:67], a[208:211], a[168:171], a[64:67]
    ds_read_b64_tr_b16 a[230:231], v13 offset:47680
    v_mfma_f32_16x16x32_bf16 a[4:7], a[200:203], a[172:175], a[4:7]
    ds_read_b64_tr_b16 a[160:161], v13 offset:96
    v_mfma_f32_16x16x32_bf16 a[4:7], a[128:131], a[100:103], a[4:7]
    ds_read_b64_tr_b16 a[162:163], v13 offset:3680
    v_mfma_f32_16x16x32_bf16 a[36:39], a[132:135], a[100:103], a[36:39]
    ds_read_b64_tr_b16 a[232:233], v13 offset:36960
    v_mfma_f32_16x16x32_bf16 a[36:39], a[204:207], a[172:175], a[36:39]
    ds_read_b64_tr_b16 a[234:235], v13 offset:40544
    v_mfma_f32_16x16x32_bf16 a[68:71], a[208:211], a[172:175], a[68:71]
    ds_read_b64_tr_b16 a[164:165], v13 offset:7264
    v_mfma_f32_16x16x32_bf16 a[68:71], a[136:139], a[100:103], a[68:71]
    ds_read_b64_tr_b16 a[166:167], v13 offset:10848
    v_mfma_f32_16x16x32_bf16 a[8:11], a[128:131], a[104:107], a[8:11]
    ds_read_b64_tr_b16 a[236:237], v13 offset:44128
    v_mfma_f32_16x16x32_bf16 a[8:11], a[200:203], a[176:179], a[8:11]
    ds_read_b64_tr_b16 a[238:239], v13 offset:47712
    v_mfma_f32_16x16x32_bf16 a[40:43], a[204:207], a[176:179], a[40:43]
    s_cmp_ge_u32 s38, 8
    s_cselect_b32 s3, s37, 0
    v_mfma_f32_16x16x32_bf16 a[40:43], a[132:135], a[104:107], a[40:43]
    s_add_u32 s3, s3, s38
    v_mfma_f32_16x16x32_bf16 a[72:75], a[136:139], a[104:107], a[72:75]
    s_and_b32 s3, s3, 7
    v_mfma_f32_16x16x32_bf16 a[72:75], a[208:211], a[176:179], a[72:75]
    s_and_b32 s33, s38, 24
    v_mfma_f32_16x16x32_bf16 a[12:15], a[200:203], a[180:183], a[12:15]
    s_or_b32 s3, s3, s33
    v_mfma_f32_16x16x32_bf16 a[12:15], a[128:131], a[108:111], a[12:15]
    s_add_u32 s38, s38, 1
    v_mfma_f32_16x16x32_bf16 a[44:47], a[132:135], a[108:111], a[44:47]
    s_mul_i32 s44, s3, 229376
    v_mfma_f32_16x16x32_bf16 a[44:47], a[204:207], a[180:183], a[44:47]
    s_mul_i32 s43, s3, s39
    v_mfma_f32_16x16x32_bf16 a[76:79], a[208:211], a[180:183], a[76:79]
    s_mul_i32 s3, s3, 16384
    v_mfma_f32_16x16x32_bf16 a[76:79], a[136:139], a[108:111], a[76:79]
    s_add_u32 s41, s40, s3
    v_mfma_f32_16x16x32_bf16 a[16:19], a[128:131], a[112:115], a[16:19]
    s_add_u32 m0, s28, 0
    v_mfma_f32_16x16x32_bf16 a[16:19], a[200:203], a[184:187], a[16:19]
    s_waitcnt lgkmcnt(0)
    s_barrier
    v_mfma_f32_16x16x32_bf16 a[48:51], a[204:207], a[184:187], a[48:51]
    buffer_load_dwordx4 v2, s[24:27], s43 offen  lds
    v_mfma_f32_16x16x32_bf16 a[48:51], a[132:135], a[112:115], a[48:51]
    v_mfma_f32_16x16x32_bf16 a[80:83], a[136:139], a[112:115], a[80:83]
    v_mfma_f32_16x16x32_bf16 a[80:83], a[208:211], a[184:187], a[80:83]
    v_mfma_f32_16x16x32_bf16 a[20:23], a[200:203], a[188:191], a[20:23]
    v_mfma_f32_16x16x32_bf16 a[20:23], a[128:131], a[116:119], a[20:23]
    s_add_u32 m0, s29, 0
    v_mfma_f32_16x16x32_bf16 a[52:55], a[132:135], a[116:119], a[52:55]
    buffer_load_dwordx4 v3, s[24:27], s43 offen  lds
    v_mfma_f32_16x16x32_bf16 a[52:55], a[204:207], a[188:191], a[52:55]
    v_mfma_f32_16x16x32_bf16 a[84:87], a[208:211], a[188:191], a[84:87]
    v_mfma_f32_16x16x32_bf16 a[84:87], a[136:139], a[116:119], a[84:87]
    v_mfma_f32_16x16x32_bf16 a[24:27], a[128:131], a[120:123], a[24:27]
    v_mfma_f32_16x16x32_bf16 a[24:27], a[200:203], a[192:195], a[24:27]
    s_add_u32 m0, s30, 0
    v_mfma_f32_16x16x32_bf16 a[56:59], a[204:207], a[192:195], a[56:59]
    buffer_load_dwordx4 v4, s[24:27], s43 offen  lds
    v_mfma_f32_16x16x32_bf16 a[56:59], a[132:135], a[120:123], a[56:59]
    v_mfma_f32_16x16x32_bf16 a[88:91], a[136:139], a[120:123], a[88:91]
    v_mfma_f32_16x16x32_bf16 a[88:91], a[208:211], a[192:195], a[88:91]
    v_mfma_f32_16x16x32_bf16 a[28:31], a[200:203], a[196:199], a[28:31]
    v_mfma_f32_16x16x32_bf16 a[28:31], a[128:131], a[124:127], a[28:31]
    s_add_u32 m0, s31, 0
    v_mfma_f32_16x16x32_bf16 a[60:63], a[132:135], a[124:127], a[60:63]
    buffer_load_dwordx4 v5, s[16:19], s44 offen  lds
    v_mfma_f32_16x16x32_bf16 a[60:63], a[204:207], a[196:199], a[60:63]
    v_mfma_f32_16x16x32_bf16 a[92:95], a[208:211], a[196:199], a[92:95]
    v_mfma_f32_16x16x32_bf16 a[92:95], a[136:139], a[124:127], a[92:95]
    v_mfma_f32_16x16x32_bf16 v[32:35], a[140:143], a[96:99], v[32:35]
    v_mfma_f32_16x16x32_bf16 v[32:35], a[212:215], a[168:171], v[32:35]
    s_add_u32 m0, s32, 0
    v_mfma_f32_16x16x32_bf16 v[36:39], a[212:215], a[172:175], v[36:39]
    buffer_load_dwordx4 v6, s[16:19], s44 offen  lds
    v_mfma_f32_16x16x32_bf16 v[36:39], a[140:143], a[100:103], v[36:39]
    v_mfma_f32_16x16x32_bf16 v[40:43], a[140:143], a[104:107], v[40:43]
    v_mfma_f32_16x16x32_bf16 v[40:43], a[212:215], a[176:179], v[40:43]
    v_mfma_f32_16x16x32_bf16 v[44:47], a[212:215], a[180:183], v[44:47]
    v_mfma_f32_16x16x32_bf16 v[44:47], a[140:143], a[108:111], v[44:47]
    s_add_u32 m0, s36, 0
    v_mfma_f32_16x16x32_bf16 v[48:51], a[140:143], a[112:115], v[48:51]
    buffer_load_dwordx4 v1, s[4:7], s41 offen offset:0 sc1 lds
    v_mfma_f32_16x16x32_bf16 v[48:51], a[212:215], a[184:187], v[48:51]
    v_mfma_f32_16x16x32_bf16 v[52:55], a[212:215], a[188:191], v[52:55]
    v_mfma_f32_16x16x32_bf16 v[52:55], a[140:143], a[116:119], v[52:55]
    v_mfma_f32_16x16x32_bf16 v[56:59], a[140:143], a[120:123], v[56:59]
    v_mfma_f32_16x16x32_bf16 v[56:59], a[212:215], a[192:195], v[56:59]
    v_mfma_f32_16x16x32_bf16 v[60:63], a[212:215], a[196:199], v[60:63]
    buffer_load_dwordx4 v1, s[4:7], s41 offen offset:1024 sc1 lds
    v_mfma_f32_16x16x32_bf16 v[60:63], a[140:143], a[124:127], v[60:63]
    v_mfma_f32_16x16x32_bf16 v[92:95], a[144:147], a[124:127], v[92:95]
    v_mfma_f32_16x16x32_bf16 v[92:95], a[216:219], a[196:199], v[92:95]
    v_mfma_f32_16x16x32_bf16 v[88:91], a[216:219], a[192:195], v[88:91]
    v_mfma_f32_16x16x32_bf16 v[88:91], a[144:147], a[120:123], v[88:91]
    v_mfma_f32_16x16x32_bf16 v[84:87], a[144:147], a[116:119], v[84:87]
    buffer_load_dwordx4 v1, s[4:7], s41 offen offset:2048 sc1 lds
    v_mfma_f32_16x16x32_bf16 v[84:87], a[216:219], a[188:191], v[84:87]
    v_mfma_f32_16x16x32_bf16 v[80:83], a[216:219], a[184:187], v[80:83]
    v_mfma_f32_16x16x32_bf16 v[80:83], a[144:147], a[112:115], v[80:83]
    v_mfma_f32_16x16x32_bf16 v[76:79], a[144:147], a[108:111], v[76:79]
    v_mfma_f32_16x16x32_bf16 v[76:79], a[216:219], a[180:183], v[76:79]
    v_mfma_f32_16x16x32_bf16 v[72:75], a[216:219], a[176:179], v[72:75]
    buffer_load_dwordx4 v1, s[4:7], s41 offen offset:3072 sc1 lds
    v_mfma_f32_16x16x32_bf16 v[72:75], a[144:147], a[104:107], v[72:75]
    s_cmp_ge_u32 s38, 8
    s_cselect_b32 s3, s37, 0
    s_add_u32 s3, s3, s38
    v_mfma_f32_16x16x32_bf16 v[68:71], a[144:147], a[100:103], v[68:71]
    s_and_b32 s3, s3, 7
    s_and_b32 s33, s38, 24
    v_mfma_f32_16x16x32_bf16 v[68:71], a[216:219], a[172:175], v[68:71]
    s_or_b32 s3, s3, s33
    v_mfma_f32_16x16x32_bf16 v[64:67], a[216:219], a[168:171], v[64:67]
    s_add_u32 s38, s38, 1
    s_mul_i32 s44, s3, 229376
    v_mfma_f32_16x16x32_bf16 v[64:67], a[144:147], a[96:99], v[64:67]
    s_waitcnt vmcnt(10)
    s_barrier
    v_mfma_f32_16x16x32_bf16 v[96:99], a[148:151], a[96:99], v[96:99]
    s_mul_i32 s43, s3, s39
    ds_read_b64_tr_b16 a[128:129], v10 offset:64
    v_mfma_f32_16x16x32_bf16 v[96:99], a[220:223], a[168:171], v[96:99]
    s_mul_i32 s3, s3, 16384
    s_add_u32 s41, s40, s3
    ds_read_b64_tr_b16 a[130:131], v10 offset:3136
    v_mfma_f32_16x16x32_bf16 v[100:103], a[220:223], a[172:175], v[100:103]
    s_add_u32 m0, s28, 36864
    ds_read_b64_tr_b16 a[200:201], v10 offset:36928
    v_mfma_f32_16x16x32_bf16 v[100:103], a[148:151], a[100:103], v[100:103]
    buffer_load_dwordx4 v2, s[24:27], s43 offen  lds
    v_mfma_f32_16x16x32_bf16 v[104:107], a[148:151], a[104:107], v[104:107]
    ds_read_b64_tr_b16 a[202:203], v10 offset:40000
    v_mfma_f32_16x16x32_bf16 v[104:107], a[220:223], a[176:179], v[104:107]
    ds_read_b64_tr_b16 a[132:133], v12 offset:96
    v_mfma_f32_16x16x32_bf16 v[108:111], a[220:223], a[180:183], v[108:111]
    s_add_u32 m0, s29, 36864
    ds_read_b64_tr_b16 a[134:135], v12 offset:3168
    v_mfma_f32_16x16x32_bf16 v[108:111], a[148:151], a[108:111], v[108:111]
    buffer_load_dwordx4 v3, s[24:27], s43 offen  lds
    v_mfma_f32_16x16x32_bf16 v[112:115], a[148:151], a[112:115], v[112:115]
    ds_read_b64_tr_b16 a[204:205], v12 offset:36960
    v_mfma_f32_16x16x32_bf16 v[112:115], a[220:223], a[184:187], v[112:115]
    ds_read_b64_tr_b16 a[206:207], v12 offset:40032
    v_mfma_f32_16x16x32_bf16 v[116:119], a[220:223], a[188:191], v[116:119]
    ds_read_b64_tr_b16 a[136:137], v14 offset:0
    v_mfma_f32_16x16x32_bf16 v[116:119], a[148:151], a[116:119], v[116:119]
    v_mfma_f32_16x16x32_bf16 v[120:123], a[148:151], a[120:123], v[120:123]
    ds_read_b64_tr_b16 a[138:139], v14 offset:3584
    v_mfma_f32_16x16x32_bf16 v[120:123], a[220:223], a[192:195], v[120:123]
    ds_read_b64_tr_b16 a[208:209], v14 offset:36864
    v_mfma_f32_16x16x32_bf16 v[124:127], a[220:223], a[196:199], v[124:127]
    s_add_u32 m0, s30, 36864
    ds_read_b64_tr_b16 a[210:211], v14 offset:40448
    v_mfma_f32_16x16x32_bf16 v[124:127], a[148:151], a[124:127], v[124:127]
    buffer_load_dwordx4 v4, s[24:27], s43 offen  lds
    v_mfma_f32_16x16x32_bf16 v[156:159], a[152:155], a[124:127], v[156:159]
    ds_read_b64_tr_b16 a[140:141], v14 offset:7168
    v_mfma_f32_16x16x32_bf16 v[156:159], a[224:227], a[196:199], v[156:159]
    ds_read_b64_tr_b16 a[142:143], v14 offset:10752
    v_mfma_f32_16x16x32_bf16 v[152:155], a[224:227], a[192:195], v[152:155]
    s_add_u32 m0, s31, 36864
    ds_read_b64_tr_b16 a[212:213], v14 offset:44032
    v_mfma_f32_16x16x32_bf16 v[152:155], a[152:155], a[120:123], v[152:155]
    buffer_load_dwordx4 v5, s[16:19], s44 offen  lds
    v_mfma_f32_16x16x32_bf16 v[148:151], a[152:155], a[116:119], v[148:151]
    ds_read_b64_tr_b16 a[214:215], v14 offset:47616
    v_mfma_f32_16x16x32_bf16 v[148:151], a[224:227], a[188:191], v[148:151]
    ds_read_b64_tr_b16 a[144:145], v14 offset:32
    v_mfma_f32_16x16x32_bf16 v[144:147], a[224:227], a[184:187], v[144:147]
    ds_read_b64_tr_b16 a[146:147], v14 offset:3616
    v_mfma_f32_16x16x32_bf16 v[144:147], a[152:155], a[112:115], v[144:147]
    v_mfma_f32_16x16x32_bf16 v[140:143], a[152:155], a[108:111], v[140:143]
    ds_read_b64_tr_b16 a[216:217], v14 offset:36896
    v_mfma_f32_16x16x32_bf16 v[140:143], a[224:227], a[180:183], v[140:143]
    ds_read_b64_tr_b16 a[218:219], v14 offset:40480
    v_mfma_f32_16x16x32_bf16 v[136:139], a[224:227], a[176:179], v[136:139]
    s_add_u32 m0, s32, 36864
    ds_read_b64_tr_b16 a[148:149], v14 offset:7200
    v_mfma_f32_16x16x32_bf16 v[136:139], a[152:155], a[104:107], v[136:139]
    buffer_load_dwordx4 v6, s[16:19], s44 offen  lds
    v_mfma_f32_16x16x32_bf16 v[132:135], a[152:155], a[100:103], v[132:135]
    ds_read_b64_tr_b16 a[150:151], v14 offset:10784
    v_mfma_f32_16x16x32_bf16 v[132:135], a[224:227], a[172:175], v[132:135]
    ds_read_b64_tr_b16 a[220:221], v14 offset:44064
    v_mfma_f32_16x16x32_bf16 v[128:131], a[224:227], a[168:171], v[128:131]
    s_add_u32 m0, s36, 36864
    ds_read_b64_tr_b16 a[222:223], v14 offset:47648
    v_mfma_f32_16x16x32_bf16 v[128:131], a[152:155], a[96:99], v[128:131]
    buffer_load_dwordx4 v1, s[4:7], s41 offen offset:0 sc1 lds
    v_mfma_f32_16x16x32_bf16 v[160:163], a[156:159], a[96:99], v[160:163]
    ds_read_b64_tr_b16 a[152:153], v14 offset:64
    v_mfma_f32_16x16x32_bf16 v[160:163], a[228:231], a[168:171], v[160:163]
    ds_read_b64_tr_b16 a[154:155], v14 offset:3648
    v_mfma_f32_16x16x32_bf16 v[192:195], a[232:235], a[168:171], v[192:195]
    ds_read_b64_tr_b16 a[224:225], v14 offset:36928
    v_mfma_f32_16x16x32_bf16 v[192:195], a[160:163], a[96:99], v[192:195]
    ds_read_b64_tr_b16 a[226:227], v14 offset:40512
    v_mfma_f32_16x16x32_bf16 v[224:227], a[164:167], a[96:99], v[224:227]
    buffer_load_dwordx4 v1, s[4:7], s41 offen offset:1024 sc1 lds
    v_mfma_f32_16x16x32_bf16 v[224:227], a[236:239], a[168:171], v[224:227]
    ds_read_b128 a[96:99], v8 offset:0
    v_mfma_f32_16x16x32_bf16 v[164:167], a[228:231], a[172:175], v[164:167]
    ds_read_b128 a[168:171], v8 offset:36864
    v_mfma_f32_16x16x32_bf16 v[164:167], a[156:159], a[100:103], v[164:167]
    v_mfma_f32_16x16x32_bf16 v[196:199], a[160:163], a[100:103], v[196:199]
    v_mfma_f32_16x16x32_bf16 v[196:199], a[232:235], a[172:175], v[196:199]
    v_mfma_f32_16x16x32_bf16 v[228:231], a[236:239], a[172:175], v[228:231]
    buffer_load_dwordx4 v1, s[4:7], s41 offen offset:2048 sc1 lds
    v_mfma_f32_16x16x32_bf16 v[228:231], a[164:167], a[100:103], v[228:231]
    ds_read_b128 a[100:103], v8 offset:1024
    v_mfma_f32_16x16x32_bf16 v[168:171], a[156:159], a[104:107], v[168:171]
    ds_read_b128 a[172:175], v8 offset:37888
    v_mfma_f32_16x16x32_bf16 v[168:171], a[228:231], a[176:179], v[168:171]
    v_mfma_f32_16x16x32_bf16 v[200:203], a[232:235], a[176:179], v[200:203]
    v_mfma_f32_16x16x32_bf16 v[200:203], a[160:163], a[104:107], v[200:203]
    v_mfma_f32_16x16x32_bf16 v[232:235], a[164:167], a[104:107], v[232:235]
    buffer_load_dwordx4 v1, s[4:7], s41 offen offset:3072 sc1 lds
    v_mfma_f32_16x16x32_bf16 v[232:235], a[236:239], a[176:179], v[232:235]
    ds_read_b128 a[104:107], v8 offset:2048
    v_mfma_f32_16x16x32_bf16 v[172:175], a[228:231], a[180:183], v[172:175]
    ds_read_b128 a[176:179], v8 offset:38912
    v_mfma_f32_16x16x32_bf16 v[172:175], a[156:159], a[108:111], v[172:175]
    v_mfma_f32_16x16x32_bf16 v[204:207], a[160:163], a[108:111], v[204:207]
    v_mfma_f32_16x16x32_bf16 v[204:207], a[232:235], a[180:183], v[204:207]
    v_mfma_f32_16x16x32_bf16 v[236:239], a[236:239], a[180:183], v[236:239]
    buffer_load_dword v16, v15, s[48:51], s42 offen
    v_mfma_f32_16x16x32_bf16 v[236:239], a[164:167], a[108:111], v[236:239]
    s_add_u32 s42, s42, s62
    ds_read_b128 a[108:111], v8 offset:3072
    v_mfma_f32_16x16x32_bf16 v[176:179], a[156:159], a[112:115], v[176:179]
    ds_read_b128 a[180:183], v8 offset:39936
    v_mfma_f32_16x16x32_bf16 v[176:179], a[228:231], a[184:187], v[176:179]
    v_mfma_f32_16x16x32_bf16 v[208:211], a[232:235], a[184:187], v[208:211]
    v_mfma_f32_16x16x32_bf16 v[208:211], a[160:163], a[112:115], v[208:211]
    v_mfma_f32_16x16x32_bf16 v[240:243], a[164:167], a[112:115], v[240:243]
    v_mfma_f32_16x16x32_bf16 v[240:243], a[236:239], a[184:187], v[240:243]
    ds_read_b128 a[112:115], v8 offset:4096
    v_mfma_f32_16x16x32_bf16 v[180:183], a[228:231], a[188:191], v[180:183]
    ds_read_b128 a[184:187], v8 offset:40960
    v_mfma_f32_16x16x32_bf16 v[180:183], a[156:159], a[116:119], v[180:183]
    v_mfma_f32_16x16x32_bf16 v[212:215], a[160:163], a[116:119], v[212:215]
    v_mfma_f32_16x16x32_bf16 v[212:215], a[232:235], a[188:191], v[212:215]
    v_mfma_f32_16x16x32_bf16 v[244:247], a[236:239], a[188:191], v[244:247]
    v_mfma_f32_16x16x32_bf16 v[244:247], a[164:167], a[116:119], v[244:247]
    ds_read_b128 a[116:119], v8 offset:5120
    v_mfma_f32_16x16x32_bf16 v[184:187], a[156:159], a[120:123], v[184:187]
    ds_read_b128 a[188:191], v8 offset:41984
    v_mfma_f32_16x16x32_bf16 v[184:187], a[228:231], a[192:195], v[184:187]
    v_mfma_f32_16x16x32_bf16 v[216:219], a[232:235], a[192:195], v[216:219]
    v_mfma_f32_16x16x32_bf16 v[216:219], a[160:163], a[120:123], v[216:219]
    v_mfma_f32_16x16x32_bf16 v[248:251], a[164:167], a[120:123], v[248:251]
    v_mfma_f32_16x16x32_bf16 v[248:251], a[236:239], a[192:195], v[248:251]
    ds_read_b128 a[120:123], v8 offset:6144
    v_mfma_f32_16x16x32_bf16 v[188:191], a[228:231], a[196:199], v[188:191]
    ds_read_b128 a[192:195], v8 offset:43008
    v_mfma_f32_16x16x32_bf16 v[188:191], a[156:159], a[124:127], v[188:191]
    v_mfma_f32_16x16x32_bf16 v[220:223], a[160:163], a[124:127], v[220:223]
    v_mfma_f32_16x16x32_bf16 v[220:223], a[232:235], a[196:199], v[220:223]
    v_mfma_f32_16x16x32_bf16 v[252:255], a[236:239], a[196:199], v[252:255]
    v_mfma_f32_16x16x32_bf16 v[252:255], a[164:167], a[124:127], v[252:255]
    s_waitcnt lgkmcnt(2)
    v_mfma_f32_16x16x32_bf16 a[0:3], a[128:131], a[96:99], a[0:3]
    ds_read_b128 a[124:127], v8 offset:7168
    v_mfma_f32_16x16x32_bf16 a[0:3], a[200:203], a[168:171], a[0:3]
    ds_read_b128 a[196:199], v8 offset:44032
    v_mfma_f32_16x16x32_bf16 a[32:35], a[204:207], a[168:171], a[32:35]
    ds_read_b64_tr_b16 a[156:157], v14 offset:7232
    v_mfma_f32_16x16x32_bf16 a[32:35], a[132:135], a[96:99], a[32:35]
    ds_read_b64_tr_b16 a[158:159], v14 offset:10816
    v_mfma_f32_16x16x32_bf16 a[64:67], a[136:139], a[96:99], a[64:67]
    ds_read_b64_tr_b16 a[228:229], v14 offset:44096
    v_mfma_f32_16x16x32_bf16 a[64:67], a[208:211], a[168:171], a[64:67]
    ds_read_b64_tr_b16 a[230:231], v14 offset:47680
    v_mfma_f32_16x16x32_bf16 a[4:7], a[200:203], a[172:175], a[4:7]
    ds_read_b64_tr_b16 a[160:161], v14 offset:96
    v_mfma_f32_16x16x32_bf16 a[4:7], a[128:131], a[100:103], a[4:7]
    ds_read_b64_tr_b16 a[162:163], v14 offset:3680
    v_mfma_f32_16x16x32_bf16 a[36:39], a[132:135], a[100:103], a[36:39]
    ds_read_b64_tr_b16 a[232:233], v14 offset:36960
    v_mfma_f32_16x16x32_bf16 a[36:39], a[204:207], a[172:175], a[36:39]
    ds_read_b64_tr_b16 a[234:235], v14 offset:40544
    v_mfma_f32_16x16x32_bf16 a[68:71], a[208:211], a[172:175], a[68:71]
    ds_read_b64_tr_b16 a[164:165], v14 offset:7264
    v_mfma_f32_16x16x32_bf16 a[68:71], a[136:139], a[100:103], a[68:71]
    ds_read_b64_tr_b16 a[166:167], v14 offset:10848
    v_mfma_f32_16x16x32_bf16 a[8:11], a[128:131], a[104:107], a[8:11]
    ds_read_b64_tr_b16 a[236:237], v14 offset:44128
    v_mfma_f32_16x16x32_bf16 a[8:11], a[200:203], a[176:179], a[8:11]
    ds_read_b64_tr_b16 a[238:239], v14 offset:47712
    v_mfma_f32_16x16x32_bf16 a[40:43], a[204:207], a[176:179], a[40:43]
    s_cmp_ge_u32 s38, 8
    s_cselect_b32 s3, s37, 0
    v_mfma_f32_16x16x32_bf16 a[40:43], a[132:135], a[104:107], a[40:43]
    s_add_u32 s3, s3, s38
    v_mfma_f32_16x16x32_bf16 a[72:75], a[136:139], a[104:107], a[72:75]
    s_and_b32 s3, s3, 7
    v_mfma_f32_16x16x32_bf16 a[72:75], a[208:211], a[176:179], a[72:75]
    s_and_b32 s33, s38, 24
    v_mfma_f32_16x16x32_bf16 a[12:15], a[200:203], a[180:183], a[12:15]
    s_or_b32 s3, s3, s33
    v_mfma_f32_16x16x32_bf16 a[12:15], a[128:131], a[108:111], a[12:15]
    s_add_u32 s38, s38, 1
    v_mfma_f32_16x16x32_bf16 a[44:47], a[132:135], a[108:111], a[44:47]
    s_mul_i32 s44, s3, 229376
    v_mfma_f32_16x16x32_bf16 a[44:47], a[204:207], a[180:183], a[44:47]
    s_mul_i32 s43, s3, s39
    v_mfma_f32_16x16x32_bf16 a[76:79], a[208:211], a[180:183], a[76:79]
    s_mul_i32 s3, s3, 16384
    v_mfma_f32_16x16x32_bf16 a[76:79], a[136:139], a[108:111], a[76:79]
    s_add_u32 s41, s40, s3
    v_mfma_f32_16x16x32_bf16 a[16:19], a[128:131], a[112:115], a[16:19]
    s_add_u32 m0, s28, 73728
    v_mfma_f32_16x16x32_bf16 a[16:19], a[200:203], a[184:187], a[16:19]
    s_waitcnt lgkmcnt(0)
    s_barrier
    v_mfma_f32_16x16x32_bf16 a[48:51], a[204:207], a[184:187], a[48:51]
    buffer_load_dwordx4 v2, s[24:27], s43 offen  lds
    v_mfma_f32_16x16x32_bf16 a[48:51], a[132:135], a[112:115], a[48:51]
    v_mfma_f32_16x16x32_bf16 a[80:83], a[136:139], a[112:115], a[80:83]
    v_mfma_f32_16x16x32_bf16 a[80:83], a[208:211], a[184:187], a[80:83]
    v_mfma_f32_16x16x32_bf16 a[20:23], a[200:203], a[188:191], a[20:23]
    v_mfma_f32_16x16x32_bf16 a[20:23], a[128:131], a[116:119], a[20:23]
    s_add_u32 m0, s29, 73728
    v_mfma_f32_16x16x32_bf16 a[52:55], a[132:135], a[116:119], a[52:55]
    buffer_load_dwordx4 v3, s[24:27], s43 offen  lds
    v_mfma_f32_16x16x32_bf16 a[52:55], a[204:207], a[188:191], a[52:55]
    v_mfma_f32_16x16x32_bf16 a[84:87], a[208:211], a[188:191], a[84:87]
    v_mfma_f32_16x16x32_bf16 a[84:87], a[136:139], a[116:119], a[84:87]
    v_mfma_f32_16x16x32_bf16 a[24:27], a[128:131], a[120:123], a[24:27]
    v_mfma_f32_16x16x32_bf16 a[24:27], a[200:203], a[192:195], a[24:27]
    s_add_u32 m0, s30, 73728
    v_mfma_f32_16x16x32_bf16 a[56:59], a[204:207], a[192:195], a[56:59]
    buffer_load_dwordx4 v4, s[24:27], s43 offen  lds
    v_mfma_f32_16x16x32_bf16 a[56:59], a[132:135], a[120:123], a[56:59]
    v_mfma_f32_16x16x32_bf16 a[88:91], a[136:139], a[120:123], a[88:91]
    v_mfma_f32_16x16x32_bf16 a[88:91], a[208:211], a[192:195], a[88:91]
    v_mfma_f32_16x16x32_bf16 a[28:31], a[200:203], a[196:199], a[28:31]
    v_mfma_f32_16x16x32_bf16 a[28:31], a[128:131], a[124:127], a[28:31]
    s_add_u32 m0, s31, 73728
    v_mfma_f32_16x16x32_bf16 a[60:63], a[132:135], a[124:127], a[60:63]
    buffer_load_dwordx4 v5, s[16:19], s44 offen  lds
    v_mfma_f32_16x16x32_bf16 a[60:63], a[204:207], a[196:199], a[60:63]
    v_mfma_f32_16x16x32_bf16 a[92:95], a[208:211], a[196:199], a[92:95]
    v_mfma_f32_16x16x32_bf16 a[92:95], a[136:139], a[124:127], a[92:95]
    v_mfma_f32_16x16x32_bf16 v[32:35], a[140:143], a[96:99], v[32:35]
    v_mfma_f32_16x16x32_bf16 v[32:35], a[212:215], a[168:171], v[32:35]
    s_add_u32 m0, s32, 73728
    v_mfma_f32_16x16x32_bf16 v[36:39], a[212:215], a[172:175], v[36:39]
    buffer_load_dwordx4 v6, s[16:19], s44 offen  lds
    v_mfma_f32_16x16x32_bf16 v[36:39], a[140:143], a[100:103], v[36:39]
    v_mfma_f32_16x16x32_bf16 v[40:43], a[140:143], a[104:107], v[40:43]
    v_mfma_f32_16x16x32_bf16 v[40:43], a[212:215], a[176:179], v[40:43]
    v_mfma_f32_16x16x32_bf16 v[44:47], a[212:215], a[180:183], v[44:47]
    v_mfma_f32_16x16x32_bf16 v[44:47], a[140:143], a[108:111], v[44:47]
    s_add_u32 m0, s36, 73728
    v_mfma_f32_16x16x32_bf16 v[48:51], a[140:143], a[112:115], v[48:51]
    buffer_load_dwordx4 v1, s[4:7], s41 offen offset:0 sc1 lds
    v_mfma_f32_16x16x32_bf16 v[48:51], a[212:215], a[184:187], v[48:51]
    v_mfma_f32_16x16x32_bf16 v[52:55], a[212:215], a[188:191], v[52:55]
    v_mfma_f32_16x16x32_bf16 v[52:55], a[140:143], a[116:119], v[52:55]
    v_mfma_f32_16x16x32_bf16 v[56:59], a[140:143], a[120:123], v[56:59]
    v_mfma_f32_16x16x32_bf16 v[56:59], a[212:215], a[192:195], v[56:59]
    v_mfma_f32_16x16x32_bf16 v[60:63], a[212:215], a[196:199], v[60:63]
    buffer_load_dwordx4 v1, s[4:7], s41 offen offset:1024 sc1 lds
    v_mfma_f32_16x16x32_bf16 v[60:63], a[140:143], a[124:127], v[60:63]
    v_mfma_f32_16x16x32_bf16 v[92:95], a[144:147], a[124:127], v[92:95]
    v_mfma_f32_16x16x32_bf16 v[92:95], a[216:219], a[196:199], v[92:95]
    v_mfma_f32_16x16x32_bf16 v[88:91], a[216:219], a[192:195], v[88:91]
    v_mfma_f32_16x16x32_bf16 v[88:91], a[144:147], a[120:123], v[88:91]
    v_mfma_f32_16x16x32_bf16 v[84:87], a[144:147], a[116:119], v[84:87]
    buffer_load_dwordx4 v1, s[4:7], s41 offen offset:2048 sc1 lds
    v_mfma_f32_16x16x32_bf16 v[84:87], a[216:219], a[188:191], v[84:87]
    v_mfma_f32_16x16x32_bf16 v[80:83], a[216:219], a[184:187], v[80:83]
    v_mfma_f32_16x16x32_bf16 v[80:83], a[144:147], a[112:115], v[80:83]
    v_mfma_f32_16x16x32_bf16 v[76:79], a[144:147], a[108:111], v[76:79]
    v_mfma_f32_16x16x32_bf16 v[76:79], a[216:219], a[180:183], v[76:79]
    v_mfma_f32_16x16x32_bf16 v[72:75], a[216:219], a[176:179], v[72:75]
    buffer_load_dwordx4 v1, s[4:7], s41 offen offset:3072 sc1 lds
    v_mfma_f32_16x16x32_bf16 v[72:75], a[144:147], a[104:107], v[72:75]
    s_cmp_ge_u32 s38, 8
    s_cselect_b32 s3, s37, 0
    s_add_u32 s3, s3, s38
    v_mfma_f32_16x16x32_bf16 v[68:71], a[144:147], a[100:103], v[68:71]
    s_and_b32 s3, s3, 7
    s_and_b32 s33, s38, 24
    v_mfma_f32_16x16x32_bf16 v[68:71], a[216:219], a[172:175], v[68:71]
    s_or_b32 s3, s3, s33
    v_mfma_f32_16x16x32_bf16 v[64:67], a[216:219], a[168:171], v[64:67]
    s_add_u32 s38, s38, 1
    s_mul_i32 s44, s3, 229376
    v_mfma_f32_16x16x32_bf16 v[64:67], a[144:147], a[96:99], v[64:67]
    s_waitcnt vmcnt(10)
    s_barrier
    v_mfma_f32_16x16x32_bf16 v[96:99], a[148:151], a[96:99], v[96:99]
    s_mul_i32 s43, s3, s39
    ds_read_b64_tr_b16 a[128:129], v9 offset:64
    v_mfma_f32_16x16x32_bf16 v[96:99], a[220:223], a[168:171], v[96:99]
    s_mul_i32 s3, s3, 16384
    s_add_u32 s41, s40, s3
    ds_read_b64_tr_b16 a[130:131], v9 offset:3136
    v_mfma_f32_16x16x32_bf16 v[100:103], a[220:223], a[172:175], v[100:103]
    s_add_u32 m0, s28, 110592
    ds_read_b64_tr_b16 a[200:201], v9 offset:36928
    v_mfma_f32_16x16x32_bf16 v[100:103], a[148:151], a[100:103], v[100:103]
    buffer_load_dwordx4 v2, s[24:27], s43 offen  lds
    v_mfma_f32_16x16x32_bf16 v[104:107], a[148:151], a[104:107], v[104:107]
    ds_read_b64_tr_b16 a[202:203], v9 offset:40000
    v_mfma_f32_16x16x32_bf16 v[104:107], a[220:223], a[176:179], v[104:107]
    ds_read_b64_tr_b16 a[132:133], v11 offset:96
    v_mfma_f32_16x16x32_bf16 v[108:111], a[220:223], a[180:183], v[108:111]
    s_add_u32 m0, s29, 110592
    ds_read_b64_tr_b16 a[134:135], v11 offset:3168
    v_mfma_f32_16x16x32_bf16 v[108:111], a[148:151], a[108:111], v[108:111]
    buffer_load_dwordx4 v3, s[24:27], s43 offen  lds
    v_mfma_f32_16x16x32_bf16 v[112:115], a[148:151], a[112:115], v[112:115]
    ds_read_b64_tr_b16 a[204:205], v11 offset:36960
    v_mfma_f32_16x16x32_bf16 v[112:115], a[220:223], a[184:187], v[112:115]
    ds_read_b64_tr_b16 a[206:207], v11 offset:40032
    v_mfma_f32_16x16x32_bf16 v[116:119], a[220:223], a[188:191], v[116:119]
    ds_read_b64_tr_b16 a[136:137], v13 offset:0
    v_mfma_f32_16x16x32_bf16 v[116:119], a[148:151], a[116:119], v[116:119]
    v_mfma_f32_16x16x32_bf16 v[120:123], a[148:151], a[120:123], v[120:123]
    ds_read_b64_tr_b16 a[138:139], v13 offset:3584
    v_mfma_f32_16x16x32_bf16 v[120:123], a[220:223], a[192:195], v[120:123]
    ds_read_b64_tr_b16 a[208:209], v13 offset:36864
    v_mfma_f32_16x16x32_bf16 v[124:127], a[220:223], a[196:199], v[124:127]
    s_add_u32 m0, s30, 110592
    ds_read_b64_tr_b16 a[210:211], v13 offset:40448
    v_mfma_f32_16x16x32_bf16 v[124:127], a[148:151], a[124:127], v[124:127]
    buffer_load_dwordx4 v4, s[24:27], s43 offen  lds
    v_mfma_f32_16x16x32_bf16 v[156:159], a[152:155], a[124:127], v[156:159]
    ds_read_b64_tr_b16 a[140:141], v13 offset:7168
    v_mfma_f32_16x16x32_bf16 v[156:159], a[224:227], a[196:199], v[156:159]
    ds_read_b64_tr_b16 a[142:143], v13 offset:10752
    v_mfma_f32_16x16x32_bf16 v[152:155], a[224:227], a[192:195], v[152:155]
    s_add_u32 m0, s31, 110592
    ds_read_b64_tr_b16 a[212:213], v13 offset:44032
    v_mfma_f32_16x16x32_bf16 v[152:155], a[152:155], a[120:123], v[152:155]
    buffer_load_dwordx4 v5, s[16:19], s44 offen  lds
    v_mfma_f32_16x16x32_bf16 v[148:151], a[152:155], a[116:119], v[148:151]
    ds_read_b64_tr_b16 a[214:215], v13 offset:47616
    v_mfma_f32_16x16x32_bf16 v[148:151], a[224:227], a[188:191], v[148:151]
    ds_read_b64_tr_b16 a[144:145], v13 offset:32
    v_mfma_f32_16x16x32_bf16 v[144:147], a[224:227], a[184:187], v[144:147]
    ds_read_b64_tr_b16 a[146:147], v13 offset:3616
    v_mfma_f32_16x16x32_bf16 v[144:147], a[152:155], a[112:115], v[144:147]
    v_mfma_f32_16x16x32_bf16 v[140:143], a[152:155], a[108:111], v[140:143]
    ds_read_b64_tr_b16 a[216:217], v13 offset:36896
    v_mfma_f32_16x16x32_bf16 v[140:143], a[224:227], a[180:183], v[140:143]
    ds_read_b64_tr_b16 a[218:219], v13 offset:40480
    v_mfma_f32_16x16x32_bf16 v[136:139], a[224:227], a[176:179], v[136:139]
    s_add_u32 m0, s32, 110592
    ds_read_b64_tr_b16 a[148:149], v13 offset:7200
    v_mfma_f32_16x16x32_bf16 v[136:139], a[152:155], a[104:107], v[136:139]
    buffer_load_dwordx4 v6, s[16:19], s44 offen  lds
    v_mfma_f32_16x16x32_bf16 v[132:135], a[152:155], a[100:103], v[132:135]
    ds_read_b64_tr_b16 a[150:151], v13 offset:10784
    v_mfma_f32_16x16x32_bf16 v[132:135], a[224:227], a[172:175], v[132:135]
    ds_read_b64_tr_b16 a[220:221], v13 offset:44064
    v_mfma_f32_16x16x32_bf16 v[128:131], a[224:227], a[168:171], v[128:131]
    s_add_u32 m0, s36, 110592
    ds_read_b64_tr_b16 a[222:223], v13 offset:47648
    v_mfma_f32_16x16x32_bf16 v[128:131], a[152:155], a[96:99], v[128:131]
    buffer_load_dwordx4 v1, s[4:7], s41 offen offset:0 sc1 lds
    v_mfma_f32_16x16x32_bf16 v[160:163], a[156:159], a[96:99], v[160:163]
    ds_read_b64_tr_b16 a[152:153], v13 offset:64
    v_mfma_f32_16x16x32_bf16 v[160:163], a[228:231], a[168:171], v[160:163]
    ds_read_b64_tr_b16 a[154:155], v13 offset:3648
    v_mfma_f32_16x16x32_bf16 v[192:195], a[232:235], a[168:171], v[192:195]
    ds_read_b64_tr_b16 a[224:225], v13 offset:36928
    v_mfma_f32_16x16x32_bf16 v[192:195], a[160:163], a[96:99], v[192:195]
    ds_read_b64_tr_b16 a[226:227], v13 offset:40512
    v_mfma_f32_16x16x32_bf16 v[224:227], a[164:167], a[96:99], v[224:227]
    buffer_load_dwordx4 v1, s[4:7], s41 offen offset:1024 sc1 lds
    v_mfma_f32_16x16x32_bf16 v[224:227], a[236:239], a[168:171], v[224:227]
    ds_read_b128 a[96:99], v7 offset:0
    v_mfma_f32_16x16x32_bf16 v[164:167], a[228:231], a[172:175], v[164:167]
    ds_read_b128 a[168:171], v7 offset:36864
    v_mfma_f32_16x16x32_bf16 v[164:167], a[156:159], a[100:103], v[164:167]
    v_mfma_f32_16x16x32_bf16 v[196:199], a[160:163], a[100:103], v[196:199]
    v_mfma_f32_16x16x32_bf16 v[196:199], a[232:235], a[172:175], v[196:199]
    v_mfma_f32_16x16x32_bf16 v[228:231], a[236:239], a[172:175], v[228:231]
    buffer_load_dwordx4 v1, s[4:7], s41 offen offset:2048 sc1 lds
    v_mfma_f32_16x16x32_bf16 v[228:231], a[164:167], a[100:103], v[228:231]
    ds_read_b128 a[100:103], v7 offset:1024
    v_mfma_f32_16x16x32_bf16 v[168:171], a[156:159], a[104:107], v[168:171]
    ds_read_b128 a[172:175], v7 offset:37888
    v_mfma_f32_16x16x32_bf16 v[168:171], a[228:231], a[176:179], v[168:171]
    v_mfma_f32_16x16x32_bf16 v[200:203], a[232:235], a[176:179], v[200:203]
    v_mfma_f32_16x16x32_bf16 v[200:203], a[160:163], a[104:107], v[200:203]
    v_mfma_f32_16x16x32_bf16 v[232:235], a[164:167], a[104:107], v[232:235]
    buffer_load_dwordx4 v1, s[4:7], s41 offen offset:3072 sc1 lds
    v_mfma_f32_16x16x32_bf16 v[232:235], a[236:239], a[176:179], v[232:235]
    ds_read_b128 a[104:107], v7 offset:2048
    v_mfma_f32_16x16x32_bf16 v[172:175], a[228:231], a[180:183], v[172:175]
    ds_read_b128 a[176:179], v7 offset:38912
    v_mfma_f32_16x16x32_bf16 v[172:175], a[156:159], a[108:111], v[172:175]
    v_mfma_f32_16x16x32_bf16 v[204:207], a[160:163], a[108:111], v[204:207]
    v_mfma_f32_16x16x32_bf16 v[204:207], a[232:235], a[180:183], v[204:207]
    v_mfma_f32_16x16x32_bf16 v[236:239], a[236:239], a[180:183], v[236:239]
    buffer_load_dword v16, v15, s[48:51], s42 offen
    v_mfma_f32_16x16x32_bf16 v[236:239], a[164:167], a[108:111], v[236:239]
    s_add_u32 s42, s42, s62
    ds_read_b128 a[108:111], v7 offset:3072
    v_mfma_f32_16x16x32_bf16 v[176:179], a[156:159], a[112:115], v[176:179]
    s_sub_u32 s60, s60, 1
    ds_read_b128 a[180:183], v7 offset:39936
    v_mfma_f32_16x16x32_bf16 v[176:179], a[228:231], a[184:187], v[176:179]
    s_cmp_lg_u32 s60, 0
    v_mfma_f32_16x16x32_bf16 v[208:211], a[232:235], a[184:187], v[208:211]
    v_mfma_f32_16x16x32_bf16 v[208:211], a[160:163], a[112:115], v[208:211]
    v_mfma_f32_16x16x32_bf16 v[240:243], a[164:167], a[112:115], v[240:243]
    v_mfma_f32_16x16x32_bf16 v[240:243], a[236:239], a[184:187], v[240:243]
    ds_read_b128 a[112:115], v7 offset:4096
    v_mfma_f32_16x16x32_bf16 v[180:183], a[228:231], a[188:191], v[180:183]
    ds_read_b128 a[184:187], v7 offset:40960
    v_mfma_f32_16x16x32_bf16 v[180:183], a[156:159], a[116:119], v[180:183]
    v_mfma_f32_16x16x32_bf16 v[212:215], a[160:163], a[116:119], v[212:215]
    v_mfma_f32_16x16x32_bf16 v[212:215], a[232:235], a[188:191], v[212:215]
    v_mfma_f32_16x16x32_bf16 v[244:247], a[236:239], a[188:191], v[244:247]
    v_mfma_f32_16x16x32_bf16 v[244:247], a[164:167], a[116:119], v[244:247]
    ds_read_b128 a[116:119], v7 offset:5120
    v_mfma_f32_16x16x32_bf16 v[184:187], a[156:159], a[120:123], v[184:187]
    ds_read_b128 a[188:191], v7 offset:41984
    v_mfma_f32_16x16x32_bf16 v[184:187], a[228:231], a[192:195], v[184:187]
    v_mfma_f32_16x16x32_bf16 v[216:219], a[232:235], a[192:195], v[216:219]
    v_mfma_f32_16x16x32_bf16 v[216:219], a[160:163], a[120:123], v[216:219]
    v_mfma_f32_16x16x32_bf16 v[248:251], a[164:167], a[120:123], v[248:251]
    v_mfma_f32_16x16x32_bf16 v[248:251], a[236:239], a[192:195], v[248:251]
    ds_read_b128 a[120:123], v7 offset:6144
    v_mfma_f32_16x16x32_bf16 v[188:191], a[228:231], a[196:199], v[188:191]
    ds_read_b128 a[192:195], v7 offset:43008
    v_mfma_f32_16x16x32_bf16 v[188:191], a[156:159], a[124:127], v[188:191]
    v_mfma_f32_16x16x32_bf16 v[220:223], a[160:163], a[124:127], v[220:223]
    v_mfma_f32_16x16x32_bf16 v[220:223], a[232:235], a[196:199], v[220:223]
    v_mfma_f32_16x16x32_bf16 v[252:255], a[236:239], a[196:199], v[252:255]
    v_mfma_f32_16x16x32_bf16 v[252:255], a[164:167], a[124:127], v[252:255]
    s_cbranch_scc1 L_g1_loop1
    s_waitcnt lgkmcnt(2)
    v_mfma_f32_16x16x32_bf16 a[0:3], a[128:131], a[96:99], a[0:3]
    ds_read_b128 a[124:127], v7 offset:7168
    v_mfma_f32_16x16x32_bf16 a[0:3], a[200:203], a[168:171], a[0:3]
    ds_read_b128 a[196:199], v7 offset:44032
    v_mfma_f32_16x16x32_bf16 a[32:35], a[204:207], a[168:171], a[32:35]
    ds_read_b64_tr_b16 a[156:157], v13 offset:7232
    v_mfma_f32_16x16x32_bf16 a[32:35], a[132:135], a[96:99], a[32:35]
    ds_read_b64_tr_b16 a[158:159], v13 offset:10816
    v_mfma_f32_16x16x32_bf16 a[64:67], a[136:139], a[96:99], a[64:67]
    ds_read_b64_tr_b16 a[228:229], v13 offset:44096
    v_mfma_f32_16x16x32_bf16 a[64:67], a[208:211], a[168:171], a[64:67]
    ds_read_b64_tr_b16 a[230:231], v13 offset:47680
    v_mfma_f32_16x16x32_bf16 a[4:7], a[200:203], a[172:175], a[4:7]
    ds_read_b64_tr_b16 a[160:161], v13 offset:96
    v_mfma_f32_16x16x32_bf16 a[4:7], a[128:131], a[100:103], a[4:7]
    ds_read_b64_tr_b16 a[162:163], v13 offset:3680
    v_mfma_f32_16x16x32_bf16 a[36:39], a[132:135], a[100:103], a[36:39]
    ds_read_b64_tr_b16 a[232:233], v13 offset:36960
    v_mfma_f32_16x16x32_bf16 a[36:39], a[204:207], a[172:175], a[36:39]
    ds_read_b64_tr_b16 a[234:235], v13 offset:40544
    v_mfma_f32_16x16x32_bf16 a[68:71], a[208:211], a[172:175], a[68:71]
    ds_read_b64_tr_b16 a[164:165], v13 offset:7264
    v_mfma_f32_16x16x32_bf16 a[68:71], a[136:139], a[100:103], a[68:71]
    ds_read_b64_tr_b16 a[166:167], v13 offset:10848
    v_mfma_f32_16x16x32_bf16 a[8:11], a[128:131], a[104:107], a[8:11]
    ds_read_b64_tr_b16 a[236:237], v13 offset:44128
    v_mfma_f32_16x16x32_bf16 a[8:11], a[200:203], a[176:179], a[8:11]
    ds_read_b64_tr_b16 a[238:239], v13 offset:47712
    v_mfma_f32_16x16x32_bf16 a[40:43], a[204:207], a[176:179], a[40:43]
    s_getpc_b64 s[34:35]
L_pc4:
    v_mfma_f32_16x16x32_bf16 a[40:43], a[132:135], a[104:107], a[40:43]
    s_add_u32 s34, s34, L_p2-L_pc4
    s_addc_u32 s35, s35, 0
    v_mfma_f32_16x16x32_bf16 a[72:75], a[136:139], a[104:107], a[72:75]
    v_mfma_f32_16x16x32_bf16 a[72:75], a[208:211], a[176:179], a[72:75]
    s_lshr_b32 s3, s2, 3
    v_mfma_f32_16x16x32_bf16 a[12:15], a[200:203], a[180:183], a[12:15]
    v_mfma_f32_16x16x32_bf16 a[12:15], a[128:131], a[108:111], a[12:15]
    s_lshl_b32 s3, s3, 2
    v_mfma_f32_16x16x32_bf16 a[44:47], a[132:135], a[108:111], a[44:47]
    v_mfma_f32_16x16x32_bf16 a[44:47], a[204:207], a[180:183], a[44:47]
    s_add_u32 s3, s3, s46
    v_mfma_f32_16x16x32_bf16 a[76:79], a[208:211], a[180:183], a[76:79]
    v_mfma_f32_16x16x32_bf16 a[76:79], a[136:139], a[108:111], a[76:79]
    s_mul_i32 s3, s3, 512
    v_mfma_f32_16x16x32_bf16 a[16:19], a[128:131], a[112:115], a[16:19]
    v_lshlrev_b32 v20, 3, v1
    v_mfma_f32_16x16x32_bf16 a[16:19], a[200:203], a[184:187], a[16:19]
    s_waitcnt lgkmcnt(0)
    v_mfma_f32_16x16x32_bf16 a[48:51], a[204:207], a[184:187], a[48:51]
    v_mfma_f32_16x16x32_bf16 a[48:51], a[132:135], a[112:115], a[48:51]
    v_and_b32 v20, 511, v20
    v_mfma_f32_16x16x32_bf16 a[80:83], a[136:139], a[112:115], a[80:83]
    v_mfma_f32_16x16x32_bf16 a[80:83], a[208:211], a[184:187], a[80:83]
    v_add_u32 v20, s3, v20
    v_mfma_f32_16x16x32_bf16 a[20:23], a[200:203], a[188:191], a[20:23]
    v_mfma_f32_16x16x32_bf16 a[20:23], a[128:131], a[116:119], a[20:23]
    v_min_u32 v20, L_at_after-L_p2, v20
    v_mfma_f32_16x16x32_bf16 a[52:55], a[132:135], a[116:119], a[52:55]
    v_mfma_f32_16x16x32_bf16 a[52:55], a[204:207], a[188:191], a[52:55]
    global_load_dword v21, v20, s[34:35]
    v_mfma_f32_16x16x32_bf16 a[84:87], a[208:211], a[188:191], a[84:87]
    s_lshl_b32 s61, s57, 4
    v_mfma_f32_16x16x32_bf16 a[84:87], a[136:139], a[116:119], a[84:87]
    v_mfma_f32_16x16x32_bf16 a[24:27], a[128:131], a[120:123], a[24:27]
    s_lshl_b32 s3, s47, 3
    v_mfma_f32_16x16x32_bf16 a[24:27], a[200:203], a[192:195], a[24:27]
    v_mfma_f32_16x16x32_bf16 a[56:59], a[204:207], a[192:195], a[56:59]
    s_add_u32 s61, s61, s3
    v_mfma_f32_16x16x32_bf16 a[56:59], a[132:135], a[120:123], a[56:59]
    v_mfma_f32_16x16x32_bf16 a[88:91], a[136:139], a[120:123], a[88:91]
    s_lshl_b32 s62, s56, 7
    v_mfma_f32_16x16x32_bf16 a[88:91], a[208:211], a[192:195], a[88:91]
    v_mfma_f32_16x16x32_bf16 a[28:31], a[200:203], a[196:199], a[28:31]
    s_add_u32 s62, s62, s61
    v_mfma_f32_16x16x32_bf16 a[28:31], a[128:131], a[124:127], a[28:31]
    s_lshl_b32 s64, s62, 11
    v_mfma_f32_16x16x32_bf16 a[60:63], a[132:135], a[124:127], a[60:63]
    v_mfma_f32_16x16x32_bf16 a[60:63], a[204:207], a[196:199], a[60:63]
    s_add_u32 s64, s64, 8388608
    v_mfma_f32_16x16x32_bf16 a[92:95], a[208:211], a[196:199], a[92:95]
    v_mfma_f32_16x16x32_bf16 a[92:95], a[136:139], a[124:127], a[92:95]
    s_lshr_b32 s65, s61, 3
    v_mfma_f32_16x16x32_bf16 v[32:35], a[140:143], a[96:99], v[32:35]
    v_mfma_f32_16x16x32_bf16 v[32:35], a[212:215], a[168:171], v[32:35]
    s_mul_i32 s65, s65, 112
    v_mfma_f32_16x16x32_bf16 v[36:39], a[212:215], a[172:175], v[36:39]
    v_mfma_f32_16x16x32_bf16 v[36:39], a[140:143], a[100:103], v[36:39]
    s_mul_i32 s3, s56, 7
    v_mfma_f32_16x16x32_bf16 v[40:43], a[140:143], a[104:107], v[40:43]
    s_add_u32 s3, s3, 1
    v_mfma_f32_16x16x32_bf16 v[40:43], a[212:215], a[176:179], v[40:43]
    v_mfma_f32_16x16x32_bf16 v[44:47], a[212:215], a[180:183], v[44:47]
    s_lshr_b32 s3, s3, 1
    v_mfma_f32_16x16x32_bf16 v[44:47], a[140:143], a[108:111], v[44:47]
    v_mfma_f32_16x16x32_bf16 v[48:51], a[140:143], a[112:115], v[48:51]
    s_add_u32 s65, s65, s3
    v_mfma_f32_16x16x32_bf16 v[48:51], a[212:215], a[184:187], v[48:51]
    v_mfma_f32_16x16x32_bf16 v[52:55], a[212:215], a[188:191], v[52:55]
    s_lshl_b32 s65, s65, 13
    v_mfma_f32_16x16x32_bf16 v[52:55], a[140:143], a[116:119], v[52:55]
    v_mfma_f32_16x16x32_bf16 v[56:59], a[140:143], a[120:123], v[56:59]
    s_add_u32 s65, s65, 16777216
    v_mfma_f32_16x16x32_bf16 v[56:59], a[212:215], a[192:195], v[56:59]
    v_mfma_f32_16x16x32_bf16 v[60:63], a[212:215], a[196:199], v[60:63]
    s_mov_b32 s70, s65
    v_mfma_f32_16x16x32_bf16 v[60:63], a[140:143], a[124:127], v[60:63]
    s_add_u32 s71, s65, 8192
    v_mfma_f32_16x16x32_bf16 v[92:95], a[144:147], a[124:127], v[92:95]
    v_mfma_f32_16x16x32_bf16 v[92:95], a[216:219], a[196:199], v[92:95]
    s_mov_b32 s55, 0x20000000
    v_mfma_f32_16x16x32_bf16 v[88:91], a[216:219], a[192:195], v[88:91]
    v_mfma_f32_16x16x32_bf16 v[88:91], a[144:147], a[120:123], v[88:91]
    s_mov_b32 s66, 0xbfb8aa3b
    v_mfma_f32_16x16x32_bf16 v[84:87], a[144:147], a[116:119], v[84:87]
    v_mfma_f32_16x16x32_bf16 v[84:87], a[216:219], a[188:191], v[84:87]
    s_mov_b32 s67, 0xbfb8aa3b
    v_mfma_f32_16x16x32_bf16 v[80:83], a[216:219], a[184:187], v[80:83]
    v_mfma_f32_16x16x32_bf16 v[80:83], a[144:147], a[112:115], v[80:83]
    s_mov_b32 s68, 0x3e8293ee
    v_mfma_f32_16x16x32_bf16 v[76:79], a[144:147], a[108:111], v[76:79]
    s_mov_b32 s69, 0x3e8293ee
    v_mfma_f32_16x16x32_bf16 v[76:79], a[216:219], a[180:183], v[76:79]
    v_mfma_f32_16x16x32_bf16 v[72:75], a[216:219], a[176:179], v[72:75]
    s_lshl_b32 s3, s47, 14
    v_mfma_f32_16x16x32_bf16 v[72:75], a[144:147], a[104:107], v[72:75]
    v_mfma_f32_16x16x32_bf16 v[68:71], a[144:147], a[100:103], v[68:71]
    v_add_u32 v22, s3, v1
    v_mfma_f32_16x16x32_bf16 v[68:71], a[216:219], a[172:175], v[68:71]
    v_mfma_f32_16x16x32_bf16 v[64:67], a[216:219], a[168:171], v[64:67]
    s_lshl_b32 s3, s47, 13
    v_mfma_f32_16x16x32_bf16 v[64:67], a[144:147], a[96:99], v[64:67]
    s_waitcnt vmcnt(1)
    s_barrier
    v_mfma_f32_16x16x32_bf16 v[96:99], a[148:151], a[96:99], v[96:99]
    ds_read_b64_tr_b16 a[128:129], v10 offset:64
    v_mfma_f32_16x16x32_bf16 v[96:99], a[220:223], a[168:171], v[96:99]
    ds_read_b64_tr_b16 a[130:131], v10 offset:3136
    v_mfma_f32_16x16x32_bf16 v[100:103], a[220:223], a[172:175], v[100:103]
    ds_read_b64_tr_b16 a[200:201], v10 offset:36928
    v_mfma_f32_16x16x32_bf16 v[100:103], a[148:151], a[100:103], v[100:103]
    v_mfma_f32_16x16x32_bf16 v[104:107], a[148:151], a[104:107], v[104:107]
    ds_read_b64_tr_b16 a[202:203], v10 offset:40000
    v_mfma_f32_16x16x32_bf16 v[104:107], a[220:223], a[176:179], v[104:107]
    ds_read_b64_tr_b16 a[132:133], v12 offset:96
    v_mfma_f32_16x16x32_bf16 v[108:111], a[220:223], a[180:183], v[108:111]
    ds_read_b64_tr_b16 a[134:135], v12 offset:3168
    v_mfma_f32_16x16x32_bf16 v[108:111], a[148:151], a[108:111], v[108:111]
    v_add_u32 v23, s3, v1
    v_mfma_f32_16x16x32_bf16 v[112:115], a[148:151], a[112:115], v[112:115]
    ds_read_b64_tr_b16 a[204:205], v12 offset:36960
    v_mfma_f32_16x16x32_bf16 v[112:115], a[220:223], a[184:187], v[112:115]
    ds_read_b64_tr_b16 a[206:207], v12 offset:40032
    v_mfma_f32_16x16x32_bf16 v[116:119], a[220:223], a[188:191], v[116:119]
    ds_read_b64_tr_b16 a[136:137], v14 offset:0
    v_mfma_f32_16x16x32_bf16 v[116:119], a[148:151], a[116:119], v[116:119]
    s_mov_b32 s12, s76
    v_mfma_f32_16x16x32_bf16 v[120:123], a[148:151], a[120:123], v[120:123]
    ds_read_b64_tr_b16 a[138:139], v14 offset:3584
    v_mfma_f32_16x16x32_bf16 v[120:123], a[220:223], a[192:195], v[120:123]
    ds_read_b64_tr_b16 a[208:209], v14 offset:36864
    v_mfma_f32_16x16x32_bf16 v[124:127], a[220:223], a[196:199], v[124:127]
    ds_read_b64_tr_b16 a[210:211], v14 offset:40448
    v_mfma_f32_16x16x32_bf16 v[124:127], a[148:151], a[124:127], v[124:127]
    v_mfma_f32_16x16x32_bf16 v[156:159], a[152:155], a[124:127], v[156:159]
    ds_read_b64_tr_b16 a[140:141], v14 offset:7168
    v_mfma_f32_16x16x32_bf16 v[156:159], a[224:227], a[196:199], v[156:159]
    ds_read_b64_tr_b16 a[142:143], v14 offset:10752
    v_mfma_f32_16x16x32_bf16 v[152:155], a[224:227], a[192:195], v[152:155]
    ds_read_b64_tr_b16 a[212:213], v14 offset:44032
    v_mfma_f32_16x16x32_bf16 v[152:155], a[152:155], a[120:123], v[152:155]
    s_mov_b32 s13, s77
    v_mfma_f32_16x16x32_bf16 v[148:151], a[152:155], a[116:119], v[148:151]
    ds_read_b64_tr_b16 a[214:215], v14 offset:47616
    v_mfma_f32_16x16x32_bf16 v[148:151], a[224:227], a[188:191], v[148:151]
    ds_read_b64_tr_b16 a[144:145], v14 offset:32
    v_mfma_f32_16x16x32_bf16 v[144:147], a[224:227], a[184:187], v[144:147]
    ds_read_b64_tr_b16 a[146:147], v14 offset:3616
    v_mfma_f32_16x16x32_bf16 v[144:147], a[152:155], a[112:115], v[144:147]
    v_mfma_f32_16x16x32_bf16 v[140:143], a[152:155], a[108:111], v[140:143]
    ds_read_b64_tr_b16 a[216:217], v14 offset:36896
    v_mfma_f32_16x16x32_bf16 v[140:143], a[224:227], a[180:183], v[140:143]
    ds_read_b64_tr_b16 a[218:219], v14 offset:40480
    v_mfma_f32_16x16x32_bf16 v[136:139], a[224:227], a[176:179], v[136:139]
    ds_read_b64_tr_b16 a[148:149], v14 offset:7200
    v_mfma_f32_16x16x32_bf16 v[136:139], a[152:155], a[104:107], v[136:139]
    s_mov_b32 s14, 2097152
    v_mfma_f32_16x16x32_bf16 v[132:135], a[152:155], a[100:103], v[132:135]
    ds_read_b64_tr_b16 a[150:151], v14 offset:10784
    v_mfma_f32_16x16x32_bf16 v[132:135], a[224:227], a[172:175], v[132:135]
    ds_read_b64_tr_b16 a[220:221], v14 offset:44064
    v_mfma_f32_16x16x32_bf16 v[128:131], a[224:227], a[168:171], v[128:131]
    ds_read_b64_tr_b16 a[222:223], v14 offset:47648
    v_mfma_f32_16x16x32_bf16 v[128:131], a[152:155], a[96:99], v[128:131]
    v_mfma_f32_16x16x32_bf16 v[160:163], a[156:159], a[96:99], v[160:163]
    ds_read_b64_tr_b16 a[152:153], v14 offset:64
    v_mfma_f32_16x16x32_bf16 v[160:163], a[228:231], a[168:171], v[160:163]
    ds_read_b64_tr_b16 a[154:155], v14 offset:3648
    v_mfma_f32_16x16x32_bf16 v[192:195], a[232:235], a[168:171], v[192:195]
    ds_read_b64_tr_b16 a[224:225], v14 offset:36928
    v_mfma_f32_16x16x32_bf16 v[192:195], a[160:163], a[96:99], v[192:195]
    ds_read_b64_tr_b16 a[226:227], v14 offset:40512
    v_mfma_f32_16x16x32_bf16 v[224:227], a[164:167], a[96:99], v[224:227]
    s_mov_b32 s15, 0x00020000
    v_mfma_f32_16x16x32_bf16 v[224:227], a[236:239], a[168:171], v[224:227]
    ds_read_b128 a[96:99], v8 offset:0
    v_mfma_f32_16x16x32_bf16 v[164:167], a[228:231], a[172:175], v[164:167]
    ds_read_b128 a[168:171], v8 offset:36864
    v_mfma_f32_16x16x32_bf16 v[164:167], a[156:159], a[100:103], v[164:167]
    v_mfma_f32_16x16x32_bf16 v[196:199], a[160:163], a[100:103], v[196:199]
    s_mov_b32 s8, s74
    v_mfma_f32_16x16x32_bf16 v[196:199], a[232:235], a[172:175], v[196:199]
    s_mov_b32 s9, s75
    v_mfma_f32_16x16x32_bf16 v[228:231], a[236:239], a[172:175], v[228:231]
    v_mfma_f32_16x16x32_bf16 v[228:231], a[164:167], a[100:103], v[228:231]
    ds_read_b128 a[100:103], v8 offset:1024
    v_mfma_f32_16x16x32_bf16 v[168:171], a[156:159], a[104:107], v[168:171]
    ds_read_b128 a[172:175], v8 offset:37888
    v_mfma_f32_16x16x32_bf16 v[168:171], a[228:231], a[176:179], v[168:171]
    s_mov_b32 s10, 7340032
    v_mfma_f32_16x16x32_bf16 v[200:203], a[232:235], a[176:179], v[200:203]
    v_mfma_f32_16x16x32_bf16 v[200:203], a[160:163], a[104:107], v[200:203]
    s_mov_b32 s11, 0x00020000
    v_mfma_f32_16x16x32_bf16 v[232:235], a[164:167], a[104:107], v[232:235]
    v_mfma_f32_16x16x32_bf16 v[232:235], a[236:239], a[176:179], v[232:235]
    ds_read_b128 a[104:107], v8 offset:2048
    v_mfma_f32_16x16x32_bf16 v[172:175], a[228:231], a[180:183], v[172:175]
    ds_read_b128 a[176:179], v8 offset:38912
    v_mfma_f32_16x16x32_bf16 v[172:175], a[156:159], a[108:111], v[172:175]
    s_lshl_b32 s34, s2, 2
    v_mfma_f32_16x16x32_bf16 v[204:207], a[160:163], a[108:111], v[204:207]
    v_mfma_f32_16x16x32_bf16 v[204:207], a[232:235], a[180:183], v[204:207]
    s_add_u32 s34, s34, s46
    v_mfma_f32_16x16x32_bf16 v[236:239], a[236:239], a[180:183], v[236:239]
    s_mul_i32 s35, s34, 7168
    v_mfma_f32_16x16x32_bf16 v[236:239], a[164:167], a[108:111], v[236:239]
    ds_read_b128 a[108:111], v8 offset:3072
    v_mfma_f32_16x16x32_bf16 v[176:179], a[156:159], a[112:115], v[176:179]
    ds_read_b128 a[180:183], v8 offset:39936
    v_mfma_f32_16x16x32_bf16 v[176:179], a[228:231], a[184:187], v[176:179]
    v_mfma_f32_16x16x32_bf16 v[208:211], a[232:235], a[184:187], v[208:211]
    s_lshl_b32 s34, s34, 11
    v_mfma_f32_16x16x32_bf16 v[208:211], a[160:163], a[112:115], v[208:211]
    v_mfma_f32_16x16x32_bf16 v[240:243], a[164:167], a[112:115], v[240:243]
    v_lshlrev_b32 v24, 3, v1
    v_mfma_f32_16x16x32_bf16 v[240:243], a[236:239], a[184:187], v[240:243]
    ds_read_b128 a[112:115], v8 offset:4096
    v_mfma_f32_16x16x32_bf16 v[180:183], a[228:231], a[188:191], v[180:183]
    ds_read_b128 a[184:187], v8 offset:40960
    v_mfma_f32_16x16x32_bf16 v[180:183], a[156:159], a[116:119], v[180:183]
    v_mfma_f32_16x16x32_bf16 v[212:215], a[160:163], a[116:119], v[212:215]
    v_and_b32 v25, 2047, v24
    v_mfma_f32_16x16x32_bf16 v[212:215], a[232:235], a[188:191], v[212:215]
    v_mfma_f32_16x16x32_bf16 v[244:247], a[236:239], a[188:191], v[244:247]
    buffer_load_dword v31, v25, s[12:15], s34 offen
    v_mfma_f32_16x16x32_bf16 v[244:247], a[164:167], a[116:119], v[244:247]
    ds_read_b128 a[116:119], v8 offset:5120
    v_mfma_f32_16x16x32_bf16 v[184:187], a[156:159], a[120:123], v[184:187]
    ds_read_b128 a[188:191], v8 offset:41984
    v_mfma_f32_16x16x32_bf16 v[184:187], a[228:231], a[192:195], v[184:187]
    v_mfma_f32_16x16x32_bf16 v[216:219], a[232:235], a[192:195], v[216:219]
    v_mfma_f32_16x16x32_bf16 v[216:219], a[160:163], a[120:123], v[216:219]
    v_mfma_f32_16x16x32_bf16 v[248:251], a[164:167], a[120:123], v[248:251]
    v_mfma_f32_16x16x32_bf16 v[248:251], a[236:239], a[192:195], v[248:251]
    ds_read_b128 a[120:123], v8 offset:6144
    v_mfma_f32_16x16x32_bf16 v[188:191], a[228:231], a[196:199], v[188:191]
    ds_read_b128 a[192:195], v8 offset:43008
    v_mfma_f32_16x16x32_bf16 v[188:191], a[156:159], a[124:127], v[188:191]
    v_mfma_f32_16x16x32_bf16 v[220:223], a[160:163], a[124:127], v[220:223]
    v_mfma_f32_16x16x32_bf16 v[220:223], a[232:235], a[196:199], v[220:223]
    v_mfma_f32_16x16x32_bf16 v[252:255], a[236:239], a[196:199], v[252:255]
    v_mfma_f32_16x16x32_bf16 v[252:255], a[164:167], a[124:127], v[252:255]
    s_waitcnt lgkmcnt(2)
    v_mfma_f32_16x16x32_bf16 a[0:3], a[128:131], a[96:99], a[0:3]
    ds_read_b128 a[124:127], v8 offset:7168
    v_mfma_f32_16x16x32_bf16 a[0:3], a[200:203], a[168:171], a[0:3]
    ds_read_b128 a[196:199], v8 offset:44032
    v_mfma_f32_16x16x32_bf16 a[32:35], a[204:207], a[168:171], a[32:35]
    ds_read_b64_tr_b16 a[156:157], v14 offset:7232
    v_mfma_f32_16x16x32_bf16 a[32:35], a[132:135], a[96:99], a[32:35]
    ds_read_b64_tr_b16 a[158:159], v14 offset:10816
    v_mfma_f32_16x16x32_bf16 a[64:67], a[136:139], a[96:99], a[64:67]
    ds_read_b64_tr_b16 a[228:229], v14 offset:44096
    v_mfma_f32_16x16x32_bf16 a[64:67], a[208:211], a[168:171], a[64:67]
    ds_read_b64_tr_b16 a[230:231], v14 offset:47680
    v_mfma_f32_16x16x32_bf16 a[4:7], a[200:203], a[172:175], a[4:7]
    ds_read_b64_tr_b16 a[160:161], v14 offset:96
    v_mfma_f32_16x16x32_bf16 a[4:7], a[128:131], a[100:103], a[4:7]
    ds_read_b64_tr_b16 a[162:163], v14 offset:3680
    v_mfma_f32_16x16x32_bf16 a[36:39], a[132:135], a[100:103], a[36:39]
    ds_read_b64_tr_b16 a[232:233], v14 offset:36960
    v_mfma_f32_16x16x32_bf16 a[36:39], a[204:207], a[172:175], a[36:39]
    ds_read_b64_tr_b16 a[234:235], v14 offset:40544
    v_mfma_f32_16x16x32_bf16 a[68:71], a[208:211], a[172:175], a[68:71]
    ds_read_b64_tr_b16 a[164:165], v14 offset:7264
    v_mfma_f32_16x16x32_bf16 a[68:71], a[136:139], a[100:103], a[68:71]
    ds_read_b64_tr_b16 a[166:167], v14 offset:10848
    v_mfma_f32_16x16x32_bf16 a[8:11], a[128:131], a[104:107], a[8:11]
    ds_read_b64_tr_b16 a[236:237], v14 offset:44128
    v_mfma_f32_16x16x32_bf16 a[8:11], a[200:203], a[176:179], a[8:11]
    ds_read_b64_tr_b16 a[238:239], v14 offset:47712
    v_mfma_f32_16x16x32_bf16 a[40:43], a[204:207], a[176:179], a[40:43]
    v_mfma_f32_16x16x32_bf16 a[40:43], a[132:135], a[104:107], a[40:43]
    v_mfma_f32_16x16x32_bf16 a[72:75], a[136:139], a[104:107], a[72:75]
    v_mfma_f32_16x16x32_bf16 a[72:75], a[208:211], a[176:179], a[72:75]
    v_mfma_f32_16x16x32_bf16 a[12:15], a[200:203], a[180:183], a[12:15]
    v_mfma_f32_16x16x32_bf16 a[12:15], a[128:131], a[108:111], a[12:15]
    v_mfma_f32_16x16x32_bf16 a[44:47], a[132:135], a[108:111], a[44:47]
    v_mfma_f32_16x16x32_bf16 a[44:47], a[204:207], a[180:183], a[44:47]
    v_mfma_f32_16x16x32_bf16 a[76:79], a[208:211], a[180:183], a[76:79]
    v_mfma_f32_16x16x32_bf16 a[76:79], a[136:139], a[108:111], a[76:79]
    v_mfma_f32_16x16x32_bf16 a[16:19], a[128:131], a[112:115], a[16:19]
    v_mfma_f32_16x16x32_bf16 a[16:19], a[200:203], a[184:187], a[16:19]
    s_waitcnt lgkmcnt(0)
    v_mfma_f32_16x16x32_bf16 a[48:51], a[204:207], a[184:187], a[48:51]
    v_mfma_f32_16x16x32_bf16 a[48:51], a[132:135], a[112:115], a[48:51]
    v_mfma_f32_16x16x32_bf16 a[80:83], a[136:139], a[112:115], a[80:83]
    v_mfma_f32_16x16x32_bf16 a[80:83], a[208:211], a[184:187], a[80:83]
    v_mfma_f32_16x16x32_bf16 a[20:23], a[200:203], a[188:191], a[20:23]
    v_mfma_f32_16x16x32_bf16 a[20:23], a[128:131], a[116:119], a[20:23]
    v_mfma_f32_16x16x32_bf16 a[52:55], a[132:135], a[116:119], a[52:55]
    v_mfma_f32_16x16x32_bf16 a[52:55], a[204:207], a[188:191], a[52:55]
    v_mfma_f32_16x16x32_bf16 a[84:87], a[208:211], a[188:191], a[84:87]
    v_mfma_f32_16x16x32_bf16 a[84:87], a[136:139], a[116:119], a[84:87]
    v_mfma_f32_16x16x32_bf16 a[24:27], a[128:131], a[120:123], a[24:27]
    v_mfma_f32_16x16x32_bf16 a[24:27], a[200:203], a[192:195], a[24:27]
    v_mfma_f32_16x16x32_bf16 a[56:59], a[204:207], a[192:195], a[56:59]
    v_mfma_f32_16x16x32_bf16 a[56:59], a[132:135], a[120:123], a[56:59]
    v_mfma_f32_16x16x32_bf16 a[88:91], a[136:139], a[120:123], a[88:91]
    v_mfma_f32_16x16x32_bf16 a[88:91], a[208:211], a[192:195], a[88:91]
    v_mfma_f32_16x16x32_bf16 a[28:31], a[200:203], a[196:199], a[28:31]
    v_mfma_f32_16x16x32_bf16 a[28:31], a[128:131], a[124:127], a[28:31]
    v_mfma_f32_16x16x32_bf16 a[60:63], a[132:135], a[124:127], a[60:63]
    v_mfma_f32_16x16x32_bf16 a[60:63], a[204:207], a[196:199], a[60:63]
    v_mfma_f32_16x16x32_bf16 a[92:95], a[208:211], a[196:199], a[92:95]
    v_mfma_f32_16x16x32_bf16 a[92:95], a[136:139], a[124:127], a[92:95]
    v_mfma_f32_16x16x32_bf16 v[32:35], a[140:143], a[96:99], v[32:35]
    v_mfma_f32_16x16x32_bf16 v[32:35], a[212:215], a[168:171], v[32:35]
    v_mfma_f32_16x16x32_bf16 v[36:39], a[212:215], a[172:175], v[36:39]
    v_mfma_f32_16x16x32_bf16 v[36:39], a[140:143], a[100:103], v[36:39]
    v_mfma_f32_16x16x32_bf16 v[40:43], a[140:143], a[104:107], v[40:43]
    v_mfma_f32_16x16x32_bf16 v[40:43], a[212:215], a[176:179], v[40:43]
    v_mfma_f32_16x16x32_bf16 v[44:47], a[212:215], a[180:183], v[44:47]
    v_accvgpr_read_b32 v2, a0
    v_accvgpr_read_b32 v3, a1
    v_mfma_f32_16x16x32_bf16 v[44:47], a[140:143], a[108:111], v[44:47]
    v_accvgpr_read_b32 v4, a2
    v_mfma_f32_16x16x32_bf16 v[48:51], a[140:143], a[112:115], v[48:51]
    v_accvgpr_read_b32 v5, a3
    v_mfma_f32_16x16x32_bf16 v[48:51], a[212:215], a[184:187], v[48:51]
    v_accvgpr_read_b32 v6, a32
    v_accvgpr_read_b32 v7, a33
    v_mfma_f32_16x16x32_bf16 v[52:55], a[212:215], a[188:191], v[52:55]
    v_accvgpr_read_b32 v8, a34
    v_mfma_f32_16x16x32_bf16 v[52:55], a[140:143], a[116:119], v[52:55]
    v_accvgpr_read_b32 v9, a35
    v_mfma_f32_16x16x32_bf16 v[56:59], a[140:143], a[120:123], v[56:59]
    v_cvt_pk_bf16_f32 v2, v2, v3
    v_cvt_pk_bf16_f32 v3, v4, v5
    v_mfma_f32_16x16x32_bf16 v[56:59], a[212:215], a[192:195], v[56:59]
    v_cvt_pk_bf16_f32 v4, v6, v7
    v_mfma_f32_16x16x32_bf16 v[60:63], a[212:215], a[196:199], v[60:63]
    v_cvt_pk_bf16_f32 v5, v8, v9
    v_mfma_f32_16x16x32_bf16 v[60:63], a[140:143], a[124:127], v[60:63]
    s_add_u32 s3, s64, 0
    buffer_store_dwordx4 v[2:5], v1, s[4:7], s3 offen sc1
    v_mfma_f32_16x16x32_bf16 v[92:95], a[144:147], a[124:127], v[92:95]
    ds_write_b128 v22, v[2:5] offset:0
    v_mfma_f32_16x16x32_bf16 v[92:95], a[216:219], a[196:199], v[92:95]
    v_accvgpr_read_b32 v10, a4
    v_mfma_f32_16x16x32_bf16 v[88:91], a[216:219], a[192:195], v[88:91]
    v_accvgpr_read_b32 v11, a5
    v_accvgpr_read_b32 v12, a6
    v_mfma_f32_16x16x32_bf16 v[88:91], a[144:147], a[120:123], v[88:91]
    v_accvgpr_read_b32 v13, a7
    v_mfma_f32_16x16x32_bf16 v[84:87], a[144:147], a[116:119], v[84:87]
    v_accvgpr_read_b32 v14, a36
    v_mfma_f32_16x16x32_bf16 v[84:87], a[216:219], a[188:191], v[84:87]
    v_accvgpr_read_b32 v15, a37
    v_accvgpr_read_b32 v16, a38
    v_mfma_f32_16x16x32_bf16 v[80:83], a[216:219], a[184:187], v[80:83]
    v_accvgpr_read_b32 v17, a39
    v_mfma_f32_16x16x32_bf16 v[80:83], a[144:147], a[112:115], v[80:83]
    v_cvt_pk_bf16_f32 v10, v10, v11
    v_mfma_f32_16x16x32_bf16 v[76:79], a[144:147], a[108:111], v[76:79]
    v_cvt_pk_bf16_f32 v11, v12, v13
    v_cvt_pk_bf16_f32 v12, v14, v15
    v_mfma_f32_16x16x32_bf16 v[76:79], a[216:219], a[180:183], v[76:79]
    v_cvt_pk_bf16_f32 v13, v16, v17
    v_mfma_f32_16x16x32_bf16 v[72:75], a[216:219], a[176:179], v[72:75]
    s_add_u32 s3, s64, 1024
    v_mfma_f32_16x16x32_bf16 v[72:75], a[144:147], a[104:107], v[72:75]
    buffer_store_dwordx4 v[10:13], v1, s[4:7], s3 offen sc1
    ds_write_b128 v22, v[10:13] offset:1024
    v_mfma_f32_16x16x32_bf16 v[68:71], a[144:147], a[100:103], v[68:71]
    v_accvgpr_read_b32 v2, a8
    v_mfma_f32_16x16x32_bf16 v[68:71], a[216:219], a[172:175], v[68:71]
    v_accvgpr_read_b32 v3, a9
    v_mfma_f32_16x16x32_bf16 v[64:67], a[216:219], a[168:171], v[64:67]
    v_accvgpr_read_b32 v4, a10
    v_accvgpr_read_b32 v5, a11
    v_mfma_f32_16x16x32_bf16 v[64:67], a[144:147], a[96:99], v[64:67]
    v_accvgpr_read_b32 v6, a40
    v_mfma_f32_16x16x32_bf16 v[96:99], a[148:151], a[96:99], v[96:99]
    v_accvgpr_read_b32 v7, a41
    v_mfma_f32_16x16x32_bf16 v[96:99], a[220:223], a[168:171], v[96:99]
    v_accvgpr_read_b32 v8, a42
    v_accvgpr_read_b32 v9, a43
    v_mfma_f32_16x16x32_bf16 v[100:103], a[220:223], a[172:175], v[100:103]
    v_cvt_pk_bf16_f32 v2, v2, v3
    v_mfma_f32_16x16x32_bf16 v[100:103], a[148:151], a[100:103], v[100:103]
    v_cvt_pk_bf16_f32 v3, v4, v5
    v_mfma_f32_16x16x32_bf16 v[104:107], a[148:151], a[104:107], v[104:107]
    v_cvt_pk_bf16_f32 v4, v6, v7
    v_cvt_pk_bf16_f32 v5, v8, v9
    v_mfma_f32_16x16x32_bf16 v[104:107], a[220:223], a[176:179], v[104:107]
    s_add_u32 s3, s64, 4096
    v_mfma_f32_16x16x32_bf16 v[108:111], a[220:223], a[180:183], v[108:111]
    buffer_store_dwordx4 v[2:5], v1, s[4:7], s3 offen sc1
    v_mfma_f32_16x16x32_bf16 v[108:111], a[148:151], a[108:111], v[108:111]
    ds_write_b128 v22, v[2:5] offset:4096
    v_accvgpr_read_b32 v10, a12
    v_mfma_f32_16x16x32_bf16 v[112:115], a[148:151], a[112:115], v[112:115]
    v_accvgpr_read_b32 v11, a13
    v_mfma_f32_16x16x32_bf16 v[112:115], a[220:223], a[184:187], v[112:115]
    v_accvgpr_read_b32 v12, a14
    v_mfma_f32_16x16x32_bf16 v[116:119], a[220:223], a[188:191], v[116:119]
    v_accvgpr_read_b32 v13, a15
    v_accvgpr_read_b32 v14, a44
    v_mfma_f32_16x16x32_bf16 v[116:119], a[148:151], a[116:119], v[116:119]
    v_accvgpr_read_b32 v15, a45
    v_mfma_f32_16x16x32_bf16 v[120:123], a[148:151], a[120:123], v[120:123]
    v_accvgpr_read_b32 v16, a46
    v_mfma_f32_16x16x32_bf16 v[120:123], a[220:223], a[192:195], v[120:123]
    v_accvgpr_read_b32 v17, a47
    v_cvt_pk_bf16_f32 v10, v10, v11
    v_mfma_f32_16x16x32_bf16 v[124:127], a[220:223], a[196:199], v[124:127]
    v_cvt_pk_bf16_f32 v11, v12, v13
    v_mfma_f32_16x16x32_bf16 v[124:127], a[148:151], a[124:127], v[124:127]
    v_cvt_pk_bf16_f32 v12, v14, v15
    v_mfma_f32_16x16x32_bf16 v[156:159], a[152:155], a[124:127], v[156:159]
    v_cvt_pk_bf16_f32 v13, v16, v17
    s_add_u32 s3, s64, 5120
    v_mfma_f32_16x16x32_bf16 v[156:159], a[224:227], a[196:199], v[156:159]
    buffer_store_dwordx4 v[10:13], v1, s[4:7], s3 offen sc1
    v_mfma_f32_16x16x32_bf16 v[152:155], a[224:227], a[192:195], v[152:155]
    ds_write_b128 v22, v[10:13] offset:5120
    v_mfma_f32_16x16x32_bf16 v[152:155], a[152:155], a[120:123], v[152:155]
    v_accvgpr_read_b32 v2, a16
    v_accvgpr_read_b32 v3, a17
    v_mfma_f32_16x16x32_bf16 v[148:151], a[152:155], a[116:119], v[148:151]
    v_accvgpr_read_b32 v4, a18
    v_mfma_f32_16x16x32_bf16 v[148:151], a[224:227], a[188:191], v[148:151]
    v_accvgpr_read_b32 v5, a19
    v_mfma_f32_16x16x32_bf16 v[144:147], a[224:227], a[184:187], v[144:147]
    v_accvgpr_read_b32 v6, a48
    v_accvgpr_read_b32 v7, a49
    v_mfma_f32_16x16x32_bf16 v[144:147], a[152:155], a[112:115], v[144:147]
    v_accvgpr_read_b32 v8, a50
    v_mfma_f32_16x16x32_bf16 v[140:143], a[152:155], a[108:111], v[140:143]
    v_accvgpr_read_b32 v9, a51
    v_mfma_f32_16x16x32_bf16 v[140:143], a[224:227], a[180:183], v[140:143]
    v_cvt_pk_bf16_f32 v2, v2, v3
    v_cvt_pk_bf16_f32 v3, v4, v5
    v_mfma_f32_16x16x32_bf16 v[136:139], a[224:227], a[176:179], v[136:139]
    v_cvt_pk_bf16_f32 v4, v6, v7
    v_mfma_f32_16x16x32_bf16 v[136:139], a[152:155], a[104:107], v[136:139]
    v_cvt_pk_bf16_f32 v5, v8, v9
    v_mfma_f32_16x16x32_bf16 v[132:135], a[152:155], a[100:103], v[132:135]
    s_add_u32 s3, s64, 8192
    buffer_store_dwordx4 v[2:5], v1, s[4:7], s3 offen sc1
    v_mfma_f32_16x16x32_bf16 v[132:135], a[224:227], a[172:175], v[132:135]
    ds_write_b128 v22, v[2:5] offset:8192
    v_mfma_f32_16x16x32_bf16 v[128:131], a[224:227], a[168:171], v[128:131]
    v_accvgpr_read_b32 v10, a20
    v_mfma_f32_16x16x32_bf16 v[128:131], a[152:155], a[96:99], v[128:131]
    v_accvgpr_read_b32 v11, a21
    v_accvgpr_read_b32 v12, a22
    v_mfma_f32_16x16x32_bf16 v[160:163], a[156:159], a[96:99], v[160:163]
    v_accvgpr_read_b32 v13, a23
    v_mfma_f32_16x16x32_bf16 v[160:163], a[228:231], a[168:171], v[160:163]
    v_accvgpr_read_b32 v14, a52
    v_mfma_f32_16x16x32_bf16 v[192:195], a[232:235], a[168:171], v[192:195]
    v_accvgpr_read_b32 v15, a53
    v_accvgpr_read_b32 v16, a54
    v_mfma_f32_16x16x32_bf16 v[192:195], a[160:163], a[96:99], v[192:195]
    v_accvgpr_read_b32 v17, a55
    v_mfma_f32_16x16x32_bf16 v[224:227], a[164:167], a[96:99], v[224:227]
    v_cvt_pk_bf16_f32 v10, v10, v11
    v_mfma_f32_16x16x32_bf16 v[224:227], a[236:239], a[168:171], v[224:227]
    v_cvt_pk_bf16_f32 v11, v12, v13
    v_cvt_pk_bf16_f32 v12, v14, v15
    v_mfma_f32_16x16x32_bf16 v[164:167], a[228:231], a[172:175], v[164:167]
    v_cvt_pk_bf16_f32 v13, v16, v17
    v_mfma_f32_16x16x32_bf16 v[164:167], a[156:159], a[100:103], v[164:167]
    s_add_u32 s3, s64, 9216
    v_mfma_f32_16x16x32_bf16 v[196:199], a[160:163], a[100:103], v[196:199]
    buffer_store_dwordx4 v[10:13], v1, s[4:7], s3 offen sc1
    ds_write_b128 v22, v[10:13] offset:9216
    v_mfma_f32_16x16x32_bf16 v[196:199], a[232:235], a[172:175], v[196:199]
    v_accvgpr_read_b32 v2, a24
    v_mfma_f32_16x16x32_bf16 v[228:231], a[236:239], a[172:175], v[228:231]
    v_accvgpr_read_b32 v3, a25
    v_mfma_f32_16x16x32_bf16 v[228:231], a[164:167], a[100:103], v[228:231]
    v_accvgpr_read_b32 v4, a26
    v_accvgpr_read_b32 v5, a27
    v_mfma_f32_16x16x32_bf16 v[168:171], a[156:159], a[104:107], v[168:171]
    v_accvgpr_read_b32 v6, a56
    v_mfma_f32_16x16x32_bf16 v[168:171], a[228:231], a[176:179], v[168:171]
    v_accvgpr_read_b32 v7, a57
    v_mfma_f32_16x16x32_bf16 v[200:203], a[232:235], a[176:179], v[200:203]
    v_accvgpr_read_b32 v8, a58
    v_accvgpr_read_b32 v9, a59
    v_mfma_f32_16x16x32_bf16 v[200:203], a[160:163], a[104:107], v[200:203]
    v_cvt_pk_bf16_f32 v2, v2, v3
    v_mfma_f32_16x16x32_bf16 v[232:235], a[164:167], a[104:107], v[232:235]
    v_cvt_pk_bf16_f32 v3, v4, v5
    v_mfma_f32_16x16x32_bf16 v[232:235], a[236:239], a[176:179], v[232:235]
    v_cvt_pk_bf16_f32 v4, v6, v7
    v_cvt_pk_bf16_f32 v5, v8, v9
    v_mfma_f32_16x16x32_bf16 v[172:175], a[228:231], a[180:183], v[172:175]
    s_add_u32 s3, s64, 12288
    v_mfma_f32_16x16x32_bf16 v[172:175], a[156:159], a[108:111], v[172:175]
    buffer_store_dwordx4 v[2:5], v1, s[4:7], s3 offen sc1
    v_mfma_f32_16x16x32_bf16 v[204:207], a[160:163], a[108:111], v[204:207]
    ds_write_b128 v22, v[2:5] offset:12288
    v_accvgpr_read_b32 v10, a28
    v_mfma_f32_16x16x32_bf16 v[204:207], a[232:235], a[180:183], v[204:207]
    v_accvgpr_read_b32 v11, a29
    v_mfma_f32_16x16x32_bf16 v[236:239], a[236:239], a[180:183], v[236:239]
    v_accvgpr_read_b32 v12, a30
    v_mfma_f32_16x16x32_bf16 v[236:239], a[164:167], a[108:111], v[236:239]
    v_accvgpr_read_b32 v13, a31
    v_accvgpr_read_b32 v14, a60
    v_mfma_f32_16x16x32_bf16 v[176:179], a[156:159], a[112:115], v[176:179]
    v_accvgpr_read_b32 v15, a61
    v_mfma_f32_16x16x32_bf16 v[176:179], a[228:231], a[184:187], v[176:179]
    v_accvgpr_read_b32 v16, a62
    v_mfma_f32_16x16x32_bf16 v[208:211], a[232:235], a[184:187], v[208:211]
    v_accvgpr_read_b32 v17, a63
    v_cvt_pk_bf16_f32 v10, v10, v11
    v_mfma_f32_16x16x32_bf16 v[208:211], a[160:163], a[112:115], v[208:211]
    v_cvt_pk_bf16_f32 v11, v12, v13
    v_mfma_f32_16x16x32_bf16 v[240:243], a[164:167], a[112:115], v[240:243]
    v_cvt_pk_bf16_f32 v12, v14, v15
    v_mfma_f32_16x16x32_bf16 v[240:243], a[236:239], a[184:187], v[240:243]
    v_cvt_pk_bf16_f32 v13, v16, v17
    s_add_u32 s3, s64, 13312
    v_mfma_f32_16x16x32_bf16 v[180:183], a[228:231], a[188:191], v[180:183]
    buffer_store_dwordx4 v[10:13], v1, s[4:7], s3 offen sc1
    v_mfma_f32_16x16x32_bf16 v[180:183], a[156:159], a[116:119], v[180:183]
    ds_write_b128 v22, v[10:13] offset:13312
    v_mfma_f32_16x16x32_bf16 v[212:215], a[160:163], a[116:119], v[212:215]
    v_mfma_f32_16x16x32_bf16 v[212:215], a[232:235], a[188:191], v[212:215]
    v_mfma_f32_16x16x32_bf16 v[244:247], a[236:239], a[188:191], v[244:247]
    v_mfma_f32_16x16x32_bf16 v[244:247], a[164:167], a[116:119], v[244:247]
    v_mfma_f32_16x16x32_bf16 v[184:187], a[156:159], a[120:123], v[184:187]
    v_mfma_f32_16x16x32_bf16 v[184:187], a[228:231], a[192:195], v[184:187]
    v_mfma_f32_16x16x32_bf16 v[216:219], a[232:235], a[192:195], v[216:219]
    v_mfma_f32_16x16x32_bf16 v[216:219], a[160:163], a[120:123], v[216:219]
    v_mfma_f32_16x16x32_bf16 v[248:251], a[164:167], a[120:123], v[248:251]
    v_mfma_f32_16x16x32_bf16 v[248:251], a[236:239], a[192:195], v[248:251]
    v_mfma_f32_16x16x32_bf16 v[188:191], a[228:231], a[196:199], v[188:191]
    v_mfma_f32_16x16x32_bf16 v[188:191], a[156:159], a[124:127], v[188:191]
    v_mfma_f32_16x16x32_bf16 v[220:223], a[160:163], a[124:127], v[220:223]
    v_mfma_f32_16x16x32_bf16 v[220:223], a[232:235], a[196:199], v[220:223]
    v_mfma_f32_16x16x32_bf16 v[252:255], a[236:239], a[196:199], v[252:255]
    v_mfma_f32_16x16x32_bf16 v[252:255], a[164:167], a[124:127], v[252:255]
    s_nop 4
    v_pk_mul_f32 v[128:129], v[128:129], s[66:67]
    v_pk_mul_f32 v[130:131], v[130:131], s[66:67]
    v_pk_mul_f32 v[192:193], v[192:193], s[66:67]
    v_pk_mul_f32 v[194:195], v[194:195], s[66:67]
    v_exp_f32 v128, v128
    v_exp_f32 v129, v129
    v_exp_f32 v130, v130
    v_exp_f32 v131, v131
    v_exp_f32 v192, v192
    v_exp_f32 v193, v193
    v_exp_f32 v194, v194
    v_exp_f32 v195, v195
    v_pk_add_f32 v[128:129], v[128:129], 1.0 op_sel_hi:[1,0]
    v_pk_add_f32 v[130:131], v[130:131], 1.0 op_sel_hi:[1,0]
    v_pk_add_f32 v[192:193], v[192:193], 1.0 op_sel_hi:[1,0]
    v_pk_add_f32 v[194:195], v[194:195], 1.0 op_sel_hi:[1,0]
    v_rcp_f32 v128, v128
    v_rcp_f32 v129, v129
    v_rcp_f32 v130, v130
    v_rcp_f32 v131, v131
    v_rcp_f32 v192, v192
    v_rcp_f32 v193, v193
    v_rcp_f32 v194, v194
    v_rcp_f32 v195, v195
    v_pk_mul_f32 v[128:129], v[128:129], v[160:161]
    v_pk_mul_f32 v[130:131], v[130:131], v[162:163]
    v_pk_mul_f32 v[192:193], v[192:193], v[224:225]
    v_pk_mul_f32 v[194:195], v[194:195], v[226:227]
    v_cvt_pk_bf16_f32 v224, v128, v129
    v_cvt_pk_bf16_f32 v225, v130, v131
    v_cvt_pk_bf16_f32 v226, v192, v193
    v_cvt_pk_bf16_f32 v227, v194, v195
    v_pk_mul_f32 v[132:133], v[132:133], s[66:67]
    v_pk_mul_f32 v[134:135], v[134:135], s[66:67]
    v_pk_mul_f32 v[196:197], v[196:197], s[66:67]
    v_pk_mul_f32 v[198:199], v[198:199], s[66:67]
    v_exp_f32 v132, v132
    v_exp_f32 v133, v133
    v_exp_f32 v134, v134
    v_exp_f32 v135, v135
    v_exp_f32 v196, v196
    v_exp_f32 v197, v197
    v_exp_f32 v198, v198
    v_exp_f32 v199, v199
    v_pk_add_f32 v[132:133], v[132:133], 1.0 op_sel_hi:[1,0]
    v_pk_add_f32 v[134:135], v[134:135], 1.0 op_sel_hi:[1,0]
    v_pk_add_f32 v[196:197], v[196:197], 1.0 op_sel_hi:[1,0]
    v_pk_add_f32 v[198:199], v[198:199], 1.0 op_sel_hi:[1,0]
    v_rcp_f32 v132, v132
    v_rcp_f32 v133, v133
    v_rcp_f32 v134, v134
    v_rcp_f32 v135, v135
    v_rcp_f32 v196, v196
    v_rcp_f32 v197, v197
    v_rcp_f32 v198, v198
    v_rcp_f32 v199, v199
    v_pk_mul_f32 v[132:133], v[132:133], v[164:165]
    v_pk_mul_f32 v[134:135], v[134:135], v[166:167]
    v_pk_mul_f32 v[196:197], v[196:197], v[228:229]
    v_pk_mul_f32 v[198:199], v[198:199], v[230:231]
    v_cvt_pk_bf16_f32 v228, v132, v133
    v_cvt_pk_bf16_f32 v229, v134, v135
    v_cvt_pk_bf16_f32 v230, v196, v197
    v_cvt_pk_bf16_f32 v231, v198, v199
    v_pk_mul_f32 v[136:137], v[136:137], s[66:67]
    v_pk_mul_f32 v[138:139], v[138:139], s[66:67]
    v_pk_mul_f32 v[200:201], v[200:201], s[66:67]
    v_pk_mul_f32 v[202:203], v[202:203], s[66:67]
    v_exp_f32 v136, v136
    v_exp_f32 v137, v137
    v_exp_f32 v138, v138
    v_exp_f32 v139, v139
    v_exp_f32 v200, v200
    v_exp_f32 v201, v201
    v_exp_f32 v202, v202
    v_exp_f32 v203, v203
    v_pk_add_f32 v[136:137], v[136:137], 1.0 op_sel_hi:[1,0]
    v_pk_add_f32 v[138:139], v[138:139], 1.0 op_sel_hi:[1,0]
    v_pk_add_f32 v[200:201], v[200:201], 1.0 op_sel_hi:[1,0]
    v_pk_add_f32 v[202:203], v[202:203], 1.0 op_sel_hi:[1,0]
    v_rcp_f32 v136, v136
    v_rcp_f32 v137, v137
    v_rcp_f32 v138, v138
    v_rcp_f32 v139, v139
    v_rcp_f32 v200, v200
    v_rcp_f32 v201, v201
    v_rcp_f32 v202, v202
    v_rcp_f32 v203, v203
    v_pk_mul_f32 v[136:137], v[136:137], v[168:169]
    v_pk_mul_f32 v[138:139], v[138:139], v[170:171]
    v_pk_mul_f32 v[200:201], v[200:201], v[232:233]
    v_pk_mul_f32 v[202:203], v[202:203], v[234:235]
    v_cvt_pk_bf16_f32 v232, v136, v137
    v_cvt_pk_bf16_f32 v233, v138, v139
    v_cvt_pk_bf16_f32 v234, v200, v201
    v_cvt_pk_bf16_f32 v235, v202, v203
    v_pk_mul_f32 v[140:141], v[140:141], s[66:67]
    v_pk_mul_f32 v[142:143], v[142:143], s[66:67]
    v_pk_mul_f32 v[204:205], v[204:205], s[66:67]
    v_pk_mul_f32 v[206:207], v[206:207], s[66:67]
    v_exp_f32 v140, v140
    v_exp_f32 v141, v141
    v_exp_f32 v142, v142
    v_exp_f32 v143, v143
    v_exp_f32 v204, v204
    v_exp_f32 v205, v205
    v_exp_f32 v206, v206
    v_exp_f32 v207, v207
    v_pk_add_f32 v[140:141], v[140:141], 1.0 op_sel_hi:[1,0]
    v_pk_add_f32 v[142:143], v[142:143], 1.0 op_sel_hi:[1,0]
    v_pk_add_f32 v[204:205], v[204:205], 1.0 op_sel_hi:[1,0]
    v_pk_add_f32 v[206:207], v[206:207], 1.0 op_sel_hi:[1,0]
    v_rcp_f32 v140, v140
    v_rcp_f32 v141, v141
    v_rcp_f32 v142, v142
    v_rcp_f32 v143, v143
    v_rcp_f32 v204, v204
    v_rcp_f32 v205, v205
    v_rcp_f32 v206, v206
    v_rcp_f32 v207, v207
    v_pk_mul_f32 v[140:141], v[140:141], v[172:173]
    v_pk_mul_f32 v[142:143], v[142:143], v[174:175]
    v_pk_mul_f32 v[204:205], v[204:205], v[236:237]
    v_pk_mul_f32 v[206:207], v[206:207], v[238:239]
    v_cvt_pk_bf16_f32 v236, v140, v141
    v_cvt_pk_bf16_f32 v237, v142, v143
    v_cvt_pk_bf16_f32 v238, v204, v205
    v_cvt_pk_bf16_f32 v239, v206, v207
    s_lshl_b32 s61, s56, 8
    s_lshl_b32 s3, s57, 2
    s_add_u32 s3, s3, s46
    s_lshl_b32 s3, s3, 2
    s_add_u32 s3, s3, s61
    s_add_u32 s3, s3, 62922752
    s_waitcnt vmcnt(0)
    v_mov_b32 v20, s72
    v_mov_b32 v21, 0
    s_mov_b64 exec, 1
    buffer_store_dword v20, v21, s[4:7], s3 offen sc1
    s_mov_b64 exec, -1
    v_pk_mul_f32 v[144:145], v[144:145], s[66:67]
    v_pk_mul_f32 v[146:147], v[146:147], s[66:67]
    v_pk_mul_f32 v[208:209], v[208:209], s[66:67]
    v_pk_mul_f32 v[210:211], v[210:211], s[66:67]
    v_exp_f32 v144, v144
    v_exp_f32 v145, v145
    v_exp_f32 v146, v146
    v_exp_f32 v147, v147
    v_exp_f32 v208, v208
    v_exp_f32 v209, v209
    v_exp_f32 v210, v210
    v_exp_f32 v211, v211
    v_pk_add_f32 v[144:145], v[144:145], 1.0 op_sel_hi:[1,0]
    v_pk_add_f32 v[146:147], v[146:147], 1.0 op_sel_hi:[1,0]
    v_pk_add_f32 v[208:209], v[208:209], 1.0 op_sel_hi:[1,0]
    v_pk_add_f32 v[210:211], v[210:211], 1.0 op_sel_hi:[1,0]
    v_rcp_f32 v144, v144
    v_rcp_f32 v145, v145
    v_rcp_f32 v146, v146
    v_rcp_f32 v147, v147
    v_rcp_f32 v208, v208
    v_rcp_f32 v209, v209
    v_rcp_f32 v210, v210
    v_rcp_f32 v211, v211
    v_pk_mul_f32 v[144:145], v[144:145], v[176:177]
    v_pk_mul_f32 v[146:147], v[146:147], v[178:179]
    v_pk_mul_f32 v[208:209], v[208:209], v[240:241]
    v_pk_mul_f32 v[210:211], v[210:211], v[242:243]
    v_cvt_pk_bf16_f32 v240, v144, v145
    v_cvt_pk_bf16_f32 v241, v146, v147
    v_cvt_pk_bf16_f32 v242, v208, v209
    v_cvt_pk_bf16_f32 v243, v210, v211
    v_pk_mul_f32 v[148:149], v[148:149], s[66:67]
    v_pk_mul_f32 v[150:151], v[150:151], s[66:67]
    v_pk_mul_f32 v[212:213], v[212:213], s[66:67]
    v_pk_mul_f32 v[214:215], v[214:215], s[66:67]
    v_exp_f32 v148, v148
    v_exp_f32 v149, v149
    v_exp_f32 v150, v150
    v_exp_f32 v151, v151
    v_exp_f32 v212, v212
    v_exp_f32 v213, v213
    v_exp_f32 v214, v214
    v_exp_f32 v215, v215
    v_pk_add_f32 v[148:149], v[148:149], 1.0 op_sel_hi:[1,0]
    v_pk_add_f32 v[150:151], v[150:151], 1.0 op_sel_hi:[1,0]
    v_pk_add_f32 v[212:213], v[212:213], 1.0 op_sel_hi:[1,0]
    v_pk_add_f32 v[214:215], v[214:215], 1.0 op_sel_hi:[1,0]
    v_rcp_f32 v148, v148
    v_rcp_f32 v149, v149
    v_rcp_f32 v150, v150
    v_rcp_f32 v151, v151
    v_rcp_f32 v212, v212
    v_rcp_f32 v213, v213
    v_rcp_f32 v214, v214
    v_rcp_f32 v215, v215
    v_pk_mul_f32 v[148:149], v[148:149], v[180:181]
    v_pk_mul_f32 v[150:151], v[150:151], v[182:183]
    v_pk_mul_f32 v[212:213], v[212:213], v[244:245]
    v_pk_mul_f32 v[214:215], v[214:215], v[246:247]
    v_cvt_pk_bf16_f32 v244, v148, v149
    v_cvt_pk_bf16_f32 v245, v150, v151
    v_cvt_pk_bf16_f32 v246, v212, v213
    v_cvt_pk_bf16_f32 v247, v214, v215
    v_pk_mul_f32 v[152:153], v[152:153], s[66:67]
    v_pk_mul_f32 v[154:155], v[154:155], s[66:67]
    v_pk_mul_f32 v[216:217], v[216:217], s[66:67]
    v_pk_mul_f32 v[218:219], v[218:219], s[66:67]
    v_exp_f32 v152, v152
    v_exp_f32 v153, v153
    v_exp_f32 v154, v154
    v_exp_f32 v155, v155
    v_exp_f32 v216, v216
    v_exp_f32 v217, v217
    v_exp_f32 v218, v218
    v_exp_f32 v219, v219
    v_pk_add_f32 v[152:153], v[152:153], 1.0 op_sel_hi:[1,0]
    v_pk_add_f32 v[154:155], v[154:155], 1.0 op_sel_hi:[1,0]
    v_pk_add_f32 v[216:217], v[216:217], 1.0 op_sel_hi:[1,0]
    v_pk_add_f32 v[218:219], v[218:219], 1.0 op_sel_hi:[1,0]
    v_rcp_f32 v152, v152
    v_rcp_f32 v153, v153
    v_rcp_f32 v154, v154
    v_rcp_f32 v155, v155
    v_rcp_f32 v216, v216
    v_rcp_f32 v217, v217
    v_rcp_f32 v218, v218
    v_rcp_f32 v219, v219
    v_pk_mul_f32 v[152:153], v[152:153], v[184:185]
    v_pk_mul_f32 v[154:155], v[154:155], v[186:187]
    v_pk_mul_f32 v[216:217], v[216:217], v[248:249]
    v_pk_mul_f32 v[218:219], v[218:219], v[250:251]
    v_cvt_pk_bf16_f32 v248, v152, v153
    v_cvt_pk_bf16_f32 v249, v154, v155
    v_cvt_pk_bf16_f32 v250, v216, v217
    v_cvt_pk_bf16_f32 v251, v218, v219
    v_pk_mul_f32 v[156:157], v[156:157], s[66:67]
    v_pk_mul_f32 v[158:159], v[158:159], s[66:67]
    v_pk_mul_f32 v[220:221], v[220:221], s[66:67]
    v_pk_mul_f32 v[222:223], v[222:223], s[66:67]
    v_exp_f32 v156, v156
    v_exp_f32 v157, v157
    v_exp_f32 v158, v158
    v_exp_f32 v159, v159
    v_exp_f32 v220, v220
    v_exp_f32 v221, v221
    v_exp_f32 v222, v222
    v_exp_f32 v223, v223
    v_pk_add_f32 v[156:157], v[156:157], 1.0 op_sel_hi:[1,0]
    v_pk_add_f32 v[158:159], v[158:159], 1.0 op_sel_hi:[1,0]
    v_pk_add_f32 v[220:221], v[220:221], 1.0 op_sel_hi:[1,0]
    v_pk_add_f32 v[222:223], v[222:223], 1.0 op_sel_hi:[1,0]
    v_rcp_f32 v156, v156
    v_rcp_f32 v157, v157
    v_rcp_f32 v158, v158
    v_rcp_f32 v159, v159
    v_rcp_f32 v220, v220
    v_rcp_f32 v221, v221
    v_rcp_f32 v222, v222
    v_rcp_f32 v223, v223
    v_pk_mul_f32 v[156:157], v[156:157], v[188:189]
    v_pk_mul_f32 v[158:159], v[158:159], v[190:191]
    v_pk_mul_f32 v[220:221], v[220:221], v[252:253]
    v_pk_mul_f32 v[222:223], v[222:223], v[254:255]
    v_cvt_pk_bf16_f32 v252, v156, v157
    v_cvt_pk_bf16_f32 v253, v158, v159
    v_cvt_pk_bf16_f32 v254, v220, v221
    v_cvt_pk_bf16_f32 v255, v222, v223
    v_accvgpr_read_b32 v2, a64
    v_accvgpr_read_b32 v3, a65
    v_accvgpr_read_b32 v4, a66
    v_accvgpr_read_b32 v5, a67
    v_pk_mul_f32 v[2:3], v[2:3], s[66:67]
    v_pk_mul_f32 v[4:5], v[4:5], s[66:67]
    v_pk_mul_f32 v[64:65], v[64:65], s[66:67]
    v_pk_mul_f32 v[66:67], v[66:67], s[66:67]
    v_exp_f32 v2, v2
    v_exp_f32 v3, v3
    v_exp_f32 v4, v4
    v_exp_f32 v5, v5
    v_exp_f32 v64, v64
    v_exp_f32 v65, v65
    v_exp_f32 v66, v66
    v_exp_f32 v67, v67
    v_pk_add_f32 v[2:3], v[2:3], 1.0 op_sel_hi:[1,0]
    v_pk_add_f32 v[4:5], v[4:5], 1.0 op_sel_hi:[1,0]
    v_pk_add_f32 v[64:65], v[64:65], 1.0 op_sel_hi:[1,0]
    v_pk_add_f32 v[66:67], v[66:67], 1.0 op_sel_hi:[1,0]
    v_rcp_f32 v2, v2
    v_rcp_f32 v3, v3
    v_rcp_f32 v4, v4
    v_rcp_f32 v5, v5
    v_rcp_f32 v64, v64
    v_rcp_f32 v65, v65
    v_rcp_f32 v66, v66
    v_rcp_f32 v67, v67
    v_pk_mul_f32 v[2:3], v[2:3], v[32:33]
    v_pk_mul_f32 v[4:5], v[4:5], v[34:35]
    v_pk_mul_f32 v[64:65], v[64:65], v[96:97]
    v_pk_mul_f32 v[66:67], v[66:67], v[98:99]
    v_cvt_pk_bf16_f32 v192, v2, v3
    v_cvt_pk_bf16_f32 v193, v4, v5
    v_cvt_pk_bf16_f32 v194, v64, v65
    v_cvt_pk_bf16_f32 v195, v66, v67
    v_accvgpr_read_b32 v6, a68
    v_accvgpr_read_b32 v7, a69
    v_accvgpr_read_b32 v8, a70
    v_accvgpr_read_b32 v9, a71
    v_pk_mul_f32 v[6:7], v[6:7], s[66:67]
    v_pk_mul_f32 v[8:9], v[8:9], s[66:67]
    v_pk_mul_f32 v[68:69], v[68:69], s[66:67]
    v_pk_mul_f32 v[70:71], v[70:71], s[66:67]
    v_exp_f32 v6, v6
    v_exp_f32 v7, v7
    v_exp_f32 v8, v8
    v_exp_f32 v9, v9
    v_exp_f32 v68, v68
    v_exp_f32 v69, v69
    v_exp_f32 v70, v70
    v_exp_f32 v71, v71
    v_pk_add_f32 v[6:7], v[6:7], 1.0 op_sel_hi:[1,0]
    v_pk_add_f32 v[8:9], v[8:9], 1.0 op_sel_hi:[1,0]
    v_pk_add_f32 v[68:69], v[68:69], 1.0 op_sel_hi:[1,0]
    v_pk_add_f32 v[70:71], v[70:71], 1.0 op_sel_hi:[1,0]
    v_rcp_f32 v6, v6
    v_rcp_f32 v7, v7
    v_rcp_f32 v8, v8
    v_rcp_f32 v9, v9
    v_rcp_f32 v68, v68
    v_rcp_f32 v69, v69
    v_rcp_f32 v70, v70
    v_rcp_f32 v71, v71
    v_pk_mul_f32 v[6:7], v[6:7], v[36:37]
    v_pk_mul_f32 v[8:9], v[8:9], v[38:39]
    v_pk_mul_f32 v[68:69], v[68:69], v[100:101]
    v_pk_mul_f32 v[70:71], v[70:71], v[102:103]
    v_cvt_pk_bf16_f32 v196, v6, v7
    v_cvt_pk_bf16_f32 v197, v8, v9
    v_cvt_pk_bf16_f32 v198, v68, v69
    v_cvt_pk_bf16_f32 v199, v70, v71
    v_accvgpr_read_b32 v10, a72
    v_accvgpr_read_b32 v11, a73
    v_accvgpr_read_b32 v12, a74
    v_accvgpr_read_b32 v13, a75
    v_pk_mul_f32 v[10:11], v[10:11], s[66:67]
    v_pk_mul_f32 v[12:13], v[12:13], s[66:67]
    v_pk_mul_f32 v[72:73], v[72:73], s[66:67]
    v_pk_mul_f32 v[74:75], v[74:75], s[66:67]
    v_exp_f32 v10, v10
    v_exp_f32 v11, v11
    v_exp_f32 v12, v12
    v_exp_f32 v13, v13
    v_exp_f32 v72, v72
    v_exp_f32 v73, v73
    v_exp_f32 v74, v74
    v_exp_f32 v75, v75
    v_pk_add_f32 v[10:11], v[10:11], 1.0 op_sel_hi:[1,0]
    v_pk_add_f32 v[12:13], v[12:13], 1.0 op_sel_hi:[1,0]
    v_pk_add_f32 v[72:73], v[72:73], 1.0 op_sel_hi:[1,0]
    v_pk_add_f32 v[74:75], v[74:75], 1.0 op_sel_hi:[1,0]
    v_rcp_f32 v10, v10
    v_rcp_f32 v11, v11
    v_rcp_f32 v12, v12
    v_rcp_f32 v13, v13
    v_rcp_f32 v72, v72
    v_rcp_f32 v73, v73
    v_rcp_f32 v74, v74
    v_rcp_f32 v75, v75
    v_pk_mul_f32 v[10:11], v[10:11], v[40:41]
    v_pk_mul_f32 v[12:13], v[12:13], v[42:43]
    v_pk_mul_f32 v[72:73], v[72:73], v[104:105]
    v_pk_mul_f32 v[74:75], v[74:75], v[106:107]
    v_cvt_pk_bf16_f32 v200, v10, v11
    v_cvt_pk_bf16_f32 v201, v12, v13
    v_cvt_pk_bf16_f32 v202, v72, v73
    v_cvt_pk_bf16_f32 v203, v74, v75
    v_accvgpr_read_b32 v14, a76
    v_accvgpr_read_b32 v15, a77
    v_accvgpr_read_b32 v16, a78
    v_accvgpr_read_b32 v17, a79
    v_pk_mul_f32 v[14:15], v[14:15], s[66:67]
    v_pk_mul_f32 v[16:17], v[16:17], s[66:67]
    v_pk_mul_f32 v[76:77], v[76:77], s[66:67]
    v_pk_mul_f32 v[78:79], v[78:79], s[66:67]
    v_exp_f32 v14, v14
    v_exp_f32 v15, v15
    v_exp_f32 v16, v16
    v_exp_f32 v17, v17
    v_exp_f32 v76, v76
    v_exp_f32 v77, v77
    v_exp_f32 v78, v78
    v_exp_f32 v79, v79
    v_pk_add_f32 v[14:15], v[14:15], 1.0 op_sel_hi:[1,0]
    v_pk_add_f32 v[16:17], v[16:17], 1.0 op_sel_hi:[1,0]
    v_pk_add_f32 v[76:77], v[76:77], 1.0 op_sel_hi:[1,0]
    v_pk_add_f32 v[78:79], v[78:79], 1.0 op_sel_hi:[1,0]
    v_rcp_f32 v14, v14
    v_rcp_f32 v15, v15
    v_rcp_f32 v16, v16
    v_rcp_f32 v17, v17
    v_rcp_f32 v76, v76
    v_rcp_f32 v77, v77
    v_rcp_f32 v78, v78
    v_rcp_f32 v79, v79
    v_pk_mul_f32 v[14:15], v[14:15], v[44:45]
    v_pk_mul_f32 v[16:17], v[16:17], v[46:47]
    v_pk_mul_f32 v[76:77], v[76:77], v[108:109]
    v_pk_mul_f32 v[78:79], v[78:79], v[110:111]
    v_cvt_pk_bf16_f32 v204, v14, v15
    v_cvt_pk_bf16_f32 v205, v16, v17
    v_cvt_pk_bf16_f32 v206, v76, v77
    v_cvt_pk_bf16_f32 v207, v78, v79
    v_accvgpr_read_b32 v2, a80
    v_accvgpr_read_b32 v3, a81
    v_accvgpr_read_b32 v4, a82
    v_accvgpr_read_b32 v5, a83
    v_pk_mul_f32 v[2:3], v[2:3], s[66:67]
    v_pk_mul_f32 v[4:5], v[4:5], s[66:67]
    v_pk_mul_f32 v[80:81], v[80:81], s[66:67]
    v_pk_mul_f32 v[82:83], v[82:83], s[66:67]
    v_exp_f32 v2, v2
    v_exp_f32 v3, v3
    v_exp_f32 v4, v4
    v_exp_f32 v5, v5
    v_exp_f32 v80, v80
    v_exp_f32 v81, v81
    v_exp_f32 v82, v82
    v_exp_f32 v83, v83
    v_pk_add_f32 v[2:3], v[2:3], 1.0 op_sel_hi:[1,0]
    v_pk_add_f32 v[4:5], v[4:5], 1.0 op_sel_hi:[1,0]
    v_pk_add_f32 v[80:81], v[80:81], 1.0 op_sel_hi:[1,0]
    v_pk_add_f32 v[82:83], v[82:83], 1.0 op_sel_hi:[1,0]
    v_rcp_f32 v2, v2
    v_rcp_f32 v3, v3
    v_rcp_f32 v4, v4
    v_rcp_f32 v5, v5
    v_rcp_f32 v80, v80
    v_rcp_f32 v81, v81
    v_rcp_f32 v82, v82
    v_rcp_f32 v83, v83
    v_pk_mul_f32 v[2:3], v[2:3], v[48:49]
    v_pk_mul_f32 v[4:5], v[4:5], v[50:51]
    v_pk_mul_f32 v[80:81], v[80:81], v[112:113]
    v_pk_mul_f32 v[82:83], v[82:83], v[114:115]
    v_cvt_pk_bf16_f32 v208, v2, v3
    v_cvt_pk_bf16_f32 v209, v4, v5
    v_cvt_pk_bf16_f32 v210, v80, v81
    v_cvt_pk_bf16_f32 v211, v82, v83
    v_accvgpr_read_b32 v6, a84
    v_accvgpr_read_b32 v7, a85
    v_accvgpr_read_b32 v8, a86
    v_accvgpr_read_b32 v9, a87
    v_pk_mul_f32 v[6:7], v[6:7], s[66:67]
    v_pk_mul_f32 v[8:9], v[8:9], s[66:67]
    v_pk_mul_f32 v[84:85], v[84:85], s[66:67]
    v_pk_mul_f32 v[86:87], v[86:87], s[66:67]
    v_exp_f32 v6, v6
    v_exp_f32 v7, v7
    v_exp_f32 v8, v8
    v_exp_f32 v9, v9
    v_exp_f32 v84, v84
    v_exp_f32 v85, v85
    v_exp_f32 v86, v86
    v_exp_f32 v87, v87
    v_pk_add_f32 v[6:7], v[6:7], 1.0 op_sel_hi:[1,0]
    v_pk_add_f32 v[8:9], v[8:9], 1.0 op_sel_hi:[1,0]
    v_pk_add_f32 v[84:85], v[84:85], 1.0 op_sel_hi:[1,0]
    v_pk_add_f32 v[86:87], v[86:87], 1.0 op_sel_hi:[1,0]
    v_rcp_f32 v6, v6
    v_rcp_f32 v7, v7
    v_rcp_f32 v8, v8
    v_rcp_f32 v9, v9
    v_rcp_f32 v84, v84
    v_rcp_f32 v85, v85
    v_rcp_f32 v86, v86
    v_rcp_f32 v87, v87
    v_pk_mul_f32 v[6:7], v[6:7], v[52:53]
    v_pk_mul_f32 v[8:9], v[8:9], v[54:55]
    v_pk_mul_f32 v[84:85], v[84:85], v[116:117]
    v_pk_mul_f32 v[86:87], v[86:87], v[118:119]
    v_cvt_pk_bf16_f32 v212, v6, v7
    v_cvt_pk_bf16_f32 v213, v8, v9
    v_cvt_pk_bf16_f32 v214, v84, v85
    v_cvt_pk_bf16_f32 v215, v86, v87
    v_accvgpr_read_b32 v10, a88
    v_accvgpr_read_b32 v11, a89
    v_accvgpr_read_b32 v12, a90
    v_accvgpr_read_b32 v13, a91
    v_pk_mul_f32 v[10:11], v[10:11], s[66:67]
    v_pk_mul_f32 v[12:13], v[12:13], s[66:67]
    v_pk_mul_f32 v[88:89], v[88:89], s[66:67]
    v_pk_mul_f32 v[90:91], v[90:91], s[66:67]
    v_exp_f32 v10, v10
    v_exp_f32 v11, v11
    v_exp_f32 v12, v12
    v_exp_f32 v13, v13
    v_exp_f32 v88, v88
    v_exp_f32 v89, v89
    v_exp_f32 v90, v90
    v_exp_f32 v91, v91
    v_pk_add_f32 v[10:11], v[10:11], 1.0 op_sel_hi:[1,0]
    v_pk_add_f32 v[12:13], v[12:13], 1.0 op_sel_hi:[1,0]
    v_pk_add_f32 v[88:89], v[88:89], 1.0 op_sel_hi:[1,0]
    v_pk_add_f32 v[90:91], v[90:91], 1.0 op_sel_hi:[1,0]
    v_rcp_f32 v10, v10
    v_rcp_f32 v11, v11
    v_rcp_f32 v12, v12
    v_rcp_f32 v13, v13
    v_rcp_f32 v88, v88
    v_rcp_f32 v89, v89
    v_rcp_f32 v90, v90
    v_rcp_f32 v91, v91
    v_pk_mul_f32 v[10:11], v[10:11], v[56:57]
    v_pk_mul_f32 v[12:13], v[12:13], v[58:59]
    v_pk_mul_f32 v[88:89], v[88:89], v[120:121]
    v_pk_mul_f32 v[90:91], v[90:91], v[122:123]
    v_cvt_pk_bf16_f32 v216, v10, v11
    v_cvt_pk_bf16_f32 v217, v12, v13
    v_cvt_pk_bf16_f32 v218, v88, v89
    v_cvt_pk_bf16_f32 v219, v90, v91
    v_accvgpr_read_b32 v14, a92
    v_accvgpr_read_b32 v15, a93
    v_accvgpr_read_b32 v16, a94
    v_accvgpr_read_b32 v17, a95
    v_pk_mul_f32 v[14:15], v[14:15], s[66:67]
    v_pk_mul_f32 v[16:17], v[16:17], s[66:67]
    v_pk_mul_f32 v[92:93], v[92:93], s[66:67]
    v_pk_mul_f32 v[94:95], v[94:95], s[66:67]
    v_exp_f32 v14, v14
    v_exp_f32 v15, v15
    v_exp_f32 v16, v16
    v_exp_f32 v17, v17
    v_exp_f32 v92, v92
    v_exp_f32 v93, v93
    v_exp_f32 v94, v94
    v_exp_f32 v95, v95
    v_pk_add_f32 v[14:15], v[14:15], 1.0 op_sel_hi:[1,0]
    v_pk_add_f32 v[16:17], v[16:17], 1.0 op_sel_hi:[1,0]
    v_pk_add_f32 v[92:93], v[92:93], 1.0 op_sel_hi:[1,0]
    v_pk_add_f32 v[94:95], v[94:95], 1.0 op_sel_hi:[1,0]
    v_rcp_f32 v14, v14
    v_rcp_f32 v15, v15
    v_rcp_f32 v16, v16
    v_rcp_f32 v17, v17
    v_rcp_f32 v92, v92
    v_rcp_f32 v93, v93
    v_rcp_f32 v94, v94
    v_rcp_f32 v95, v95
    v_pk_mul_f32 v[14:15], v[14:15], v[60:61]
    v_pk_mul_f32 v[16:17], v[16:17], v[62:63]
    v_pk_mul_f32 v[92:93], v[92:93], v[124:125]
    v_pk_mul_f32 v[94:95], v[94:95], v[126:127]
    v_cvt_pk_bf16_f32 v220, v14, v15
    v_cvt_pk_bf16_f32 v221, v16, v17
    v_cvt_pk_bf16_f32 v222, v92, v93
    v_cvt_pk_bf16_f32 v223, v94, v95
L_p2:
    v_lshrrev_b32 v18, 4, v1
    v_lshrrev_b32 v26, 5, v18
    v_lshlrev_b32 v26, 8, v26
    v_bfe_u32 v27, v18, 4, 1
    v_and_b32 v28, 15, v18
    v_lshl_add_u32 v24, v27, 10, v26
    v_lshl_add_u32 v24, v28, 4, v24
    v_bfe_u32 v25, v18, 3, 1
    v_lshl_add_u32 v25, v25, 10, v26
    v_lshl_add_u32 v25, v27, 7, v25
    v_and_b32 v28, 7, v18
    v_lshl_add_u32 v25, v28, 4, v25
    s_lshl_b32 s45, s46, 12
    v_add_u32 v26, s45, v24
    s_waitcnt lgkmcnt(0)
    s_barrier
    ds_read_b128 a[96:99], v26 offset:49152
    ds_read_b128 a[100:103], v26 offset:49664
    ds_read_b128 a[104:107], v26 offset:51200
    ds_read_b128 a[108:111], v26 offset:51712
    ds_read_b128 v[144:147], v25 offset:0
    ds_read_b128 v[148:151], v25 offset:512
    ds_read_b128 v[152:155], v25 offset:4096
    ds_read_b128 v[156:159], v25 offset:4608
    ds_read_b128 v[160:163], v24 offset:2048
    ds_read_b128 v[164:167], v24 offset:2560
    s_lshl_b32 s58, s56, 18
    s_add_u32 s58, s58, 8388608
    s_add_u32 s59, s58, s45
    s_lshl_b32 s42, s57, 15
    s_add_u32 s42, s42, 32768
    s_and_b32 s42, s42, 0x3ffff
    s_lshl_b32 s44, s56, 8
    s_add_u32 s44, s44, 62922752
    v_lshlrev_b32 v14, 2, v18
    v_and_b32 v4, 127, v14
    s_mov_b32 s61, 1
    v_mov_b32 v10, 0xff800000
    v_mov_b32 v11, 0xff800000
    s_waitcnt lgkmcnt(4)
    v_mfma_f32_32x32x16_bf16 v[32:47], v[144:147], a[96:99], 0
    v_mfma_f32_32x32x16_bf16 v[32:47], v[148:151], a[100:103], v[32:47]
    v_mfma_f32_32x32x16_bf16 v[48:63], v[144:147], a[104:107], 0
    v_mfma_f32_32x32x16_bf16 v[48:63], v[148:151], a[108:111], v[48:63]
    v_mov_b32 v96, 0
    v_mov_b32 v97, 0
    v_mov_b32 v98, 0
    v_mov_b32 v99, 0
    v_mov_b32 v100, 0
    v_mov_b32 v101, 0
    v_mov_b32 v102, 0
    v_mov_b32 v103, 0
    v_mov_b32 v104, 0
    v_mov_b32 v105, 0
    v_mov_b32 v106, 0
    v_mov_b32 v107, 0
    v_mov_b32 v108, 0
    v_mov_b32 v109, 0
    v_mov_b32 v110, 0
    v_mov_b32 v111, 0
    v_mov_b32 v112, 0
    v_mov_b32 v113, 0
    v_mov_b32 v114, 0
    v_mov_b32 v115, 0
    v_mov_b32 v116, 0
    v_mov_b32 v117, 0
    v_mov_b32 v118, 0
    v_mov_b32 v119, 0
    v_mov_b32 v120, 0
    v_mov_b32 v121, 0
    v_mov_b32 v122, 0
    v_mov_b32 v123, 0
    v_mov_b32 v124, 0
    v_mov_b32 v125, 0
    v_mov_b32 v126, 0
    v_mov_b32 v127, 0
    v_max3_f32 v10, v32, v33, v10
    v_max3_f32 v10, v34, v35, v10
    v_max3_f32 v10, v36, v37, v10
    v_max3_f32 v10, v38, v39, v10
    v_max3_f32 v10, v40, v41, v10
    v_max3_f32 v10, v42, v43, v10
    v_max3_f32 v10, v44, v45, v10
    v_max3_f32 v10, v46, v47, v10
    v_max3_f32 v11, v48, v49, v11
    v_max3_f32 v11, v50, v51, v11
    v_max3_f32 v11, v52, v53, v11
    v_max3_f32 v11, v54, v55, v11
    v_max3_f32 v11, v56, v57, v11
    v_max3_f32 v11, v58, v59, v11
    v_max3_f32 v11, v60, v61, v11
    v_max3_f32 v11, v62, v63, v11
L_at_maxdone:
    v_mov_b32 v12, v10
    s_nop 1
    v_permlane32_swap_b32 v10, v12
    v_max_f32 v12, v10, v12
    v_sub_f32 v64, 0, v12
    v_sub_f32 v65, 0, v12
    v_sub_f32 v66, 0, v12
    v_sub_f32 v67, 0, v12
    v_sub_f32 v68, 0, v12
    v_sub_f32 v69, 0, v12
    v_sub_f32 v70, 0, v12
    v_sub_f32 v71, 0, v12
    v_sub_f32 v72, 0, v12
    v_sub_f32 v73, 0, v12
    v_sub_f32 v74, 0, v12
    v_sub_f32 v75, 0, v12
    v_sub_f32 v76, 0, v12
    v_sub_f32 v77, 0, v12
    v_sub_f32 v78, 0, v12
    v_sub_f32 v79, 0, v12
    v_mov_b32 v12, v11
    s_nop 1
    v_permlane32_swap_b32 v11, v12
    v_max_f32 v12, v11, v12
    v_sub_f32 v80, 0, v12
    v_sub_f32 v81, 0, v12
    v_sub_f32 v82, 0, v12
    v_sub_f32 v83, 0, v12
    v_sub_f32 v84, 0, v12
    v_sub_f32 v85, 0, v12
    v_sub_f32 v86, 0, v12
    v_sub_f32 v87, 0, v12
    v_sub_f32 v88, 0, v12
    v_sub_f32 v89, 0, v12
    v_sub_f32 v90, 0, v12
    v_sub_f32 v91, 0, v12
    v_sub_f32 v92, 0, v12
    v_sub_f32 v93, 0, v12
    v_sub_f32 v94, 0, v12
    v_sub_f32 v95, 0, v12
    s_waitcnt lgkmcnt(0)
    v_mfma_f32_32x32x16_bf16 v[32:47], v[144:147], a[96:99], v[64:79]
    v_mfma_f32_32x32x16_bf16 v[32:47], v[148:151], a[100:103], v[32:47]
    v_bfe_u32 v7, v18, 4, 1
    v_lshlrev_b32 v7, 2, v7
    v_and_b32 v6, 15, v18
    v_cmp_eq_u32 vcc, v7, v6
    v_mov_b32 v6, 0x3f803f80
    v_add_u32 v8, 65536, v24
    v_add_u32 v9, 65536, v25
    v_cndmask_b32 v184, 0, v6, vcc
    v_mov_b32 v185, v184
    v_mov_b32 v186, v184
    v_mov_b32 v187, v184
    v_mov_b32 v176, 0
    v_mov_b32 v177, 0
    v_mov_b32 v178, 0
    v_mov_b32 v179, 0
    v_mov_b32 v180, 0
    v_mov_b32 v181, 0
    v_mov_b32 v182, 0
    v_mov_b32 v183, 0
.p2align 6
    v_mfma_f32_32x32x16_bf16 v[48:63], v[144:147], a[104:107], v[80:95]
    buffer_load_dword v5, v4, s[4:7], s44 offen sc1
    v_exp_f32 v32, v32
    v_exp_f32 v33, v33
    v_exp_f32 v34, v34
    v_cvt_pk_bf16_f32 v128, v32, v33
    v_mfma_f32_32x32x16_bf16 v[48:63], v[148:151], a[108:111], v[48:63]
    v_exp_f32 v35, v35
    v_exp_f32 v36, v36
    v_exp_f32 v37, v37
    v_cvt_pk_bf16_f32 v129, v34, v35
    v_exp_f32 v38, v38
    v_exp_f32 v39, v39
    v_exp_f32 v40, v40
    v_cvt_pk_bf16_f32 v130, v36, v37
    v_exp_f32 v41, v41
    v_exp_f32 v42, v42
    v_exp_f32 v43, v43
    v_cvt_pk_bf16_f32 v131, v38, v39
    v_exp_f32 v44, v44
    v_exp_f32 v45, v45
    v_cvt_pk_bf16_f32 v132, v40, v41
    v_cvt_pk_bf16_f32 v133, v42, v43
    s_waitcnt lgkmcnt(0)
    v_exp_f32 v46, v46
    v_exp_f32 v47, v47
    v_cvt_pk_bf16_f32 v134, v44, v45
    v_cvt_pk_bf16_f32 v135, v46, v47
    v_mfma_f32_32x32x16_bf16 v[32:47], v[152:155], a[96:99], v[64:79]
    v_exp_f32 v48, v48
    v_exp_f32 v49, v49
    v_exp_f32 v50, v50
    v_cvt_pk_bf16_f32 v136, v48, v49
    v_mfma_f32_32x32x16_bf16 v[32:47], v[156:159], a[100:103], v[32:47]
    v_exp_f32 v51, v51
    v_exp_f32 v52, v52
    v_exp_f32 v53, v53
    v_cvt_pk_bf16_f32 v137, v50, v51
    v_mfma_f32_32x32x16_bf16 v[96:111], v[160:163], v[128:131], v[96:111]
    ds_read_b128 v[144:147], v25 offset:8192
    v_exp_f32 v54, v54
    v_exp_f32 v55, v55
    v_exp_f32 v56, v56
    v_cvt_pk_bf16_f32 v138, v52, v53
    v_mfma_f32_32x32x16_bf16 v[96:111], v[164:167], v[132:135], v[96:111]
    ds_read_b128 v[148:151], v25 offset:8704
    v_exp_f32 v57, v57
    v_exp_f32 v58, v58
    v_exp_f32 v59, v59
    v_cvt_pk_bf16_f32 v139, v54, v55
    v_mfma_f32_16x16x32_bf16 v[176:179], v[184:187], v[128:131], v[176:179]
    ds_read_b128 v[168:171], v24 offset:6144
    v_exp_f32 v60, v60
    v_exp_f32 v61, v61
    v_cvt_pk_bf16_f32 v140, v56, v57
    v_cvt_pk_bf16_f32 v141, v58, v59
    v_mfma_f32_16x16x32_bf16 v[176:179], v[184:187], v[132:135], v[176:179]
    ds_read_b128 v[172:175], v24 offset:6656
    v_exp_f32 v62, v62
    v_exp_f32 v63, v63
    v_cvt_pk_bf16_f32 v142, v60, v61
    v_cvt_pk_bf16_f32 v143, v62, v63
    v_mfma_f32_32x32x16_bf16 v[48:63], v[152:155], a[104:107], v[80:95]
    v_exp_f32 v32, v32
    v_exp_f32 v33, v33
    v_exp_f32 v34, v34
    v_cvt_pk_bf16_f32 v128, v32, v33
    v_mfma_f32_32x32x16_bf16 v[48:63], v[156:159], a[108:111], v[48:63]
    v_exp_f32 v35, v35
    v_exp_f32 v36, v36
    v_exp_f32 v37, v37
    v_cvt_pk_bf16_f32 v129, v34, v35
    v_mfma_f32_32x32x16_bf16 v[112:127], v[160:163], v[136:139], v[112:127]
    v_exp_f32 v38, v38
    v_exp_f32 v39, v39
    v_exp_f32 v40, v40
    v_cvt_pk_bf16_f32 v130, v36, v37
    v_mfma_f32_32x32x16_bf16 v[112:127], v[164:167], v[140:143], v[112:127]
    v_exp_f32 v41, v41
    v_exp_f32 v42, v42
    v_exp_f32 v43, v43
    v_cvt_pk_bf16_f32 v131, v38, v39
    v_mfma_f32_16x16x32_bf16 v[180:183], v[184:187], v[136:139], v[180:183]
    v_exp_f32 v44, v44
    v_exp_f32 v45, v45
    v_cvt_pk_bf16_f32 v132, v40, v41
    v_cvt_pk_bf16_f32 v133, v42, v43
    v_mfma_f32_16x16x32_bf16 v[180:183], v[184:187], v[140:143], v[180:183]
    s_waitcnt vmcnt(0) lgkmcnt(0)
    v_cmp_ne_u32 vcc, s72, v5
    s_cmp_lg_u64 vcc, 0
    s_cbranch_scc1 L_at_spinkv
L_at_spinkvback:
    v_exp_f32 v46, v46
    v_exp_f32 v47, v47
    v_cvt_pk_bf16_f32 v134, v44, v45
    v_cvt_pk_bf16_f32 v135, v46, v47
    v_mfma_f32_32x32x16_bf16 v[32:47], v[144:147], a[96:99], v[64:79]
    s_add_u32 m0, s45, 32768
    s_add_u32 s43, s59, s42
    v_exp_f32 v48, v48
    v_exp_f32 v49, v49
    v_exp_f32 v50, v50
    v_cvt_pk_bf16_f32 v136, v48, v49
    v_mfma_f32_32x32x16_bf16 v[32:47], v[148:151], a[100:103], v[32:47]
    buffer_load_dwordx4 v1, s[4:7], s43 offen offset:0 sc1 lds
    v_exp_f32 v51, v51
    v_exp_f32 v52, v52
    v_exp_f32 v53, v53
    v_cvt_pk_bf16_f32 v137, v50, v51
    v_mfma_f32_32x32x16_bf16 v[96:111], v[168:171], v[128:131], v[96:111]
    ds_read_b128 v[152:155], v25 offset:12288
    v_exp_f32 v54, v54
    v_exp_f32 v55, v55
    v_exp_f32 v56, v56
    v_cvt_pk_bf16_f32 v138, v52, v53
    v_mfma_f32_32x32x16_bf16 v[96:111], v[172:175], v[132:135], v[96:111]
    ds_read_b128 v[156:159], v25 offset:12800
    v_exp_f32 v57, v57
    v_exp_f32 v58, v58
    v_exp_f32 v59, v59
    v_cvt_pk_bf16_f32 v139, v54, v55
    v_mfma_f32_16x16x32_bf16 v[176:179], v[184:187], v[128:131], v[176:179]
    ds_read_b128 v[160:163], v24 offset:10240
    v_exp_f32 v60, v60
    v_exp_f32 v61, v61
    v_cvt_pk_bf16_f32 v140, v56, v57
    v_cvt_pk_bf16_f32 v141, v58, v59
    v_mfma_f32_16x16x32_bf16 v[176:179], v[184:187], v[132:135], v[176:179]
    ds_read_b128 v[164:167], v24 offset:10752
    v_exp_f32 v62, v62
    v_exp_f32 v63, v63
    v_cvt_pk_bf16_f32 v142, v60, v61
    v_cvt_pk_bf16_f32 v143, v62, v63
    v_mfma_f32_32x32x16_bf16 v[48:63], v[144:147], a[104:107], v[80:95]
    buffer_load_dwordx4 v1, s[4:7], s43 offen offset:1024 sc1 lds
    v_exp_f32 v32, v32
    v_exp_f32 v33, v33
    v_exp_f32 v34, v34
    v_cvt_pk_bf16_f32 v128, v32, v33
    v_mfma_f32_32x32x16_bf16 v[48:63], v[148:151], a[108:111], v[48:63]
    buffer_load_dwordx4 v1, s[4:7], s43 offen offset:2048 sc1 lds
    v_exp_f32 v35, v35
    v_exp_f32 v36, v36
    v_exp_f32 v37, v37
    v_cvt_pk_bf16_f32 v129, v34, v35
    v_mfma_f32_32x32x16_bf16 v[112:127], v[168:171], v[136:139], v[112:127]
    buffer_load_dwordx4 v1, s[4:7], s43 offen offset:3072 sc1 lds
    v_exp_f32 v38, v38
    v_exp_f32 v39, v39
    v_exp_f32 v40, v40
    v_cvt_pk_bf16_f32 v130, v36, v37
    v_mfma_f32_32x32x16_bf16 v[112:127], v[172:175], v[140:143], v[112:127]
    s_add_u32 s42, s42, 16384
    v_exp_f32 v41, v41
    v_exp_f32 v42, v42
    v_exp_f32 v43, v43
    v_cvt_pk_bf16_f32 v131, v38, v39
    v_mfma_f32_16x16x32_bf16 v[180:183], v[184:187], v[136:139], v[180:183]
    s_and_b32 s42, s42, 0x3ffff
    v_exp_f32 v44, v44
    v_exp_f32 v45, v45
    v_cvt_pk_bf16_f32 v132, v40, v41
    v_cvt_pk_bf16_f32 v133, v42, v43
    v_mfma_f32_16x16x32_bf16 v[180:183], v[184:187], v[140:143], v[180:183]
    s_waitcnt vmcnt(63) lgkmcnt(0)
    s_barrier
    v_exp_f32 v46, v46
    v_exp_f32 v47, v47
    v_cvt_pk_bf16_f32 v134, v44, v45
    v_cvt_pk_bf16_f32 v135, v46, v47
    v_mfma_f32_32x32x16_bf16 v[32:47], v[152:155], a[96:99], v[64:79]
    s_add_u32 m0, s45, 49152
    v_exp_f32 v48, v48
    v_exp_f32 v49, v49
    v_exp_f32 v50, v50
    v_cvt_pk_bf16_f32 v136, v48, v49
    v_mfma_f32_32x32x16_bf16 v[32:47], v[156:159], a[100:103], v[32:47]
    s_add_u32 s43, s59, s42
    v_exp_f32 v51, v51
    v_exp_f32 v52, v52
    v_exp_f32 v53, v53
    v_cvt_pk_bf16_f32 v137, v50, v51
    v_mfma_f32_32x32x16_bf16 v[96:111], v[160:163], v[128:131], v[96:111]
    ds_read_b128 v[144:147], v25 offset:16384
    v_exp_f32 v54, v54
    v_exp_f32 v55, v55
    v_exp_f32 v56, v56
    v_cvt_pk_bf16_f32 v138, v52, v53
    v_mfma_f32_32x32x16_bf16 v[96:111], v[164:167], v[132:135], v[96:111]
    ds_read_b128 v[148:151], v25 offset:16896
    v_exp_f32 v57, v57
    v_exp_f32 v58, v58
    v_exp_f32 v59, v59
    v_cvt_pk_bf16_f32 v139, v54, v55
    v_mfma_f32_16x16x32_bf16 v[176:179], v[184:187], v[128:131], v[176:179]
    ds_read_b128 v[168:171], v24 offset:14336
    v_exp_f32 v60, v60
    v_exp_f32 v61, v61
    v_cvt_pk_bf16_f32 v140, v56, v57
    v_cvt_pk_bf16_f32 v141, v58, v59
    v_mfma_f32_16x16x32_bf16 v[176:179], v[184:187], v[132:135], v[176:179]
    ds_read_b128 v[172:175], v24 offset:14848
    v_exp_f32 v62, v62
    v_exp_f32 v63, v63
    v_cvt_pk_bf16_f32 v142, v60, v61
    v_cvt_pk_bf16_f32 v143, v62, v63
    v_mfma_f32_32x32x16_bf16 v[48:63], v[152:155], a[104:107], v[80:95]
    buffer_load_dwordx4 v1, s[4:7], s43 offen offset:0 sc1 lds
    v_exp_f32 v32, v32
    v_exp_f32 v33, v33
    v_exp_f32 v34, v34
    v_cvt_pk_bf16_f32 v128, v32, v33
    v_mfma_f32_32x32x16_bf16 v[48:63], v[156:159], a[108:111], v[48:63]
    buffer_load_dwordx4 v1, s[4:7], s43 offen offset:1024 sc1 lds
    v_exp_f32 v35, v35
    v_exp_f32 v36, v36
    v_exp_f32 v37, v37
    v_cvt_pk_bf16_f32 v129, v34, v35
    v_mfma_f32_32x32x16_bf16 v[112:127], v[160:163], v[136:139], v[112:127]
    buffer_load_dwordx4 v1, s[4:7], s43 offen offset:2048 sc1 lds
    v_exp_f32 v38, v38
    v_exp_f32 v39, v39
    v_exp_f32 v40, v40
    v_cvt_pk_bf16_f32 v130, v36, v37
    v_mfma_f32_32x32x16_bf16 v[112:127], v[164:167], v[140:143], v[112:127]
    buffer_load_dwordx4 v1, s[4:7], s43 offen offset:3072 sc1 lds
    v_exp_f32 v41, v41
    v_exp_f32 v42, v42
    v_exp_f32 v43, v43
    v_cvt_pk_bf16_f32 v131, v38, v39
    v_mfma_f32_16x16x32_bf16 v[180:183], v[184:187], v[136:139], v[180:183]
    s_add_u32 s42, s42, 16384
    v_exp_f32 v44, v44
    v_exp_f32 v45, v45
    v_cvt_pk_bf16_f32 v132, v40, v41
    v_cvt_pk_bf16_f32 v133, v42, v43
    v_mfma_f32_16x16x32_bf16 v[180:183], v[184:187], v[140:143], v[180:183]
    s_waitcnt lgkmcnt(0)
    v_exp_f32 v46, v46
    v_exp_f32 v47, v47
    v_cvt_pk_bf16_f32 v134, v44, v45
    v_cvt_pk_bf16_f32 v135, v46, v47
    v_mfma_f32_32x32x16_bf16 v[32:47], v[144:147], a[96:99], v[64:79]
    s_and_b32 s42, s42, 0x3ffff
    v_exp_f32 v48, v48
    v_exp_f32 v49, v49
    v_exp_f32 v50, v50
    v_cvt_pk_bf16_f32 v136, v48, v49
    v_mfma_f32_32x32x16_bf16 v[32:47], v[148:151], a[100:103], v[32:47]
    v_exp_f32 v51, v51
    v_exp_f32 v52, v52
    v_exp_f32 v53, v53
    v_cvt_pk_bf16_f32 v137, v50, v51
    v_mfma_f32_32x32x16_bf16 v[96:111], v[168:171], v[128:131], v[96:111]
    ds_read_b128 v[152:155], v25 offset:20480
    v_exp_f32 v54, v54
    v_exp_f32 v55, v55
    v_exp_f32 v56, v56
    v_cvt_pk_bf16_f32 v138, v52, v53
    v_mfma_f32_32x32x16_bf16 v[96:111], v[172:175], v[132:135], v[96:111]
    ds_read_b128 v[156:159], v25 offset:20992
    v_exp_f32 v57, v57
    v_exp_f32 v58, v58
    v_exp_f32 v59, v59
    v_cvt_pk_bf16_f32 v139, v54, v55
    v_mfma_f32_16x16x32_bf16 v[176:179], v[184:187], v[128:131], v[176:179]
    ds_read_b128 v[160:163], v24 offset:18432
    v_exp_f32 v60, v60
    v_exp_f32 v61, v61
    v_cvt_pk_bf16_f32 v140, v56, v57
    v_cvt_pk_bf16_f32 v141, v58, v59
    v_mfma_f32_16x16x32_bf16 v[176:179], v[184:187], v[132:135], v[176:179]
    ds_read_b128 v[164:167], v24 offset:18944
    v_exp_f32 v62, v62
    v_exp_f32 v63, v63
    v_cvt_pk_bf16_f32 v142, v60, v61
    v_cvt_pk_bf16_f32 v143, v62, v63
    v_mfma_f32_32x32x16_bf16 v[48:63], v[144:147], a[104:107], v[80:95]
    buffer_store_dwordx4 v[192:195], v1, s[4:7], s70 offen offset:0 sc1
    v_exp_f32 v32, v32
    v_exp_f32 v33, v33
    v_exp_f32 v34, v34
    v_cvt_pk_bf16_f32 v128, v32, v33
    v_mfma_f32_32x32x16_bf16 v[48:63], v[148:151], a[108:111], v[48:63]
    buffer_store_dwordx4 v[224:227], v1, s[4:7], s71 offen offset:0 sc1
    v_exp_f32 v35, v35
    v_exp_f32 v36, v36
    v_exp_f32 v37, v37
    v_cvt_pk_bf16_f32 v129, v34, v35
    v_mfma_f32_32x32x16_bf16 v[112:127], v[168:171], v[136:139], v[112:127]
    buffer_store_dwordx2 v[224:225], v1, s[4:7], s55 offen offset:0 sc1
    v_exp_f32 v38, v38
    v_exp_f32 v39, v39
    v_exp_f32 v40, v40
    v_cvt_pk_bf16_f32 v130, v36, v37
    v_mfma_f32_32x32x16_bf16 v[112:127], v[172:175], v[140:143], v[112:127]
    buffer_store_dwordx4 v[196:199], v1, s[4:7], s70 offen offset:1024 sc1
    v_exp_f32 v41, v41
    v_exp_f32 v42, v42
    v_exp_f32 v43, v43
    v_cvt_pk_bf16_f32 v131, v38, v39
    v_mfma_f32_16x16x32_bf16 v[180:183], v[184:187], v[136:139], v[180:183]
    v_exp_f32 v44, v44
    v_exp_f32 v45, v45
    v_cvt_pk_bf16_f32 v132, v40, v41
    v_cvt_pk_bf16_f32 v133, v42, v43
    v_mfma_f32_16x16x32_bf16 v[180:183], v[184:187], v[140:143], v[180:183]
    s_waitcnt lgkmcnt(0)
    v_exp_f32 v46, v46
    v_exp_f32 v47, v47
    v_cvt_pk_bf16_f32 v134, v44, v45
    v_cvt_pk_bf16_f32 v135, v46, v47
    v_mfma_f32_32x32x16_bf16 v[32:47], v[152:155], a[96:99], v[64:79]
    s_add_u32 m0, s45, 65536
    v_exp_f32 v48, v48
    v_exp_f32 v49, v49
    v_exp_f32 v50, v50
    v_cvt_pk_bf16_f32 v136, v48, v49
    v_mfma_f32_32x32x16_bf16 v[32:47], v[156:159], a[100:103], v[32:47]
    s_add_u32 s43, s59, s42
    v_exp_f32 v51, v51
    v_exp_f32 v52, v52
    v_exp_f32 v53, v53
    v_cvt_pk_bf16_f32 v137, v50, v51
    v_mfma_f32_32x32x16_bf16 v[96:111], v[160:163], v[128:131], v[96:111]
    ds_read_b128 v[144:147], v25 offset:24576
    v_exp_f32 v54, v54
    v_exp_f32 v55, v55
    v_exp_f32 v56, v56
    v_cvt_pk_bf16_f32 v138, v52, v53
    v_mfma_f32_32x32x16_bf16 v[96:111], v[164:167], v[132:135], v[96:111]
    ds_read_b128 v[148:151], v25 offset:25088
    v_exp_f32 v57, v57
    v_exp_f32 v58, v58
    v_exp_f32 v59, v59
    v_cvt_pk_bf16_f32 v139, v54, v55
    v_mfma_f32_16x16x32_bf16 v[176:179], v[184:187], v[128:131], v[176:179]
    ds_read_b128 v[168:171], v24 offset:22528
    v_exp_f32 v60, v60
    v_exp_f32 v61, v61
    v_cvt_pk_bf16_f32 v140, v56, v57
    v_cvt_pk_bf16_f32 v141, v58, v59
    v_mfma_f32_16x16x32_bf16 v[176:179], v[184:187], v[132:135], v[176:179]
    ds_read_b128 v[172:175], v24 offset:23040
    v_exp_f32 v62, v62
    v_exp_f32 v63, v63
    v_cvt_pk_bf16_f32 v142, v60, v61
    v_cvt_pk_bf16_f32 v143, v62, v63
    v_mfma_f32_32x32x16_bf16 v[48:63], v[152:155], a[104:107], v[80:95]
    buffer_load_dwordx4 v1, s[4:7], s43 offen offset:0 sc1 lds
    v_exp_f32 v32, v32
    v_exp_f32 v33, v33
    v_exp_f32 v34, v34
    v_cvt_pk_bf16_f32 v128, v32, v33
    v_mfma_f32_32x32x16_bf16 v[48:63], v[156:159], a[108:111], v[48:63]
    buffer_load_dwordx4 v1, s[4:7], s43 offen offset:1024 sc1 lds
    v_exp_f32 v35, v35
    v_exp_f32 v36, v36
    v_exp_f32 v37, v37
    v_cvt_pk_bf16_f32 v129, v34, v35
    v_mfma_f32_32x32x16_bf16 v[112:127], v[160:163], v[136:139], v[112:127]
    buffer_load_dwordx4 v1, s[4:7], s43 offen offset:2048 sc1 lds
    v_exp_f32 v38, v38
    v_exp_f32 v39, v39
    v_exp_f32 v40, v40
    v_cvt_pk_bf16_f32 v130, v36, v37
    v_mfma_f32_32x32x16_bf16 v[112:127], v[164:167], v[140:143], v[112:127]
    buffer_load_dwordx4 v1, s[4:7], s43 offen offset:3072 sc1 lds
    v_exp_f32 v41, v41
    v_exp_f32 v42, v42
    v_exp_f32 v43, v43
    v_cvt_pk_bf16_f32 v131, v38, v39
    v_mfma_f32_16x16x32_bf16 v[180:183], v[184:187], v[136:139], v[180:183]
    s_add_u32 s42, s42, 16384
    v_exp_f32 v44, v44
    v_exp_f32 v45, v45
    v_cvt_pk_bf16_f32 v132, v40, v41
    v_cvt_pk_bf16_f32 v133, v42, v43
    v_mfma_f32_16x16x32_bf16 v[180:183], v[184:187], v[140:143], v[180:183]
    s_waitcnt lgkmcnt(0)
    v_exp_f32 v46, v46
    v_exp_f32 v47, v47
    v_cvt_pk_bf16_f32 v134, v44, v45
    v_cvt_pk_bf16_f32 v135, v46, v47
    v_mfma_f32_32x32x16_bf16 v[32:47], v[144:147], a[96:99], v[64:79]
    s_and_b32 s42, s42, 0x3ffff
    v_exp_f32 v48, v48
    v_exp_f32 v49, v49
    v_exp_f32 v50, v50
    v_cvt_pk_bf16_f32 v136, v48, v49
    v_mfma_f32_32x32x16_bf16 v[32:47], v[148:151], a[100:103], v[32:47]
    v_exp_f32 v51, v51
    v_exp_f32 v52, v52
    v_exp_f32 v53, v53
    v_cvt_pk_bf16_f32 v137, v50, v51
    v_mfma_f32_32x32x16_bf16 v[96:111], v[168:171], v[128:131], v[96:111]
    ds_read_b128 v[152:155], v25 offset:28672
    v_exp_f32 v54, v54
    v_exp_f32 v55, v55
    v_exp_f32 v56, v56
    v_cvt_pk_bf16_f32 v138, v52, v53
    v_mfma_f32_32x32x16_bf16 v[96:111], v[172:175], v[132:135], v[96:111]
    ds_read_b128 v[156:159], v25 offset:29184
    v_exp_f32 v57, v57
    v_exp_f32 v58, v58
    v_exp_f32 v59, v59
    v_cvt_pk_bf16_f32 v139, v54, v55
    v_mfma_f32_16x16x32_bf16 v[176:179], v[184:187], v[128:131], v[176:179]
    ds_read_b128 v[160:163], v24 offset:26624
    v_exp_f32 v60, v60
    v_exp_f32 v61, v61
    v_cvt_pk_bf16_f32 v140, v56, v57
    v_cvt_pk_bf16_f32 v141, v58, v59
    v_mfma_f32_16x16x32_bf16 v[176:179], v[184:187], v[132:135], v[176:179]
    ds_read_b128 v[164:167], v24 offset:27136
    v_exp_f32 v62, v62
    v_exp_f32 v63, v63
    v_cvt_pk_bf16_f32 v142, v60, v61
    v_cvt_pk_bf16_f32 v143, v62, v63
    v_mfma_f32_32x32x16_bf16 v[48:63], v[144:147], a[104:107], v[80:95]
    buffer_store_dwordx4 v[228:231], v1, s[4:7], s71 offen offset:1024 sc1
    v_exp_f32 v32, v32
    v_exp_f32 v33, v33
    v_exp_f32 v34, v34
    v_cvt_pk_bf16_f32 v128, v32, v33
    v_mfma_f32_32x32x16_bf16 v[48:63], v[148:151], a[108:111], v[48:63]
    buffer_store_dwordx2 v[228:229], v1, s[4:7], s55 offen offset:1024 sc1
    v_exp_f32 v35, v35
    v_exp_f32 v36, v36
    v_exp_f32 v37, v37
    v_cvt_pk_bf16_f32 v129, v34, v35
    v_mfma_f32_32x32x16_bf16 v[112:127], v[168:171], v[136:139], v[112:127]
    v_exp_f32 v38, v38
    v_exp_f32 v39, v39
    v_exp_f32 v40, v40
    v_cvt_pk_bf16_f32 v130, v36, v37
    v_mfma_f32_32x32x16_bf16 v[112:127], v[172:175], v[140:143], v[112:127]
    v_exp_f32 v41, v41
    v_exp_f32 v42, v42
    v_exp_f32 v43, v43
    v_cvt_pk_bf16_f32 v131, v38, v39
    v_mfma_f32_16x16x32_bf16 v[180:183], v[184:187], v[136:139], v[180:183]
    v_exp_f32 v44, v44
    v_exp_f32 v45, v45
    v_cvt_pk_bf16_f32 v132, v40, v41
    v_cvt_pk_bf16_f32 v133, v42, v43
    v_mfma_f32_16x16x32_bf16 v[180:183], v[184:187], v[140:143], v[180:183]
    s_waitcnt vmcnt(14) lgkmcnt(0)
    s_barrier
    v_exp_f32 v46, v46
    v_exp_f32 v47, v47
    v_cvt_pk_bf16_f32 v134, v44, v45
    v_cvt_pk_bf16_f32 v135, v46, v47
    v_mfma_f32_32x32x16_bf16 v[32:47], v[152:155], a[96:99], v[64:79]
    s_add_u32 m0, s45, 81920
    v_exp_f32 v48, v48
    v_exp_f32 v49, v49
    v_exp_f32 v50, v50
    v_cvt_pk_bf16_f32 v136, v48, v49
    v_mfma_f32_32x32x16_bf16 v[32:47], v[156:159], a[100:103], v[32:47]
    s_add_u32 s43, s59, s42
    v_exp_f32 v51, v51
    v_exp_f32 v52, v52
    v_exp_f32 v53, v53
    v_cvt_pk_bf16_f32 v137, v50, v51
    v_mfma_f32_32x32x16_bf16 v[96:111], v[160:163], v[128:131], v[96:111]
    ds_read_b128 v[144:147], v25 offset:32768
    v_exp_f32 v54, v54
    v_exp_f32 v55, v55
    v_exp_f32 v56, v56
    v_cvt_pk_bf16_f32 v138, v52, v53
    v_mfma_f32_32x32x16_bf16 v[96:111], v[164:167], v[132:135], v[96:111]
    ds_read_b128 v[148:151], v25 offset:33280
    v_exp_f32 v57, v57
    v_exp_f32 v58, v58
    v_exp_f32 v59, v59
    v_cvt_pk_bf16_f32 v139, v54, v55
    v_mfma_f32_16x16x32_bf16 v[176:179], v[184:187], v[128:131], v[176:179]
    ds_read_b128 v[168:171], v24 offset:30720
    v_exp_f32 v60, v60
    v_exp_f32 v61, v61
    v_cvt_pk_bf16_f32 v140, v56, v57
    v_cvt_pk_bf16_f32 v141, v58, v59
    v_mfma_f32_16x16x32_bf16 v[176:179], v[184:187], v[132:135], v[176:179]
    ds_read_b128 v[172:175], v24 offset:31232
    v_exp_f32 v62, v62
    v_exp_f32 v63, v63
    v_cvt_pk_bf16_f32 v142, v60, v61
    v_cvt_pk_bf16_f32 v143, v62, v63
    v_mfma_f32_32x32x16_bf16 v[48:63], v[152:155], a[104:107], v[80:95]
    buffer_load_dwordx4 v1, s[4:7], s43 offen offset:0 sc1 lds
    v_exp_f32 v32, v32
    v_exp_f32 v33, v33
    v_exp_f32 v34, v34
    v_cvt_pk_bf16_f32 v128, v32, v33
    v_mfma_f32_32x32x16_bf16 v[48:63], v[156:159], a[108:111], v[48:63]
    buffer_load_dwordx4 v1, s[4:7], s43 offen offset:1024 sc1 lds
    v_exp_f32 v35, v35
    v_exp_f32 v36, v36
    v_exp_f32 v37, v37
    v_cvt_pk_bf16_f32 v129, v34, v35
    v_mfma_f32_32x32x16_bf16 v[112:127], v[160:163], v[136:139], v[112:127]
    buffer_load_dwordx4 v1, s[4:7], s43 offen offset:2048 sc1 lds
    v_exp_f32 v38, v38
    v_exp_f32 v39, v39
    v_exp_f32 v40, v40
    v_cvt_pk_bf16_f32 v130, v36, v37
    v_mfma_f32_32x32x16_bf16 v[112:127], v[164:167], v[140:143], v[112:127]
    buffer_load_dwordx4 v1, s[4:7], s43 offen offset:3072 sc1 lds
    v_exp_f32 v41, v41
    v_exp_f32 v42, v42
    v_exp_f32 v43, v43
    v_cvt_pk_bf16_f32 v131, v38, v39
    v_mfma_f32_16x16x32_bf16 v[180:183], v[184:187], v[136:139], v[180:183]
    s_add_u32 s42, s42, 16384
    v_exp_f32 v44, v44
    v_exp_f32 v45, v45
    v_cvt_pk_bf16_f32 v132, v40, v41
    v_cvt_pk_bf16_f32 v133, v42, v43
    v_mfma_f32_16x16x32_bf16 v[180:183], v[184:187], v[140:143], v[180:183]
    s_waitcnt lgkmcnt(0)
    v_exp_f32 v46, v46
    v_exp_f32 v47, v47
    v_cvt_pk_bf16_f32 v134, v44, v45
    v_cvt_pk_bf16_f32 v135, v46, v47
    v_mfma_f32_32x32x16_bf16 v[32:47], v[144:147], a[96:99], v[64:79]
    s_and_b32 s42, s42, 0x3ffff
    v_exp_f32 v48, v48
    v_exp_f32 v49, v49
    v_exp_f32 v50, v50
    v_cvt_pk_bf16_f32 v136, v48, v49
    v_mfma_f32_32x32x16_bf16 v[32:47], v[148:151], a[100:103], v[32:47]
    v_exp_f32 v51, v51
    v_exp_f32 v52, v52
    v_exp_f32 v53, v53
    v_cvt_pk_bf16_f32 v137, v50, v51
    v_mfma_f32_32x32x16_bf16 v[96:111], v[168:171], v[128:131], v[96:111]
    ds_read_b128 v[152:155], v25 offset:36864
    v_exp_f32 v54, v54
    v_exp_f32 v55, v55
    v_exp_f32 v56, v56
    v_cvt_pk_bf16_f32 v138, v52, v53
    v_mfma_f32_32x32x16_bf16 v[96:111], v[172:175], v[132:135], v[96:111]
    ds_read_b128 v[156:159], v25 offset:37376
    v_exp_f32 v57, v57
    v_exp_f32 v58, v58
    v_exp_f32 v59, v59
    v_cvt_pk_bf16_f32 v139, v54, v55
    v_mfma_f32_16x16x32_bf16 v[176:179], v[184:187], v[128:131], v[176:179]
    ds_read_b128 v[160:163], v24 offset:34816
    v_exp_f32 v60, v60
    v_exp_f32 v61, v61
    v_cvt_pk_bf16_f32 v140, v56, v57
    v_cvt_pk_bf16_f32 v141, v58, v59
    v_mfma_f32_16x16x32_bf16 v[176:179], v[184:187], v[132:135], v[176:179]
    ds_read_b128 v[164:167], v24 offset:35328
    v_exp_f32 v62, v62
    v_exp_f32 v63, v63
    v_cvt_pk_bf16_f32 v142, v60, v61
    v_cvt_pk_bf16_f32 v143, v62, v63
    v_mfma_f32_32x32x16_bf16 v[48:63], v[144:147], a[104:107], v[80:95]
    buffer_store_dwordx4 v[200:203], v1, s[4:7], s70 offen offset:2048 sc1
    v_exp_f32 v32, v32
    v_exp_f32 v33, v33
    v_exp_f32 v34, v34
    v_cvt_pk_bf16_f32 v128, v32, v33
    v_mfma_f32_32x32x16_bf16 v[48:63], v[148:151], a[108:111], v[48:63]
    buffer_store_dwordx4 v[232:235], v1, s[4:7], s71 offen offset:2048 sc1
    v_exp_f32 v35, v35
    v_exp_f32 v36, v36
    v_exp_f32 v37, v37
    v_cvt_pk_bf16_f32 v129, v34, v35
    v_mfma_f32_32x32x16_bf16 v[112:127], v[168:171], v[136:139], v[112:127]
    buffer_store_dwordx2 v[232:233], v1, s[4:7], s55 offen offset:2048 sc1
    v_exp_f32 v38, v38
    v_exp_f32 v39, v39
    v_exp_f32 v40, v40
    v_cvt_pk_bf16_f32 v130, v36, v37
    v_mfma_f32_32x32x16_bf16 v[112:127], v[172:175], v[140:143], v[112:127]
    buffer_store_dwordx4 v[204:207], v1, s[4:7], s70 offen offset:3072 sc1
    v_exp_f32 v41, v41
    v_exp_f32 v42, v42
    v_exp_f32 v43, v43
    v_cvt_pk_bf16_f32 v131, v38, v39
    v_mfma_f32_16x16x32_bf16 v[180:183], v[184:187], v[136:139], v[180:183]
    v_exp_f32 v44, v44
    v_exp_f32 v45, v45
    v_cvt_pk_bf16_f32 v132, v40, v41
    v_cvt_pk_bf16_f32 v133, v42, v43
    v_mfma_f32_16x16x32_bf16 v[180:183], v[184:187], v[140:143], v[180:183]
    s_waitcnt lgkmcnt(0)
    v_exp_f32 v46, v46
    v_exp_f32 v47, v47
    v_cvt_pk_bf16_f32 v134, v44, v45
    v_cvt_pk_bf16_f32 v135, v46, v47
    v_mfma_f32_32x32x16_bf16 v[32:47], v[152:155], a[96:99], v[64:79]
    s_add_u32 m0, s45, 98304
    v_exp_f32 v48, v48
    v_exp_f32 v49, v49
    v_exp_f32 v50, v50
    v_cvt_pk_bf16_f32 v136, v48, v49
    v_mfma_f32_32x32x16_bf16 v[32:47], v[156:159], a[100:103], v[32:47]
    s_add_u32 s43, s59, s42
    v_exp_f32 v51, v51
    v_exp_f32 v52, v52
    v_exp_f32 v53, v53
    v_cvt_pk_bf16_f32 v137, v50, v51
    v_mfma_f32_32x32x16_bf16 v[96:111], v[160:163], v[128:131], v[96:111]
    ds_read_b128 v[144:147], v25 offset:40960
    v_exp_f32 v54, v54
    v_exp_f32 v55, v55
    v_exp_f32 v56, v56
    v_cvt_pk_bf16_f32 v138, v52, v53
    v_mfma_f32_32x32x16_bf16 v[96:111], v[164:167], v[132:135], v[96:111]
    ds_read_b128 v[148:151], v25 offset:41472
    v_exp_f32 v57, v57
    v_exp_f32 v58, v58
    v_exp_f32 v59, v59
    v_cvt_pk_bf16_f32 v139, v54, v55
    v_mfma_f32_16x16x32_bf16 v[176:179], v[184:187], v[128:131], v[176:179]
    ds_read_b128 v[168:171], v24 offset:38912
    v_exp_f32 v60, v60
    v_exp_f32 v61, v61
    v_cvt_pk_bf16_f32 v140, v56, v57
    v_cvt_pk_bf16_f32 v141, v58, v59
    v_mfma_f32_16x16x32_bf16 v[176:179], v[184:187], v[132:135], v[176:179]
    ds_read_b128 v[172:175], v24 offset:39424
    v_exp_f32 v62, v62
    v_exp_f32 v63, v63
    v_cvt_pk_bf16_f32 v142, v60, v61
    v_cvt_pk_bf16_f32 v143, v62, v63
    v_mfma_f32_32x32x16_bf16 v[48:63], v[152:155], a[104:107], v[80:95]
    buffer_load_dwordx4 v1, s[4:7], s43 offen offset:0 sc1 lds
    v_exp_f32 v32, v32
    v_exp_f32 v33, v33
    v_exp_f32 v34, v34
    v_cvt_pk_bf16_f32 v128, v32, v33
    v_mfma_f32_32x32x16_bf16 v[48:63], v[156:159], a[108:111], v[48:63]
    buffer_load_dwordx4 v1, s[4:7], s43 offen offset:1024 sc1 lds
    v_exp_f32 v35, v35
    v_exp_f32 v36, v36
    v_exp_f32 v37, v37
    v_cvt_pk_bf16_f32 v129, v34, v35
    v_mfma_f32_32x32x16_bf16 v[112:127], v[160:163], v[136:139], v[112:127]
    buffer_load_dwordx4 v1, s[4:7], s43 offen offset:2048 sc1 lds
    v_exp_f32 v38, v38
    v_exp_f32 v39, v39
    v_exp_f32 v40, v40
    v_cvt_pk_bf16_f32 v130, v36, v37
    v_mfma_f32_32x32x16_bf16 v[112:127], v[164:167], v[140:143], v[112:127]
    buffer_load_dwordx4 v1, s[4:7], s43 offen offset:3072 sc1 lds
    v_exp_f32 v41, v41
    v_exp_f32 v42, v42
    v_exp_f32 v43, v43
    v_cvt_pk_bf16_f32 v131, v38, v39
    v_mfma_f32_16x16x32_bf16 v[180:183], v[184:187], v[136:139], v[180:183]
    s_add_u32 s42, s42, 16384
    v_exp_f32 v44, v44
    v_exp_f32 v45, v45
    v_cvt_pk_bf16_f32 v132, v40, v41
    v_cvt_pk_bf16_f32 v133, v42, v43
    v_mfma_f32_16x16x32_bf16 v[180:183], v[184:187], v[140:143], v[180:183]
    s_waitcnt lgkmcnt(0)
    v_exp_f32 v46, v46
    v_exp_f32 v47, v47
    v_cvt_pk_bf16_f32 v134, v44, v45
    v_cvt_pk_bf16_f32 v135, v46, v47
    v_mfma_f32_32x32x16_bf16 v[32:47], v[144:147], a[96:99], v[64:79]
    s_and_b32 s42, s42, 0x3ffff
    v_exp_f32 v48, v48
    v_exp_f32 v49, v49
    v_exp_f32 v50, v50
    v_cvt_pk_bf16_f32 v136, v48, v49
    v_mfma_f32_32x32x16_bf16 v[32:47], v[148:151], a[100:103], v[32:47]
    v_exp_f32 v51, v51
    v_exp_f32 v52, v52
    v_exp_f32 v53, v53
    v_cvt_pk_bf16_f32 v137, v50, v51
    v_mfma_f32_32x32x16_bf16 v[96:111], v[168:171], v[128:131], v[96:111]
    ds_read_b128 v[152:155], v25 offset:45056
    v_exp_f32 v54, v54
    v_exp_f32 v55, v55
    v_exp_f32 v56, v56
    v_cvt_pk_bf16_f32 v138, v52, v53
    v_mfma_f32_32x32x16_bf16 v[96:111], v[172:175], v[132:135], v[96:111]
    ds_read_b128 v[156:159], v25 offset:45568
    v_exp_f32 v57, v57
    v_exp_f32 v58, v58
    v_exp_f32 v59, v59
    v_cvt_pk_bf16_f32 v139, v54, v55
    v_mfma_f32_16x16x32_bf16 v[176:179], v[184:187], v[128:131], v[176:179]
    ds_read_b128 v[160:163], v24 offset:43008
    v_exp_f32 v60, v60
    v_exp_f32 v61, v61
    v_cvt_pk_bf16_f32 v140, v56, v57
    v_cvt_pk_bf16_f32 v141, v58, v59
    v_mfma_f32_16x16x32_bf16 v[176:179], v[184:187], v[132:135], v[176:179]
    ds_read_b128 v[164:167], v24 offset:43520
    v_exp_f32 v62, v62
    v_exp_f32 v63, v63
    v_cvt_pk_bf16_f32 v142, v60, v61
    v_cvt_pk_bf16_f32 v143, v62, v63
    v_mfma_f32_32x32x16_bf16 v[48:63], v[144:147], a[104:107], v[80:95]
    buffer_store_dwordx4 v[236:239], v1, s[4:7], s71 offen offset:3072 sc1
    v_exp_f32 v32, v32
    v_exp_f32 v33, v33
    v_exp_f32 v34, v34
    v_cvt_pk_bf16_f32 v128, v32, v33
    v_mfma_f32_32x32x16_bf16 v[48:63], v[148:151], a[108:111], v[48:63]
    buffer_store_dwordx2 v[236:237], v1, s[4:7], s55 offen offset:3072 sc1
    v_exp_f32 v35, v35
    v_exp_f32 v36, v36
    v_exp_f32 v37, v37
    v_cvt_pk_bf16_f32 v129, v34, v35
    v_mfma_f32_32x32x16_bf16 v[112:127], v[168:171], v[136:139], v[112:127]
    s_add_u32 s36, s70, 4096
    v_exp_f32 v38, v38
    v_exp_f32 v39, v39
    v_exp_f32 v40, v40
    v_cvt_pk_bf16_f32 v130, v36, v37
    v_mfma_f32_32x32x16_bf16 v[112:127], v[172:175], v[140:143], v[112:127]
    v_exp_f32 v41, v41
    v_exp_f32 v42, v42
    v_exp_f32 v43, v43
    v_cvt_pk_bf16_f32 v131, v38, v39
    v_mfma_f32_16x16x32_bf16 v[180:183], v[184:187], v[136:139], v[180:183]
    v_exp_f32 v44, v44
    v_exp_f32 v45, v45
    v_cvt_pk_bf16_f32 v132, v40, v41
    v_cvt_pk_bf16_f32 v133, v42, v43
    v_mfma_f32_16x16x32_bf16 v[180:183], v[184:187], v[140:143], v[180:183]
    s_waitcnt vmcnt(16) lgkmcnt(0)
    s_barrier
    v_exp_f32 v46, v46
    v_exp_f32 v47, v47
    v_cvt_pk_bf16_f32 v134, v44, v45
    v_cvt_pk_bf16_f32 v135, v46, v47
    v_mfma_f32_32x32x16_bf16 v[32:47], v[152:155], a[96:99], v[64:79]
    s_add_u32 m0, s45, 114688
    v_exp_f32 v48, v48
    v_exp_f32 v49, v49
    v_exp_f32 v50, v50
    v_cvt_pk_bf16_f32 v136, v48, v49
    v_mfma_f32_32x32x16_bf16 v[32:47], v[156:159], a[100:103], v[32:47]
    s_add_u32 s43, s59, s42
    v_exp_f32 v51, v51
    v_exp_f32 v52, v52
    v_exp_f32 v53, v53
    v_cvt_pk_bf16_f32 v137, v50, v51
    v_mfma_f32_32x32x16_bf16 v[96:111], v[160:163], v[128:131], v[96:111]
    ds_read_b128 v[144:147], v25 offset:49152
    v_exp_f32 v54, v54
    v_exp_f32 v55, v55
    v_exp_f32 v56, v56
    v_cvt_pk_bf16_f32 v138, v52, v53
    v_mfma_f32_32x32x16_bf16 v[96:111], v[164:167], v[132:135], v[96:111]
    ds_read_b128 v[148:151], v25 offset:49664
    v_exp_f32 v57, v57
    v_exp_f32 v58, v58
    v_exp_f32 v59, v59
    v_cvt_pk_bf16_f32 v139, v54, v55
    v_mfma_f32_16x16x32_bf16 v[176:179], v[184:187], v[128:131], v[176:179]
    ds_read_b128 v[168:171], v24 offset:47104
    v_exp_f32 v60, v60
    v_exp_f32 v61, v61
    v_cvt_pk_bf16_f32 v140, v56, v57
    v_cvt_pk_bf16_f32 v141, v58, v59
    v_mfma_f32_16x16x32_bf16 v[176:179], v[184:187], v[132:135], v[176:179]
    ds_read_b128 v[172:175], v24 offset:47616
    v_exp_f32 v62, v62
    v_exp_f32 v63, v63
    v_cvt_pk_bf16_f32 v142, v60, v61
    v_cvt_pk_bf16_f32 v143, v62, v63
    v_mfma_f32_32x32x16_bf16 v[48:63], v[152:155], a[104:107], v[80:95]
    buffer_load_dwordx4 v1, s[4:7], s43 offen offset:0 sc1 lds
    v_exp_f32 v32, v32
    v_exp_f32 v33, v33
    v_exp_f32 v34, v34
    v_cvt_pk_bf16_f32 v128, v32, v33
    v_mfma_f32_32x32x16_bf16 v[48:63], v[156:159], a[108:111], v[48:63]
    buffer_load_dwordx4 v1, s[4:7], s43 offen offset:1024 sc1 lds
    v_exp_f32 v35, v35
    v_exp_f32 v36, v36
    v_exp_f32 v37, v37
    v_cvt_pk_bf16_f32 v129, v34, v35
    v_mfma_f32_32x32x16_bf16 v[112:127], v[160:163], v[136:139], v[112:127]
    buffer_load_dwordx4 v1, s[4:7], s43 offen offset:2048 sc1 lds
    v_exp_f32 v38, v38
    v_exp_f32 v39, v39
    v_exp_f32 v40, v40
    v_cvt_pk_bf16_f32 v130, v36, v37
    v_mfma_f32_32x32x16_bf16 v[112:127], v[164:167], v[140:143], v[112:127]
    buffer_load_dwordx4 v1, s[4:7], s43 offen offset:3072 sc1 lds
    v_exp_f32 v41, v41
    v_exp_f32 v42, v42
    v_exp_f32 v43, v43
    v_cvt_pk_bf16_f32 v131, v38, v39
    v_mfma_f32_16x16x32_bf16 v[180:183], v[184:187], v[136:139], v[180:183]
    s_add_u32 s42, s42, 16384
    v_exp_f32 v44, v44
    v_exp_f32 v45, v45
    v_cvt_pk_bf16_f32 v132, v40, v41
    v_cvt_pk_bf16_f32 v133, v42, v43
    v_mfma_f32_16x16x32_bf16 v[180:183], v[184:187], v[140:143], v[180:183]
    s_waitcnt lgkmcnt(0)
    v_exp_f32 v46, v46
    v_exp_f32 v47, v47
    v_cvt_pk_bf16_f32 v134, v44, v45
    v_cvt_pk_bf16_f32 v135, v46, v47
    v_mfma_f32_32x32x16_bf16 v[32:47], v[144:147], a[96:99], v[64:79]
    s_and_b32 s42, s42, 0x3ffff
    v_exp_f32 v48, v48
    v_exp_f32 v49, v49
    v_exp_f32 v50, v50
    v_cvt_pk_bf16_f32 v136, v48, v49
    v_mfma_f32_32x32x16_bf16 v[32:47], v[148:151], a[100:103], v[32:47]
    v_exp_f32 v51, v51
    v_exp_f32 v52, v52
    v_exp_f32 v53, v53
    v_cvt_pk_bf16_f32 v137, v50, v51
    v_mfma_f32_32x32x16_bf16 v[96:111], v[168:171], v[128:131], v[96:111]
    ds_read_b128 v[152:155], v25 offset:53248
    v_exp_f32 v54, v54
    v_exp_f32 v55, v55
    v_exp_f32 v56, v56
    v_cvt_pk_bf16_f32 v138, v52, v53
    v_mfma_f32_32x32x16_bf16 v[96:111], v[172:175], v[132:135], v[96:111]
    ds_read_b128 v[156:159], v25 offset:53760
    v_exp_f32 v57, v57
    v_exp_f32 v58, v58
    v_exp_f32 v59, v59
    v_cvt_pk_bf16_f32 v139, v54, v55
    v_mfma_f32_16x16x32_bf16 v[176:179], v[184:187], v[128:131], v[176:179]
    ds_read_b128 v[160:163], v24 offset:51200
    v_exp_f32 v60, v60
    v_exp_f32 v61, v61
    v_cvt_pk_bf16_f32 v140, v56, v57
    v_cvt_pk_bf16_f32 v141, v58, v59
    v_mfma_f32_16x16x32_bf16 v[176:179], v[184:187], v[132:135], v[176:179]
    ds_read_b128 v[164:167], v24 offset:51712
    v_exp_f32 v62, v62
    v_exp_f32 v63, v63
    v_cvt_pk_bf16_f32 v142, v60, v61
    v_cvt_pk_bf16_f32 v143, v62, v63
    v_mfma_f32_32x32x16_bf16 v[48:63], v[144:147], a[104:107], v[80:95]
    s_add_u32 s37, s71, 4096
    v_exp_f32 v32, v32
    v_exp_f32 v33, v33
    v_exp_f32 v34, v34
    v_cvt_pk_bf16_f32 v128, v32, v33
    v_mfma_f32_32x32x16_bf16 v[48:63], v[148:151], a[108:111], v[48:63]
    s_add_u32 s38, s55, 4096
    v_exp_f32 v35, v35
    v_exp_f32 v36, v36
    v_exp_f32 v37, v37
    v_cvt_pk_bf16_f32 v129, v34, v35
    v_mfma_f32_32x32x16_bf16 v[112:127], v[168:171], v[136:139], v[112:127]
    buffer_store_dwordx4 v[208:211], v1, s[4:7], s36 offen offset:0 sc1
    v_exp_f32 v38, v38
    v_exp_f32 v39, v39
    v_exp_f32 v40, v40
    v_cvt_pk_bf16_f32 v130, v36, v37
    v_mfma_f32_32x32x16_bf16 v[112:127], v[172:175], v[140:143], v[112:127]
    buffer_store_dwordx4 v[240:243], v1, s[4:7], s37 offen offset:0 sc1
    v_exp_f32 v41, v41
    v_exp_f32 v42, v42
    v_exp_f32 v43, v43
    v_cvt_pk_bf16_f32 v131, v38, v39
    v_mfma_f32_16x16x32_bf16 v[180:183], v[184:187], v[136:139], v[180:183]
    v_exp_f32 v44, v44
    v_exp_f32 v45, v45
    v_cvt_pk_bf16_f32 v132, v40, v41
    v_cvt_pk_bf16_f32 v133, v42, v43
    v_mfma_f32_16x16x32_bf16 v[180:183], v[184:187], v[140:143], v[180:183]
    s_waitcnt lgkmcnt(0)
    v_exp_f32 v46, v46
    v_exp_f32 v47, v47
    v_cvt_pk_bf16_f32 v134, v44, v45
    v_cvt_pk_bf16_f32 v135, v46, v47
    v_mfma_f32_32x32x16_bf16 v[32:47], v[152:155], a[96:99], v[64:79]
    s_add_u32 m0, s45, 0
    v_exp_f32 v48, v48
    v_exp_f32 v49, v49
    v_exp_f32 v50, v50
    v_cvt_pk_bf16_f32 v136, v48, v49
    v_mfma_f32_32x32x16_bf16 v[32:47], v[156:159], a[100:103], v[32:47]
    s_add_u32 s43, s59, s42
    v_exp_f32 v51, v51
    v_exp_f32 v52, v52
    v_exp_f32 v53, v53
    v_cvt_pk_bf16_f32 v137, v50, v51
    v_mfma_f32_32x32x16_bf16 v[96:111], v[160:163], v[128:131], v[96:111]
    ds_read_b128 v[144:147], v25 offset:57344
    v_exp_f32 v54, v54
    v_exp_f32 v55, v55
    v_exp_f32 v56, v56
    v_cvt_pk_bf16_f32 v138, v52, v53
    v_mfma_f32_32x32x16_bf16 v[96:111], v[164:167], v[132:135], v[96:111]
    ds_read_b128 v[148:151], v25 offset:57856
    v_exp_f32 v57, v57
    v_exp_f32 v58, v58
    v_exp_f32 v59, v59
    v_cvt_pk_bf16_f32 v139, v54, v55
    v_mfma_f32_16x16x32_bf16 v[176:179], v[184:187], v[128:131], v[176:179]
    ds_read_b128 v[168:171], v24 offset:55296
    v_exp_f32 v60, v60
    v_exp_f32 v61, v61
    v_cvt_pk_bf16_f32 v140, v56, v57
    v_cvt_pk_bf16_f32 v141, v58, v59
    v_mfma_f32_16x16x32_bf16 v[176:179], v[184:187], v[132:135], v[176:179]
    ds_read_b128 v[172:175], v24 offset:55808
    v_exp_f32 v62, v62
    v_exp_f32 v63, v63
    v_cvt_pk_bf16_f32 v142, v60, v61
    v_cvt_pk_bf16_f32 v143, v62, v63
    v_mfma_f32_32x32x16_bf16 v[48:63], v[152:155], a[104:107], v[80:95]
    buffer_load_dwordx4 v1, s[4:7], s43 offen offset:0 sc1 lds
    v_exp_f32 v32, v32
    v_exp_f32 v33, v33
    v_exp_f32 v34, v34
    v_cvt_pk_bf16_f32 v128, v32, v33
    v_mfma_f32_32x32x16_bf16 v[48:63], v[156:159], a[108:111], v[48:63]
    buffer_load_dwordx4 v1, s[4:7], s43 offen offset:1024 sc1 lds
    v_exp_f32 v35, v35
    v_exp_f32 v36, v36
    v_exp_f32 v37, v37
    v_cvt_pk_bf16_f32 v129, v34, v35
    v_mfma_f32_32x32x16_bf16 v[112:127], v[160:163], v[136:139], v[112:127]
    buffer_load_dwordx4 v1, s[4:7], s43 offen offset:2048 sc1 lds
    v_exp_f32 v38, v38
    v_exp_f32 v39, v39
    v_exp_f32 v40, v40
    v_cvt_pk_bf16_f32 v130, v36, v37
    v_mfma_f32_32x32x16_bf16 v[112:127], v[164:167], v[140:143], v[112:127]
    buffer_load_dwordx4 v1, s[4:7], s43 offen offset:3072 sc1 lds
    v_exp_f32 v41, v41
    v_exp_f32 v42, v42
    v_exp_f32 v43, v43
    v_cvt_pk_bf16_f32 v131, v38, v39
    v_mfma_f32_16x16x32_bf16 v[180:183], v[184:187], v[136:139], v[180:183]
    s_add_u32 s42, s42, 16384
    v_exp_f32 v44, v44
    v_exp_f32 v45, v45
    v_cvt_pk_bf16_f32 v132, v40, v41
    v_cvt_pk_bf16_f32 v133, v42, v43
    v_mfma_f32_16x16x32_bf16 v[180:183], v[184:187], v[140:143], v[180:183]
    s_waitcnt lgkmcnt(0)
    v_exp_f32 v46, v46
    v_exp_f32 v47, v47
    v_cvt_pk_bf16_f32 v134, v44, v45
    v_cvt_pk_bf16_f32 v135, v46, v47
    v_mfma_f32_32x32x16_bf16 v[32:47], v[144:147], a[96:99], v[64:79]
    s_and_b32 s42, s42, 0x3ffff
    v_exp_f32 v48, v48
    v_exp_f32 v49, v49
    v_exp_f32 v50, v50
    v_cvt_pk_bf16_f32 v136, v48, v49
    v_mfma_f32_32x32x16_bf16 v[32:47], v[148:151], a[100:103], v[32:47]
    v_exp_f32 v51, v51
    v_exp_f32 v52, v52
    v_exp_f32 v53, v53
    v_cvt_pk_bf16_f32 v137, v50, v51
    v_mfma_f32_32x32x16_bf16 v[96:111], v[168:171], v[128:131], v[96:111]
    ds_read_b128 v[152:155], v25 offset:61440
    v_exp_f32 v54, v54
    v_exp_f32 v55, v55
    v_exp_f32 v56, v56
    v_cvt_pk_bf16_f32 v138, v52, v53
    v_mfma_f32_32x32x16_bf16 v[96:111], v[172:175], v[132:135], v[96:111]
    ds_read_b128 v[156:159], v25 offset:61952
    v_exp_f32 v57, v57
    v_exp_f32 v58, v58
    v_exp_f32 v59, v59
    v_cvt_pk_bf16_f32 v139, v54, v55
    v_mfma_f32_16x16x32_bf16 v[176:179], v[184:187], v[128:131], v[176:179]
    ds_read_b128 v[160:163], v24 offset:59392
    v_exp_f32 v60, v60
    v_exp_f32 v61, v61
    v_cvt_pk_bf16_f32 v140, v56, v57
    v_cvt_pk_bf16_f32 v141, v58, v59
    v_mfma_f32_16x16x32_bf16 v[176:179], v[184:187], v[132:135], v[176:179]
    ds_read_b128 v[164:167], v24 offset:59904
    v_exp_f32 v62, v62
    v_exp_f32 v63, v63
    v_cvt_pk_bf16_f32 v142, v60, v61
    v_cvt_pk_bf16_f32 v143, v62, v63
    v_mfma_f32_32x32x16_bf16 v[48:63], v[144:147], a[104:107], v[80:95]
    buffer_store_dwordx2 v[240:241], v1, s[4:7], s38 offen offset:0 sc1
    v_exp_f32 v32, v32
    v_exp_f32 v33, v33
    v_exp_f32 v34, v34
    v_cvt_pk_bf16_f32 v128, v32, v33
    v_mfma_f32_32x32x16_bf16 v[48:63], v[148:151], a[108:111], v[48:63]
    buffer_store_dwordx4 v[212:215], v1, s[4:7], s36 offen offset:1024 sc1
    v_exp_f32 v35, v35
    v_exp_f32 v36, v36
    v_exp_f32 v37, v37
    v_cvt_pk_bf16_f32 v129, v34, v35
    v_mfma_f32_32x32x16_bf16 v[112:127], v[168:171], v[136:139], v[112:127]
    buffer_store_dwordx4 v[244:247], v1, s[4:7], s37 offen offset:1024 sc1
    v_exp_f32 v38, v38
    v_exp_f32 v39, v39
    v_exp_f32 v40, v40
    v_cvt_pk_bf16_f32 v130, v36, v37
    v_mfma_f32_32x32x16_bf16 v[112:127], v[172:175], v[140:143], v[112:127]
    v_exp_f32 v41, v41
    v_exp_f32 v42, v42
    v_exp_f32 v43, v43
    v_cvt_pk_bf16_f32 v131, v38, v39
    v_mfma_f32_16x16x32_bf16 v[180:183], v[184:187], v[136:139], v[180:183]
    v_exp_f32 v44, v44
    v_exp_f32 v45, v45
    v_cvt_pk_bf16_f32 v132, v40, v41
    v_cvt_pk_bf16_f32 v133, v42, v43
    v_mfma_f32_16x16x32_bf16 v[180:183], v[184:187], v[140:143], v[180:183]
    s_waitcnt lgkmcnt(0)
    v_exp_f32 v46, v46
    v_exp_f32 v47, v47
    v_cvt_pk_bf16_f32 v134, v44, v45
    v_cvt_pk_bf16_f32 v135, v46, v47
    v_mfma_f32_32x32x16_bf16 v[32:47], v[152:155], a[96:99], v[64:79]
    v_exp_f32 v48, v48
    v_exp_f32 v49, v49
    v_exp_f32 v50, v50
    v_cvt_pk_bf16_f32 v136, v48, v49
    v_mfma_f32_32x32x16_bf16 v[32:47], v[156:159], a[100:103], v[32:47]
    v_exp_f32 v51, v51
    v_exp_f32 v52, v52
    v_exp_f32 v53, v53
    v_cvt_pk_bf16_f32 v137, v50, v51
    v_mfma_f32_32x32x16_bf16 v[96:111], v[160:163], v[128:131], v[96:111]
    ds_read_b128 v[144:147], v9 offset:0
    v_exp_f32 v54, v54
    v_exp_f32 v55, v55
    v_exp_f32 v56, v56
    v_cvt_pk_bf16_f32 v138, v52, v53
    v_mfma_f32_32x32x16_bf16 v[96:111], v[164:167], v[132:135], v[96:111]
    ds_read_b128 v[148:151], v9 offset:512
    v_exp_f32 v57, v57
    v_exp_f32 v58, v58
    v_exp_f32 v59, v59
    v_cvt_pk_bf16_f32 v139, v54, v55
    v_mfma_f32_16x16x32_bf16 v[176:179], v[184:187], v[128:131], v[176:179]
    ds_read_b128 v[168:171], v24 offset:63488
    v_exp_f32 v60, v60
    v_exp_f32 v61, v61
    v_cvt_pk_bf16_f32 v140, v56, v57
    v_cvt_pk_bf16_f32 v141, v58, v59
    v_mfma_f32_16x16x32_bf16 v[176:179], v[184:187], v[132:135], v[176:179]
    ds_read_b128 v[172:175], v24 offset:64000
    v_exp_f32 v62, v62
    v_exp_f32 v63, v63
    v_cvt_pk_bf16_f32 v142, v60, v61
    v_cvt_pk_bf16_f32 v143, v62, v63
    v_mfma_f32_32x32x16_bf16 v[48:63], v[152:155], a[104:107], v[80:95]
    v_exp_f32 v32, v32
    v_exp_f32 v33, v33
    v_exp_f32 v34, v34
    v_cvt_pk_bf16_f32 v128, v32, v33
    v_mfma_f32_32x32x16_bf16 v[48:63], v[156:159], a[108:111], v[48:63]
    v_exp_f32 v35, v35
    v_exp_f32 v36, v36
    v_exp_f32 v37, v37
    v_cvt_pk_bf16_f32 v129, v34, v35
    v_mfma_f32_32x32x16_bf16 v[112:127], v[160:163], v[136:139], v[112:127]
    v_exp_f32 v38, v38
    v_exp_f32 v39, v39
    v_exp_f32 v40, v40
    v_cvt_pk_bf16_f32 v130, v36, v37
    v_mfma_f32_32x32x16_bf16 v[112:127], v[164:167], v[140:143], v[112:127]
    v_exp_f32 v41, v41
    v_exp_f32 v42, v42
    v_exp_f32 v43, v43
    v_cvt_pk_bf16_f32 v131, v38, v39
    v_mfma_f32_16x16x32_bf16 v[180:183], v[184:187], v[136:139], v[180:183]
    v_exp_f32 v44, v44
    v_exp_f32 v45, v45
    v_cvt_pk_bf16_f32 v132, v40, v41
    v_cvt_pk_bf16_f32 v133, v42, v43
    v_mfma_f32_16x16x32_bf16 v[180:183], v[184:187], v[140:143], v[180:183]
    s_waitcnt lgkmcnt(0)
    v_exp_f32 v46, v46
    v_exp_f32 v47, v47
    v_cvt_pk_bf16_f32 v134, v44, v45
    v_cvt_pk_bf16_f32 v135, v46, v47
    v_mfma_f32_32x32x16_bf16 v[32:47], v[144:147], a[96:99], v[64:79]
    v_exp_f32 v48, v48
    v_exp_f32 v49, v49
    v_exp_f32 v50, v50
    v_cvt_pk_bf16_f32 v136, v48, v49
    v_mfma_f32_32x32x16_bf16 v[32:47], v[148:151], a[100:103], v[32:47]
    v_exp_f32 v51, v51
    v_exp_f32 v52, v52
    v_exp_f32 v53, v53
    v_cvt_pk_bf16_f32 v137, v50, v51
    v_mfma_f32_32x32x16_bf16 v[96:111], v[168:171], v[128:131], v[96:111]
    ds_read_b128 v[152:155], v9 offset:4096
    v_exp_f32 v54, v54
    v_exp_f32 v55, v55
    v_exp_f32 v56, v56
    v_cvt_pk_bf16_f32 v138, v52, v53
    v_mfma_f32_32x32x16_bf16 v[96:111], v[172:175], v[132:135], v[96:111]
    ds_read_b128 v[156:159], v9 offset:4608
    v_exp_f32 v57, v57
    v_exp_f32 v58, v58
    v_exp_f32 v59, v59
    v_cvt_pk_bf16_f32 v139, v54, v55
    v_mfma_f32_16x16x32_bf16 v[176:179], v[184:187], v[128:131], v[176:179]
    ds_read_b128 v[160:163], v8 offset:2048
    v_exp_f32 v60, v60
    v_exp_f32 v61, v61
    v_cvt_pk_bf16_f32 v140, v56, v57
    v_cvt_pk_bf16_f32 v141, v58, v59
    v_mfma_f32_16x16x32_bf16 v[176:179], v[184:187], v[132:135], v[176:179]
    ds_read_b128 v[164:167], v8 offset:2560
    v_exp_f32 v62, v62
    v_exp_f32 v63, v63
    v_cvt_pk_bf16_f32 v142, v60, v61
    v_cvt_pk_bf16_f32 v143, v62, v63
    v_mfma_f32_32x32x16_bf16 v[48:63], v[144:147], a[104:107], v[80:95]
    buffer_store_dwordx2 v[244:245], v1, s[4:7], s38 offen offset:1024 sc1
    v_exp_f32 v32, v32
    v_exp_f32 v33, v33
    v_exp_f32 v34, v34
    v_cvt_pk_bf16_f32 v128, v32, v33
    v_mfma_f32_32x32x16_bf16 v[48:63], v[148:151], a[108:111], v[48:63]
    buffer_store_dwordx4 v[216:219], v1, s[4:7], s36 offen offset:2048 sc1
    v_exp_f32 v35, v35
    v_exp_f32 v36, v36
    v_exp_f32 v37, v37
    v_cvt_pk_bf16_f32 v129, v34, v35
    v_mfma_f32_32x32x16_bf16 v[112:127], v[168:171], v[136:139], v[112:127]
    buffer_store_dwordx4 v[248:251], v1, s[4:7], s37 offen offset:2048 sc1
    v_exp_f32 v38, v38
    v_exp_f32 v39, v39
    v_exp_f32 v40, v40
    v_cvt_pk_bf16_f32 v130, v36, v37
    v_mfma_f32_32x32x16_bf16 v[112:127], v[172:175], v[140:143], v[112:127]
    buffer_store_dwordx2 v[248:249], v1, s[4:7], s38 offen offset:2048 sc1
    v_exp_f32 v41, v41
    v_exp_f32 v42, v42
    v_exp_f32 v43, v43
    v_cvt_pk_bf16_f32 v131, v38, v39
    v_mfma_f32_16x16x32_bf16 v[180:183], v[184:187], v[136:139], v[180:183]
    v_exp_f32 v44, v44
    v_exp_f32 v45, v45
    v_cvt_pk_bf16_f32 v132, v40, v41
    v_cvt_pk_bf16_f32 v133, v42, v43
    v_mfma_f32_16x16x32_bf16 v[180:183], v[184:187], v[140:143], v[180:183]
    s_waitcnt lgkmcnt(0)
    v_exp_f32 v46, v46
    v_exp_f32 v47, v47
    v_cvt_pk_bf16_f32 v134, v44, v45
    v_cvt_pk_bf16_f32 v135, v46, v47
    v_mfma_f32_32x32x16_bf16 v[32:47], v[152:155], a[96:99], v[64:79]
    s_add_u32 m0, s45, 16384
    v_exp_f32 v48, v48
    v_exp_f32 v49, v49
    v_exp_f32 v50, v50
    v_cvt_pk_bf16_f32 v136, v48, v49
    v_mfma_f32_32x32x16_bf16 v[32:47], v[156:159], a[100:103], v[32:47]
    s_add_u32 s43, s59, s42
    v_exp_f32 v51, v51
    v_exp_f32 v52, v52
    v_exp_f32 v53, v53
    v_cvt_pk_bf16_f32 v137, v50, v51
    v_mfma_f32_32x32x16_bf16 v[96:111], v[160:163], v[128:131], v[96:111]
    ds_read_b128 v[144:147], v9 offset:8192
    v_exp_f32 v54, v54
    v_exp_f32 v55, v55
    v_exp_f32 v56, v56
    v_cvt_pk_bf16_f32 v138, v52, v53
    v_mfma_f32_32x32x16_bf16 v[96:111], v[164:167], v[132:135], v[96:111]
    ds_read_b128 v[148:151], v9 offset:8704
    v_exp_f32 v57, v57
    v_exp_f32 v58, v58
    v_exp_f32 v59, v59
    v_cvt_pk_bf16_f32 v139, v54, v55
    v_mfma_f32_16x16x32_bf16 v[176:179], v[184:187], v[128:131], v[176:179]
    ds_read_b128 v[168:171], v8 offset:6144
    v_exp_f32 v60, v60
    v_exp_f32 v61, v61
    v_cvt_pk_bf16_f32 v140, v56, v57
    v_cvt_pk_bf16_f32 v141, v58, v59
    v_mfma_f32_16x16x32_bf16 v[176:179], v[184:187], v[132:135], v[176:179]
    ds_read_b128 v[172:175], v8 offset:6656
    v_exp_f32 v62, v62
    v_exp_f32 v63, v63
    v_cvt_pk_bf16_f32 v142, v60, v61
    v_cvt_pk_bf16_f32 v143, v62, v63
    v_mfma_f32_32x32x16_bf16 v[48:63], v[152:155], a[104:107], v[80:95]
    buffer_load_dwordx4 v1, s[4:7], s43 offen offset:0 sc1 lds
    v_exp_f32 v32, v32
    v_exp_f32 v33, v33
    v_exp_f32 v34, v34
    v_cvt_pk_bf16_f32 v128, v32, v33
    v_mfma_f32_32x32x16_bf16 v[48:63], v[156:159], a[108:111], v[48:63]
    buffer_load_dwordx4 v1, s[4:7], s43 offen offset:1024 sc1 lds
    v_exp_f32 v35, v35
    v_exp_f32 v36, v36
    v_exp_f32 v37, v37
    v_cvt_pk_bf16_f32 v129, v34, v35
    v_mfma_f32_32x32x16_bf16 v[112:127], v[160:163], v[136:139], v[112:127]
    buffer_load_dwordx4 v1, s[4:7], s43 offen offset:2048 sc1 lds
    v_exp_f32 v38, v38
    v_exp_f32 v39, v39
    v_exp_f32 v40, v40
    v_cvt_pk_bf16_f32 v130, v36, v37
    v_mfma_f32_32x32x16_bf16 v[112:127], v[164:167], v[140:143], v[112:127]
    buffer_load_dwordx4 v1, s[4:7], s43 offen offset:3072 sc1 lds
    v_exp_f32 v41, v41
    v_exp_f32 v42, v42
    v_exp_f32 v43, v43
    v_cvt_pk_bf16_f32 v131, v38, v39
    v_mfma_f32_16x16x32_bf16 v[180:183], v[184:187], v[136:139], v[180:183]
    s_add_u32 s42, s42, 16384
    v_exp_f32 v44, v44
    v_exp_f32 v45, v45
    v_cvt_pk_bf16_f32 v132, v40, v41
    v_cvt_pk_bf16_f32 v133, v42, v43
    v_mfma_f32_16x16x32_bf16 v[180:183], v[184:187], v[140:143], v[180:183]
    s_waitcnt lgkmcnt(0)
    v_exp_f32 v46, v46
    v_exp_f32 v47, v47
    v_cvt_pk_bf16_f32 v134, v44, v45
    v_cvt_pk_bf16_f32 v135, v46, v47
    v_mfma_f32_32x32x16_bf16 v[32:47], v[144:147], a[96:99], v[64:79]
    s_and_b32 s42, s42, 0x3ffff
    v_exp_f32 v48, v48
    v_exp_f32 v49, v49
    v_exp_f32 v50, v50
    v_cvt_pk_bf16_f32 v136, v48, v49
    v_mfma_f32_32x32x16_bf16 v[32:47], v[148:151], a[100:103], v[32:47]
    v_exp_f32 v51, v51
    v_exp_f32 v52, v52
    v_exp_f32 v53, v53
    v_cvt_pk_bf16_f32 v137, v50, v51
    v_mfma_f32_32x32x16_bf16 v[96:111], v[168:171], v[128:131], v[96:111]
    ds_read_b128 v[152:155], v9 offset:12288
    v_exp_f32 v54, v54
    v_exp_f32 v55, v55
    v_exp_f32 v56, v56
    v_cvt_pk_bf16_f32 v138, v52, v53
    v_mfma_f32_32x32x16_bf16 v[96:111], v[172:175], v[132:135], v[96:111]
    ds_read_b128 v[156:159], v9 offset:12800
    v_exp_f32 v57, v57
    v_exp_f32 v58, v58
    v_exp_f32 v59, v59
    v_cvt_pk_bf16_f32 v139, v54, v55
    v_mfma_f32_16x16x32_bf16 v[176:179], v[184:187], v[128:131], v[176:179]
    ds_read_b128 v[160:163], v8 offset:10240
    v_exp_f32 v60, v60
    v_exp_f32 v61, v61
    v_cvt_pk_bf16_f32 v140, v56, v57
    v_cvt_pk_bf16_f32 v141, v58, v59
    v_mfma_f32_16x16x32_bf16 v[176:179], v[184:187], v[132:135], v[176:179]
    ds_read_b128 v[164:167], v8 offset:10752
    v_exp_f32 v62, v62
    v_exp_f32 v63, v63
    v_cvt_pk_bf16_f32 v142, v60, v61
    v_cvt_pk_bf16_f32 v143, v62, v63
    v_mfma_f32_32x32x16_bf16 v[48:63], v[144:147], a[104:107], v[80:95]
    buffer_store_dwordx4 v[220:223], v1, s[4:7], s36 offen offset:3072 sc1
    v_exp_f32 v32, v32
    v_exp_f32 v33, v33
    v_exp_f32 v34, v34
    v_cvt_pk_bf16_f32 v128, v32, v33
    v_mfma_f32_32x32x16_bf16 v[48:63], v[148:151], a[108:111], v[48:63]
    buffer_store_dwordx4 v[252:255], v1, s[4:7], s37 offen offset:3072 sc1
    v_exp_f32 v35, v35
    v_exp_f32 v36, v36
    v_exp_f32 v37, v37
    v_cvt_pk_bf16_f32 v129, v34, v35
    v_mfma_f32_32x32x16_bf16 v[112:127], v[168:171], v[136:139], v[112:127]
    buffer_store_dwordx2 v[252:253], v1, s[4:7], s38 offen offset:3072 sc1
    v_exp_f32 v38, v38
    v_exp_f32 v39, v39
    v_exp_f32 v40, v40
    v_cvt_pk_bf16_f32 v130, v36, v37
    v_mfma_f32_32x32x16_bf16 v[112:127], v[172:175], v[140:143], v[112:127]
    v_exp_f32 v41, v41
    v_exp_f32 v42, v42
    v_exp_f32 v43, v43
    v_cvt_pk_bf16_f32 v131, v38, v39
    v_mfma_f32_16x16x32_bf16 v[180:183], v[184:187], v[136:139], v[180:183]
    s_lshl_b32 s63, s57, 8
    v_exp_f32 v44, v44
    v_exp_f32 v45, v45
    v_cvt_pk_bf16_f32 v132, v40, v41
    v_cvt_pk_bf16_f32 v133, v42, v43
    v_mfma_f32_16x16x32_bf16 v[180:183], v[184:187], v[140:143], v[180:183]
    s_waitcnt vmcnt(26) lgkmcnt(0)
    s_barrier
    v_exp_f32 v46, v46
    v_exp_f32 v47, v47
    v_cvt_pk_bf16_f32 v134, v44, v45
    v_cvt_pk_bf16_f32 v135, v46, v47
    v_mfma_f32_32x32x16_bf16 v[32:47], v[152:155], a[96:99], v[64:79]
    s_lshl_b32 s3, s56, 2
    v_exp_f32 v48, v48
    v_exp_f32 v49, v49
    v_exp_f32 v50, v50
    v_cvt_pk_bf16_f32 v136, v48, v49
    v_mfma_f32_32x32x16_bf16 v[32:47], v[156:159], a[100:103], v[32:47]
    s_add_u32 s63, s63, s3
    v_exp_f32 v51, v51
    v_exp_f32 v52, v52
    v_exp_f32 v53, v53
    v_cvt_pk_bf16_f32 v137, v50, v51
    v_mfma_f32_32x32x16_bf16 v[96:111], v[160:163], v[128:131], v[96:111]
    ds_read_b128 v[144:147], v9 offset:16384
    v_exp_f32 v54, v54
    v_exp_f32 v55, v55
    v_exp_f32 v56, v56
    v_cvt_pk_bf16_f32 v138, v52, v53
    v_mfma_f32_32x32x16_bf16 v[96:111], v[164:167], v[132:135], v[96:111]
    ds_read_b128 v[148:151], v9 offset:16896
    v_exp_f32 v57, v57
    v_exp_f32 v58, v58
    v_exp_f32 v59, v59
    v_cvt_pk_bf16_f32 v139, v54, v55
    v_mfma_f32_16x16x32_bf16 v[176:179], v[184:187], v[128:131], v[176:179]
    ds_read_b128 v[168:171], v8 offset:14336
    v_exp_f32 v60, v60
    v_exp_f32 v61, v61
    v_cvt_pk_bf16_f32 v140, v56, v57
    v_cvt_pk_bf16_f32 v141, v58, v59
    v_mfma_f32_16x16x32_bf16 v[176:179], v[184:187], v[132:135], v[176:179]
    ds_read_b128 v[172:175], v8 offset:14848
    v_exp_f32 v62, v62
    v_exp_f32 v63, v63
    v_cvt_pk_bf16_f32 v142, v60, v61
    v_cvt_pk_bf16_f32 v143, v62, v63
    v_mfma_f32_32x32x16_bf16 v[48:63], v[152:155], a[104:107], v[80:95]
    s_add_u32 s63, s63, 62935040
    v_exp_f32 v32, v32
    v_exp_f32 v33, v33
    v_exp_f32 v34, v34
    v_cvt_pk_bf16_f32 v128, v32, v33
    v_mfma_f32_32x32x16_bf16 v[48:63], v[156:159], a[108:111], v[48:63]
    v_mov_b32 v20, s72
    v_exp_f32 v35, v35
    v_exp_f32 v36, v36
    v_exp_f32 v37, v37
    v_cvt_pk_bf16_f32 v129, v34, v35
    v_mfma_f32_32x32x16_bf16 v[112:127], v[160:163], v[136:139], v[112:127]
    v_mov_b32 v21, 0
    v_exp_f32 v38, v38
    v_exp_f32 v39, v39
    v_exp_f32 v40, v40
    v_cvt_pk_bf16_f32 v130, v36, v37
    v_mfma_f32_32x32x16_bf16 v[112:127], v[164:167], v[140:143], v[112:127]
    s_bfe_u32 s52, s2, 0x20001
    v_exp_f32 v41, v41
    v_exp_f32 v42, v42
    v_exp_f32 v43, v43
    v_cvt_pk_bf16_f32 v131, v38, v39
    v_mfma_f32_16x16x32_bf16 v[180:183], v[184:187], v[136:139], v[180:183]
    s_lshl_b32 s52, s52, 2
    v_exp_f32 v44, v44
    v_exp_f32 v45, v45
    v_cvt_pk_bf16_f32 v132, v40, v41
    v_cvt_pk_bf16_f32 v133, v42, v43
    v_mfma_f32_16x16x32_bf16 v[180:183], v[184:187], v[140:143], v[180:183]
    s_waitcnt lgkmcnt(0)
    v_exp_f32 v46, v46
    v_exp_f32 v47, v47
    v_cvt_pk_bf16_f32 v134, v44, v45
    v_cvt_pk_bf16_f32 v135, v46, v47
    v_mfma_f32_32x32x16_bf16 v[32:47], v[144:147], a[96:99], v[64:79]
    s_bfe_u32 s3, s2, 0x20003
    v_exp_f32 v48, v48
    v_exp_f32 v49, v49
    v_exp_f32 v50, v50
    v_cvt_pk_bf16_f32 v136, v48, v49
    v_mfma_f32_32x32x16_bf16 v[32:47], v[148:151], a[100:103], v[32:47]
    s_add_u32 s52, s52, s3
    v_exp_f32 v51, v51
    v_exp_f32 v52, v52
    v_exp_f32 v53, v53
    v_cvt_pk_bf16_f32 v137, v50, v51
    v_mfma_f32_32x32x16_bf16 v[96:111], v[168:171], v[128:131], v[96:111]
    ds_read_b128 v[152:155], v9 offset:20480
    v_exp_f32 v54, v54
    v_exp_f32 v55, v55
    v_exp_f32 v56, v56
    v_cvt_pk_bf16_f32 v138, v52, v53
    v_mfma_f32_32x32x16_bf16 v[96:111], v[172:175], v[132:135], v[96:111]
    ds_read_b128 v[156:159], v9 offset:20992
    v_exp_f32 v57, v57
    v_exp_f32 v58, v58
    v_exp_f32 v59, v59
    v_cvt_pk_bf16_f32 v139, v54, v55
    v_mfma_f32_16x16x32_bf16 v[176:179], v[184:187], v[128:131], v[176:179]
    ds_read_b128 v[160:163], v8 offset:18432
    v_exp_f32 v60, v60
    v_exp_f32 v61, v61
    v_cvt_pk_bf16_f32 v140, v56, v57
    v_cvt_pk_bf16_f32 v141, v58, v59
    v_mfma_f32_16x16x32_bf16 v[176:179], v[184:187], v[132:135], v[176:179]
    ds_read_b128 v[164:167], v8 offset:18944
    v_exp_f32 v62, v62
    v_exp_f32 v63, v63
    v_cvt_pk_bf16_f32 v142, v60, v61
    v_cvt_pk_bf16_f32 v143, v62, v63
    v_mfma_f32_32x32x16_bf16 v[48:63], v[144:147], a[104:107], v[80:95]
    v_exp_f32 v32, v32
    v_exp_f32 v33, v33
    v_exp_f32 v34, v34
    v_cvt_pk_bf16_f32 v128, v32, v33
    v_mfma_f32_32x32x16_bf16 v[48:63], v[148:151], a[108:111], v[48:63]
    v_exp_f32 v35, v35
    v_exp_f32 v36, v36
    v_exp_f32 v37, v37
    v_cvt_pk_bf16_f32 v129, v34, v35
    v_mfma_f32_32x32x16_bf16 v[112:127], v[168:171], v[136:139], v[112:127]
    v_exp_f32 v38, v38
    v_exp_f32 v39, v39
    v_exp_f32 v40, v40
    v_cvt_pk_bf16_f32 v130, v36, v37
    v_mfma_f32_32x32x16_bf16 v[112:127], v[172:175], v[140:143], v[112:127]
    v_exp_f32 v41, v41
    v_exp_f32 v42, v42
    v_exp_f32 v43, v43
    v_cvt_pk_bf16_f32 v131, v38, v39
    v_mfma_f32_16x16x32_bf16 v[180:183], v[184:187], v[136:139], v[180:183]
    s_lshl_b32 s33, s3, 1
    v_exp_f32 v44, v44
    v_exp_f32 v45, v45
    v_cvt_pk_bf16_f32 v132, v40, v41
    v_cvt_pk_bf16_f32 v133, v42, v43
    v_mfma_f32_16x16x32_bf16 v[180:183], v[184:187], v[140:143], v[180:183]
    s_waitcnt lgkmcnt(0)
    v_exp_f32 v46, v46
    v_exp_f32 v47, v47
    v_cvt_pk_bf16_f32 v134, v44, v45
    v_cvt_pk_bf16_f32 v135, v46, v47
    v_mfma_f32_32x32x16_bf16 v[32:47], v[152:155], a[96:99], v[64:79]
    s_add_u32 m0, s45, 32768
    v_exp_f32 v48, v48
    v_exp_f32 v49, v49
    v_exp_f32 v50, v50
    v_cvt_pk_bf16_f32 v136, v48, v49
    v_mfma_f32_32x32x16_bf16 v[32:47], v[156:159], a[100:103], v[32:47]
    s_add_u32 s43, s59, s42
    v_exp_f32 v51, v51
    v_exp_f32 v52, v52
    v_exp_f32 v53, v53
    v_cvt_pk_bf16_f32 v137, v50, v51
    v_mfma_f32_32x32x16_bf16 v[96:111], v[160:163], v[128:131], v[96:111]
    ds_read_b128 v[144:147], v9 offset:24576
    v_exp_f32 v54, v54
    v_exp_f32 v55, v55
    v_exp_f32 v56, v56
    v_cvt_pk_bf16_f32 v138, v52, v53
    v_mfma_f32_32x32x16_bf16 v[96:111], v[164:167], v[132:135], v[96:111]
    ds_read_b128 v[148:151], v9 offset:25088
    v_exp_f32 v57, v57
    v_exp_f32 v58, v58
    v_exp_f32 v59, v59
    v_cvt_pk_bf16_f32 v139, v54, v55
    v_mfma_f32_16x16x32_bf16 v[176:179], v[184:187], v[128:131], v[176:179]
    ds_read_b128 v[168:171], v8 offset:22528
    v_exp_f32 v60, v60
    v_exp_f32 v61, v61
    v_cvt_pk_bf16_f32 v140, v56, v57
    v_cvt_pk_bf16_f32 v141, v58, v59
    v_mfma_f32_16x16x32_bf16 v[176:179], v[184:187], v[132:135], v[176:179]
    ds_read_b128 v[172:175], v8 offset:23040
    v_exp_f32 v62, v62
    v_exp_f32 v63, v63
    v_cvt_pk_bf16_f32 v142, v60, v61
    v_cvt_pk_bf16_f32 v143, v62, v63
    v_mfma_f32_32x32x16_bf16 v[48:63], v[152:155], a[104:107], v[80:95]
    buffer_load_dwordx4 v1, s[4:7], s43 offen offset:0 sc1 lds
    v_exp_f32 v32, v32
    v_exp_f32 v33, v33
    v_exp_f32 v34, v34
    v_cvt_pk_bf16_f32 v128, v32, v33
    v_mfma_f32_32x32x16_bf16 v[48:63], v[156:159], a[108:111], v[48:63]
    buffer_load_dwordx4 v1, s[4:7], s43 offen offset:1024 sc1 lds
    v_exp_f32 v35, v35
    v_exp_f32 v36, v36
    v_exp_f32 v37, v37
    v_cvt_pk_bf16_f32 v129, v34, v35
    v_mfma_f32_32x32x16_bf16 v[112:127], v[160:163], v[136:139], v[112:127]
    buffer_load_dwordx4 v1, s[4:7], s43 offen offset:2048 sc1 lds
    v_exp_f32 v38, v38
    v_exp_f32 v39, v39
    v_exp_f32 v40, v40
    v_cvt_pk_bf16_f32 v130, v36, v37
    v_mfma_f32_32x32x16_bf16 v[112:127], v[164:167], v[140:143], v[112:127]
    buffer_load_dwordx4 v1, s[4:7], s43 offen offset:3072 sc1 lds
    v_exp_f32 v41, v41
    v_exp_f32 v42, v42
    v_exp_f32 v43, v43
    v_cvt_pk_bf16_f32 v131, v38, v39
    v_mfma_f32_16x16x32_bf16 v[180:183], v[184:187], v[136:139], v[180:183]
    s_add_u32 s42, s42, 16384
    v_exp_f32 v44, v44
    v_exp_f32 v45, v45
    v_cvt_pk_bf16_f32 v132, v40, v41
    v_cvt_pk_bf16_f32 v133, v42, v43
    v_mfma_f32_16x16x32_bf16 v[180:183], v[184:187], v[140:143], v[180:183]
    s_waitcnt lgkmcnt(0)
    v_exp_f32 v46, v46
    v_exp_f32 v47, v47
    v_cvt_pk_bf16_f32 v134, v44, v45
    v_cvt_pk_bf16_f32 v135, v46, v47
    v_mfma_f32_32x32x16_bf16 v[32:47], v[144:147], a[96:99], v[64:79]
    s_and_b32 s42, s42, 0x3ffff
    v_exp_f32 v48, v48
    v_exp_f32 v49, v49
    v_exp_f32 v50, v50
    v_cvt_pk_bf16_f32 v136, v48, v49
    v_mfma_f32_32x32x16_bf16 v[32:47], v[148:151], a[100:103], v[32:47]
    s_lshr_b32 s53, s2, 5
    v_exp_f32 v51, v51
    v_exp_f32 v52, v52
    v_exp_f32 v53, v53
    v_cvt_pk_bf16_f32 v137, v50, v51
    v_mfma_f32_32x32x16_bf16 v[96:111], v[168:171], v[128:131], v[96:111]
    ds_read_b128 v[152:155], v9 offset:28672
    v_exp_f32 v54, v54
    v_exp_f32 v55, v55
    v_exp_f32 v56, v56
    v_cvt_pk_bf16_f32 v138, v52, v53
    v_mfma_f32_32x32x16_bf16 v[96:111], v[172:175], v[132:135], v[96:111]
    ds_read_b128 v[156:159], v9 offset:29184
    v_exp_f32 v57, v57
    v_exp_f32 v58, v58
    v_exp_f32 v59, v59
    v_cvt_pk_bf16_f32 v139, v54, v55
    v_mfma_f32_16x16x32_bf16 v[176:179], v[184:187], v[128:131], v[176:179]
    ds_read_b128 v[160:163], v8 offset:26624
    v_exp_f32 v60, v60
    v_exp_f32 v61, v61
    v_cvt_pk_bf16_f32 v140, v56, v57
    v_cvt_pk_bf16_f32 v141, v58, v59
    v_mfma_f32_16x16x32_bf16 v[176:179], v[184:187], v[132:135], v[176:179]
    ds_read_b128 v[164:167], v8 offset:27136
    v_exp_f32 v62, v62
    v_exp_f32 v63, v63
    v_cvt_pk_bf16_f32 v142, v60, v61
    v_cvt_pk_bf16_f32 v143, v62, v63
    v_mfma_f32_32x32x16_bf16 v[48:63], v[144:147], a[104:107], v[80:95]
    s_add_u32 s33, s33, s53
    v_exp_f32 v32, v32
    v_exp_f32 v33, v33
    v_exp_f32 v34, v34
    v_cvt_pk_bf16_f32 v128, v32, v33
    v_mfma_f32_32x32x16_bf16 v[48:63], v[148:151], a[108:111], v[48:63]
    s_add_u32 s3, s33, 0
    v_exp_f32 v35, v35
    v_exp_f32 v36, v36
    v_exp_f32 v37, v37
    v_cvt_pk_bf16_f32 v129, v34, v35
    v_mfma_f32_32x32x16_bf16 v[112:127], v[168:171], v[136:139], v[112:127]
    s_and_b32 s3, s3, 7
    v_exp_f32 v38, v38
    v_exp_f32 v39, v39
    v_exp_f32 v40, v40
    v_cvt_pk_bf16_f32 v130, v36, v37
    v_mfma_f32_32x32x16_bf16 v[112:127], v[172:175], v[140:143], v[112:127]
    s_lshl_b32 s24, s3, 13
    v_exp_f32 v41, v41
    v_exp_f32 v42, v42
    v_exp_f32 v43, v43
    v_cvt_pk_bf16_f32 v131, v38, v39
    v_mfma_f32_16x16x32_bf16 v[180:183], v[184:187], v[136:139], v[180:183]
    s_add_u32 s3, s33, 1
    v_exp_f32 v44, v44
    v_exp_f32 v45, v45
    v_cvt_pk_bf16_f32 v132, v40, v41
    v_cvt_pk_bf16_f32 v133, v42, v43
    v_mfma_f32_16x16x32_bf16 v[180:183], v[184:187], v[140:143], v[180:183]
    s_waitcnt lgkmcnt(0)
    v_exp_f32 v46, v46
    v_exp_f32 v47, v47
    v_cvt_pk_bf16_f32 v134, v44, v45
    v_cvt_pk_bf16_f32 v135, v46, v47
    v_mfma_f32_32x32x16_bf16 v[32:47], v[152:155], a[96:99], v[64:79]
    s_and_b32 s3, s3, 7
    v_exp_f32 v48, v48
    v_exp_f32 v49, v49
    v_exp_f32 v50, v50
    v_cvt_pk_bf16_f32 v136, v48, v49
    v_mfma_f32_32x32x16_bf16 v[32:47], v[156:159], a[100:103], v[32:47]
    s_lshl_b32 s25, s3, 13
    v_exp_f32 v51, v51
    v_exp_f32 v52, v52
    v_exp_f32 v53, v53
    v_cvt_pk_bf16_f32 v137, v50, v51
    v_mfma_f32_32x32x16_bf16 v[96:111], v[160:163], v[128:131], v[96:111]
    ds_read_b128 v[144:147], v9 offset:32768
    v_exp_f32 v54, v54
    v_exp_f32 v55, v55
    v_exp_f32 v56, v56
    v_cvt_pk_bf16_f32 v138, v52, v53
    v_mfma_f32_32x32x16_bf16 v[96:111], v[164:167], v[132:135], v[96:111]
    ds_read_b128 v[148:151], v9 offset:33280
    v_exp_f32 v57, v57
    v_exp_f32 v58, v58
    v_exp_f32 v59, v59
    v_cvt_pk_bf16_f32 v139, v54, v55
    v_mfma_f32_16x16x32_bf16 v[176:179], v[184:187], v[128:131], v[176:179]
    ds_read_b128 v[168:171], v8 offset:30720
    v_exp_f32 v60, v60
    v_exp_f32 v61, v61
    v_cvt_pk_bf16_f32 v140, v56, v57
    v_cvt_pk_bf16_f32 v141, v58, v59
    v_mfma_f32_16x16x32_bf16 v[176:179], v[184:187], v[132:135], v[176:179]
    ds_read_b128 v[172:175], v8 offset:31232
    v_exp_f32 v62, v62
    v_exp_f32 v63, v63
    v_cvt_pk_bf16_f32 v142, v60, v61
    v_cvt_pk_bf16_f32 v143, v62, v63
    v_mfma_f32_32x32x16_bf16 v[48:63], v[152:155], a[104:107], v[80:95]
    s_add_u32 s3, s33, 2
    v_exp_f32 v32, v32
    v_exp_f32 v33, v33
    v_exp_f32 v34, v34
    v_cvt_pk_bf16_f32 v128, v32, v33
    v_mfma_f32_32x32x16_bf16 v[48:63], v[156:159], a[108:111], v[48:63]
    s_and_b32 s3, s3, 7
    v_exp_f32 v35, v35
    v_exp_f32 v36, v36
    v_exp_f32 v37, v37
    v_cvt_pk_bf16_f32 v129, v34, v35
    v_mfma_f32_32x32x16_bf16 v[112:127], v[160:163], v[136:139], v[112:127]
    s_lshl_b32 s26, s3, 13
    v_exp_f32 v38, v38
    v_exp_f32 v39, v39
    v_exp_f32 v40, v40
    v_cvt_pk_bf16_f32 v130, v36, v37
    v_mfma_f32_32x32x16_bf16 v[112:127], v[164:167], v[140:143], v[112:127]
    s_add_u32 s3, s33, 3
    v_exp_f32 v41, v41
    v_exp_f32 v42, v42
    v_exp_f32 v43, v43
    v_cvt_pk_bf16_f32 v131, v38, v39
    v_mfma_f32_16x16x32_bf16 v[180:183], v[184:187], v[136:139], v[180:183]
    s_and_b32 s3, s3, 7
    v_exp_f32 v44, v44
    v_exp_f32 v45, v45
    v_cvt_pk_bf16_f32 v132, v40, v41
    v_cvt_pk_bf16_f32 v133, v42, v43
    v_mfma_f32_16x16x32_bf16 v[180:183], v[184:187], v[140:143], v[180:183]
    s_waitcnt lgkmcnt(0)
    v_exp_f32 v46, v46
    v_exp_f32 v47, v47
    v_cvt_pk_bf16_f32 v134, v44, v45
    v_cvt_pk_bf16_f32 v135, v46, v47
    v_mfma_f32_32x32x16_bf16 v[32:47], v[144:147], a[96:99], v[64:79]
    s_lshl_b32 s27, s3, 13
    v_exp_f32 v48, v48
    v_exp_f32 v49, v49
    v_exp_f32 v50, v50
    v_cvt_pk_bf16_f32 v136, v48, v49
    v_mfma_f32_32x32x16_bf16 v[32:47], v[148:151], a[100:103], v[32:47]
    s_add_u32 s3, s33, 4
    v_exp_f32 v51, v51
    v_exp_f32 v52, v52
    v_exp_f32 v53, v53
    v_cvt_pk_bf16_f32 v137, v50, v51
    v_mfma_f32_32x32x16_bf16 v[96:111], v[168:171], v[128:131], v[96:111]
    ds_read_b128 v[152:155], v9 offset:36864
    v_exp_f32 v54, v54
    v_exp_f32 v55, v55
    v_exp_f32 v56, v56
    v_cvt_pk_bf16_f32 v138, v52, v53
    v_mfma_f32_32x32x16_bf16 v[96:111], v[172:175], v[132:135], v[96:111]
    ds_read_b128 v[156:159], v9 offset:37376
    v_exp_f32 v57, v57
    v_exp_f32 v58, v58
    v_exp_f32 v59, v59
    v_cvt_pk_bf16_f32 v139, v54, v55
    v_mfma_f32_16x16x32_bf16 v[176:179], v[184:187], v[128:131], v[176:179]
    ds_read_b128 v[160:163], v8 offset:34816
    v_exp_f32 v60, v60
    v_exp_f32 v61, v61
    v_cvt_pk_bf16_f32 v140, v56, v57
    v_cvt_pk_bf16_f32 v141, v58, v59
    v_mfma_f32_16x16x32_bf16 v[176:179], v[184:187], v[132:135], v[176:179]
    ds_read_b128 v[164:167], v8 offset:35328
    v_exp_f32 v62, v62
    v_exp_f32 v63, v63
    v_cvt_pk_bf16_f32 v142, v60, v61
    v_cvt_pk_bf16_f32 v143, v62, v63
    v_mfma_f32_32x32x16_bf16 v[48:63], v[144:147], a[104:107], v[80:95]
    v_exp_f32 v32, v32
    v_exp_f32 v33, v33
    v_exp_f32 v34, v34
    v_cvt_pk_bf16_f32 v128, v32, v33
    v_mfma_f32_32x32x16_bf16 v[48:63], v[148:151], a[108:111], v[48:63]
    v_exp_f32 v35, v35
    v_exp_f32 v36, v36
    v_exp_f32 v37, v37
    v_cvt_pk_bf16_f32 v129, v34, v35
    v_mfma_f32_32x32x16_bf16 v[112:127], v[168:171], v[136:139], v[112:127]
    v_exp_f32 v38, v38
    v_exp_f32 v39, v39
    v_exp_f32 v40, v40
    v_cvt_pk_bf16_f32 v130, v36, v37
    v_mfma_f32_32x32x16_bf16 v[112:127], v[172:175], v[140:143], v[112:127]
    v_exp_f32 v41, v41
    v_exp_f32 v42, v42
    v_exp_f32 v43, v43
    v_cvt_pk_bf16_f32 v131, v38, v39
    v_mfma_f32_16x16x32_bf16 v[180:183], v[184:187], v[136:139], v[180:183]
    s_and_b32 s3, s3, 7
    v_exp_f32 v44, v44
    v_exp_f32 v45, v45
    v_cvt_pk_bf16_f32 v132, v40, v41
    v_cvt_pk_bf16_f32 v133, v42, v43
    v_mfma_f32_16x16x32_bf16 v[180:183], v[184:187], v[140:143], v[180:183]
    s_waitcnt lgkmcnt(0)
    v_exp_f32 v46, v46
    v_exp_f32 v47, v47
    v_cvt_pk_bf16_f32 v134, v44, v45
    v_cvt_pk_bf16_f32 v135, v46, v47
    v_mfma_f32_32x32x16_bf16 v[32:47], v[152:155], a[96:99], v[64:79]
    s_add_u32 m0, s45, 49152
    v_exp_f32 v48, v48
    v_exp_f32 v49, v49
    v_exp_f32 v50, v50
    v_cvt_pk_bf16_f32 v136, v48, v49
    v_mfma_f32_32x32x16_bf16 v[32:47], v[156:159], a[100:103], v[32:47]
    s_add_u32 s43, s59, s42
    v_exp_f32 v51, v51
    v_exp_f32 v52, v52
    v_exp_f32 v53, v53
    v_cvt_pk_bf16_f32 v137, v50, v51
    v_mfma_f32_32x32x16_bf16 v[96:111], v[160:163], v[128:131], v[96:111]
    ds_read_b128 v[144:147], v9 offset:40960
    v_exp_f32 v54, v54
    v_exp_f32 v55, v55
    v_exp_f32 v56, v56
    v_cvt_pk_bf16_f32 v138, v52, v53
    v_mfma_f32_32x32x16_bf16 v[96:111], v[164:167], v[132:135], v[96:111]
    ds_read_b128 v[148:151], v9 offset:41472
    v_exp_f32 v57, v57
    v_exp_f32 v58, v58
    v_exp_f32 v59, v59
    v_cvt_pk_bf16_f32 v139, v54, v55
    v_mfma_f32_16x16x32_bf16 v[176:179], v[184:187], v[128:131], v[176:179]
    ds_read_b128 v[168:171], v8 offset:38912
    v_exp_f32 v60, v60
    v_exp_f32 v61, v61
    v_cvt_pk_bf16_f32 v140, v56, v57
    v_cvt_pk_bf16_f32 v141, v58, v59
    v_mfma_f32_16x16x32_bf16 v[176:179], v[184:187], v[132:135], v[176:179]
    ds_read_b128 v[172:175], v8 offset:39424
    v_exp_f32 v62, v62
    v_exp_f32 v63, v63
    v_cvt_pk_bf16_f32 v142, v60, v61
    v_cvt_pk_bf16_f32 v143, v62, v63
    v_mfma_f32_32x32x16_bf16 v[48:63], v[152:155], a[104:107], v[80:95]
    buffer_load_dwordx4 v1, s[4:7], s43 offen offset:0 sc1 lds
    v_exp_f32 v32, v32
    v_exp_f32 v33, v33
    v_exp_f32 v34, v34
    v_cvt_pk_bf16_f32 v128, v32, v33
    v_mfma_f32_32x32x16_bf16 v[48:63], v[156:159], a[108:111], v[48:63]
    buffer_load_dwordx4 v1, s[4:7], s43 offen offset:1024 sc1 lds
    v_exp_f32 v35, v35
    v_exp_f32 v36, v36
    v_exp_f32 v37, v37
    v_cvt_pk_bf16_f32 v129, v34, v35
    v_mfma_f32_32x32x16_bf16 v[112:127], v[160:163], v[136:139], v[112:127]
    buffer_load_dwordx4 v1, s[4:7], s43 offen offset:2048 sc1 lds
    v_exp_f32 v38, v38
    v_exp_f32 v39, v39
    v_exp_f32 v40, v40
    v_cvt_pk_bf16_f32 v130, v36, v37
    v_mfma_f32_32x32x16_bf16 v[112:127], v[164:167], v[140:143], v[112:127]
    buffer_load_dwordx4 v1, s[4:7], s43 offen offset:3072 sc1 lds
    v_exp_f32 v41, v41
    v_exp_f32 v42, v42
    v_exp_f32 v43, v43
    v_cvt_pk_bf16_f32 v131, v38, v39
    v_mfma_f32_16x16x32_bf16 v[180:183], v[184:187], v[136:139], v[180:183]
    s_add_u32 s42, s42, 16384
    v_exp_f32 v44, v44
    v_exp_f32 v45, v45
    v_cvt_pk_bf16_f32 v132, v40, v41
    v_cvt_pk_bf16_f32 v133, v42, v43
    v_mfma_f32_16x16x32_bf16 v[180:183], v[184:187], v[140:143], v[180:183]
    s_waitcnt lgkmcnt(0)
    v_exp_f32 v46, v46
    v_exp_f32 v47, v47
    v_cvt_pk_bf16_f32 v134, v44, v45
    v_cvt_pk_bf16_f32 v135, v46, v47
    v_mfma_f32_32x32x16_bf16 v[32:47], v[144:147], a[96:99], v[64:79]
    s_and_b32 s42, s42, 0x3ffff
    v_exp_f32 v48, v48
    v_exp_f32 v49, v49
    v_exp_f32 v50, v50
    v_cvt_pk_bf16_f32 v136, v48, v49
    v_mfma_f32_32x32x16_bf16 v[32:47], v[148:151], a[100:103], v[32:47]
    s_lshl_b32 s28, s3, 13
    v_exp_f32 v51, v51
    v_exp_f32 v52, v52
    v_exp_f32 v53, v53
    v_cvt_pk_bf16_f32 v137, v50, v51
    v_mfma_f32_32x32x16_bf16 v[96:111], v[168:171], v[128:131], v[96:111]
    ds_read_b128 v[152:155], v9 offset:45056
    v_exp_f32 v54, v54
    v_exp_f32 v55, v55
    v_exp_f32 v56, v56
    v_cvt_pk_bf16_f32 v138, v52, v53
    v_mfma_f32_32x32x16_bf16 v[96:111], v[172:175], v[132:135], v[96:111]
    ds_read_b128 v[156:159], v9 offset:45568
    v_exp_f32 v57, v57
    v_exp_f32 v58, v58
    v_exp_f32 v59, v59
    v_cvt_pk_bf16_f32 v139, v54, v55
    v_mfma_f32_16x16x32_bf16 v[176:179], v[184:187], v[128:131], v[176:179]
    ds_read_b128 v[160:163], v8 offset:43008
    v_exp_f32 v60, v60
    v_exp_f32 v61, v61
    v_cvt_pk_bf16_f32 v140, v56, v57
    v_cvt_pk_bf16_f32 v141, v58, v59
    v_mfma_f32_16x16x32_bf16 v[176:179], v[184:187], v[132:135], v[176:179]
    ds_read_b128 v[164:167], v8 offset:43520
    v_exp_f32 v62, v62
    v_exp_f32 v63, v63
    v_cvt_pk_bf16_f32 v142, v60, v61
    v_cvt_pk_bf16_f32 v143, v62, v63
    v_mfma_f32_32x32x16_bf16 v[48:63], v[144:147], a[104:107], v[80:95]
    s_add_u32 s3, s33, 5
    v_exp_f32 v32, v32
    v_exp_f32 v33, v33
    v_exp_f32 v34, v34
    v_cvt_pk_bf16_f32 v128, v32, v33
    v_mfma_f32_32x32x16_bf16 v[48:63], v[148:151], a[108:111], v[48:63]
    s_and_b32 s3, s3, 7
    v_exp_f32 v35, v35
    v_exp_f32 v36, v36
    v_exp_f32 v37, v37
    v_cvt_pk_bf16_f32 v129, v34, v35
    v_mfma_f32_32x32x16_bf16 v[112:127], v[168:171], v[136:139], v[112:127]
    s_lshl_b32 s29, s3, 13
    v_exp_f32 v38, v38
    v_exp_f32 v39, v39
    v_exp_f32 v40, v40
    v_cvt_pk_bf16_f32 v130, v36, v37
    v_mfma_f32_32x32x16_bf16 v[112:127], v[172:175], v[140:143], v[112:127]
    s_add_u32 s3, s33, 6
    v_exp_f32 v41, v41
    v_exp_f32 v42, v42
    v_exp_f32 v43, v43
    v_cvt_pk_bf16_f32 v131, v38, v39
    v_mfma_f32_16x16x32_bf16 v[180:183], v[184:187], v[136:139], v[180:183]
    s_and_b32 s3, s3, 7
    v_exp_f32 v44, v44
    v_exp_f32 v45, v45
    v_cvt_pk_bf16_f32 v132, v40, v41
    v_cvt_pk_bf16_f32 v133, v42, v43
    v_mfma_f32_16x16x32_bf16 v[180:183], v[184:187], v[140:143], v[180:183]
    s_waitcnt vmcnt(8) lgkmcnt(0)
    s_barrier
    s_cmp_lg_u32 s46, 0
    s_cbranch_scc1 L_at_noflag
    s_mov_b64 exec, 1
    buffer_store_dword v20, v21, s[4:7], s63 offen sc1
    s_mov_b64 exec, -1
L_at_noflag:
    v_exp_f32 v46, v46
    v_exp_f32 v47, v47
    v_cvt_pk_bf16_f32 v134, v44, v45
    v_cvt_pk_bf16_f32 v135, v46, v47
    v_mfma_f32_32x32x16_bf16 v[32:47], v[152:155], a[96:99], v[64:79]
    s_lshl_b32 s30, s3, 13
    v_exp_f32 v48, v48
    v_exp_f32 v49, v49
    v_exp_f32 v50, v50
    v_cvt_pk_bf16_f32 v136, v48, v49
    v_mfma_f32_32x32x16_bf16 v[32:47], v[156:159], a[100:103], v[32:47]
    s_add_u32 s3, s33, 7
    v_exp_f32 v51, v51
    v_exp_f32 v52, v52
    v_exp_f32 v53, v53
    v_cvt_pk_bf16_f32 v137, v50, v51
    v_mfma_f32_32x32x16_bf16 v[96:111], v[160:163], v[128:131], v[96:111]
    ds_read_b128 v[144:147], v9 offset:49152
    v_exp_f32 v54, v54
    v_exp_f32 v55, v55
    v_exp_f32 v56, v56
    v_cvt_pk_bf16_f32 v138, v52, v53
    v_mfma_f32_32x32x16_bf16 v[96:111], v[164:167], v[132:135], v[96:111]
    ds_read_b128 v[148:151], v9 offset:49664
    v_exp_f32 v57, v57
    v_exp_f32 v58, v58
    v_exp_f32 v59, v59
    v_cvt_pk_bf16_f32 v139, v54, v55
    v_mfma_f32_16x16x32_bf16 v[176:179], v[184:187], v[128:131], v[176:179]
    ds_read_b128 v[168:171], v8 offset:47104
    v_exp_f32 v60, v60
    v_exp_f32 v61, v61
    v_cvt_pk_bf16_f32 v140, v56, v57
    v_cvt_pk_bf16_f32 v141, v58, v59
    v_mfma_f32_16x16x32_bf16 v[176:179], v[184:187], v[132:135], v[176:179]
    ds_read_b128 v[172:175], v8 offset:47616
    v_exp_f32 v62, v62
    v_exp_f32 v63, v63
    v_cvt_pk_bf16_f32 v142, v60, v61
    v_cvt_pk_bf16_f32 v143, v62, v63
    v_mfma_f32_32x32x16_bf16 v[48:63], v[152:155], a[104:107], v[80:95]
    s_and_b32 s3, s3, 7
    v_exp_f32 v32, v32
    v_exp_f32 v33, v33
    v_exp_f32 v34, v34
    v_cvt_pk_bf16_f32 v128, v32, v33
    v_mfma_f32_32x32x16_bf16 v[48:63], v[156:159], a[108:111], v[48:63]
    s_lshl_b32 s31, s3, 13
    v_exp_f32 v35, v35
    v_exp_f32 v36, v36
    v_exp_f32 v37, v37
    v_cvt_pk_bf16_f32 v129, v34, v35
    v_mfma_f32_32x32x16_bf16 v[112:127], v[160:163], v[136:139], v[112:127]
    s_lshr_b32 s54, s52, 1
    v_exp_f32 v38, v38
    v_exp_f32 v39, v39
    v_exp_f32 v40, v40
    v_cvt_pk_bf16_f32 v130, v36, v37
    v_mfma_f32_32x32x16_bf16 v[112:127], v[164:167], v[140:143], v[112:127]
    s_lshl_b32 s54, s54, 8
    v_exp_f32 v41, v41
    v_exp_f32 v42, v42
    v_exp_f32 v43, v43
    v_cvt_pk_bf16_f32 v131, v38, v39
    v_mfma_f32_16x16x32_bf16 v[180:183], v[184:187], v[136:139], v[180:183]
    s_lshl_b32 s49, s46, 11
    v_exp_f32 v44, v44
    v_exp_f32 v45, v45
    v_cvt_pk_bf16_f32 v132, v40, v41
    v_cvt_pk_bf16_f32 v133, v42, v43
    v_mfma_f32_16x16x32_bf16 v[180:183], v[184:187], v[140:143], v[180:183]
    s_waitcnt lgkmcnt(0)
    v_exp_f32 v46, v46
    v_exp_f32 v47, v47
    v_cvt_pk_bf16_f32 v134, v44, v45
    v_cvt_pk_bf16_f32 v135, v46, v47
    v_mfma_f32_32x32x16_bf16 v[32:47], v[144:147], a[96:99], v[64:79]
    s_and_b32 s33, s2, 1
    v_exp_f32 v48, v48
    v_exp_f32 v49, v49
    v_exp_f32 v50, v50
    v_cvt_pk_bf16_f32 v136, v48, v49
    v_mfma_f32_32x32x16_bf16 v[32:47], v[148:151], a[100:103], v[32:47]
    s_mul_i32 s48, s52, 917504
    v_exp_f32 v51, v51
    v_exp_f32 v52, v52
    v_exp_f32 v53, v53
    v_cvt_pk_bf16_f32 v137, v50, v51
    v_mfma_f32_32x32x16_bf16 v[96:111], v[168:171], v[128:131], v[96:111]
    ds_read_b128 v[152:155], v9 offset:53248
    v_exp_f32 v54, v54
    v_exp_f32 v55, v55
    v_exp_f32 v56, v56
    v_cvt_pk_bf16_f32 v138, v52, v53
    v_mfma_f32_32x32x16_bf16 v[96:111], v[172:175], v[132:135], v[96:111]
    ds_read_b128 v[156:159], v9 offset:53760
    v_exp_f32 v57, v57
    v_exp_f32 v58, v58
    v_exp_f32 v59, v59
    v_cvt_pk_bf16_f32 v139, v54, v55
    v_mfma_f32_16x16x32_bf16 v[176:179], v[184:187], v[128:131], v[176:179]
    ds_read_b128 v[160:163], v8 offset:51200
    v_exp_f32 v60, v60
    v_exp_f32 v61, v61
    v_cvt_pk_bf16_f32 v140, v56, v57
    v_cvt_pk_bf16_f32 v141, v58, v59
    v_mfma_f32_16x16x32_bf16 v[176:179], v[184:187], v[132:135], v[176:179]
    ds_read_b128 v[164:167], v8 offset:51712
    v_exp_f32 v62, v62
    v_exp_f32 v63, v63
    v_cvt_pk_bf16_f32 v142, v60, v61
    v_cvt_pk_bf16_f32 v143, v62, v63
    v_mfma_f32_32x32x16_bf16 v[48:63], v[144:147], a[104:107], v[80:95]
    v_exp_f32 v32, v32
    v_exp_f32 v33, v33
    v_exp_f32 v34, v34
    v_cvt_pk_bf16_f32 v128, v32, v33
    v_mfma_f32_32x32x16_bf16 v[48:63], v[148:151], a[108:111], v[48:63]
    v_exp_f32 v35, v35
    v_exp_f32 v36, v36
    v_exp_f32 v37, v37
    v_cvt_pk_bf16_f32 v129, v34, v35
    v_mfma_f32_32x32x16_bf16 v[112:127], v[168:171], v[136:139], v[112:127]
    v_exp_f32 v38, v38
    v_exp_f32 v39, v39
    v_exp_f32 v40, v40
    v_cvt_pk_bf16_f32 v130, v36, v37
    v_mfma_f32_32x32x16_bf16 v[112:127], v[172:175], v[140:143], v[112:127]
    v_exp_f32 v41, v41
    v_exp_f32 v42, v42
    v_exp_f32 v43, v43
    v_cvt_pk_bf16_f32 v131, v38, v39
    v_mfma_f32_16x16x32_bf16 v[180:183], v[184:187], v[136:139], v[180:183]
    s_mul_i32 s3, s33, 491520
    v_exp_f32 v44, v44
    v_exp_f32 v45, v45
    v_cvt_pk_bf16_f32 v132, v40, v41
    v_cvt_pk_bf16_f32 v133, v42, v43
    v_mfma_f32_16x16x32_bf16 v[180:183], v[184:187], v[140:143], v[180:183]
    s_waitcnt lgkmcnt(0)
    v_exp_f32 v46, v46
    v_exp_f32 v47, v47
    v_cvt_pk_bf16_f32 v134, v44, v45
    v_cvt_pk_bf16_f32 v135, v46, v47
    v_mfma_f32_32x32x16_bf16 v[32:47], v[152:155], a[96:99], v[64:79]
    s_add_u32 m0, s45, 65536
    v_exp_f32 v48, v48
    v_exp_f32 v49, v49
    v_exp_f32 v50, v50
    v_cvt_pk_bf16_f32 v136, v48, v49
    v_mfma_f32_32x32x16_bf16 v[32:47], v[156:159], a[100:103], v[32:47]
    s_add_u32 s43, s59, s42
    v_exp_f32 v51, v51
    v_exp_f32 v52, v52
    v_exp_f32 v53, v53
    v_cvt_pk_bf16_f32 v137, v50, v51
    v_mfma_f32_32x32x16_bf16 v[96:111], v[160:163], v[128:131], v[96:111]
    ds_read_b128 v[144:147], v9 offset:57344
    v_exp_f32 v54, v54
    v_exp_f32 v55, v55
    v_exp_f32 v56, v56
    v_cvt_pk_bf16_f32 v138, v52, v53
    v_mfma_f32_32x32x16_bf16 v[96:111], v[164:167], v[132:135], v[96:111]
    ds_read_b128 v[148:151], v9 offset:57856
    v_exp_f32 v57, v57
    v_exp_f32 v58, v58
    v_exp_f32 v59, v59
    v_cvt_pk_bf16_f32 v139, v54, v55
    v_mfma_f32_16x16x32_bf16 v[176:179], v[184:187], v[128:131], v[176:179]
    ds_read_b128 v[168:171], v8 offset:55296
    v_exp_f32 v60, v60
    v_exp_f32 v61, v61
    v_cvt_pk_bf16_f32 v140, v56, v57
    v_cvt_pk_bf16_f32 v141, v58, v59
    v_mfma_f32_16x16x32_bf16 v[176:179], v[184:187], v[132:135], v[176:179]
    ds_read_b128 v[172:175], v8 offset:55808
    v_exp_f32 v62, v62
    v_exp_f32 v63, v63
    v_cvt_pk_bf16_f32 v142, v60, v61
    v_cvt_pk_bf16_f32 v143, v62, v63
    v_mfma_f32_32x32x16_bf16 v[48:63], v[152:155], a[104:107], v[80:95]
    buffer_load_dwordx4 v1, s[4:7], s43 offen offset:0 sc1 lds
    v_exp_f32 v32, v32
    v_exp_f32 v33, v33
    v_exp_f32 v34, v34
    v_cvt_pk_bf16_f32 v128, v32, v33
    v_mfma_f32_32x32x16_bf16 v[48:63], v[156:159], a[108:111], v[48:63]
    buffer_load_dwordx4 v1, s[4:7], s43 offen offset:1024 sc1 lds
    v_exp_f32 v35, v35
    v_exp_f32 v36, v36
    v_exp_f32 v37, v37
    v_cvt_pk_bf16_f32 v129, v34, v35
    v_mfma_f32_32x32x16_bf16 v[112:127], v[160:163], v[136:139], v[112:127]
    buffer_load_dwordx4 v1, s[4:7], s43 offen offset:2048 sc1 lds
    v_exp_f32 v38, v38
    v_exp_f32 v39, v39
    v_exp_f32 v40, v40
    v_cvt_pk_bf16_f32 v130, v36, v37
    v_mfma_f32_32x32x16_bf16 v[112:127], v[164:167], v[140:143], v[112:127]
    buffer_load_dwordx4 v1, s[4:7], s43 offen offset:3072 sc1 lds
    v_exp_f32 v41, v41
    v_exp_f32 v42, v42
    v_exp_f32 v43, v43
    v_cvt_pk_bf16_f32 v131, v38, v39
    v_mfma_f32_16x16x32_bf16 v[180:183], v[184:187], v[136:139], v[180:183]
    s_add_u32 s42, s42, 16384
    v_exp_f32 v44, v44
    v_exp_f32 v45, v45
    v_cvt_pk_bf16_f32 v132, v40, v41
    v_cvt_pk_bf16_f32 v133, v42, v43
    v_mfma_f32_16x16x32_bf16 v[180:183], v[184:187], v[140:143], v[180:183]
    s_waitcnt lgkmcnt(0)
    v_exp_f32 v46, v46
    v_exp_f32 v47, v47
    v_cvt_pk_bf16_f32 v134, v44, v45
    v_cvt_pk_bf16_f32 v135, v46, v47
    v_mfma_f32_32x32x16_bf16 v[32:47], v[144:147], a[96:99], v[64:79]
    s_and_b32 s42, s42, 0x3ffff
    v_exp_f32 v48, v48
    v_exp_f32 v49, v49
    v_exp_f32 v50, v50
    v_cvt_pk_bf16_f32 v136, v48, v49
    v_mfma_f32_32x32x16_bf16 v[32:47], v[148:151], a[100:103], v[32:47]
    s_add_u32 s48, s48, s3
    v_exp_f32 v51, v51
    v_exp_f32 v52, v52
    v_exp_f32 v53, v53
    v_cvt_pk_bf16_f32 v137, v50, v51
    v_mfma_f32_32x32x16_bf16 v[96:111], v[168:171], v[128:131], v[96:111]
    ds_read_b128 v[152:155], v9 offset:61440
    v_exp_f32 v54, v54
    v_exp_f32 v55, v55
    v_exp_f32 v56, v56
    v_cvt_pk_bf16_f32 v138, v52, v53
    v_mfma_f32_32x32x16_bf16 v[96:111], v[172:175], v[132:135], v[96:111]
    ds_read_b128 v[156:159], v9 offset:61952
    v_exp_f32 v57, v57
    v_exp_f32 v58, v58
    v_exp_f32 v59, v59
    v_cvt_pk_bf16_f32 v139, v54, v55
    v_mfma_f32_16x16x32_bf16 v[176:179], v[184:187], v[128:131], v[176:179]
    ds_read_b128 v[160:163], v8 offset:59392
    v_exp_f32 v60, v60
    v_exp_f32 v61, v61
    v_cvt_pk_bf16_f32 v140, v56, v57
    v_cvt_pk_bf16_f32 v141, v58, v59
    v_mfma_f32_16x16x32_bf16 v[176:179], v[184:187], v[132:135], v[176:179]
    ds_read_b128 v[164:167], v8 offset:59904
    v_exp_f32 v62, v62
    v_exp_f32 v63, v63
    v_cvt_pk_bf16_f32 v142, v60, v61
    v_cvt_pk_bf16_f32 v143, v62, v63
    v_mfma_f32_32x32x16_bf16 v[48:63], v[144:147], a[104:107], v[80:95]
    s_add_u32 s48, s48, s49
    v_exp_f32 v32, v32
    v_exp_f32 v33, v33
    v_exp_f32 v34, v34
    v_cvt_pk_bf16_f32 v128, v32, v33
    v_mfma_f32_32x32x16_bf16 v[48:63], v[148:151], a[108:111], v[48:63]
    s_add_u32 s48, s48, 16777216
    v_exp_f32 v35, v35
    v_exp_f32 v36, v36
    v_exp_f32 v37, v37
    v_cvt_pk_bf16_f32 v129, v34, v35
    v_mfma_f32_32x32x16_bf16 v[112:127], v[168:171], v[136:139], v[112:127]
    s_mul_i32 s50, s33, 3932160
    v_exp_f32 v38, v38
    v_exp_f32 v39, v39
    v_exp_f32 v40, v40
    v_cvt_pk_bf16_f32 v130, v36, v37
    v_mfma_f32_32x32x16_bf16 v[112:127], v[172:175], v[140:143], v[112:127]
    s_lshl_b32 s3, s46, 14
    v_exp_f32 v41, v41
    v_exp_f32 v42, v42
    v_exp_f32 v43, v43
    v_cvt_pk_bf16_f32 v131, v38, v39
    v_mfma_f32_16x16x32_bf16 v[180:183], v[184:187], v[136:139], v[180:183]
    s_add_u32 s50, s50, s3
    v_exp_f32 v44, v44
    v_exp_f32 v45, v45
    v_cvt_pk_bf16_f32 v132, v40, v41
    v_cvt_pk_bf16_f32 v133, v42, v43
    v_mfma_f32_16x16x32_bf16 v[180:183], v[184:187], v[140:143], v[180:183]
    s_waitcnt lgkmcnt(0)
    v_exp_f32 v46, v46
    v_exp_f32 v47, v47
    v_cvt_pk_bf16_f32 v134, v44, v45
    v_cvt_pk_bf16_f32 v135, v46, v47
    v_mfma_f32_32x32x16_bf16 v[32:47], v[152:155], a[96:99], v[64:79]
    s_lshl_b32 s3, s53, 8
    v_exp_f32 v48, v48
    v_exp_f32 v49, v49
    v_exp_f32 v50, v50
    v_cvt_pk_bf16_f32 v136, v48, v49
    v_mfma_f32_32x32x16_bf16 v[32:47], v[156:159], a[100:103], v[32:47]
    s_add_u32 s50, s50, s3
    v_exp_f32 v51, v51
    v_exp_f32 v52, v52
    v_exp_f32 v53, v53
    v_cvt_pk_bf16_f32 v137, v50, v51
    v_mfma_f32_32x32x16_bf16 v[96:111], v[160:163], v[128:131], v[96:111]
    ds_read_b128 v[144:147], v25 offset:0
    v_exp_f32 v54, v54
    v_exp_f32 v55, v55
    v_exp_f32 v56, v56
    v_cvt_pk_bf16_f32 v138, v52, v53
    v_mfma_f32_32x32x16_bf16 v[96:111], v[164:167], v[132:135], v[96:111]
    ds_read_b128 v[148:151], v25 offset:512
    v_exp_f32 v57, v57
    v_exp_f32 v58, v58
    v_exp_f32 v59, v59
    v_cvt_pk_bf16_f32 v139, v54, v55
    v_mfma_f32_16x16x32_bf16 v[176:179], v[184:187], v[128:131], v[176:179]
    ds_read_b128 v[168:171], v8 offset:63488
    v_exp_f32 v60, v60
    v_exp_f32 v61, v61
    v_cvt_pk_bf16_f32 v140, v56, v57
    v_cvt_pk_bf16_f32 v141, v58, v59
    v_mfma_f32_16x16x32_bf16 v[176:179], v[184:187], v[132:135], v[176:179]
    ds_read_b128 v[172:175], v8 offset:64000
    v_exp_f32 v62, v62
    v_exp_f32 v63, v63
    v_cvt_pk_bf16_f32 v142, v60, v61
    v_cvt_pk_bf16_f32 v143, v62, v63
    v_mfma_f32_32x32x16_bf16 v[48:63], v[152:155], a[104:107], v[80:95]
    s_lshl_b32 s53, s53, 1
    v_exp_f32 v32, v32
    v_exp_f32 v33, v33
    v_exp_f32 v34, v34
    v_cvt_pk_bf16_f32 v128, v32, v33
    v_mfma_f32_32x32x16_bf16 v[48:63], v[156:159], a[108:111], v[48:63]
    s_add_u32 s53, s53, s33
    v_exp_f32 v35, v35
    v_exp_f32 v36, v36
    v_exp_f32 v37, v37
    v_cvt_pk_bf16_f32 v129, v34, v35
    v_mfma_f32_32x32x16_bf16 v[112:127], v[160:163], v[136:139], v[112:127]
    s_lshl_b32 s33, s33, 2
    v_exp_f32 v38, v38
    v_exp_f32 v39, v39
    v_exp_f32 v40, v40
    v_cvt_pk_bf16_f32 v130, v36, v37
    v_mfma_f32_32x32x16_bf16 v[112:127], v[164:167], v[140:143], v[112:127]
    v_lshrrev_b32 v12, 4, v18
    v_exp_f32 v41, v41
    v_exp_f32 v42, v42
    v_exp_f32 v43, v43
    v_cvt_pk_bf16_f32 v131, v38, v39
    v_mfma_f32_16x16x32_bf16 v[180:183], v[184:187], v[136:139], v[180:183]
    v_bfe_u32 v13, v18, 1, 3
    v_exp_f32 v44, v44
    v_exp_f32 v45, v45
    v_cvt_pk_bf16_f32 v132, v40, v41
    v_cvt_pk_bf16_f32 v133, v42, v43
    v_mfma_f32_16x16x32_bf16 v[180:183], v[184:187], v[140:143], v[180:183]
    s_waitcnt lgkmcnt(0)
    v_exp_f32 v46, v46
    v_exp_f32 v47, v47
    v_cvt_pk_bf16_f32 v134, v44, v45
    v_cvt_pk_bf16_f32 v135, v46, v47
    v_mfma_f32_32x32x16_bf16 v[32:47], v[144:147], a[96:99], v[64:79]
    v_xor_b32 v13, v13, v12
    v_exp_f32 v48, v48
    v_exp_f32 v49, v49
    v_exp_f32 v50, v50
    v_cvt_pk_bf16_f32 v136, v48, v49
    v_mfma_f32_32x32x16_bf16 v[32:47], v[148:151], a[100:103], v[32:47]
    v_xor_b32 v13, s33, v13
    v_exp_f32 v51, v51
    v_exp_f32 v52, v52
    v_exp_f32 v53, v53
    v_cvt_pk_bf16_f32 v137, v50, v51
    v_mfma_f32_32x32x16_bf16 v[96:111], v[168:171], v[128:131], v[96:111]
    ds_read_b128 v[152:155], v25 offset:4096
    v_exp_f32 v54, v54
    v_exp_f32 v55, v55
    v_exp_f32 v56, v56
    v_cvt_pk_bf16_f32 v138, v52, v53
    v_mfma_f32_32x32x16_bf16 v[96:111], v[172:175], v[132:135], v[96:111]
    ds_read_b128 v[156:159], v25 offset:4608
    v_exp_f32 v57, v57
    v_exp_f32 v58, v58
    v_exp_f32 v59, v59
    v_cvt_pk_bf16_f32 v139, v54, v55
    v_mfma_f32_16x16x32_bf16 v[176:179], v[184:187], v[128:131], v[176:179]
    ds_read_b128 v[160:163], v24 offset:2048
    v_exp_f32 v60, v60
    v_exp_f32 v61, v61
    v_cvt_pk_bf16_f32 v140, v56, v57
    v_cvt_pk_bf16_f32 v141, v58, v59
    v_mfma_f32_16x16x32_bf16 v[176:179], v[184:187], v[132:135], v[176:179]
    ds_read_b128 v[164:167], v24 offset:2560
    v_exp_f32 v62, v62
    v_exp_f32 v63, v63
    v_cvt_pk_bf16_f32 v142, v60, v61
    v_cvt_pk_bf16_f32 v143, v62, v63
    v_mfma_f32_32x32x16_bf16 v[48:63], v[144:147], a[104:107], v[80:95]
    v_exp_f32 v32, v32
    v_exp_f32 v33, v33
    v_exp_f32 v34, v34
    v_cvt_pk_bf16_f32 v128, v32, v33
    v_mfma_f32_32x32x16_bf16 v[48:63], v[148:151], a[108:111], v[48:63]
    v_exp_f32 v35, v35
    v_exp_f32 v36, v36
    v_exp_f32 v37, v37
    v_cvt_pk_bf16_f32 v129, v34, v35
    v_mfma_f32_32x32x16_bf16 v[112:127], v[168:171], v[136:139], v[112:127]
    v_exp_f32 v38, v38
    v_exp_f32 v39, v39
    v_exp_f32 v40, v40
    v_cvt_pk_bf16_f32 v130, v36, v37
    v_mfma_f32_32x32x16_bf16 v[112:127], v[172:175], v[140:143], v[112:127]
    v_exp_f32 v41, v41
    v_exp_f32 v42, v42
    v_exp_f32 v43, v43
    v_cvt_pk_bf16_f32 v131, v38, v39
    v_mfma_f32_16x16x32_bf16 v[180:183], v[184:187], v[136:139], v[180:183]
    v_exp_f32 v44, v44
    v_exp_f32 v45, v45
    v_cvt_pk_bf16_f32 v132, v40, v41
    v_cvt_pk_bf16_f32 v133, v42, v43
    v_mfma_f32_16x16x32_bf16 v[180:183], v[184:187], v[140:143], v[180:183]
    s_waitcnt lgkmcnt(0)
    v_exp_f32 v46, v46
    v_exp_f32 v47, v47
    v_cvt_pk_bf16_f32 v134, v44, v45
    v_cvt_pk_bf16_f32 v135, v46, v47
    v_mfma_f32_32x32x16_bf16 v[32:47], v[152:155], a[96:99], v[64:79]
    s_add_u32 m0, s45, 81920
    v_exp_f32 v48, v48
    v_exp_f32 v49, v49
    v_exp_f32 v50, v50
    v_cvt_pk_bf16_f32 v136, v48, v49
    v_mfma_f32_32x32x16_bf16 v[32:47], v[156:159], a[100:103], v[32:47]
    s_add_u32 s43, s59, s42
    v_exp_f32 v51, v51
    v_exp_f32 v52, v52
    v_exp_f32 v53, v53
    v_cvt_pk_bf16_f32 v137, v50, v51
    v_mfma_f32_32x32x16_bf16 v[96:111], v[160:163], v[128:131], v[96:111]
    ds_read_b128 v[144:147], v25 offset:8192
    v_exp_f32 v54, v54
    v_exp_f32 v55, v55
    v_exp_f32 v56, v56
    v_cvt_pk_bf16_f32 v138, v52, v53
    v_mfma_f32_32x32x16_bf16 v[96:111], v[164:167], v[132:135], v[96:111]
    ds_read_b128 v[148:151], v25 offset:8704
    v_exp_f32 v57, v57
    v_exp_f32 v58, v58
    v_exp_f32 v59, v59
    v_cvt_pk_bf16_f32 v139, v54, v55
    v_mfma_f32_16x16x32_bf16 v[176:179], v[184:187], v[128:131], v[176:179]
    ds_read_b128 v[168:171], v24 offset:6144
    v_exp_f32 v60, v60
    v_exp_f32 v61, v61
    v_cvt_pk_bf16_f32 v140, v56, v57
    v_cvt_pk_bf16_f32 v141, v58, v59
    v_mfma_f32_16x16x32_bf16 v[176:179], v[184:187], v[132:135], v[176:179]
    ds_read_b128 v[172:175], v24 offset:6656
    v_exp_f32 v62, v62
    v_exp_f32 v63, v63
    v_cvt_pk_bf16_f32 v142, v60, v61
    v_cvt_pk_bf16_f32 v143, v62, v63
    v_mfma_f32_32x32x16_bf16 v[48:63], v[152:155], a[104:107], v[80:95]
    buffer_load_dwordx4 v1, s[4:7], s43 offen offset:0 sc1 lds
    v_exp_f32 v32, v32
    v_exp_f32 v33, v33
    v_exp_f32 v34, v34
    v_cvt_pk_bf16_f32 v128, v32, v33
    v_mfma_f32_32x32x16_bf16 v[48:63], v[156:159], a[108:111], v[48:63]
    buffer_load_dwordx4 v1, s[4:7], s43 offen offset:1024 sc1 lds
    v_exp_f32 v35, v35
    v_exp_f32 v36, v36
    v_exp_f32 v37, v37
    v_cvt_pk_bf16_f32 v129, v34, v35
    v_mfma_f32_32x32x16_bf16 v[112:127], v[160:163], v[136:139], v[112:127]
    buffer_load_dwordx4 v1, s[4:7], s43 offen offset:2048 sc1 lds
    v_exp_f32 v38, v38
    v_exp_f32 v39, v39
    v_exp_f32 v40, v40
    v_cvt_pk_bf16_f32 v130, v36, v37
    v_mfma_f32_32x32x16_bf16 v[112:127], v[164:167], v[140:143], v[112:127]
    buffer_load_dwordx4 v1, s[4:7], s43 offen offset:3072 sc1 lds
    v_exp_f32 v41, v41
    v_exp_f32 v42, v42
    v_exp_f32 v43, v43
    v_cvt_pk_bf16_f32 v131, v38, v39
    v_mfma_f32_16x16x32_bf16 v[180:183], v[184:187], v[136:139], v[180:183]
    s_add_u32 s42, s42, 16384
    v_exp_f32 v44, v44
    v_exp_f32 v45, v45
    v_cvt_pk_bf16_f32 v132, v40, v41
    v_cvt_pk_bf16_f32 v133, v42, v43
    v_mfma_f32_16x16x32_bf16 v[180:183], v[184:187], v[140:143], v[180:183]
    s_waitcnt lgkmcnt(0)
    v_exp_f32 v46, v46
    v_exp_f32 v47, v47
    v_cvt_pk_bf16_f32 v134, v44, v45
    v_cvt_pk_bf16_f32 v135, v46, v47
    v_mfma_f32_32x32x16_bf16 v[32:47], v[144:147], a[96:99], v[64:79]
    s_and_b32 s42, s42, 0x3ffff
    v_exp_f32 v48, v48
    v_exp_f32 v49, v49
    v_exp_f32 v50, v50
    v_cvt_pk_bf16_f32 v136, v48, v49
    v_mfma_f32_32x32x16_bf16 v[32:47], v[148:151], a[100:103], v[32:47]
    v_exp_f32 v51, v51
    v_exp_f32 v52, v52
    v_exp_f32 v53, v53
    v_cvt_pk_bf16_f32 v137, v50, v51
    v_mfma_f32_32x32x16_bf16 v[96:111], v[168:171], v[128:131], v[96:111]
    ds_read_b128 v[152:155], v25 offset:12288
    v_exp_f32 v54, v54
    v_exp_f32 v55, v55
    v_exp_f32 v56, v56
    v_cvt_pk_bf16_f32 v138, v52, v53
    v_mfma_f32_32x32x16_bf16 v[96:111], v[172:175], v[132:135], v[96:111]
    ds_read_b128 v[156:159], v25 offset:12800
    v_exp_f32 v57, v57
    v_exp_f32 v58, v58
    v_exp_f32 v59, v59
    v_cvt_pk_bf16_f32 v139, v54, v55
    v_mfma_f32_16x16x32_bf16 v[176:179], v[184:187], v[128:131], v[176:179]
    ds_read_b128 v[160:163], v24 offset:10240
    v_exp_f32 v60, v60
    v_exp_f32 v61, v61
    v_cvt_pk_bf16_f32 v140, v56, v57
    v_cvt_pk_bf16_f32 v141, v58, v59
    v_mfma_f32_16x16x32_bf16 v[176:179], v[184:187], v[132:135], v[176:179]
    ds_read_b128 v[164:167], v24 offset:10752
    v_exp_f32 v62, v62
    v_exp_f32 v63, v63
    v_cvt_pk_bf16_f32 v142, v60, v61
    v_cvt_pk_bf16_f32 v143, v62, v63
    v_mfma_f32_32x32x16_bf16 v[48:63], v[144:147], a[104:107], v[80:95]
    v_and_b32 v15, 1, v18
    v_exp_f32 v32, v32
    v_exp_f32 v33, v33
    v_exp_f32 v34, v34
    v_cvt_pk_bf16_f32 v128, v32, v33
    v_mfma_f32_32x32x16_bf16 v[48:63], v[148:151], a[108:111], v[48:63]
    v_lshlrev_b32 v12, 11, v12
    v_exp_f32 v35, v35
    v_exp_f32 v36, v36
    v_exp_f32 v37, v37
    v_cvt_pk_bf16_f32 v129, v34, v35
    v_mfma_f32_32x32x16_bf16 v[112:127], v[168:171], v[136:139], v[112:127]
    v_lshl_add_u32 v12, v15, 4, v12
    v_exp_f32 v38, v38
    v_exp_f32 v39, v39
    v_exp_f32 v40, v40
    v_cvt_pk_bf16_f32 v130, v36, v37
    v_mfma_f32_32x32x16_bf16 v[112:127], v[172:175], v[140:143], v[112:127]
    v_lshl_add_u32 v188, v13, 5, v12
    v_exp_f32 v41, v41
    v_exp_f32 v42, v42
    v_exp_f32 v43, v43
    v_cvt_pk_bf16_f32 v131, v38, v39
    v_mfma_f32_16x16x32_bf16 v[180:183], v[184:187], v[136:139], v[180:183]
    v_xor_b32 v13, 4, v13
    v_exp_f32 v44, v44
    v_exp_f32 v45, v45
    v_cvt_pk_bf16_f32 v132, v40, v41
    v_cvt_pk_bf16_f32 v133, v42, v43
    v_mfma_f32_16x16x32_bf16 v[180:183], v[184:187], v[140:143], v[180:183]
    s_waitcnt vmcnt(12) lgkmcnt(0)
    s_barrier
    v_exp_f32 v46, v46
    v_exp_f32 v47, v47
    v_cvt_pk_bf16_f32 v134, v44, v45
    v_cvt_pk_bf16_f32 v135, v46, v47
    v_mfma_f32_32x32x16_bf16 v[32:47], v[152:155], a[96:99], v[64:79]
    v_lshl_add_u32 v190, v13, 5, v12
    v_exp_f32 v48, v48
    v_exp_f32 v49, v49
    v_exp_f32 v50, v50
    v_cvt_pk_bf16_f32 v136, v48, v49
    v_mfma_f32_32x32x16_bf16 v[32:47], v[156:159], a[100:103], v[32:47]
    v_add_u32 v190, 7168, v190
    v_exp_f32 v51, v51
    v_exp_f32 v52, v52
    v_exp_f32 v53, v53
    v_cvt_pk_bf16_f32 v137, v50, v51
    v_mfma_f32_32x32x16_bf16 v[96:111], v[160:163], v[128:131], v[96:111]
    ds_read_b128 v[144:147], v25 offset:16384
    v_exp_f32 v54, v54
    v_exp_f32 v55, v55
    v_exp_f32 v56, v56
    v_cvt_pk_bf16_f32 v138, v52, v53
    v_mfma_f32_32x32x16_bf16 v[96:111], v[164:167], v[132:135], v[96:111]
    ds_read_b128 v[148:151], v25 offset:16896
    v_exp_f32 v57, v57
    v_exp_f32 v58, v58
    v_exp_f32 v59, v59
    v_cvt_pk_bf16_f32 v139, v54, v55
    v_mfma_f32_16x16x32_bf16 v[176:179], v[184:187], v[128:131], v[176:179]
    ds_read_b128 v[168:171], v24 offset:14336
    v_exp_f32 v60, v60
    v_exp_f32 v61, v61
    v_cvt_pk_bf16_f32 v140, v56, v57
    v_cvt_pk_bf16_f32 v141, v58, v59
    v_mfma_f32_16x16x32_bf16 v[176:179], v[184:187], v[132:135], v[176:179]
    ds_read_b128 v[172:175], v24 offset:14848
    v_exp_f32 v62, v62
    v_exp_f32 v63, v63
    v_cvt_pk_bf16_f32 v142, v60, v61
    v_cvt_pk_bf16_f32 v143, v62, v63
    v_mfma_f32_32x32x16_bf16 v[48:63], v[152:155], a[104:107], v[80:95]
    s_and_b32 s64, s46, 1
    v_exp_f32 v32, v32
    v_exp_f32 v33, v33
    v_exp_f32 v34, v34
    v_cvt_pk_bf16_f32 v128, v32, v33
    v_mfma_f32_32x32x16_bf16 v[48:63], v[156:159], a[108:111], v[48:63]
    s_add_u32 s65, s54, 62935040
    v_exp_f32 v35, v35
    v_exp_f32 v36, v36
    v_exp_f32 v37, v37
    v_cvt_pk_bf16_f32 v129, v34, v35
    v_mfma_f32_32x32x16_bf16 v[112:127], v[160:163], v[136:139], v[112:127]
    v_and_b32 v12, 15, v18
    v_exp_f32 v38, v38
    v_exp_f32 v39, v39
    v_exp_f32 v40, v40
    v_cvt_pk_bf16_f32 v130, v36, v37
    v_mfma_f32_32x32x16_bf16 v[112:127], v[164:167], v[140:143], v[112:127]
    v_lshlrev_b32 v191, 11, v12
    v_exp_f32 v41, v41
    v_exp_f32 v42, v42
    v_exp_f32 v43, v43
    v_cvt_pk_bf16_f32 v131, v38, v39
    v_mfma_f32_16x16x32_bf16 v[180:183], v[184:187], v[136:139], v[180:183]
    v_bfe_u32 v12, v18, 4, 1
    v_exp_f32 v44, v44
    v_exp_f32 v45, v45
    v_cvt_pk_bf16_f32 v132, v40, v41
    v_cvt_pk_bf16_f32 v133, v42, v43
    v_mfma_f32_16x16x32_bf16 v[180:183], v[184:187], v[140:143], v[180:183]
    s_waitcnt lgkmcnt(0)
    v_exp_f32 v46, v46
    v_exp_f32 v47, v47
    v_cvt_pk_bf16_f32 v134, v44, v45
    v_cvt_pk_bf16_f32 v135, v46, v47
    v_mfma_f32_32x32x16_bf16 v[32:47], v[144:147], a[96:99], v[64:79]
    v_lshl_add_u32 v191, v12, 5, v191
    v_exp_f32 v48, v48
    v_exp_f32 v49, v49
    v_exp_f32 v50, v50
    v_cvt_pk_bf16_f32 v136, v48, v49
    v_mfma_f32_32x32x16_bf16 v[32:47], v[148:151], a[100:103], v[32:47]
    v_lshrrev_b32 v12, 5, v18
    v_exp_f32 v51, v51
    v_exp_f32 v52, v52
    v_exp_f32 v53, v53
    v_cvt_pk_bf16_f32 v137, v50, v51
    v_mfma_f32_32x32x16_bf16 v[96:111], v[168:171], v[128:131], v[96:111]
    ds_read_b128 v[152:155], v25 offset:20480
    v_exp_f32 v54, v54
    v_exp_f32 v55, v55
    v_exp_f32 v56, v56
    v_cvt_pk_bf16_f32 v138, v52, v53
    v_mfma_f32_32x32x16_bf16 v[96:111], v[172:175], v[132:135], v[96:111]
    ds_read_b128 v[156:159], v25 offset:20992
    v_exp_f32 v57, v57
    v_exp_f32 v58, v58
    v_exp_f32 v59, v59
    v_cvt_pk_bf16_f32 v139, v54, v55
    v_mfma_f32_16x16x32_bf16 v[176:179], v[184:187], v[128:131], v[176:179]
    ds_read_b128 v[160:163], v24 offset:18432
    v_exp_f32 v60, v60
    v_exp_f32 v61, v61
    v_cvt_pk_bf16_f32 v140, v56, v57
    v_cvt_pk_bf16_f32 v141, v58, v59
    v_mfma_f32_16x16x32_bf16 v[176:179], v[184:187], v[132:135], v[176:179]
    ds_read_b128 v[164:167], v24 offset:18944
    v_exp_f32 v62, v62
    v_exp_f32 v63, v63
    v_cvt_pk_bf16_f32 v142, v60, v61
    v_cvt_pk_bf16_f32 v143, v62, v63
    v_mfma_f32_32x32x16_bf16 v[48:63], v[144:147], a[104:107], v[80:95]
    v_exp_f32 v32, v32
    v_exp_f32 v33, v33
    v_exp_f32 v34, v34
    v_cvt_pk_bf16_f32 v128, v32, v33
    v_mfma_f32_32x32x16_bf16 v[48:63], v[148:151], a[108:111], v[48:63]
    v_exp_f32 v35, v35
    v_exp_f32 v36, v36
    v_exp_f32 v37, v37
    v_cvt_pk_bf16_f32 v129, v34, v35
    v_mfma_f32_32x32x16_bf16 v[112:127], v[168:171], v[136:139], v[112:127]
    v_exp_f32 v38, v38
    v_exp_f32 v39, v39
    v_exp_f32 v40, v40
    v_cvt_pk_bf16_f32 v130, v36, v37
    v_mfma_f32_32x32x16_bf16 v[112:127], v[172:175], v[140:143], v[112:127]
    v_exp_f32 v41, v41
    v_exp_f32 v42, v42
    v_exp_f32 v43, v43
    v_cvt_pk_bf16_f32 v131, v38, v39
    v_mfma_f32_16x16x32_bf16 v[180:183], v[184:187], v[136:139], v[180:183]
    v_exp_f32 v44, v44
    v_exp_f32 v45, v45
    v_cvt_pk_bf16_f32 v132, v40, v41
    v_cvt_pk_bf16_f32 v133, v42, v43
    v_mfma_f32_16x16x32_bf16 v[180:183], v[184:187], v[140:143], v[180:183]
    s_waitcnt lgkmcnt(0)
    v_exp_f32 v46, v46
    v_exp_f32 v47, v47
    v_cvt_pk_bf16_f32 v134, v44, v45
    v_cvt_pk_bf16_f32 v135, v46, v47
    v_mfma_f32_32x32x16_bf16 v[32:47], v[152:155], a[96:99], v[64:79]
    s_add_u32 m0, s45, 98304
    v_exp_f32 v48, v48
    v_exp_f32 v49, v49
    v_exp_f32 v50, v50
    v_cvt_pk_bf16_f32 v136, v48, v49
    v_mfma_f32_32x32x16_bf16 v[32:47], v[156:159], a[100:103], v[32:47]
    s_add_u32 s43, s59, s42
    v_exp_f32 v51, v51
    v_exp_f32 v52, v52
    v_exp_f32 v53, v53
    v_cvt_pk_bf16_f32 v137, v50, v51
    v_mfma_f32_32x32x16_bf16 v[96:111], v[160:163], v[128:131], v[96:111]
    ds_read_b128 v[144:147], v25 offset:24576
    v_exp_f32 v54, v54
    v_exp_f32 v55, v55
    v_exp_f32 v56, v56
    v_cvt_pk_bf16_f32 v138, v52, v53
    v_mfma_f32_32x32x16_bf16 v[96:111], v[164:167], v[132:135], v[96:111]
    ds_read_b128 v[148:151], v25 offset:25088
    v_exp_f32 v57, v57
    v_exp_f32 v58, v58
    v_exp_f32 v59, v59
    v_cvt_pk_bf16_f32 v139, v54, v55
    v_mfma_f32_16x16x32_bf16 v[176:179], v[184:187], v[128:131], v[176:179]
    ds_read_b128 v[168:171], v24 offset:22528
    v_exp_f32 v60, v60
    v_exp_f32 v61, v61
    v_cvt_pk_bf16_f32 v140, v56, v57
    v_cvt_pk_bf16_f32 v141, v58, v59
    v_mfma_f32_16x16x32_bf16 v[176:179], v[184:187], v[132:135], v[176:179]
    ds_read_b128 v[172:175], v24 offset:23040
    v_exp_f32 v62, v62
    v_exp_f32 v63, v63
    v_cvt_pk_bf16_f32 v142, v60, v61
    v_cvt_pk_bf16_f32 v143, v62, v63
    v_mfma_f32_32x32x16_bf16 v[48:63], v[152:155], a[104:107], v[80:95]
    buffer_load_dwordx4 v1, s[4:7], s43 offen offset:0 sc1 lds
    v_exp_f32 v32, v32
    v_exp_f32 v33, v33
    v_exp_f32 v34, v34
    v_cvt_pk_bf16_f32 v128, v32, v33
    v_mfma_f32_32x32x16_bf16 v[48:63], v[156:159], a[108:111], v[48:63]
    buffer_load_dwordx4 v1, s[4:7], s43 offen offset:1024 sc1 lds
    v_exp_f32 v35, v35
    v_exp_f32 v36, v36
    v_exp_f32 v37, v37
    v_cvt_pk_bf16_f32 v129, v34, v35
    v_mfma_f32_32x32x16_bf16 v[112:127], v[160:163], v[136:139], v[112:127]
    buffer_load_dwordx4 v1, s[4:7], s43 offen offset:2048 sc1 lds
    v_exp_f32 v38, v38
    v_exp_f32 v39, v39
    v_exp_f32 v40, v40
    v_cvt_pk_bf16_f32 v130, v36, v37
    v_mfma_f32_32x32x16_bf16 v[112:127], v[164:167], v[140:143], v[112:127]
    buffer_load_dwordx4 v1, s[4:7], s43 offen offset:3072 sc1 lds
    v_exp_f32 v41, v41
    v_exp_f32 v42, v42
    v_exp_f32 v43, v43
    v_cvt_pk_bf16_f32 v131, v38, v39
    v_mfma_f32_16x16x32_bf16 v[180:183], v[184:187], v[136:139], v[180:183]
    s_add_u32 s42, s42, 16384
    v_exp_f32 v44, v44
    v_exp_f32 v45, v45
    v_cvt_pk_bf16_f32 v132, v40, v41
    v_cvt_pk_bf16_f32 v133, v42, v43
    v_mfma_f32_16x16x32_bf16 v[180:183], v[184:187], v[140:143], v[180:183]
    s_waitcnt lgkmcnt(0)
    v_exp_f32 v46, v46
    v_exp_f32 v47, v47
    v_cvt_pk_bf16_f32 v134, v44, v45
    v_cvt_pk_bf16_f32 v135, v46, v47
    v_mfma_f32_32x32x16_bf16 v[32:47], v[144:147], a[96:99], v[64:79]
    s_and_b32 s42, s42, 0x3ffff
    v_exp_f32 v48, v48
    v_exp_f32 v49, v49
    v_exp_f32 v50, v50
    v_cvt_pk_bf16_f32 v136, v48, v49
    v_mfma_f32_32x32x16_bf16 v[32:47], v[148:151], a[100:103], v[32:47]
    v_exp_f32 v51, v51
    v_exp_f32 v52, v52
    v_exp_f32 v53, v53
    v_cvt_pk_bf16_f32 v137, v50, v51
    v_mfma_f32_32x32x16_bf16 v[96:111], v[168:171], v[128:131], v[96:111]
    ds_read_b128 v[152:155], v25 offset:28672
    v_exp_f32 v54, v54
    v_exp_f32 v55, v55
    v_exp_f32 v56, v56
    v_cvt_pk_bf16_f32 v138, v52, v53
    v_mfma_f32_32x32x16_bf16 v[96:111], v[172:175], v[132:135], v[96:111]
    ds_read_b128 v[156:159], v25 offset:29184
    v_exp_f32 v57, v57
    v_exp_f32 v58, v58
    v_exp_f32 v59, v59
    v_cvt_pk_bf16_f32 v139, v54, v55
    v_mfma_f32_16x16x32_bf16 v[176:179], v[184:187], v[128:131], v[176:179]
    ds_read_b128 v[160:163], v24 offset:26624
    v_exp_f32 v60, v60
    v_exp_f32 v61, v61
    v_cvt_pk_bf16_f32 v140, v56, v57
    v_cvt_pk_bf16_f32 v141, v58, v59
    v_mfma_f32_16x16x32_bf16 v[176:179], v[184:187], v[132:135], v[176:179]
    ds_read_b128 v[164:167], v24 offset:27136
    v_exp_f32 v62, v62
    v_exp_f32 v63, v63
    v_cvt_pk_bf16_f32 v142, v60, v61
    v_cvt_pk_bf16_f32 v143, v62, v63
    v_mfma_f32_32x32x16_bf16 v[48:63], v[144:147], a[104:107], v[80:95]
    v_exp_f32 v32, v32
    v_exp_f32 v33, v33
    v_exp_f32 v34, v34
    v_cvt_pk_bf16_f32 v128, v32, v33
    v_mfma_f32_32x32x16_bf16 v[48:63], v[148:151], a[108:111], v[48:63]
    v_exp_f32 v35, v35
    v_exp_f32 v36, v36
    v_exp_f32 v37, v37
    v_cvt_pk_bf16_f32 v129, v34, v35
    v_mfma_f32_32x32x16_bf16 v[112:127], v[168:171], v[136:139], v[112:127]
    v_exp_f32 v38, v38
    v_exp_f32 v39, v39
    v_exp_f32 v40, v40
    v_cvt_pk_bf16_f32 v130, v36, v37
    v_mfma_f32_32x32x16_bf16 v[112:127], v[172:175], v[140:143], v[112:127]
    v_lshl_add_u32 v191, v12, 4, v191
    v_exp_f32 v41, v41
    v_exp_f32 v42, v42
    v_exp_f32 v43, v43
    v_cvt_pk_bf16_f32 v131, v38, v39
    v_mfma_f32_16x16x32_bf16 v[180:183], v[184:187], v[136:139], v[180:183]
    s_lshl_b32 s68, s52, 2
    v_exp_f32 v44, v44
    v_exp_f32 v45, v45
    v_cvt_pk_bf16_f32 v132, v40, v41
    v_cvt_pk_bf16_f32 v133, v42, v43
    v_mfma_f32_16x16x32_bf16 v[180:183], v[184:187], v[140:143], v[180:183]
    s_waitcnt lgkmcnt(0)
    v_exp_f32 v46, v46
    v_exp_f32 v47, v47
    v_cvt_pk_bf16_f32 v134, v44, v45
    v_cvt_pk_bf16_f32 v135, v46, v47
    v_mfma_f32_32x32x16_bf16 v[32:47], v[152:155], a[96:99], v[64:79]
    s_add_u32 s68, s68, s46
    v_exp_f32 v48, v48
    v_exp_f32 v49, v49
    v_exp_f32 v50, v50
    v_cvt_pk_bf16_f32 v136, v48, v49
    v_mfma_f32_32x32x16_bf16 v[32:47], v[156:159], a[100:103], v[32:47]
    s_lshl_b32 s68, s68, 16
    v_exp_f32 v51, v51
    v_exp_f32 v52, v52
    v_exp_f32 v53, v53
    v_cvt_pk_bf16_f32 v137, v50, v51
    v_mfma_f32_32x32x16_bf16 v[96:111], v[160:163], v[128:131], v[96:111]
    ds_read_b128 v[144:147], v25 offset:32768
    v_exp_f32 v54, v54
    v_exp_f32 v55, v55
    v_exp_f32 v56, v56
    v_cvt_pk_bf16_f32 v138, v52, v53
    v_mfma_f32_32x32x16_bf16 v[96:111], v[164:167], v[132:135], v[96:111]
    ds_read_b128 v[148:151], v25 offset:33280
    v_exp_f32 v57, v57
    v_exp_f32 v58, v58
    v_exp_f32 v59, v59
    v_cvt_pk_bf16_f32 v139, v54, v55
    v_mfma_f32_16x16x32_bf16 v[176:179], v[184:187], v[128:131], v[176:179]
    ds_read_b128 v[168:171], v24 offset:30720
    v_exp_f32 v60, v60
    v_exp_f32 v61, v61
    v_cvt_pk_bf16_f32 v140, v56, v57
    v_cvt_pk_bf16_f32 v141, v58, v59
    v_mfma_f32_16x16x32_bf16 v[176:179], v[184:187], v[132:135], v[176:179]
    ds_read_b128 v[172:175], v24 offset:31232
    v_exp_f32 v62, v62
    v_exp_f32 v63, v63
    v_cvt_pk_bf16_f32 v142, v60, v61
    v_cvt_pk_bf16_f32 v143, v62, v63
    v_mfma_f32_32x32x16_bf16 v[48:63], v[152:155], a[104:107], v[80:95]
    s_lshl_b32 s33, s53, 7
    v_exp_f32 v32, v32
    v_exp_f32 v33, v33
    v_exp_f32 v34, v34
    v_cvt_pk_bf16_f32 v128, v32, v33
    v_mfma_f32_32x32x16_bf16 v[48:63], v[156:159], a[108:111], v[48:63]
    s_add_u32 s68, s68, s33
    v_exp_f32 v35, v35
    v_exp_f32 v36, v36
    v_exp_f32 v37, v37
    v_cvt_pk_bf16_f32 v129, v34, v35
    v_mfma_f32_32x32x16_bf16 v[112:127], v[160:163], v[136:139], v[112:127]
    s_add_u32 s69, s68, 32768
    v_exp_f32 v38, v38
    v_exp_f32 v39, v39
    v_exp_f32 v40, v40
    v_cvt_pk_bf16_f32 v130, v36, v37
    v_mfma_f32_32x32x16_bf16 v[112:127], v[164:167], v[140:143], v[112:127]
    buffer_load_dwordx4 a[224:227], v191, s[20:23], s68 offen offset:0
    v_exp_f32 v41, v41
    v_exp_f32 v42, v42
    v_exp_f32 v43, v43
    v_cvt_pk_bf16_f32 v131, v38, v39
    v_mfma_f32_16x16x32_bf16 v[180:183], v[184:187], v[136:139], v[180:183]
    buffer_load_dwordx4 a[228:231], v191, s[20:23], s69 offen offset:0
    v_exp_f32 v44, v44
    v_exp_f32 v45, v45
    v_cvt_pk_bf16_f32 v132, v40, v41
    v_cvt_pk_bf16_f32 v133, v42, v43
    v_mfma_f32_16x16x32_bf16 v[180:183], v[184:187], v[140:143], v[180:183]
    s_waitcnt lgkmcnt(0)
    v_exp_f32 v46, v46
    v_exp_f32 v47, v47
    v_cvt_pk_bf16_f32 v134, v44, v45
    v_cvt_pk_bf16_f32 v135, v46, v47
    v_mfma_f32_32x32x16_bf16 v[32:47], v[144:147], a[96:99], v[64:79]
    buffer_load_dwordx4 a[232:235], v191, s[20:23], s68 offen offset:64
    v_exp_f32 v48, v48
    v_exp_f32 v49, v49
    v_exp_f32 v50, v50
    v_cvt_pk_bf16_f32 v136, v48, v49
    v_mfma_f32_32x32x16_bf16 v[32:47], v[148:151], a[100:103], v[32:47]
    buffer_load_dwordx4 a[236:239], v191, s[20:23], s69 offen offset:64
    v_exp_f32 v51, v51
    v_exp_f32 v52, v52
    v_exp_f32 v53, v53
    v_cvt_pk_bf16_f32 v137, v50, v51
    v_mfma_f32_32x32x16_bf16 v[96:111], v[168:171], v[128:131], v[96:111]
    ds_read_b128 v[152:155], v25 offset:36864
    v_exp_f32 v54, v54
    v_exp_f32 v55, v55
    v_exp_f32 v56, v56
    v_cvt_pk_bf16_f32 v138, v52, v53
    v_mfma_f32_32x32x16_bf16 v[96:111], v[172:175], v[132:135], v[96:111]
    ds_read_b128 v[156:159], v25 offset:37376
    v_exp_f32 v57, v57
    v_exp_f32 v58, v58
    v_exp_f32 v59, v59
    v_cvt_pk_bf16_f32 v139, v54, v55
    v_mfma_f32_16x16x32_bf16 v[176:179], v[184:187], v[128:131], v[176:179]
    ds_read_b128 v[160:163], v24 offset:34816
    v_exp_f32 v60, v60
    v_exp_f32 v61, v61
    v_cvt_pk_bf16_f32 v140, v56, v57
    v_cvt_pk_bf16_f32 v141, v58, v59
    v_mfma_f32_16x16x32_bf16 v[176:179], v[184:187], v[132:135], v[176:179]
    ds_read_b128 v[164:167], v24 offset:35328
    v_exp_f32 v62, v62
    v_exp_f32 v63, v63
    v_cvt_pk_bf16_f32 v142, v60, v61
    v_cvt_pk_bf16_f32 v143, v62, v63
    v_mfma_f32_32x32x16_bf16 v[48:63], v[144:147], a[104:107], v[80:95]
    v_exp_f32 v32, v32
    v_exp_f32 v33, v33
    v_exp_f32 v34, v34
    v_cvt_pk_bf16_f32 v128, v32, v33
    v_mfma_f32_32x32x16_bf16 v[48:63], v[148:151], a[108:111], v[48:63]
    v_exp_f32 v35, v35
    v_exp_f32 v36, v36
    v_exp_f32 v37, v37
    v_cvt_pk_bf16_f32 v129, v34, v35
    v_mfma_f32_32x32x16_bf16 v[112:127], v[168:171], v[136:139], v[112:127]
    v_exp_f32 v38, v38
    v_exp_f32 v39, v39
    v_exp_f32 v40, v40
    v_cvt_pk_bf16_f32 v130, v36, v37
    v_mfma_f32_32x32x16_bf16 v[112:127], v[172:175], v[140:143], v[112:127]
    v_exp_f32 v41, v41
    v_exp_f32 v42, v42
    v_exp_f32 v43, v43
    v_cvt_pk_bf16_f32 v131, v38, v39
    v_mfma_f32_16x16x32_bf16 v[180:183], v[184:187], v[136:139], v[180:183]
    v_exp_f32 v44, v44
    v_exp_f32 v45, v45
    v_cvt_pk_bf16_f32 v132, v40, v41
    v_cvt_pk_bf16_f32 v133, v42, v43
    v_mfma_f32_16x16x32_bf16 v[180:183], v[184:187], v[140:143], v[180:183]
    s_waitcnt lgkmcnt(0)
    v_exp_f32 v46, v46
    v_exp_f32 v47, v47
    v_cvt_pk_bf16_f32 v134, v44, v45
    v_cvt_pk_bf16_f32 v135, v46, v47
    v_mfma_f32_32x32x16_bf16 v[32:47], v[152:155], a[96:99], v[64:79]
    s_add_u32 m0, s45, 114688
    v_exp_f32 v48, v48
    v_exp_f32 v49, v49
    v_exp_f32 v50, v50
    v_cvt_pk_bf16_f32 v136, v48, v49
    v_mfma_f32_32x32x16_bf16 v[32:47], v[156:159], a[100:103], v[32:47]
    s_add_u32 s43, s59, s42
    v_exp_f32 v51, v51
    v_exp_f32 v52, v52
    v_exp_f32 v53, v53
    v_cvt_pk_bf16_f32 v137, v50, v51
    v_mfma_f32_32x32x16_bf16 v[96:111], v[160:163], v[128:131], v[96:111]
    ds_read_b128 v[144:147], v25 offset:40960
    v_exp_f32 v54, v54
    v_exp_f32 v55, v55
    v_exp_f32 v56, v56
    v_cvt_pk_bf16_f32 v138, v52, v53
    v_mfma_f32_32x32x16_bf16 v[96:111], v[164:167], v[132:135], v[96:111]
    ds_read_b128 v[148:151], v25 offset:41472
    v_exp_f32 v57, v57
    v_exp_f32 v58, v58
    v_exp_f32 v59, v59
    v_cvt_pk_bf16_f32 v139, v54, v55
    v_mfma_f32_16x16x32_bf16 v[176:179], v[184:187], v[128:131], v[176:179]
    ds_read_b128 v[168:171], v24 offset:38912
    v_exp_f32 v60, v60
    v_exp_f32 v61, v61
    v_cvt_pk_bf16_f32 v140, v56, v57
    v_cvt_pk_bf16_f32 v141, v58, v59
    v_mfma_f32_16x16x32_bf16 v[176:179], v[184:187], v[132:135], v[176:179]
    ds_read_b128 v[172:175], v24 offset:39424
    v_exp_f32 v62, v62
    v_exp_f32 v63, v63
    v_cvt_pk_bf16_f32 v142, v60, v61
    v_cvt_pk_bf16_f32 v143, v62, v63
    v_mfma_f32_32x32x16_bf16 v[48:63], v[152:155], a[104:107], v[80:95]
    buffer_load_dwordx4 v1, s[4:7], s43 offen offset:0 sc1 lds
    v_exp_f32 v32, v32
    v_exp_f32 v33, v33
    v_exp_f32 v34, v34
    v_cvt_pk_bf16_f32 v128, v32, v33
    v_mfma_f32_32x32x16_bf16 v[48:63], v[156:159], a[108:111], v[48:63]
    buffer_load_dwordx4 v1, s[4:7], s43 offen offset:1024 sc1 lds
    v_exp_f32 v35, v35
    v_exp_f32 v36, v36
    v_exp_f32 v37, v37
    v_cvt_pk_bf16_f32 v129, v34, v35
    v_mfma_f32_32x32x16_bf16 v[112:127], v[160:163], v[136:139], v[112:127]
    buffer_load_dwordx4 v1, s[4:7], s43 offen offset:2048 sc1 lds
    v_exp_f32 v38, v38
    v_exp_f32 v39, v39
    v_exp_f32 v40, v40
    v_cvt_pk_bf16_f32 v130, v36, v37
    v_mfma_f32_32x32x16_bf16 v[112:127], v[164:167], v[140:143], v[112:127]
    buffer_load_dwordx4 v1, s[4:7], s43 offen offset:3072 sc1 lds
    v_exp_f32 v41, v41
    v_exp_f32 v42, v42
    v_exp_f32 v43, v43
    v_cvt_pk_bf16_f32 v131, v38, v39
    v_mfma_f32_16x16x32_bf16 v[180:183], v[184:187], v[136:139], v[180:183]
    s_add_u32 s42, s42, 16384
    v_exp_f32 v44, v44
    v_exp_f32 v45, v45
    v_cvt_pk_bf16_f32 v132, v40, v41
    v_cvt_pk_bf16_f32 v133, v42, v43
    v_mfma_f32_16x16x32_bf16 v[180:183], v[184:187], v[140:143], v[180:183]
    s_waitcnt lgkmcnt(0)
    v_exp_f32 v46, v46
    v_exp_f32 v47, v47
    v_cvt_pk_bf16_f32 v134, v44, v45
    v_cvt_pk_bf16_f32 v135, v46, v47
    v_mfma_f32_32x32x16_bf16 v[32:47], v[144:147], a[96:99], v[64:79]
    s_and_b32 s42, s42, 0x3ffff
    v_exp_f32 v48, v48
    v_exp_f32 v49, v49
    v_exp_f32 v50, v50
    v_cvt_pk_bf16_f32 v136, v48, v49
    v_mfma_f32_32x32x16_bf16 v[32:47], v[148:151], a[100:103], v[32:47]
    v_exp_f32 v51, v51
    v_exp_f32 v52, v52
    v_exp_f32 v53, v53
    v_cvt_pk_bf16_f32 v137, v50, v51
    v_mfma_f32_32x32x16_bf16 v[96:111], v[168:171], v[128:131], v[96:111]
    ds_read_b128 v[152:155], v25 offset:45056
    v_exp_f32 v54, v54
    v_exp_f32 v55, v55
    v_exp_f32 v56, v56
    v_cvt_pk_bf16_f32 v138, v52, v53
    v_mfma_f32_32x32x16_bf16 v[96:111], v[172:175], v[132:135], v[96:111]
    ds_read_b128 v[156:159], v25 offset:45568
    v_exp_f32 v57, v57
    v_exp_f32 v58, v58
    v_exp_f32 v59, v59
    v_cvt_pk_bf16_f32 v139, v54, v55
    v_mfma_f32_16x16x32_bf16 v[176:179], v[184:187], v[128:131], v[176:179]
    ds_read_b128 v[160:163], v24 offset:43008
    v_exp_f32 v60, v60
    v_exp_f32 v61, v61
    v_cvt_pk_bf16_f32 v140, v56, v57
    v_cvt_pk_bf16_f32 v141, v58, v59
    v_mfma_f32_16x16x32_bf16 v[176:179], v[184:187], v[132:135], v[176:179]
    ds_read_b128 v[164:167], v24 offset:43520
    v_exp_f32 v62, v62
    v_exp_f32 v63, v63
    v_cvt_pk_bf16_f32 v142, v60, v61
    v_cvt_pk_bf16_f32 v143, v62, v63
    v_mfma_f32_32x32x16_bf16 v[48:63], v[144:147], a[104:107], v[80:95]
    v_exp_f32 v32, v32
    v_exp_f32 v33, v33
    v_exp_f32 v34, v34
    v_cvt_pk_bf16_f32 v128, v32, v33
    v_mfma_f32_32x32x16_bf16 v[48:63], v[148:151], a[108:111], v[48:63]
    v_exp_f32 v35, v35
    v_exp_f32 v36, v36
    v_exp_f32 v37, v37
    v_cvt_pk_bf16_f32 v129, v34, v35
    v_mfma_f32_32x32x16_bf16 v[112:127], v[168:171], v[136:139], v[112:127]
    v_exp_f32 v38, v38
    v_exp_f32 v39, v39
    v_exp_f32 v40, v40
    v_cvt_pk_bf16_f32 v130, v36, v37
    v_mfma_f32_32x32x16_bf16 v[112:127], v[172:175], v[140:143], v[112:127]
    s_getpc_b64 s[34:35]
L_pc5:
    v_exp_f32 v41, v41
    v_exp_f32 v42, v42
    v_exp_f32 v43, v43
    v_cvt_pk_bf16_f32 v131, v38, v39
    v_mfma_f32_16x16x32_bf16 v[180:183], v[184:187], v[136:139], v[180:183]
    s_add_u32 s34, s34, L_at_after-L_pc5
    s_addc_u32 s35, s35, 0
    v_exp_f32 v44, v44
    v_exp_f32 v45, v45
    v_cvt_pk_bf16_f32 v132, v40, v41
    v_cvt_pk_bf16_f32 v133, v42, v43
    v_mfma_f32_16x16x32_bf16 v[180:183], v[184:187], v[140:143], v[180:183]
    s_waitcnt vmcnt(20) lgkmcnt(0)
    s_barrier
    v_exp_f32 v46, v46
    v_exp_f32 v47, v47
    v_cvt_pk_bf16_f32 v134, v44, v45
    v_cvt_pk_bf16_f32 v135, v46, v47
    v_mfma_f32_32x32x16_bf16 v[32:47], v[152:155], a[96:99], v[64:79]
    s_lshr_b32 s3, s2, 3
    v_exp_f32 v48, v48
    v_exp_f32 v49, v49
    v_exp_f32 v50, v50
    v_cvt_pk_bf16_f32 v136, v48, v49
    v_mfma_f32_32x32x16_bf16 v[32:47], v[156:159], a[100:103], v[32:47]
    s_lshl_b32 s3, s3, 2
    v_exp_f32 v51, v51
    v_exp_f32 v52, v52
    v_exp_f32 v53, v53
    v_cvt_pk_bf16_f32 v137, v50, v51
    v_mfma_f32_32x32x16_bf16 v[96:111], v[160:163], v[128:131], v[96:111]
    ds_read_b128 v[144:147], v25 offset:49152
    v_exp_f32 v54, v54
    v_exp_f32 v55, v55
    v_exp_f32 v56, v56
    v_cvt_pk_bf16_f32 v138, v52, v53
    v_mfma_f32_32x32x16_bf16 v[96:111], v[164:167], v[132:135], v[96:111]
    ds_read_b128 v[148:151], v25 offset:49664
    v_exp_f32 v57, v57
    v_exp_f32 v58, v58
    v_exp_f32 v59, v59
    v_cvt_pk_bf16_f32 v139, v54, v55
    v_mfma_f32_16x16x32_bf16 v[176:179], v[184:187], v[128:131], v[176:179]
    ds_read_b128 v[168:171], v24 offset:47104
    v_exp_f32 v60, v60
    v_exp_f32 v61, v61
    v_cvt_pk_bf16_f32 v140, v56, v57
    v_cvt_pk_bf16_f32 v141, v58, v59
    v_mfma_f32_16x16x32_bf16 v[176:179], v[184:187], v[132:135], v[176:179]
    ds_read_b128 v[172:175], v24 offset:47616
    v_exp_f32 v62, v62
    v_exp_f32 v63, v63
    v_cvt_pk_bf16_f32 v142, v60, v61
    v_cvt_pk_bf16_f32 v143, v62, v63
    v_mfma_f32_32x32x16_bf16 v[48:63], v[152:155], a[104:107], v[80:95]
    s_add_u32 s3, s3, s46
    v_exp_f32 v32, v32
    v_exp_f32 v33, v33
    v_exp_f32 v34, v34
    v_cvt_pk_bf16_f32 v128, v32, v33
    v_mfma_f32_32x32x16_bf16 v[48:63], v[156:159], a[108:111], v[48:63]
    s_mul_i32 s3, s3, 512
    v_exp_f32 v35, v35
    v_exp_f32 v36, v36
    v_exp_f32 v37, v37
    v_cvt_pk_bf16_f32 v129, v34, v35
    v_mfma_f32_32x32x16_bf16 v[112:127], v[160:163], v[136:139], v[112:127]
    v_lshlrev_b32 v16, 3, v1
    v_exp_f32 v38, v38
    v_exp_f32 v39, v39
    v_exp_f32 v40, v40
    v_cvt_pk_bf16_f32 v130, v36, v37
    v_mfma_f32_32x32x16_bf16 v[112:127], v[164:167], v[140:143], v[112:127]
    v_and_b32 v16, 511, v16
    v_exp_f32 v41, v41
    v_exp_f32 v42, v42
    v_exp_f32 v43, v43
    v_cvt_pk_bf16_f32 v131, v38, v39
    v_mfma_f32_16x16x32_bf16 v[180:183], v[184:187], v[136:139], v[180:183]
    v_add_u32 v16, s3, v16
    v_exp_f32 v44, v44
    v_exp_f32 v45, v45
    v_cvt_pk_bf16_f32 v132, v40, v41
    v_cvt_pk_bf16_f32 v133, v42, v43
    v_mfma_f32_16x16x32_bf16 v[180:183], v[184:187], v[140:143], v[180:183]
    s_waitcnt lgkmcnt(0)
    v_exp_f32 v46, v46
    v_exp_f32 v47, v47
    v_cvt_pk_bf16_f32 v134, v44, v45
    v_cvt_pk_bf16_f32 v135, v46, v47
    v_mfma_f32_32x32x16_bf16 v[32:47], v[144:147], a[96:99], v[64:79]
    v_min_u32 v16, L_end-L_at_after, v16
    v_exp_f32 v48, v48
    v_exp_f32 v49, v49
    v_exp_f32 v50, v50
    v_cvt_pk_bf16_f32 v136, v48, v49
    v_mfma_f32_32x32x16_bf16 v[32:47], v[148:151], a[100:103], v[32:47]
    global_load_dword v17, v16, s[34:35]
    v_exp_f32 v51, v51
    v_exp_f32 v52, v52
    v_exp_f32 v53, v53
    v_cvt_pk_bf16_f32 v137, v50, v51
    v_mfma_f32_32x32x16_bf16 v[96:111], v[168:171], v[128:131], v[96:111]
    ds_read_b128 v[152:155], v25 offset:53248
    v_exp_f32 v54, v54
    v_exp_f32 v55, v55
    v_exp_f32 v56, v56
    v_cvt_pk_bf16_f32 v138, v52, v53
    v_mfma_f32_32x32x16_bf16 v[96:111], v[172:175], v[132:135], v[96:111]
    ds_read_b128 v[156:159], v25 offset:53760
    v_exp_f32 v57, v57
    v_exp_f32 v58, v58
    v_exp_f32 v59, v59
    v_cvt_pk_bf16_f32 v139, v54, v55
    v_mfma_f32_16x16x32_bf16 v[176:179], v[184:187], v[128:131], v[176:179]
    ds_read_b128 v[160:163], v24 offset:51200
    v_exp_f32 v60, v60
    v_exp_f32 v61, v61
    v_cvt_pk_bf16_f32 v140, v56, v57
    v_cvt_pk_bf16_f32 v141, v58, v59
    v_mfma_f32_16x16x32_bf16 v[176:179], v[184:187], v[132:135], v[176:179]
    ds_read_b128 v[164:167], v24 offset:51712
    v_exp_f32 v62, v62
    v_exp_f32 v63, v63
    v_cvt_pk_bf16_f32 v142, v60, v61
    v_cvt_pk_bf16_f32 v143, v62, v63
    v_mfma_f32_32x32x16_bf16 v[48:63], v[144:147], a[104:107], v[80:95]
    buffer_load_dword v5, v4, s[4:7], s65 offen sc1
    v_exp_f32 v32, v32
    v_exp_f32 v33, v33
    v_exp_f32 v34, v34
    v_cvt_pk_bf16_f32 v128, v32, v33
    v_mfma_f32_32x32x16_bf16 v[48:63], v[148:151], a[108:111], v[48:63]
    s_lshl_b32 s3, s24, 3
    v_exp_f32 v35, v35
    v_exp_f32 v36, v36
    v_exp_f32 v37, v37
    v_cvt_pk_bf16_f32 v129, v34, v35
    v_mfma_f32_32x32x16_bf16 v[112:127], v[168:171], v[136:139], v[112:127]
    s_add_u32 m0, s49, 0
    v_exp_f32 v38, v38
    v_exp_f32 v39, v39
    v_exp_f32 v40, v40
    v_cvt_pk_bf16_f32 v130, v36, v37
    v_mfma_f32_32x32x16_bf16 v[112:127], v[172:175], v[140:143], v[112:127]
    v_exp_f32 v41, v41
    v_exp_f32 v42, v42
    v_exp_f32 v43, v43
    v_cvt_pk_bf16_f32 v131, v38, v39
    v_mfma_f32_16x16x32_bf16 v[180:183], v[184:187], v[136:139], v[180:183]
    s_add_u32 s41, s50, s3
    v_exp_f32 v44, v44
    v_exp_f32 v45, v45
    v_cvt_pk_bf16_f32 v132, v40, v41
    v_cvt_pk_bf16_f32 v133, v42, v43
    v_mfma_f32_16x16x32_bf16 v[180:183], v[184:187], v[140:143], v[180:183]
    s_waitcnt lgkmcnt(0)
    v_exp_f32 v46, v46
    v_exp_f32 v47, v47
    v_cvt_pk_bf16_f32 v134, v44, v45
    v_cvt_pk_bf16_f32 v135, v46, v47
    v_mfma_f32_32x32x16_bf16 v[32:47], v[152:155], a[96:99], v[64:79]
    buffer_load_dwordx4 v188, s[8:11], s41 offen  lds
    v_exp_f32 v48, v48
    v_exp_f32 v49, v49
    v_exp_f32 v50, v50
    v_cvt_pk_bf16_f32 v136, v48, v49
    v_mfma_f32_32x32x16_bf16 v[32:47], v[156:159], a[100:103], v[32:47]
    buffer_load_dwordx4 v190, s[8:11], s41 offen offset:1024  lds
    v_exp_f32 v51, v51
    v_exp_f32 v52, v52
    v_exp_f32 v53, v53
    v_cvt_pk_bf16_f32 v137, v50, v51
    v_mfma_f32_32x32x16_bf16 v[96:111], v[160:163], v[128:131], v[96:111]
    ds_read_b128 v[144:147], v25 offset:57344
    v_exp_f32 v54, v54
    v_exp_f32 v55, v55
    v_exp_f32 v56, v56
    v_cvt_pk_bf16_f32 v138, v52, v53
    v_mfma_f32_32x32x16_bf16 v[96:111], v[164:167], v[132:135], v[96:111]
    ds_read_b128 v[148:151], v25 offset:57856
    v_exp_f32 v57, v57
    v_exp_f32 v58, v58
    v_exp_f32 v59, v59
    v_cvt_pk_bf16_f32 v139, v54, v55
    v_mfma_f32_16x16x32_bf16 v[176:179], v[184:187], v[128:131], v[176:179]
    ds_read_b128 v[168:171], v24 offset:55296
    v_exp_f32 v60, v60
    v_exp_f32 v61, v61
    v_cvt_pk_bf16_f32 v140, v56, v57
    v_cvt_pk_bf16_f32 v141, v58, v59
    v_mfma_f32_16x16x32_bf16 v[176:179], v[184:187], v[132:135], v[176:179]
    ds_read_b128 v[172:175], v24 offset:55808
    v_exp_f32 v62, v62
    v_exp_f32 v63, v63
    v_cvt_pk_bf16_f32 v142, v60, v61
    v_cvt_pk_bf16_f32 v143, v62, v63
    v_mfma_f32_32x32x16_bf16 v[48:63], v[152:155], a[104:107], v[80:95]
    v_exp_f32 v32, v32
    v_exp_f32 v33, v33
    v_exp_f32 v34, v34
    v_cvt_pk_bf16_f32 v128, v32, v33
    v_mfma_f32_32x32x16_bf16 v[48:63], v[156:159], a[108:111], v[48:63]
    s_lshl_b32 s3, s25, 3
    v_exp_f32 v35, v35
    v_exp_f32 v36, v36
    v_exp_f32 v37, v37
    v_cvt_pk_bf16_f32 v129, v34, v35
    v_mfma_f32_32x32x16_bf16 v[112:127], v[160:163], v[136:139], v[112:127]
    s_add_u32 m0, s49, 8192
    v_exp_f32 v38, v38
    v_exp_f32 v39, v39
    v_exp_f32 v40, v40
    v_cvt_pk_bf16_f32 v130, v36, v37
    v_mfma_f32_32x32x16_bf16 v[112:127], v[164:167], v[140:143], v[112:127]
    s_add_u32 s41, s50, s3
    v_exp_f32 v41, v41
    v_exp_f32 v42, v42
    v_exp_f32 v43, v43
    v_cvt_pk_bf16_f32 v131, v38, v39
    v_mfma_f32_16x16x32_bf16 v[180:183], v[184:187], v[136:139], v[180:183]
    v_exp_f32 v44, v44
    v_exp_f32 v45, v45
    v_cvt_pk_bf16_f32 v132, v40, v41
    v_cvt_pk_bf16_f32 v133, v42, v43
    v_mfma_f32_16x16x32_bf16 v[180:183], v[184:187], v[140:143], v[180:183]
    s_waitcnt lgkmcnt(0)
    v_exp_f32 v46, v46
    v_exp_f32 v47, v47
    v_cvt_pk_bf16_f32 v134, v44, v45
    v_cvt_pk_bf16_f32 v135, v46, v47
    v_mfma_f32_32x32x16_bf16 v[32:47], v[144:147], a[96:99], v[64:79]
    buffer_load_dwordx4 v188, s[8:11], s41 offen  lds
    v_exp_f32 v48, v48
    v_exp_f32 v49, v49
    v_exp_f32 v50, v50
    v_cvt_pk_bf16_f32 v136, v48, v49
    v_mfma_f32_32x32x16_bf16 v[32:47], v[148:151], a[100:103], v[32:47]
    buffer_load_dwordx4 v190, s[8:11], s41 offen offset:1024  lds
    v_exp_f32 v51, v51
    v_exp_f32 v52, v52
    v_exp_f32 v53, v53
    v_cvt_pk_bf16_f32 v137, v50, v51
    v_mfma_f32_32x32x16_bf16 v[96:111], v[168:171], v[128:131], v[96:111]
    ds_read_b128 v[152:155], v25 offset:61440
    v_exp_f32 v54, v54
    v_exp_f32 v55, v55
    v_exp_f32 v56, v56
    v_cvt_pk_bf16_f32 v138, v52, v53
    v_mfma_f32_32x32x16_bf16 v[96:111], v[172:175], v[132:135], v[96:111]
    ds_read_b128 v[156:159], v25 offset:61952
    v_exp_f32 v57, v57
    v_exp_f32 v58, v58
    v_exp_f32 v59, v59
    v_cvt_pk_bf16_f32 v139, v54, v55
    v_mfma_f32_16x16x32_bf16 v[176:179], v[184:187], v[128:131], v[176:179]
    ds_read_b128 v[160:163], v24 offset:59392
    v_exp_f32 v60, v60
    v_exp_f32 v61, v61
    v_cvt_pk_bf16_f32 v140, v56, v57
    v_cvt_pk_bf16_f32 v141, v58, v59
    v_mfma_f32_16x16x32_bf16 v[176:179], v[184:187], v[132:135], v[176:179]
    ds_read_b128 v[164:167], v24 offset:59904
    v_exp_f32 v62, v62
    v_exp_f32 v63, v63
    v_cvt_pk_bf16_f32 v142, v60, v61
    v_cvt_pk_bf16_f32 v143, v62, v63
    v_mfma_f32_32x32x16_bf16 v[48:63], v[144:147], a[104:107], v[80:95]
    s_lshl_b32 s3, s26, 3
    v_exp_f32 v32, v32
    v_exp_f32 v33, v33
    v_exp_f32 v34, v34
    v_cvt_pk_bf16_f32 v128, v32, v33
    v_mfma_f32_32x32x16_bf16 v[48:63], v[148:151], a[108:111], v[48:63]
    v_exp_f32 v35, v35
    v_exp_f32 v36, v36
    v_exp_f32 v37, v37
    v_cvt_pk_bf16_f32 v129, v34, v35
    v_mfma_f32_32x32x16_bf16 v[112:127], v[168:171], v[136:139], v[112:127]
    s_add_u32 m0, s49, 16384
    v_exp_f32 v38, v38
    v_exp_f32 v39, v39
    v_exp_f32 v40, v40
    v_cvt_pk_bf16_f32 v130, v36, v37
    v_mfma_f32_32x32x16_bf16 v[112:127], v[172:175], v[140:143], v[112:127]
    s_add_u32 s41, s50, s3
    v_exp_f32 v41, v41
    v_exp_f32 v42, v42
    v_exp_f32 v43, v43
    v_cvt_pk_bf16_f32 v131, v38, v39
    v_mfma_f32_16x16x32_bf16 v[180:183], v[184:187], v[136:139], v[180:183]
    buffer_load_dwordx4 v188, s[8:11], s41 offen  lds
    v_exp_f32 v44, v44
    v_exp_f32 v45, v45
    v_cvt_pk_bf16_f32 v132, v40, v41
    v_cvt_pk_bf16_f32 v133, v42, v43
    v_mfma_f32_16x16x32_bf16 v[180:183], v[184:187], v[140:143], v[180:183]
    s_waitcnt vmcnt(5) lgkmcnt(0)
    s_barrier
    v_cmp_ne_u32 vcc, s72, v5
    s_cmp_lg_u64 vcc, 0
    s_cbranch_scc1 L_at_spin
L_at_spinback:
    v_exp_f32 v46, v46
    v_exp_f32 v47, v47
    v_cvt_pk_bf16_f32 v134, v44, v45
    v_cvt_pk_bf16_f32 v135, v46, v47
    v_mfma_f32_32x32x16_bf16 v[32:47], v[152:155], a[96:99], v[64:79]
    v_exp_f32 v48, v48
    v_exp_f32 v49, v49
    v_exp_f32 v50, v50
    v_cvt_pk_bf16_f32 v136, v48, v49
    v_mfma_f32_32x32x16_bf16 v[32:47], v[156:159], a[100:103], v[32:47]
    buffer_load_dwordx4 v190, s[8:11], s41 offen offset:1024  lds
    v_exp_f32 v51, v51
    v_exp_f32 v52, v52
    v_exp_f32 v53, v53
    v_cvt_pk_bf16_f32 v137, v50, v51
    v_mfma_f32_32x32x16_bf16 v[96:111], v[160:163], v[128:131], v[96:111]
    ds_read_b128 v[144:147], v9 offset:0
    v_exp_f32 v54, v54
    v_exp_f32 v55, v55
    v_exp_f32 v56, v56
    v_cvt_pk_bf16_f32 v138, v52, v53
    v_mfma_f32_32x32x16_bf16 v[96:111], v[164:167], v[132:135], v[96:111]
    ds_read_b128 v[148:151], v9 offset:512
    v_exp_f32 v57, v57
    v_exp_f32 v58, v58
    v_exp_f32 v59, v59
    v_cvt_pk_bf16_f32 v139, v54, v55
    v_mfma_f32_16x16x32_bf16 v[176:179], v[184:187], v[128:131], v[176:179]
    ds_read_b128 v[168:171], v24 offset:63488
    v_exp_f32 v60, v60
    v_exp_f32 v61, v61
    v_cvt_pk_bf16_f32 v140, v56, v57
    v_cvt_pk_bf16_f32 v141, v58, v59
    v_mfma_f32_16x16x32_bf16 v[176:179], v[184:187], v[132:135], v[176:179]
    ds_read_b128 v[172:175], v24 offset:64000
    v_exp_f32 v62, v62
    v_exp_f32 v63, v63
    v_cvt_pk_bf16_f32 v142, v60, v61
    v_cvt_pk_bf16_f32 v143, v62, v63
    v_mfma_f32_32x32x16_bf16 v[48:63], v[152:155], a[104:107], v[80:95]
    s_lshl_b32 s3, s27, 3
    v_exp_f32 v32, v32
    v_exp_f32 v33, v33
    v_exp_f32 v34, v34
    v_cvt_pk_bf16_f32 v128, v32, v33
    v_mfma_f32_32x32x16_bf16 v[48:63], v[156:159], a[108:111], v[48:63]
    s_add_u32 m0, s49, 24576
    v_exp_f32 v35, v35
    v_exp_f32 v36, v36
    v_exp_f32 v37, v37
    v_cvt_pk_bf16_f32 v129, v34, v35
    v_mfma_f32_32x32x16_bf16 v[112:127], v[160:163], v[136:139], v[112:127]
    v_exp_f32 v38, v38
    v_exp_f32 v39, v39
    v_exp_f32 v40, v40
    v_cvt_pk_bf16_f32 v130, v36, v37
    v_mfma_f32_32x32x16_bf16 v[112:127], v[164:167], v[140:143], v[112:127]
    s_add_u32 s41, s50, s3
    v_exp_f32 v41, v41
    v_exp_f32 v42, v42
    v_exp_f32 v43, v43
    v_cvt_pk_bf16_f32 v131, v38, v39
    v_mfma_f32_16x16x32_bf16 v[180:183], v[184:187], v[136:139], v[180:183]
    buffer_load_dwordx4 v188, s[8:11], s41 offen  lds
    v_exp_f32 v44, v44
    v_exp_f32 v45, v45
    v_cvt_pk_bf16_f32 v132, v40, v41
    v_cvt_pk_bf16_f32 v133, v42, v43
    v_mfma_f32_16x16x32_bf16 v[180:183], v[184:187], v[140:143], v[180:183]
    s_waitcnt lgkmcnt(0)
    v_exp_f32 v46, v46
    v_exp_f32 v47, v47
    v_cvt_pk_bf16_f32 v134, v44, v45
    v_cvt_pk_bf16_f32 v135, v46, v47
    v_mfma_f32_32x32x16_bf16 v[32:47], v[144:147], a[96:99], v[64:79]
    buffer_load_dwordx4 v190, s[8:11], s41 offen offset:1024  lds
    v_exp_f32 v48, v48
    v_exp_f32 v49, v49
    v_exp_f32 v50, v50
    v_cvt_pk_bf16_f32 v136, v48, v49
    v_mfma_f32_32x32x16_bf16 v[32:47], v[148:151], a[100:103], v[32:47]
    v_exp_f32 v51, v51
    v_exp_f32 v52, v52
    v_exp_f32 v53, v53
    v_cvt_pk_bf16_f32 v137, v50, v51
    v_mfma_f32_32x32x16_bf16 v[96:111], v[168:171], v[128:131], v[96:111]
    ds_read_b128 v[152:155], v9 offset:4096
    v_exp_f32 v54, v54
    v_exp_f32 v55, v55
    v_exp_f32 v56, v56
    v_cvt_pk_bf16_f32 v138, v52, v53
    v_mfma_f32_32x32x16_bf16 v[96:111], v[172:175], v[132:135], v[96:111]
    ds_read_b128 v[156:159], v9 offset:4608
    v_exp_f32 v57, v57
    v_exp_f32 v58, v58
    v_exp_f32 v59, v59
    v_cvt_pk_bf16_f32 v139, v54, v55
    v_mfma_f32_16x16x32_bf16 v[176:179], v[184:187], v[128:131], v[176:179]
    ds_read_b128 v[160:163], v8 offset:2048
    v_exp_f32 v60, v60
    v_exp_f32 v61, v61
    v_cvt_pk_bf16_f32 v140, v56, v57
    v_cvt_pk_bf16_f32 v141, v58, v59
    v_mfma_f32_16x16x32_bf16 v[176:179], v[184:187], v[132:135], v[176:179]
    ds_read_b128 v[164:167], v8 offset:2560
    v_exp_f32 v62, v62
    v_exp_f32 v63, v63
    v_cvt_pk_bf16_f32 v142, v60, v61
    v_cvt_pk_bf16_f32 v143, v62, v63
    v_mfma_f32_32x32x16_bf16 v[48:63], v[144:147], a[104:107], v[80:95]
    s_add_u32 s40, s48, s24
    v_exp_f32 v32, v32
    v_exp_f32 v33, v33
    v_exp_f32 v34, v34
    v_cvt_pk_bf16_f32 v128, v32, v33
    v_mfma_f32_32x32x16_bf16 v[48:63], v[148:151], a[108:111], v[48:63]
    buffer_load_dwordx4 a[128:131], v1, s[4:7], s40 offen offset:0 sc1
    v_exp_f32 v35, v35
    v_exp_f32 v36, v36
    v_exp_f32 v37, v37
    v_cvt_pk_bf16_f32 v129, v34, v35
    v_mfma_f32_32x32x16_bf16 v[112:127], v[168:171], v[136:139], v[112:127]
    buffer_load_dwordx4 a[132:135], v1, s[4:7], s40 offen offset:1024 sc1
    v_exp_f32 v38, v38
    v_exp_f32 v39, v39
    v_exp_f32 v40, v40
    v_cvt_pk_bf16_f32 v130, v36, v37
    v_mfma_f32_32x32x16_bf16 v[112:127], v[172:175], v[140:143], v[112:127]
    s_add_u32 s40, s48, s25
    v_exp_f32 v41, v41
    v_exp_f32 v42, v42
    v_exp_f32 v43, v43
    v_cvt_pk_bf16_f32 v131, v38, v39
    v_mfma_f32_16x16x32_bf16 v[180:183], v[184:187], v[136:139], v[180:183]
    buffer_load_dwordx4 a[136:139], v1, s[4:7], s40 offen offset:0 sc1
    v_exp_f32 v44, v44
    v_exp_f32 v45, v45
    v_cvt_pk_bf16_f32 v132, v40, v41
    v_cvt_pk_bf16_f32 v133, v42, v43
    v_mfma_f32_16x16x32_bf16 v[180:183], v[184:187], v[140:143], v[180:183]
    s_waitcnt lgkmcnt(0)
    v_exp_f32 v46, v46
    v_exp_f32 v47, v47
    v_cvt_pk_bf16_f32 v134, v44, v45
    v_cvt_pk_bf16_f32 v135, v46, v47
    v_mfma_f32_32x32x16_bf16 v[32:47], v[152:155], a[96:99], v[64:79]
    v_exp_f32 v48, v48
    v_exp_f32 v49, v49
    v_exp_f32 v50, v50
    v_cvt_pk_bf16_f32 v136, v48, v49
    v_mfma_f32_32x32x16_bf16 v[32:47], v[156:159], a[100:103], v[32:47]
    buffer_load_dwordx4 a[140:143], v1, s[4:7], s40 offen offset:1024 sc1
    v_exp_f32 v51, v51
    v_exp_f32 v52, v52
    v_exp_f32 v53, v53
    v_cvt_pk_bf16_f32 v137, v50, v51
    v_mfma_f32_32x32x16_bf16 v[96:111], v[160:163], v[128:131], v[96:111]
    ds_read_b128 v[144:147], v9 offset:8192
    v_exp_f32 v54, v54
    v_exp_f32 v55, v55
    v_exp_f32 v56, v56
    v_cvt_pk_bf16_f32 v138, v52, v53
    v_mfma_f32_32x32x16_bf16 v[96:111], v[164:167], v[132:135], v[96:111]
    ds_read_b128 v[148:151], v9 offset:8704
    v_exp_f32 v57, v57
    v_exp_f32 v58, v58
    v_exp_f32 v59, v59
    v_cvt_pk_bf16_f32 v139, v54, v55
    v_mfma_f32_16x16x32_bf16 v[176:179], v[184:187], v[128:131], v[176:179]
    ds_read_b128 v[168:171], v8 offset:6144
    v_exp_f32 v60, v60
    v_exp_f32 v61, v61
    v_cvt_pk_bf16_f32 v140, v56, v57
    v_cvt_pk_bf16_f32 v141, v58, v59
    v_mfma_f32_16x16x32_bf16 v[176:179], v[184:187], v[132:135], v[176:179]
    ds_read_b128 v[172:175], v8 offset:6656
    v_exp_f32 v62, v62
    v_exp_f32 v63, v63
    v_cvt_pk_bf16_f32 v142, v60, v61
    v_cvt_pk_bf16_f32 v143, v62, v63
    v_mfma_f32_32x32x16_bf16 v[48:63], v[152:155], a[104:107], v[80:95]
    s_add_u32 s40, s48, s26
    v_exp_f32 v32, v32
    v_exp_f32 v33, v33
    v_exp_f32 v34, v34
    v_cvt_pk_bf16_f32 v128, v32, v33
    v_mfma_f32_32x32x16_bf16 v[48:63], v[156:159], a[108:111], v[48:63]
    buffer_load_dwordx4 a[144:147], v1, s[4:7], s40 offen offset:0 sc1
    v_exp_f32 v35, v35
    v_exp_f32 v36, v36
    v_exp_f32 v37, v37
    v_cvt_pk_bf16_f32 v129, v34, v35
    v_mfma_f32_32x32x16_bf16 v[112:127], v[160:163], v[136:139], v[112:127]
    buffer_load_dwordx4 a[148:151], v1, s[4:7], s40 offen offset:1024 sc1
    v_exp_f32 v38, v38
    v_exp_f32 v39, v39
    v_exp_f32 v40, v40
    v_cvt_pk_bf16_f32 v130, v36, v37
    v_mfma_f32_32x32x16_bf16 v[112:127], v[164:167], v[140:143], v[112:127]
    s_add_u32 s40, s48, s27
    v_exp_f32 v41, v41
    v_exp_f32 v42, v42
    v_exp_f32 v43, v43
    v_cvt_pk_bf16_f32 v131, v38, v39
    v_mfma_f32_16x16x32_bf16 v[180:183], v[184:187], v[136:139], v[180:183]
    v_exp_f32 v44, v44
    v_exp_f32 v45, v45
    v_cvt_pk_bf16_f32 v132, v40, v41
    v_cvt_pk_bf16_f32 v133, v42, v43
    v_mfma_f32_16x16x32_bf16 v[180:183], v[184:187], v[140:143], v[180:183]
    s_waitcnt lgkmcnt(0)
    v_exp_f32 v46, v46
    v_exp_f32 v47, v47
    v_cvt_pk_bf16_f32 v134, v44, v45
    v_cvt_pk_bf16_f32 v135, v46, v47
    v_mfma_f32_32x32x16_bf16 v[32:47], v[144:147], a[96:99], v[64:79]
    buffer_load_dwordx4 a[152:155], v1, s[4:7], s40 offen offset:0 sc1
    v_exp_f32 v48, v48
    v_exp_f32 v49, v49
    v_exp_f32 v50, v50
    v_cvt_pk_bf16_f32 v136, v48, v49
    v_mfma_f32_32x32x16_bf16 v[32:47], v[148:151], a[100:103], v[32:47]
    buffer_load_dwordx4 a[156:159], v1, s[4:7], s40 offen offset:1024 sc1
    v_exp_f32 v51, v51
    v_exp_f32 v52, v52
    v_exp_f32 v53, v53
    v_cvt_pk_bf16_f32 v137, v50, v51
    v_mfma_f32_32x32x16_bf16 v[96:111], v[168:171], v[128:131], v[96:111]
    ds_read_b128 v[152:155], v9 offset:12288
    v_exp_f32 v54, v54
    v_exp_f32 v55, v55
    v_exp_f32 v56, v56
    v_cvt_pk_bf16_f32 v138, v52, v53
    v_mfma_f32_32x32x16_bf16 v[96:111], v[172:175], v[132:135], v[96:111]
    ds_read_b128 v[156:159], v9 offset:12800
    v_exp_f32 v57, v57
    v_exp_f32 v58, v58
    v_exp_f32 v59, v59
    v_cvt_pk_bf16_f32 v139, v54, v55
    v_mfma_f32_16x16x32_bf16 v[176:179], v[184:187], v[128:131], v[176:179]
    ds_read_b128 v[160:163], v8 offset:10240
    v_exp_f32 v60, v60
    v_exp_f32 v61, v61
    v_cvt_pk_bf16_f32 v140, v56, v57
    v_cvt_pk_bf16_f32 v141, v58, v59
    v_mfma_f32_16x16x32_bf16 v[176:179], v[184:187], v[132:135], v[176:179]
    ds_read_b128 v[164:167], v8 offset:10752
    v_exp_f32 v62, v62
    v_exp_f32 v63, v63
    v_cvt_pk_bf16_f32 v142, v60, v61
    v_cvt_pk_bf16_f32 v143, v62, v63
    v_mfma_f32_32x32x16_bf16 v[48:63], v[144:147], a[104:107], v[80:95]
    s_lshl_b32 s3, s28, 3
    v_exp_f32 v32, v32
    v_exp_f32 v33, v33
    v_exp_f32 v34, v34
    v_cvt_pk_bf16_f32 v128, v32, v33
    v_mfma_f32_32x32x16_bf16 v[48:63], v[148:151], a[108:111], v[48:63]
    s_add_u32 m0, s49, 32768
    v_exp_f32 v35, v35
    v_exp_f32 v36, v36
    v_exp_f32 v37, v37
    v_cvt_pk_bf16_f32 v129, v34, v35
    v_mfma_f32_32x32x16_bf16 v[112:127], v[168:171], v[136:139], v[112:127]
    v_exp_f32 v38, v38
    v_exp_f32 v39, v39
    v_exp_f32 v40, v40
    v_cvt_pk_bf16_f32 v130, v36, v37
    v_mfma_f32_32x32x16_bf16 v[112:127], v[172:175], v[140:143], v[112:127]
    s_add_u32 s41, s50, s3
    v_exp_f32 v41, v41
    v_exp_f32 v42, v42
    v_exp_f32 v43, v43
    v_cvt_pk_bf16_f32 v131, v38, v39
    v_mfma_f32_16x16x32_bf16 v[180:183], v[184:187], v[136:139], v[180:183]
    buffer_load_dwordx4 v188, s[8:11], s41 offen  lds
    v_exp_f32 v44, v44
    v_exp_f32 v45, v45
    v_cvt_pk_bf16_f32 v132, v40, v41
    v_cvt_pk_bf16_f32 v133, v42, v43
    v_mfma_f32_16x16x32_bf16 v[180:183], v[184:187], v[140:143], v[180:183]
    s_waitcnt vmcnt(19) lgkmcnt(0)
    s_barrier
    v_exp_f32 v46, v46
    v_exp_f32 v47, v47
    v_cvt_pk_bf16_f32 v134, v44, v45
    v_cvt_pk_bf16_f32 v135, v46, v47
    v_mfma_f32_32x32x16_bf16 v[32:47], v[152:155], a[96:99], v[64:79]
    buffer_load_dwordx4 v190, s[8:11], s41 offen offset:1024  lds
    v_exp_f32 v48, v48
    v_exp_f32 v49, v49
    v_exp_f32 v50, v50
    v_cvt_pk_bf16_f32 v136, v48, v49
    v_mfma_f32_32x32x16_bf16 v[32:47], v[156:159], a[100:103], v[32:47]
    s_add_u32 s40, s48, s28
    v_exp_f32 v51, v51
    v_exp_f32 v52, v52
    v_exp_f32 v53, v53
    v_cvt_pk_bf16_f32 v137, v50, v51
    v_mfma_f32_32x32x16_bf16 v[96:111], v[160:163], v[128:131], v[96:111]
    ds_read_b128 v[144:147], v9 offset:16384
    v_exp_f32 v54, v54
    v_exp_f32 v55, v55
    v_exp_f32 v56, v56
    v_cvt_pk_bf16_f32 v138, v52, v53
    v_mfma_f32_32x32x16_bf16 v[96:111], v[164:167], v[132:135], v[96:111]
    ds_read_b128 v[148:151], v9 offset:16896
    v_exp_f32 v57, v57
    v_exp_f32 v58, v58
    v_exp_f32 v59, v59
    v_cvt_pk_bf16_f32 v139, v54, v55
    v_mfma_f32_16x16x32_bf16 v[176:179], v[184:187], v[128:131], v[176:179]
    ds_read_b128 v[168:171], v8 offset:14336
    v_exp_f32 v60, v60
    v_exp_f32 v61, v61
    v_cvt_pk_bf16_f32 v140, v56, v57
    v_cvt_pk_bf16_f32 v141, v58, v59
    v_mfma_f32_16x16x32_bf16 v[176:179], v[184:187], v[132:135], v[176:179]
    ds_read_b128 v[172:175], v8 offset:14848
    v_exp_f32 v62, v62
    v_exp_f32 v63, v63
    v_cvt_pk_bf16_f32 v142, v60, v61
    v_cvt_pk_bf16_f32 v143, v62, v63
    v_mfma_f32_32x32x16_bf16 v[48:63], v[152:155], a[104:107], v[80:95]
    buffer_load_dwordx4 a[160:163], v1, s[4:7], s40 offen offset:0 sc1
    v_exp_f32 v32, v32
    v_exp_f32 v33, v33
    v_exp_f32 v34, v34
    v_cvt_pk_bf16_f32 v128, v32, v33
    v_mfma_f32_32x32x16_bf16 v[48:63], v[156:159], a[108:111], v[48:63]
    v_exp_f32 v35, v35
    v_exp_f32 v36, v36
    v_exp_f32 v37, v37
    v_cvt_pk_bf16_f32 v129, v34, v35
    v_mfma_f32_32x32x16_bf16 v[112:127], v[160:163], v[136:139], v[112:127]
    buffer_load_dwordx4 a[164:167], v1, s[4:7], s40 offen offset:1024 sc1
    v_exp_f32 v38, v38
    v_exp_f32 v39, v39
    v_exp_f32 v40, v40
    v_cvt_pk_bf16_f32 v130, v36, v37
    v_mfma_f32_32x32x16_bf16 v[112:127], v[164:167], v[140:143], v[112:127]
    s_lshl_b32 s3, s29, 3
    v_exp_f32 v41, v41
    v_exp_f32 v42, v42
    v_exp_f32 v43, v43
    v_cvt_pk_bf16_f32 v131, v38, v39
    v_mfma_f32_16x16x32_bf16 v[180:183], v[184:187], v[136:139], v[180:183]
    s_add_u32 m0, s49, 40960
    v_exp_f32 v44, v44
    v_exp_f32 v45, v45
    v_cvt_pk_bf16_f32 v132, v40, v41
    v_cvt_pk_bf16_f32 v133, v42, v43
    v_mfma_f32_16x16x32_bf16 v[180:183], v[184:187], v[140:143], v[180:183]
    s_waitcnt lgkmcnt(0)
    v_exp_f32 v46, v46
    v_exp_f32 v47, v47
    v_cvt_pk_bf16_f32 v134, v44, v45
    v_cvt_pk_bf16_f32 v135, v46, v47
    v_mfma_f32_32x32x16_bf16 v[32:47], v[144:147], a[96:99], v[64:79]
    s_add_u32 s41, s50, s3
    v_exp_f32 v48, v48
    v_exp_f32 v49, v49
    v_exp_f32 v50, v50
    v_cvt_pk_bf16_f32 v136, v48, v49
    v_mfma_f32_32x32x16_bf16 v[32:47], v[148:151], a[100:103], v[32:47]
    v_exp_f32 v51, v51
    v_exp_f32 v52, v52
    v_exp_f32 v53, v53
    v_cvt_pk_bf16_f32 v137, v50, v51
    v_mfma_f32_32x32x16_bf16 v[96:111], v[168:171], v[128:131], v[96:111]
    ds_read_b128 v[152:155], v9 offset:20480
    v_exp_f32 v54, v54
    v_exp_f32 v55, v55
    v_exp_f32 v56, v56
    v_cvt_pk_bf16_f32 v138, v52, v53
    v_mfma_f32_32x32x16_bf16 v[96:111], v[172:175], v[132:135], v[96:111]
    ds_read_b128 v[156:159], v9 offset:20992
    v_exp_f32 v57, v57
    v_exp_f32 v58, v58
    v_exp_f32 v59, v59
    v_cvt_pk_bf16_f32 v139, v54, v55
    v_mfma_f32_16x16x32_bf16 v[176:179], v[184:187], v[128:131], v[176:179]
    ds_read_b128 v[160:163], v8 offset:18432
    v_exp_f32 v60, v60
    v_exp_f32 v61, v61
    v_cvt_pk_bf16_f32 v140, v56, v57
    v_cvt_pk_bf16_f32 v141, v58, v59
    v_mfma_f32_16x16x32_bf16 v[176:179], v[184:187], v[132:135], v[176:179]
    ds_read_b128 v[164:167], v8 offset:18944
    v_exp_f32 v62, v62
    v_exp_f32 v63, v63
    v_cvt_pk_bf16_f32 v142, v60, v61
    v_cvt_pk_bf16_f32 v143, v62, v63
    v_mfma_f32_32x32x16_bf16 v[48:63], v[144:147], a[104:107], v[80:95]
    buffer_load_dwordx4 v188, s[8:11], s41 offen  lds
    v_exp_f32 v32, v32
    v_exp_f32 v33, v33
    v_exp_f32 v34, v34
    v_cvt_pk_bf16_f32 v128, v32, v33
    v_mfma_f32_32x32x16_bf16 v[48:63], v[148:151], a[108:111], v[48:63]
    buffer_load_dwordx4 v190, s[8:11], s41 offen offset:1024  lds
    v_exp_f32 v35, v35
    v_exp_f32 v36, v36
    v_exp_f32 v37, v37
    v_cvt_pk_bf16_f32 v129, v34, v35
    v_mfma_f32_32x32x16_bf16 v[112:127], v[168:171], v[136:139], v[112:127]
    s_add_u32 s40, s48, s29
    v_exp_f32 v38, v38
    v_exp_f32 v39, v39
    v_exp_f32 v40, v40
    v_cvt_pk_bf16_f32 v130, v36, v37
    v_mfma_f32_32x32x16_bf16 v[112:127], v[172:175], v[140:143], v[112:127]
    buffer_load_dwordx4 a[168:171], v1, s[4:7], s40 offen offset:0 sc1
    v_exp_f32 v41, v41
    v_exp_f32 v42, v42
    v_exp_f32 v43, v43
    v_cvt_pk_bf16_f32 v131, v38, v39
    v_mfma_f32_16x16x32_bf16 v[180:183], v[184:187], v[136:139], v[180:183]
    buffer_load_dwordx4 a[172:175], v1, s[4:7], s40 offen offset:1024 sc1
    v_exp_f32 v44, v44
    v_exp_f32 v45, v45
    v_cvt_pk_bf16_f32 v132, v40, v41
    v_cvt_pk_bf16_f32 v133, v42, v43
    v_mfma_f32_16x16x32_bf16 v[180:183], v[184:187], v[140:143], v[180:183]
    s_waitcnt lgkmcnt(0)
    v_exp_f32 v46, v46
    v_exp_f32 v47, v47
    v_cvt_pk_bf16_f32 v134, v44, v45
    v_cvt_pk_bf16_f32 v135, v46, v47
    v_mfma_f32_32x32x16_bf16 v[32:47], v[152:155], a[96:99], v[64:79]
    s_lshl_b32 s3, s30, 3
    v_exp_f32 v48, v48
    v_exp_f32 v49, v49
    v_exp_f32 v50, v50
    v_cvt_pk_bf16_f32 v136, v48, v49
    v_mfma_f32_32x32x16_bf16 v[32:47], v[156:159], a[100:103], v[32:47]
    v_exp_f32 v51, v51
    v_exp_f32 v52, v52
    v_exp_f32 v53, v53
    v_cvt_pk_bf16_f32 v137, v50, v51
    v_mfma_f32_32x32x16_bf16 v[96:111], v[160:163], v[128:131], v[96:111]
    ds_read_b128 v[144:147], v9 offset:24576
    v_exp_f32 v54, v54
    v_exp_f32 v55, v55
    v_exp_f32 v56, v56
    v_cvt_pk_bf16_f32 v138, v52, v53
    v_mfma_f32_32x32x16_bf16 v[96:111], v[164:167], v[132:135], v[96:111]
    ds_read_b128 v[148:151], v9 offset:25088
    v_exp_f32 v57, v57
    v_exp_f32 v58, v58
    v_exp_f32 v59, v59
    v_cvt_pk_bf16_f32 v139, v54, v55
    v_mfma_f32_16x16x32_bf16 v[176:179], v[184:187], v[128:131], v[176:179]
    ds_read_b128 v[168:171], v8 offset:22528
    v_exp_f32 v60, v60
    v_exp_f32 v61, v61
    v_cvt_pk_bf16_f32 v140, v56, v57
    v_cvt_pk_bf16_f32 v141, v58, v59
    v_mfma_f32_16x16x32_bf16 v[176:179], v[184:187], v[132:135], v[176:179]
    ds_read_b128 v[172:175], v8 offset:23040
    v_exp_f32 v62, v62
    v_exp_f32 v63, v63
    v_cvt_pk_bf16_f32 v142, v60, v61
    v_cvt_pk_bf16_f32 v143, v62, v63
    v_mfma_f32_32x32x16_bf16 v[48:63], v[152:155], a[104:107], v[80:95]
    s_add_u32 m0, s49, 49152
    v_exp_f32 v32, v32
    v_exp_f32 v33, v33
    v_exp_f32 v34, v34
    v_cvt_pk_bf16_f32 v128, v32, v33
    v_mfma_f32_32x32x16_bf16 v[48:63], v[156:159], a[108:111], v[48:63]
    s_add_u32 s41, s50, s3
    v_exp_f32 v35, v35
    v_exp_f32 v36, v36
    v_exp_f32 v37, v37
    v_cvt_pk_bf16_f32 v129, v34, v35
    v_mfma_f32_32x32x16_bf16 v[112:127], v[160:163], v[136:139], v[112:127]
    buffer_load_dwordx4 v188, s[8:11], s41 offen  lds
    v_exp_f32 v38, v38
    v_exp_f32 v39, v39
    v_exp_f32 v40, v40
    v_cvt_pk_bf16_f32 v130, v36, v37
    v_mfma_f32_32x32x16_bf16 v[112:127], v[164:167], v[140:143], v[112:127]
    buffer_load_dwordx4 v190, s[8:11], s41 offen offset:1024  lds
    v_exp_f32 v41, v41
    v_exp_f32 v42, v42
    v_exp_f32 v43, v43
    v_cvt_pk_bf16_f32 v131, v38, v39
    v_mfma_f32_16x16x32_bf16 v[180:183], v[184:187], v[136:139], v[180:183]
    s_add_u32 s40, s48, s30
    v_exp_f32 v44, v44
    v_exp_f32 v45, v45
    v_cvt_pk_bf16_f32 v132, v40, v41
    v_cvt_pk_bf16_f32 v133, v42, v43
    v_mfma_f32_16x16x32_bf16 v[180:183], v[184:187], v[140:143], v[180:183]
    s_waitcnt lgkmcnt(0)
    v_exp_f32 v46, v46
    v_exp_f32 v47, v47
    v_cvt_pk_bf16_f32 v134, v44, v45
    v_cvt_pk_bf16_f32 v135, v46, v47
    v_mfma_f32_32x32x16_bf16 v[32:47], v[144:147], a[96:99], v[64:79]
    buffer_load_dwordx4 a[176:179], v1, s[4:7], s40 offen offset:0 sc1
    v_exp_f32 v48, v48
    v_exp_f32 v49, v49
    v_exp_f32 v50, v50
    v_cvt_pk_bf16_f32 v136, v48, v49
    v_mfma_f32_32x32x16_bf16 v[32:47], v[148:151], a[100:103], v[32:47]
    v_exp_f32 v51, v51
    v_exp_f32 v52, v52
    v_exp_f32 v53, v53
    v_cvt_pk_bf16_f32 v137, v50, v51
    v_mfma_f32_32x32x16_bf16 v[96:111], v[168:171], v[128:131], v[96:111]
    ds_read_b128 v[152:155], v9 offset:28672
    v_exp_f32 v54, v54
    v_exp_f32 v55, v55
    v_exp_f32 v56, v56
    v_cvt_pk_bf16_f32 v138, v52, v53
    v_mfma_f32_32x32x16_bf16 v[96:111], v[172:175], v[132:135], v[96:111]
    ds_read_b128 v[156:159], v9 offset:29184
    v_exp_f32 v57, v57
    v_exp_f32 v58, v58
    v_exp_f32 v59, v59
    v_cvt_pk_bf16_f32 v139, v54, v55
    v_mfma_f32_16x16x32_bf16 v[176:179], v[184:187], v[128:131], v[176:179]
    ds_read_b128 v[160:163], v8 offset:26624
    v_exp_f32 v60, v60
    v_exp_f32 v61, v61
    v_cvt_pk_bf16_f32 v140, v56, v57
    v_cvt_pk_bf16_f32 v141, v58, v59
    v_mfma_f32_16x16x32_bf16 v[176:179], v[184:187], v[132:135], v[176:179]
    ds_read_b128 v[164:167], v8 offset:27136
    v_exp_f32 v62, v62
    v_exp_f32 v63, v63
    v_cvt_pk_bf16_f32 v142, v60, v61
    v_cvt_pk_bf16_f32 v143, v62, v63
    v_mfma_f32_32x32x16_bf16 v[48:63], v[144:147], a[104:107], v[80:95]
    buffer_load_dwordx4 a[180:183], v1, s[4:7], s40 offen offset:1024 sc1
    v_exp_f32 v32, v32
    v_exp_f32 v33, v33
    v_exp_f32 v34, v34
    v_cvt_pk_bf16_f32 v128, v32, v33
    v_mfma_f32_32x32x16_bf16 v[48:63], v[148:151], a[108:111], v[48:63]
    s_lshl_b32 s3, s31, 3
    v_exp_f32 v35, v35
    v_exp_f32 v36, v36
    v_exp_f32 v37, v37
    v_cvt_pk_bf16_f32 v129, v34, v35
    v_mfma_f32_32x32x16_bf16 v[112:127], v[168:171], v[136:139], v[112:127]
    s_add_u32 m0, s49, 57344
    v_exp_f32 v38, v38
    v_exp_f32 v39, v39
    v_exp_f32 v40, v40
    v_cvt_pk_bf16_f32 v130, v36, v37
    v_mfma_f32_32x32x16_bf16 v[112:127], v[172:175], v[140:143], v[112:127]
    s_add_u32 s41, s50, s3
    v_exp_f32 v41, v41
    v_exp_f32 v42, v42
    v_exp_f32 v43, v43
    v_cvt_pk_bf16_f32 v131, v38, v39
    v_mfma_f32_16x16x32_bf16 v[180:183], v[184:187], v[136:139], v[180:183]
    buffer_load_dwordx4 v188, s[8:11], s41 offen  lds
    v_exp_f32 v44, v44
    v_exp_f32 v45, v45
    v_cvt_pk_bf16_f32 v132, v40, v41
    v_cvt_pk_bf16_f32 v133, v42, v43
    v_mfma_f32_16x16x32_bf16 v[180:183], v[184:187], v[140:143], v[180:183]
    s_waitcnt lgkmcnt(0)
    v_exp_f32 v46, v46
    v_exp_f32 v47, v47
    v_cvt_pk_bf16_f32 v134, v44, v45
    v_cvt_pk_bf16_f32 v135, v46, v47
    v_mfma_f32_32x32x16_bf16 v[32:47], v[152:155], a[96:99], v[64:79]
    buffer_load_dwordx4 v190, s[8:11], s41 offen offset:1024  lds
    v_exp_f32 v48, v48
    v_exp_f32 v49, v49
    v_exp_f32 v50, v50
    v_cvt_pk_bf16_f32 v136, v48, v49
    v_mfma_f32_32x32x16_bf16 v[32:47], v[156:159], a[100:103], v[32:47]
    v_exp_f32 v51, v51
    v_exp_f32 v52, v52
    v_exp_f32 v53, v53
    v_cvt_pk_bf16_f32 v137, v50, v51
    v_mfma_f32_32x32x16_bf16 v[96:111], v[160:163], v[128:131], v[96:111]
    ds_read_b128 v[144:147], v9 offset:32768
    v_exp_f32 v54, v54
    v_exp_f32 v55, v55
    v_exp_f32 v56, v56
    v_cvt_pk_bf16_f32 v138, v52, v53
    v_mfma_f32_32x32x16_bf16 v[96:111], v[164:167], v[132:135], v[96:111]
    ds_read_b128 v[148:151], v9 offset:33280
    v_exp_f32 v57, v57
    v_exp_f32 v58, v58
    v_exp_f32 v59, v59
    v_cvt_pk_bf16_f32 v139, v54, v55
    v_mfma_f32_16x16x32_bf16 v[176:179], v[184:187], v[128:131], v[176:179]
    ds_read_b128 v[168:171], v8 offset:30720
    v_exp_f32 v60, v60
    v_exp_f32 v61, v61
    v_cvt_pk_bf16_f32 v140, v56, v57
    v_cvt_pk_bf16_f32 v141, v58, v59
    v_mfma_f32_16x16x32_bf16 v[176:179], v[184:187], v[132:135], v[176:179]
    ds_read_b128 v[172:175], v8 offset:31232
    v_exp_f32 v62, v62
    v_exp_f32 v63, v63
    v_cvt_pk_bf16_f32 v142, v60, v61
    v_cvt_pk_bf16_f32 v143, v62, v63
    v_mfma_f32_32x32x16_bf16 v[48:63], v[152:155], a[104:107], v[80:95]
    s_add_u32 s40, s48, s31
    v_exp_f32 v32, v32
    v_exp_f32 v33, v33
    v_exp_f32 v34, v34
    v_cvt_pk_bf16_f32 v128, v32, v33
    v_mfma_f32_32x32x16_bf16 v[48:63], v[156:159], a[108:111], v[48:63]
    buffer_load_dwordx4 a[184:187], v1, s[4:7], s40 offen offset:0 sc1
    v_exp_f32 v35, v35
    v_exp_f32 v36, v36
    v_exp_f32 v37, v37
    v_cvt_pk_bf16_f32 v129, v34, v35
    v_mfma_f32_32x32x16_bf16 v[112:127], v[160:163], v[136:139], v[112:127]
    buffer_load_dwordx4 a[188:191], v1, s[4:7], s40 offen offset:1024 sc1
    v_exp_f32 v38, v38
    v_exp_f32 v39, v39
    v_exp_f32 v40, v40
    v_cvt_pk_bf16_f32 v130, v36, v37
    v_mfma_f32_32x32x16_bf16 v[112:127], v[164:167], v[140:143], v[112:127]
    s_add_u32 s48, s48, 65536
    v_exp_f32 v41, v41
    v_exp_f32 v42, v42
    v_exp_f32 v43, v43
    v_cvt_pk_bf16_f32 v131, v38, v39
    v_mfma_f32_16x16x32_bf16 v[180:183], v[184:187], v[136:139], v[180:183]
    s_add_u32 s40, s48, s24
    v_exp_f32 v44, v44
    v_exp_f32 v45, v45
    v_cvt_pk_bf16_f32 v132, v40, v41
    v_cvt_pk_bf16_f32 v133, v42, v43
    v_mfma_f32_16x16x32_bf16 v[180:183], v[184:187], v[140:143], v[180:183]
    s_waitcnt lgkmcnt(0)
    v_exp_f32 v46, v46
    v_exp_f32 v47, v47
    v_cvt_pk_bf16_f32 v134, v44, v45
    v_cvt_pk_bf16_f32 v135, v46, v47
    v_mfma_f32_32x32x16_bf16 v[32:47], v[144:147], a[96:99], v[64:79]
    buffer_load_dwordx4 a[0:3], v1, s[4:7], s40 offen offset:0 sc1
    v_exp_f32 v48, v48
    v_exp_f32 v49, v49
    v_exp_f32 v50, v50
    v_cvt_pk_bf16_f32 v136, v48, v49
    v_mfma_f32_32x32x16_bf16 v[32:47], v[148:151], a[100:103], v[32:47]
    v_exp_f32 v51, v51
    v_exp_f32 v52, v52
    v_exp_f32 v53, v53
    v_cvt_pk_bf16_f32 v137, v50, v51
    v_mfma_f32_32x32x16_bf16 v[96:111], v[168:171], v[128:131], v[96:111]
    ds_read_b128 v[152:155], v9 offset:36864
    v_exp_f32 v54, v54
    v_exp_f32 v55, v55
    v_exp_f32 v56, v56
    v_cvt_pk_bf16_f32 v138, v52, v53
    v_mfma_f32_32x32x16_bf16 v[96:111], v[172:175], v[132:135], v[96:111]
    ds_read_b128 v[156:159], v9 offset:37376
    v_exp_f32 v57, v57
    v_exp_f32 v58, v58
    v_exp_f32 v59, v59
    v_cvt_pk_bf16_f32 v139, v54, v55
    v_mfma_f32_16x16x32_bf16 v[176:179], v[184:187], v[128:131], v[176:179]
    ds_read_b128 v[160:163], v8 offset:34816
    v_exp_f32 v60, v60
    v_exp_f32 v61, v61
    v_cvt_pk_bf16_f32 v140, v56, v57
    v_cvt_pk_bf16_f32 v141, v58, v59
    v_mfma_f32_16x16x32_bf16 v[176:179], v[184:187], v[132:135], v[176:179]
    ds_read_b128 v[164:167], v8 offset:35328
    v_exp_f32 v62, v62
    v_exp_f32 v63, v63
    v_cvt_pk_bf16_f32 v142, v60, v61
    v_cvt_pk_bf16_f32 v143, v62, v63
    v_mfma_f32_32x32x16_bf16 v[48:63], v[144:147], a[104:107], v[80:95]
    buffer_load_dwordx4 a[4:7], v1, s[4:7], s40 offen offset:1024 sc1
    v_exp_f32 v32, v32
    v_exp_f32 v33, v33
    v_exp_f32 v34, v34
    v_cvt_pk_bf16_f32 v128, v32, v33
    v_mfma_f32_32x32x16_bf16 v[48:63], v[148:151], a[108:111], v[48:63]
    s_add_u32 s40, s48, s25
    v_exp_f32 v35, v35
    v_exp_f32 v36, v36
    v_exp_f32 v37, v37
    v_cvt_pk_bf16_f32 v129, v34, v35
    v_mfma_f32_32x32x16_bf16 v[112:127], v[168:171], v[136:139], v[112:127]
    buffer_load_dwordx4 a[8:11], v1, s[4:7], s40 offen offset:0 sc1
    v_exp_f32 v38, v38
    v_exp_f32 v39, v39
    v_exp_f32 v40, v40
    v_cvt_pk_bf16_f32 v130, v36, v37
    v_mfma_f32_32x32x16_bf16 v[112:127], v[172:175], v[140:143], v[112:127]
    buffer_load_dwordx4 a[12:15], v1, s[4:7], s40 offen offset:1024 sc1
    v_exp_f32 v41, v41
    v_exp_f32 v42, v42
    v_exp_f32 v43, v43
    v_cvt_pk_bf16_f32 v131, v38, v39
    v_mfma_f32_16x16x32_bf16 v[180:183], v[184:187], v[136:139], v[180:183]
    s_add_u32 s40, s48, s26
    v_exp_f32 v44, v44
    v_exp_f32 v45, v45
    v_cvt_pk_bf16_f32 v132, v40, v41
    v_cvt_pk_bf16_f32 v133, v42, v43
    v_mfma_f32_16x16x32_bf16 v[180:183], v[184:187], v[140:143], v[180:183]
    s_waitcnt lgkmcnt(0)
    v_exp_f32 v46, v46
    v_exp_f32 v47, v47
    v_cvt_pk_bf16_f32 v134, v44, v45
    v_cvt_pk_bf16_f32 v135, v46, v47
    v_mfma_f32_32x32x16_bf16 v[32:47], v[152:155], a[96:99], v[64:79]
    v_exp_f32 v48, v48
    v_exp_f32 v49, v49
    v_exp_f32 v50, v50
    v_cvt_pk_bf16_f32 v136, v48, v49
    v_mfma_f32_32x32x16_bf16 v[32:47], v[156:159], a[100:103], v[32:47]
    buffer_load_dwordx4 a[16:19], v1, s[4:7], s40 offen offset:0 sc1
    v_exp_f32 v51, v51
    v_exp_f32 v52, v52
    v_exp_f32 v53, v53
    v_cvt_pk_bf16_f32 v137, v50, v51
    v_mfma_f32_32x32x16_bf16 v[96:111], v[160:163], v[128:131], v[96:111]
    ds_read_b128 v[144:147], v9 offset:40960
    v_exp_f32 v54, v54
    v_exp_f32 v55, v55
    v_exp_f32 v56, v56
    v_cvt_pk_bf16_f32 v138, v52, v53
    v_mfma_f32_32x32x16_bf16 v[96:111], v[164:167], v[132:135], v[96:111]
    ds_read_b128 v[148:151], v9 offset:41472
    v_exp_f32 v57, v57
    v_exp_f32 v58, v58
    v_exp_f32 v59, v59
    v_cvt_pk_bf16_f32 v139, v54, v55
    v_mfma_f32_16x16x32_bf16 v[176:179], v[184:187], v[128:131], v[176:179]
    ds_read_b128 v[168:171], v8 offset:38912
    v_exp_f32 v60, v60
    v_exp_f32 v61, v61
    v_cvt_pk_bf16_f32 v140, v56, v57
    v_cvt_pk_bf16_f32 v141, v58, v59
    v_mfma_f32_16x16x32_bf16 v[176:179], v[184:187], v[132:135], v[176:179]
    ds_read_b128 v[172:175], v8 offset:39424
    v_exp_f32 v62, v62
    v_exp_f32 v63, v63
    v_cvt_pk_bf16_f32 v142, v60, v61
    v_cvt_pk_bf16_f32 v143, v62, v63
    v_mfma_f32_32x32x16_bf16 v[48:63], v[152:155], a[104:107], v[80:95]
    buffer_load_dwordx4 a[20:23], v1, s[4:7], s40 offen offset:1024 sc1
    v_exp_f32 v32, v32
    v_exp_f32 v33, v33
    v_exp_f32 v34, v34
    v_cvt_pk_bf16_f32 v128, v32, v33
    v_mfma_f32_32x32x16_bf16 v[48:63], v[156:159], a[108:111], v[48:63]
    s_add_u32 s40, s48, s27
    v_exp_f32 v35, v35
    v_exp_f32 v36, v36
    v_exp_f32 v37, v37
    v_cvt_pk_bf16_f32 v129, v34, v35
    v_mfma_f32_32x32x16_bf16 v[112:127], v[160:163], v[136:139], v[112:127]
    buffer_load_dwordx4 a[24:27], v1, s[4:7], s40 offen offset:0 sc1
    v_exp_f32 v38, v38
    v_exp_f32 v39, v39
    v_exp_f32 v40, v40
    v_cvt_pk_bf16_f32 v130, v36, v37
    v_mfma_f32_32x32x16_bf16 v[112:127], v[164:167], v[140:143], v[112:127]
    buffer_load_dwordx4 a[28:31], v1, s[4:7], s40 offen offset:1024 sc1
    v_exp_f32 v41, v41
    v_exp_f32 v42, v42
    v_exp_f32 v43, v43
    v_cvt_pk_bf16_f32 v131, v38, v39
    v_mfma_f32_16x16x32_bf16 v[180:183], v[184:187], v[136:139], v[180:183]
    v_exp_f32 v44, v44
    v_exp_f32 v45, v45
    v_cvt_pk_bf16_f32 v132, v40, v41
    v_cvt_pk_bf16_f32 v133, v42, v43
    v_mfma_f32_16x16x32_bf16 v[180:183], v[184:187], v[140:143], v[180:183]
    s_waitcnt lgkmcnt(0)
    v_exp_f32 v46, v46
    v_exp_f32 v47, v47
    v_cvt_pk_bf16_f32 v134, v44, v45
    v_cvt_pk_bf16_f32 v135, v46, v47
    v_mfma_f32_32x32x16_bf16 v[32:47], v[144:147], a[96:99], v[64:79]
    s_add_u32 s40, s48, s28
    v_exp_f32 v48, v48
    v_exp_f32 v49, v49
    v_exp_f32 v50, v50
    v_cvt_pk_bf16_f32 v136, v48, v49
    v_mfma_f32_32x32x16_bf16 v[32:47], v[148:151], a[100:103], v[32:47]
    buffer_load_dwordx4 a[32:35], v1, s[4:7], s40 offen offset:0 sc1
    v_exp_f32 v51, v51
    v_exp_f32 v52, v52
    v_exp_f32 v53, v53
    v_cvt_pk_bf16_f32 v137, v50, v51
    v_mfma_f32_32x32x16_bf16 v[96:111], v[168:171], v[128:131], v[96:111]
    ds_read_b128 v[152:155], v9 offset:45056
    v_exp_f32 v54, v54
    v_exp_f32 v55, v55
    v_exp_f32 v56, v56
    v_cvt_pk_bf16_f32 v138, v52, v53
    v_mfma_f32_32x32x16_bf16 v[96:111], v[172:175], v[132:135], v[96:111]
    ds_read_b128 v[156:159], v9 offset:45568
    v_exp_f32 v57, v57
    v_exp_f32 v58, v58
    v_exp_f32 v59, v59
    v_cvt_pk_bf16_f32 v139, v54, v55
    v_mfma_f32_16x16x32_bf16 v[176:179], v[184:187], v[128:131], v[176:179]
    ds_read_b128 v[160:163], v8 offset:43008
    v_exp_f32 v60, v60
    v_exp_f32 v61, v61
    v_cvt_pk_bf16_f32 v140, v56, v57
    v_cvt_pk_bf16_f32 v141, v58, v59
    v_mfma_f32_16x16x32_bf16 v[176:179], v[184:187], v[132:135], v[176:179]
    ds_read_b128 v[164:167], v8 offset:43520
    v_exp_f32 v62, v62
    v_exp_f32 v63, v63
    v_cvt_pk_bf16_f32 v142, v60, v61
    v_cvt_pk_bf16_f32 v143, v62, v63
    v_mfma_f32_32x32x16_bf16 v[48:63], v[144:147], a[104:107], v[80:95]
    buffer_load_dwordx4 a[36:39], v1, s[4:7], s40 offen offset:1024 sc1
    v_exp_f32 v32, v32
    v_exp_f32 v33, v33
    v_exp_f32 v34, v34
    v_cvt_pk_bf16_f32 v128, v32, v33
    v_mfma_f32_32x32x16_bf16 v[48:63], v[148:151], a[108:111], v[48:63]
    s_add_u32 s40, s48, s29
    v_exp_f32 v35, v35
    v_exp_f32 v36, v36
    v_exp_f32 v37, v37
    v_cvt_pk_bf16_f32 v129, v34, v35
    v_mfma_f32_32x32x16_bf16 v[112:127], v[168:171], v[136:139], v[112:127]
    v_exp_f32 v38, v38
    v_exp_f32 v39, v39
    v_exp_f32 v40, v40
    v_cvt_pk_bf16_f32 v130, v36, v37
    v_mfma_f32_32x32x16_bf16 v[112:127], v[172:175], v[140:143], v[112:127]
    buffer_load_dwordx4 a[40:43], v1, s[4:7], s40 offen offset:0 sc1
    v_exp_f32 v41, v41
    v_exp_f32 v42, v42
    v_exp_f32 v43, v43
    v_cvt_pk_bf16_f32 v131, v38, v39
    v_mfma_f32_16x16x32_bf16 v[180:183], v[184:187], v[136:139], v[180:183]
    buffer_load_dwordx4 a[44:47], v1, s[4:7], s40 offen offset:1024 sc1
    v_exp_f32 v44, v44
    v_exp_f32 v45, v45
    v_cvt_pk_bf16_f32 v132, v40, v41
    v_cvt_pk_bf16_f32 v133, v42, v43
    v_mfma_f32_16x16x32_bf16 v[180:183], v[184:187], v[140:143], v[180:183]
    s_waitcnt lgkmcnt(0)
    v_exp_f32 v46, v46
    v_exp_f32 v47, v47
    v_cvt_pk_bf16_f32 v134, v44, v45
    v_cvt_pk_bf16_f32 v135, v46, v47
    v_mfma_f32_32x32x16_bf16 v[32:47], v[152:155], a[96:99], v[64:79]
    s_add_u32 s40, s48, s30
    v_exp_f32 v48, v48
    v_exp_f32 v49, v49
    v_exp_f32 v50, v50
    v_cvt_pk_bf16_f32 v136, v48, v49
    v_mfma_f32_32x32x16_bf16 v[32:47], v[156:159], a[100:103], v[32:47]
    buffer_load_dwordx4 a[48:51], v1, s[4:7], s40 offen offset:0 sc1
    v_exp_f32 v51, v51
    v_exp_f32 v52, v52
    v_exp_f32 v53, v53
    v_cvt_pk_bf16_f32 v137, v50, v51
    v_mfma_f32_32x32x16_bf16 v[96:111], v[160:163], v[128:131], v[96:111]
    ds_read_b128 v[144:147], v9 offset:49152
    v_exp_f32 v54, v54
    v_exp_f32 v55, v55
    v_exp_f32 v56, v56
    v_cvt_pk_bf16_f32 v138, v52, v53
    v_mfma_f32_32x32x16_bf16 v[96:111], v[164:167], v[132:135], v[96:111]
    ds_read_b128 v[148:151], v9 offset:49664
    v_exp_f32 v57, v57
    v_exp_f32 v58, v58
    v_exp_f32 v59, v59
    v_cvt_pk_bf16_f32 v139, v54, v55
    v_mfma_f32_16x16x32_bf16 v[176:179], v[184:187], v[128:131], v[176:179]
    ds_read_b128 v[168:171], v8 offset:47104
    v_exp_f32 v60, v60
    v_exp_f32 v61, v61
    v_cvt_pk_bf16_f32 v140, v56, v57
    v_cvt_pk_bf16_f32 v141, v58, v59
    v_mfma_f32_16x16x32_bf16 v[176:179], v[184:187], v[132:135], v[176:179]
    ds_read_b128 v[172:175], v8 offset:47616
    v_exp_f32 v62, v62
    v_exp_f32 v63, v63
    v_cvt_pk_bf16_f32 v142, v60, v61
    v_cvt_pk_bf16_f32 v143, v62, v63
    v_mfma_f32_32x32x16_bf16 v[48:63], v[152:155], a[104:107], v[80:95]
    buffer_load_dwordx4 a[52:55], v1, s[4:7], s40 offen offset:1024 sc1
    v_exp_f32 v32, v32
    v_exp_f32 v33, v33
    v_exp_f32 v34, v34
    v_cvt_pk_bf16_f32 v128, v32, v33
    v_mfma_f32_32x32x16_bf16 v[48:63], v[156:159], a[108:111], v[48:63]
    v_exp_f32 v35, v35
    v_exp_f32 v36, v36
    v_exp_f32 v37, v37
    v_cvt_pk_bf16_f32 v129, v34, v35
    v_mfma_f32_32x32x16_bf16 v[112:127], v[160:163], v[136:139], v[112:127]
    s_add_u32 s40, s48, s31
    v_exp_f32 v38, v38
    v_exp_f32 v39, v39
    v_exp_f32 v40, v40
    v_cvt_pk_bf16_f32 v130, v36, v37
    v_mfma_f32_32x32x16_bf16 v[112:127], v[164:167], v[140:143], v[112:127]
    buffer_load_dwordx4 a[56:59], v1, s[4:7], s40 offen offset:0 sc1
    v_exp_f32 v41, v41
    v_exp_f32 v42, v42
    v_exp_f32 v43, v43
    v_cvt_pk_bf16_f32 v131, v38, v39
    v_mfma_f32_16x16x32_bf16 v[180:183], v[184:187], v[136:139], v[180:183]
    buffer_load_dwordx4 a[60:63], v1, s[4:7], s40 offen offset:1024 sc1
    v_exp_f32 v44, v44
    v_exp_f32 v45, v45
    v_cvt_pk_bf16_f32 v132, v40, v41
    v_cvt_pk_bf16_f32 v133, v42, v43
    v_mfma_f32_16x16x32_bf16 v[180:183], v[184:187], v[140:143], v[180:183]
    s_waitcnt lgkmcnt(0)
    v_exp_f32 v46, v46
    v_exp_f32 v47, v47
    v_cvt_pk_bf16_f32 v134, v44, v45
    v_cvt_pk_bf16_f32 v135, v46, v47
    v_mfma_f32_32x32x16_bf16 v[32:47], v[144:147], a[96:99], v[64:79]
    s_add_u32 s48, s48, 65536
    v_exp_f32 v48, v48
    v_exp_f32 v49, v49
    v_exp_f32 v50, v50
    v_cvt_pk_bf16_f32 v136, v48, v49
    v_mfma_f32_32x32x16_bf16 v[32:47], v[148:151], a[100:103], v[32:47]
    v_exp_f32 v51, v51
    v_exp_f32 v52, v52
    v_exp_f32 v53, v53
    v_cvt_pk_bf16_f32 v137, v50, v51
    v_mfma_f32_32x32x16_bf16 v[96:111], v[168:171], v[128:131], v[96:111]
    ds_read_b128 v[152:155], v9 offset:53248
    v_exp_f32 v54, v54
    v_exp_f32 v55, v55
    v_exp_f32 v56, v56
    v_cvt_pk_bf16_f32 v138, v52, v53
    v_mfma_f32_32x32x16_bf16 v[96:111], v[172:175], v[132:135], v[96:111]
    ds_read_b128 v[156:159], v9 offset:53760
    v_exp_f32 v57, v57
    v_exp_f32 v58, v58
    v_exp_f32 v59, v59
    v_cvt_pk_bf16_f32 v139, v54, v55
    v_mfma_f32_16x16x32_bf16 v[176:179], v[184:187], v[128:131], v[176:179]
    ds_read_b128 v[160:163], v8 offset:51200
    v_exp_f32 v60, v60
    v_exp_f32 v61, v61
    v_cvt_pk_bf16_f32 v140, v56, v57
    v_cvt_pk_bf16_f32 v141, v58, v59
    v_mfma_f32_16x16x32_bf16 v[176:179], v[184:187], v[132:135], v[176:179]
    ds_read_b128 v[164:167], v8 offset:51712
    v_exp_f32 v62, v62
    v_exp_f32 v63, v63
    v_cvt_pk_bf16_f32 v142, v60, v61
    v_cvt_pk_bf16_f32 v143, v62, v63
    v_mfma_f32_32x32x16_bf16 v[48:63], v[144:147], a[104:107], v[80:95]
    s_add_u32 s40, s48, s24
    v_exp_f32 v32, v32
    v_exp_f32 v33, v33
    v_exp_f32 v34, v34
    v_cvt_pk_bf16_f32 v128, v32, v33
    v_mfma_f32_32x32x16_bf16 v[48:63], v[148:151], a[108:111], v[48:63]
    buffer_load_dwordx4 a[64:67], v1, s[4:7], s40 offen offset:0 sc1
    v_exp_f32 v35, v35
    v_exp_f32 v36, v36
    v_exp_f32 v37, v37
    v_cvt_pk_bf16_f32 v129, v34, v35
    v_mfma_f32_32x32x16_bf16 v[112:127], v[168:171], v[136:139], v[112:127]
    buffer_load_dwordx4 a[68:71], v1, s[4:7], s40 offen offset:1024 sc1
    v_exp_f32 v38, v38
    v_exp_f32 v39, v39
    v_exp_f32 v40, v40
    v_cvt_pk_bf16_f32 v130, v36, v37
    v_mfma_f32_32x32x16_bf16 v[112:127], v[172:175], v[140:143], v[112:127]
    s_add_u32 s40, s48, s25
    v_exp_f32 v41, v41
    v_exp_f32 v42, v42
    v_exp_f32 v43, v43
    v_cvt_pk_bf16_f32 v131, v38, v39
    v_mfma_f32_16x16x32_bf16 v[180:183], v[184:187], v[136:139], v[180:183]
    buffer_load_dwordx4 a[72:75], v1, s[4:7], s40 offen offset:0 sc1
    v_exp_f32 v44, v44
    v_exp_f32 v45, v45
    v_cvt_pk_bf16_f32 v132, v40, v41
    v_cvt_pk_bf16_f32 v133, v42, v43
    v_mfma_f32_16x16x32_bf16 v[180:183], v[184:187], v[140:143], v[180:183]
    s_waitcnt lgkmcnt(0)
    v_exp_f32 v46, v46
    v_exp_f32 v47, v47
    v_cvt_pk_bf16_f32 v134, v44, v45
    v_cvt_pk_bf16_f32 v135, v46, v47
    v_mfma_f32_32x32x16_bf16 v[32:47], v[152:155], a[96:99], v[64:79]
    buffer_load_dwordx4 a[76:79], v1, s[4:7], s40 offen offset:1024 sc1
    v_exp_f32 v48, v48
    v_exp_f32 v49, v49
    v_exp_f32 v50, v50
    v_cvt_pk_bf16_f32 v136, v48, v49
    v_mfma_f32_32x32x16_bf16 v[32:47], v[156:159], a[100:103], v[32:47]
    v_exp_f32 v51, v51
    v_exp_f32 v52, v52
    v_exp_f32 v53, v53
    v_cvt_pk_bf16_f32 v137, v50, v51
    v_mfma_f32_32x32x16_bf16 v[96:111], v[160:163], v[128:131], v[96:111]
    ds_read_b128 v[144:147], v9 offset:57344
    v_exp_f32 v54, v54
    v_exp_f32 v55, v55
    v_exp_f32 v56, v56
    v_cvt_pk_bf16_f32 v138, v52, v53
    v_mfma_f32_32x32x16_bf16 v[96:111], v[164:167], v[132:135], v[96:111]
    ds_read_b128 v[148:151], v9 offset:57856
    v_exp_f32 v57, v57
    v_exp_f32 v58, v58
    v_exp_f32 v59, v59
    v_cvt_pk_bf16_f32 v139, v54, v55
    v_mfma_f32_16x16x32_bf16 v[176:179], v[184:187], v[128:131], v[176:179]
    ds_read_b128 v[168:171], v8 offset:55296
    v_exp_f32 v60, v60
    v_exp_f32 v61, v61
    v_cvt_pk_bf16_f32 v140, v56, v57
    v_cvt_pk_bf16_f32 v141, v58, v59
    v_mfma_f32_16x16x32_bf16 v[176:179], v[184:187], v[132:135], v[176:179]
    ds_read_b128 v[172:175], v8 offset:55808
    v_exp_f32 v62, v62
    v_exp_f32 v63, v63
    v_cvt_pk_bf16_f32 v142, v60, v61
    v_cvt_pk_bf16_f32 v143, v62, v63
    v_mfma_f32_32x32x16_bf16 v[48:63], v[152:155], a[104:107], v[80:95]
    s_add_u32 s40, s48, s26
    v_exp_f32 v32, v32
    v_exp_f32 v33, v33
    v_exp_f32 v34, v34
    v_cvt_pk_bf16_f32 v128, v32, v33
    v_mfma_f32_32x32x16_bf16 v[48:63], v[156:159], a[108:111], v[48:63]
    buffer_load_dwordx4 a[80:83], v1, s[4:7], s40 offen offset:0 sc1
    v_exp_f32 v35, v35
    v_exp_f32 v36, v36
    v_exp_f32 v37, v37
    v_cvt_pk_bf16_f32 v129, v34, v35
    v_mfma_f32_32x32x16_bf16 v[112:127], v[160:163], v[136:139], v[112:127]
    buffer_load_dwordx4 a[84:87], v1, s[4:7], s40 offen offset:1024 sc1
    v_exp_f32 v38, v38
    v_exp_f32 v39, v39
    v_exp_f32 v40, v40
    v_cvt_pk_bf16_f32 v130, v36, v37
    v_mfma_f32_32x32x16_bf16 v[112:127], v[164:167], v[140:143], v[112:127]
    s_add_u32 s40, s48, s27
    v_exp_f32 v41, v41
    v_exp_f32 v42, v42
    v_exp_f32 v43, v43
    v_cvt_pk_bf16_f32 v131, v38, v39
    v_mfma_f32_16x16x32_bf16 v[180:183], v[184:187], v[136:139], v[180:183]
    buffer_load_dwordx4 a[88:91], v1, s[4:7], s40 offen offset:0 sc1
    v_exp_f32 v44, v44
    v_exp_f32 v45, v45
    v_cvt_pk_bf16_f32 v132, v40, v41
    v_cvt_pk_bf16_f32 v133, v42, v43
    v_mfma_f32_16x16x32_bf16 v[180:183], v[184:187], v[140:143], v[180:183]
    s_waitcnt lgkmcnt(0)
    v_exp_f32 v46, v46
    v_exp_f32 v47, v47
    v_cvt_pk_bf16_f32 v134, v44, v45
    v_cvt_pk_bf16_f32 v135, v46, v47
    v_mfma_f32_32x32x16_bf16 v[32:47], v[144:147], a[96:99], v[64:79]
    buffer_load_dwordx4 a[92:95], v1, s[4:7], s40 offen offset:1024 sc1
    v_exp_f32 v48, v48
    v_exp_f32 v49, v49
    v_exp_f32 v50, v50
    v_cvt_pk_bf16_f32 v136, v48, v49
    v_mfma_f32_32x32x16_bf16 v[32:47], v[148:151], a[100:103], v[32:47]
    v_exp_f32 v51, v51
    v_exp_f32 v52, v52
    v_exp_f32 v53, v53
    v_cvt_pk_bf16_f32 v137, v50, v51
    v_mfma_f32_32x32x16_bf16 v[96:111], v[168:171], v[128:131], v[96:111]
    ds_read_b128 v[152:155], v9 offset:61440
    v_exp_f32 v54, v54
    v_exp_f32 v55, v55
    v_exp_f32 v56, v56
    v_cvt_pk_bf16_f32 v138, v52, v53
    v_mfma_f32_32x32x16_bf16 v[96:111], v[172:175], v[132:135], v[96:111]
    ds_read_b128 v[156:159], v9 offset:61952
    v_exp_f32 v57, v57
    v_exp_f32 v58, v58
    v_exp_f32 v59, v59
    v_cvt_pk_bf16_f32 v139, v54, v55
    v_mfma_f32_16x16x32_bf16 v[176:179], v[184:187], v[128:131], v[176:179]
    ds_read_b128 v[160:163], v8 offset:59392
    v_exp_f32 v60, v60
    v_exp_f32 v61, v61
    v_cvt_pk_bf16_f32 v140, v56, v57
    v_cvt_pk_bf16_f32 v141, v58, v59
    v_mfma_f32_16x16x32_bf16 v[176:179], v[184:187], v[132:135], v[176:179]
    ds_read_b128 v[164:167], v8 offset:59904
    v_exp_f32 v62, v62
    v_exp_f32 v63, v63
    v_cvt_pk_bf16_f32 v142, v60, v61
    v_cvt_pk_bf16_f32 v143, v62, v63
    v_mfma_f32_32x32x16_bf16 v[48:63], v[144:147], a[104:107], v[80:95]
    s_add_u32 s40, s48, s28
    v_exp_f32 v32, v32
    v_exp_f32 v33, v33
    v_exp_f32 v34, v34
    v_cvt_pk_bf16_f32 v128, v32, v33
    v_mfma_f32_32x32x16_bf16 v[48:63], v[148:151], a[108:111], v[48:63]
    buffer_load_dwordx4 a[192:195], v1, s[4:7], s40 offen offset:0 sc1
    v_exp_f32 v35, v35
    v_exp_f32 v36, v36
    v_exp_f32 v37, v37
    v_cvt_pk_bf16_f32 v129, v34, v35
    v_mfma_f32_32x32x16_bf16 v[112:127], v[168:171], v[136:139], v[112:127]
    buffer_load_dwordx4 a[196:199], v1, s[4:7], s40 offen offset:1024 sc1
    v_exp_f32 v38, v38
    v_exp_f32 v39, v39
    v_exp_f32 v40, v40
    v_cvt_pk_bf16_f32 v130, v36, v37
    v_mfma_f32_32x32x16_bf16 v[112:127], v[172:175], v[140:143], v[112:127]
    s_add_u32 s40, s48, s29
    v_exp_f32 v41, v41
    v_exp_f32 v42, v42
    v_exp_f32 v43, v43
    v_cvt_pk_bf16_f32 v131, v38, v39
    v_mfma_f32_16x16x32_bf16 v[180:183], v[184:187], v[136:139], v[180:183]
    buffer_load_dwordx4 a[200:203], v1, s[4:7], s40 offen offset:0 sc1
    v_exp_f32 v44, v44
    v_exp_f32 v45, v45
    v_cvt_pk_bf16_f32 v132, v40, v41
    v_cvt_pk_bf16_f32 v133, v42, v43
    v_mfma_f32_16x16x32_bf16 v[180:183], v[184:187], v[140:143], v[180:183]
    s_waitcnt lgkmcnt(0)
    v_exp_f32 v46, v46
    v_exp_f32 v47, v47
    v_cvt_pk_bf16_f32 v134, v44, v45
    v_cvt_pk_bf16_f32 v135, v46, v47
    v_mfma_f32_32x32x16_bf16 v[32:47], v[152:155], a[96:99], v[64:79]
    buffer_load_dwordx4 a[204:207], v1, s[4:7], s40 offen offset:1024 sc1
    v_exp_f32 v48, v48
    v_exp_f32 v49, v49
    v_exp_f32 v50, v50
    v_cvt_pk_bf16_f32 v136, v48, v49
    v_mfma_f32_32x32x16_bf16 v[32:47], v[156:159], a[100:103], v[32:47]
    v_exp_f32 v51, v51
    v_exp_f32 v52, v52
    v_exp_f32 v53, v53
    v_cvt_pk_bf16_f32 v137, v50, v51
    v_mfma_f32_32x32x16_bf16 v[96:111], v[160:163], v[128:131], v[96:111]
    v_exp_f32 v54, v54
    v_exp_f32 v55, v55
    v_exp_f32 v56, v56
    v_cvt_pk_bf16_f32 v138, v52, v53
    v_mfma_f32_32x32x16_bf16 v[96:111], v[164:167], v[132:135], v[96:111]
    v_exp_f32 v57, v57
    v_exp_f32 v58, v58
    v_exp_f32 v59, v59
    v_cvt_pk_bf16_f32 v139, v54, v55
    v_mfma_f32_16x16x32_bf16 v[176:179], v[184:187], v[128:131], v[176:179]
    ds_read_b128 v[168:171], v8 offset:63488
    v_exp_f32 v60, v60
    v_exp_f32 v61, v61
    v_cvt_pk_bf16_f32 v140, v56, v57
    v_cvt_pk_bf16_f32 v141, v58, v59
    v_mfma_f32_16x16x32_bf16 v[176:179], v[184:187], v[132:135], v[176:179]
    ds_read_b128 v[172:175], v8 offset:64000
    v_exp_f32 v62, v62
    v_exp_f32 v63, v63
    v_cvt_pk_bf16_f32 v142, v60, v61
    v_cvt_pk_bf16_f32 v143, v62, v63
    v_mfma_f32_32x32x16_bf16 v[48:63], v[152:155], a[104:107], v[80:95]
    s_add_u32 s40, s48, s30
    v_exp_f32 v32, v32
    v_exp_f32 v33, v33
    v_exp_f32 v34, v34
    v_cvt_pk_bf16_f32 v128, v32, v33
    v_mfma_f32_32x32x16_bf16 v[48:63], v[156:159], a[108:111], v[48:63]
    buffer_load_dwordx4 a[208:211], v1, s[4:7], s40 offen offset:0 sc1
    v_exp_f32 v35, v35
    v_exp_f32 v36, v36
    v_exp_f32 v37, v37
    v_cvt_pk_bf16_f32 v129, v34, v35
    v_mfma_f32_32x32x16_bf16 v[112:127], v[160:163], v[136:139], v[112:127]
    buffer_load_dwordx4 a[212:215], v1, s[4:7], s40 offen offset:1024 sc1
    v_exp_f32 v38, v38
    v_exp_f32 v39, v39
    v_exp_f32 v40, v40
    v_cvt_pk_bf16_f32 v130, v36, v37
    v_mfma_f32_32x32x16_bf16 v[112:127], v[164:167], v[140:143], v[112:127]
    s_add_u32 s40, s48, s31
    v_exp_f32 v41, v41
    v_exp_f32 v42, v42
    v_exp_f32 v43, v43
    v_cvt_pk_bf16_f32 v131, v38, v39
    v_mfma_f32_16x16x32_bf16 v[180:183], v[184:187], v[136:139], v[180:183]
    buffer_load_dwordx4 a[216:219], v1, s[4:7], s40 offen offset:0 sc1
    v_exp_f32 v44, v44
    v_exp_f32 v45, v45
    v_cvt_pk_bf16_f32 v132, v40, v41
    v_cvt_pk_bf16_f32 v133, v42, v43
    v_mfma_f32_16x16x32_bf16 v[180:183], v[184:187], v[140:143], v[180:183]
    s_waitcnt lgkmcnt(0)
    v_exp_f32 v46, v46
    v_exp_f32 v47, v47
    v_cvt_pk_bf16_f32 v134, v44, v45
    v_cvt_pk_bf16_f32 v135, v46, v47
    buffer_load_dwordx4 a[220:223], v1, s[4:7], s40 offen offset:1024 sc1
    v_exp_f32 v48, v48
    v_exp_f32 v49, v49
    v_exp_f32 v50, v50
    v_cvt_pk_bf16_f32 v136, v48, v49
    v_exp_f32 v51, v51
    v_exp_f32 v52, v52
    v_exp_f32 v53, v53
    v_cvt_pk_bf16_f32 v137, v50, v51
    v_mfma_f32_32x32x16_bf16 v[96:111], v[168:171], v[128:131], v[96:111]
    v_exp_f32 v54, v54
    v_exp_f32 v55, v55
    v_exp_f32 v56, v56
    v_cvt_pk_bf16_f32 v138, v52, v53
    v_mfma_f32_32x32x16_bf16 v[96:111], v[172:175], v[132:135], v[96:111]
    v_exp_f32 v57, v57
    v_exp_f32 v58, v58
    v_exp_f32 v59, v59
    v_cvt_pk_bf16_f32 v139, v54, v55
    v_mfma_f32_16x16x32_bf16 v[176:179], v[184:187], v[128:131], v[176:179]
    v_exp_f32 v60, v60
    v_exp_f32 v61, v61
    v_cvt_pk_bf16_f32 v140, v56, v57
    v_cvt_pk_bf16_f32 v141, v58, v59
    v_mfma_f32_16x16x32_bf16 v[176:179], v[184:187], v[132:135], v[176:179]
    v_exp_f32 v62, v62
    v_exp_f32 v63, v63
    v_cvt_pk_bf16_f32 v142, v60, v61
    v_cvt_pk_bf16_f32 v143, v62, v63
    s_branch L_at_after
L_at_spin:
    v_and_b32 v12, 127, v14
    s_mov_b32 s73, 0x40000
L_poll6:
    buffer_load_dword v13, v12, s[4:7], s65 offen sc1
    s_waitcnt vmcnt(0)
    v_cmp_ne_u32 vcc, s72, v13
    s_cmp_eq_u64 vcc, 0
    s_cbranch_scc1 L_poll6_done
    s_sub_u32 s73, s73, 1
    s_cbranch_scc1 L_poll6_done
    s_sleep 1
    s_branch L_poll6
L_poll6_done:
    s_branch L_at_spinback
L_at_spinkv:
    v_and_b32 v12, 127, v14
    s_mov_b32 s73, 0x40000
L_poll7:
    buffer_load_dword v13, v12, s[4:7], s44 offen sc1
    s_waitcnt vmcnt(0)
    v_cmp_ne_u32 vcc, s72, v13
    s_cmp_eq_u64 vcc, 0
    s_cbranch_scc1 L_poll7_done
    s_sub_u32 s73, s73, 1
    s_cbranch_scc1 L_poll7_done
    s_sleep 1
    s_branch L_poll7
L_poll7_done:
    s_branch L_at_spinkvback
L_at_restart:
    s_waitcnt vmcnt(0) lgkmcnt(0)
    s_barrier
    s_lshl_b32 s42, s57, 15
    v_and_b32 v4, 127, v14
    s_add_u32 m0, s45, 0
    s_nop 0
    s_add_u32 s43, s59, s42
    buffer_load_dwordx4 v1, s[4:7], s43 offen offset:0 sc1 lds
    buffer_load_dwordx4 v1, s[4:7], s43 offen offset:1024 sc1 lds
    buffer_load_dwordx4 v1, s[4:7], s43 offen offset:2048 sc1 lds
    buffer_load_dwordx4 v1, s[4:7], s43 offen offset:3072 sc1 lds
    s_add_u32 s42, s42, 16384
    s_and_b32 s42, s42, 0x3ffff
    s_add_u32 m0, s45, 16384
    s_nop 0
    s_add_u32 s43, s59, s42
    buffer_load_dwordx4 v1, s[4:7], s43 offen offset:0 sc1 lds
    buffer_load_dwordx4 v1, s[4:7], s43 offen offset:1024 sc1 lds
    buffer_load_dwordx4 v1, s[4:7], s43 offen offset:2048 sc1 lds
    buffer_load_dwordx4 v1, s[4:7], s43 offen offset:3072 sc1 lds
    s_add_u32 s42, s42, 16384
    s_and_b32 s42, s42, 0x3ffff
    v_mov_b32 v10, 0xff800000
    v_mov_b32 v11, 0xff800000
    s_mov_b32 s62, s58
    s_mov_b32 s60, 64
L_at_maxloop:
    buffer_load_dwordx4 a[112:115], v25, s[4:7], s62 offen sc1
    buffer_load_dwordx4 a[116:119], v25, s[4:7], s62 offen offset:512 sc1
    s_waitcnt vmcnt(0)
    v_mfma_f32_32x32x16_bf16 v[32:47], a[112:115], a[96:99], 0
    v_mfma_f32_32x32x16_bf16 v[32:47], a[116:119], a[100:103], v[32:47]
    v_mfma_f32_32x32x16_bf16 v[48:63], a[112:115], a[104:107], 0
    v_mfma_f32_32x32x16_bf16 v[48:63], a[116:119], a[108:111], v[48:63]
    v_mov_b32 v96, 0
    v_mov_b32 v97, 0
    v_mov_b32 v98, 0
    v_mov_b32 v99, 0
    v_mov_b32 v100, 0
    v_mov_b32 v101, 0
    v_mov_b32 v102, 0
    v_mov_b32 v103, 0
    v_mov_b32 v104, 0
    v_mov_b32 v105, 0
    v_mov_b32 v106, 0
    v_mov_b32 v107, 0
    v_mov_b32 v108, 0
    v_mov_b32 v109, 0
    v_mov_b32 v110, 0
    v_mov_b32 v111, 0
    v_mov_b32 v112, 0
    v_mov_b32 v113, 0
    v_mov_b32 v114, 0
    v_mov_b32 v115, 0
    v_mov_b32 v116, 0
    v_mov_b32 v117, 0
    v_mov_b32 v118, 0
    v_mov_b32 v119, 0
    v_mov_b32 v120, 0
    v_mov_b32 v121, 0
    v_mov_b32 v122, 0
    v_mov_b32 v123, 0
    v_mov_b32 v124, 0
    v_mov_b32 v125, 0
    v_mov_b32 v126, 0
    v_mov_b32 v127, 0
    v_max3_f32 v10, v32, v33, v10
    v_max3_f32 v10, v34, v35, v10
    v_max3_f32 v10, v36, v37, v10
    v_max3_f32 v10, v38, v39, v10
    v_max3_f32 v10, v40, v41, v10
    v_max3_f32 v10, v42, v43, v10
    v_max3_f32 v10, v44, v45, v10
    v_max3_f32 v10, v46, v47, v10
    v_max3_f32 v11, v48, v49, v11
    v_max3_f32 v11, v50, v51, v11
    v_max3_f32 v11, v52, v53, v11
    v_max3_f32 v11, v54, v55, v11
    v_max3_f32 v11, v56, v57, v11
    v_max3_f32 v11, v58, v59, v11
    v_max3_f32 v11, v60, v61, v11
    v_max3_f32 v11, v62, v63, v11
    s_add_u32 s62, s62, 4096
    s_sub_u32 s60, s60, 1
    s_cmp_lg_u32 s60, 0
    s_cbranch_scc1 L_at_maxloop
    s_barrier
    ds_read_b128 v[144:147], v25 offset:0
    ds_read_b128 v[148:151], v25 offset:512
    ds_read_b128 v[152:155], v25 offset:4096
    ds_read_b128 v[156:159], v25 offset:4608
    ds_read_b128 v[160:163], v24 offset:2048
    ds_read_b128 v[164:167], v24 offset:2560
    s_branch L_at_maxdone
L_at_after:
    v_mfma_f32_32x32x16_bf16 v[112:127], v[168:171], v[136:139], v[112:127]
    v_mfma_f32_32x32x16_bf16 v[112:127], v[172:175], v[140:143], v[112:127]
    v_mfma_f32_16x16x32_bf16 v[180:183], v[184:187], v[136:139], v[180:183]
    v_mfma_f32_16x16x32_bf16 v[180:183], v[184:187], v[140:143], v[180:183]
    v_lshrrev_b32 v10, 2, v18
    v_and_b32 v11, 3, v18
    v_lshlrev_b32 v11, 3, v11
    v_lshl_add_u32 v12, v10, 8, v11
    v_and_b32 v13, 7, v10
    v_mov_b32 v26, 0
    v_max3_f32 v26, abs(v96), abs(v97), v26
    v_max3_f32 v26, abs(v98), abs(v99), v26
    v_max3_f32 v26, abs(v100), abs(v101), v26
    v_max3_f32 v26, abs(v102), abs(v103), v26
    v_max3_f32 v26, abs(v104), abs(v105), v26
    v_max3_f32 v26, abs(v106), abs(v107), v26
    v_max3_f32 v26, abs(v108), abs(v109), v26
    v_max3_f32 v26, abs(v110), abs(v111), v26
    v_max3_f32 v26, abs(v112), abs(v113), v26
    v_max3_f32 v26, abs(v114), abs(v115), v26
    v_max3_f32 v26, abs(v116), abs(v117), v26
    v_max3_f32 v26, abs(v118), abs(v119), v26
    v_max3_f32 v26, abs(v120), abs(v121), v26
    v_max3_f32 v26, abs(v122), abs(v123), v26
    v_max3_f32 v26, abs(v124), abs(v125), v26
    v_max3_f32 v26, abs(v126), abs(v127), v26
    v_mov_b32 v177, v176
    v_mov_b32 v181, v180
    s_nop 1
    v_permlane32_swap_b32 v176, v177
    v_permlane32_swap_b32 v180, v181
    v_add_f32 v27, v176, v180
    v_mov_b32 v28, 0x5f800000
    v_cmp_nle_f32 vcc, v27, v28
    v_mov_b32 v28, 0x7f000000
    v_cmp_nle_f32 s[66:67], v26, v28
    s_lshl_b32 s33, s46, 2
    s_add_u32 s33, s33, 147456
    s_or_b64 vcc, vcc, s[66:67]
    s_cselect_b32 s3, 1, 0
    v_mov_b32 v27, s33
    v_mov_b32 v26, s3
    ds_write_b32 v27, v26
    v_mov_b32 v27, 147456
    v_xor_b32 v15, 0, v13
    v_lshl_add_u32 v2, v15, 5, v12
    v_xor_b32 v15, 1, v13
    v_lshl_add_u32 v3, v15, 5, v12
    v_xor_b32 v15, 2, v13
    v_lshl_add_u32 v4, v15, 5, v12
    v_xor_b32 v15, 3, v13
    v_lshl_add_u32 v5, v15, 5, v12
    v_xor_b32 v15, 4, v13
    v_lshl_add_u32 v6, v15, 5, v12
    v_xor_b32 v15, 5, v13
    v_lshl_add_u32 v7, v15, 5, v12
    v_xor_b32 v15, 6, v13
    v_lshl_add_u32 v8, v15, 5, v12
    v_xor_b32 v15, 7, v13
    v_lshl_add_u32 v9, v15, 5, v12
    s_waitcnt vmcnt(48) lgkmcnt(0)
    s_barrier
    ds_read_b128 v[28:31], v27
    ds_read_b64_tr_b16 v[64:65], v6 offset:0
    ds_read_b64_tr_b16 v[66:67], v6 offset:4096
    ds_read_b64_tr_b16 v[128:129], v6 offset:8192
    ds_read_b64_tr_b16 v[130:131], v6 offset:12288
    ds_read_b64_tr_b16 v[68:69], v7 offset:0
    ds_read_b64_tr_b16 v[70:71], v7 offset:4096
    ds_read_b64_tr_b16 v[132:133], v7 offset:8192
    ds_read_b64_tr_b16 v[134:135], v7 offset:12288
    ds_read_b64_tr_b16 v[72:73], v8 offset:0
    ds_read_b64_tr_b16 v[74:75], v8 offset:4096
    ds_read_b64_tr_b16 v[136:137], v8 offset:8192
    ds_read_b64_tr_b16 v[138:139], v8 offset:12288
    v_rcp_f32 v22, v176
    v_rcp_f32 v23, v180
    s_waitcnt lgkmcnt(12)
    v_or3_b32 v28, v28, v29, v30
    v_or_b32 v28, v28, v31
    ds_read_b64_tr_b16 v[76:77], v9 offset:0
    ds_read_b64_tr_b16 v[78:79], v9 offset:4096
    ds_read_b64_tr_b16 v[140:141], v9 offset:8192
    ds_read_b64_tr_b16 v[142:143], v9 offset:12288
    ds_read_b64_tr_b16 v[80:81], v2 offset:0
    ds_read_b64_tr_b16 v[82:83], v2 offset:4096
    ds_read_b64_tr_b16 v[144:145], v2 offset:8192
    ds_read_b64_tr_b16 v[146:147], v2 offset:12288
    ds_read_b64_tr_b16 v[84:85], v3 offset:0
    ds_read_b64_tr_b16 v[86:87], v3 offset:4096
    ds_read_b64_tr_b16 v[148:149], v3 offset:8192
    ds_read_b64_tr_b16 v[150:151], v3 offset:12288
    ds_read_b64_tr_b16 v[88:89], v4 offset:0
    ds_read_b64_tr_b16 v[90:91], v4 offset:4096
    ds_read_b64_tr_b16 v[152:153], v4 offset:8192
    ds_read_b64_tr_b16 v[154:155], v4 offset:12288
    v_readfirstlane_b32 s3, v28
    s_cmp_eq_u32 s61, 1
    s_cselect_b32 s3, s3, 0
    s_mov_b32 s61, 64
    s_cmp_lg_u32 s3, 0
    s_cbranch_scc1 L_at_restart
    s_waitcnt lgkmcnt(12)
    v_mfma_f32_16x16x32_bf16 v[224:227], v[64:67], a[128:131], 0
    s_lshl_b32 s62, s57, 1
    ds_read_b64_tr_b16 v[92:93], v5 offset:0
    s_add_u32 s62, s62, s47
    v_mfma_f32_16x16x32_bf16 v[224:227], v[128:131], a[136:139], v[224:227]
    s_lshl_b32 s62, s62, 5
    ds_read_b64_tr_b16 v[94:95], v5 offset:4096
    v_mfma_f32_16x16x32_bf16 v[228:231], v[128:131], a[140:143], 0
    s_add_u32 s62, s62, s56
    ds_read_b64_tr_b16 v[156:157], v5 offset:8192
    v_mfma_f32_16x16x32_bf16 v[228:231], v[64:67], a[132:135], v[228:231]
    s_lshl_b32 s62, s62, 13
    ds_read_b64_tr_b16 v[158:159], v5 offset:12288
    v_mfma_f32_16x16x32_bf16 v[236:239], v[68:71], a[132:135], 0
    s_lshl_b32 s33, s64, 12
    ds_read_b64_tr_b16 v[64:65], v6 offset:16384
    v_mfma_f32_16x16x32_bf16 v[236:239], v[132:135], a[140:143], v[236:239]
    s_add_u32 s62, s62, s33
    ds_read_b64_tr_b16 v[66:67], v6 offset:20480
    v_mfma_f32_16x16x32_bf16 v[232:235], v[132:135], a[136:139], 0
    s_add_u32 s62, s62, 33554432
    ds_read_b64_tr_b16 v[128:129], v6 offset:24576
    v_mfma_f32_16x16x32_bf16 v[232:235], v[68:71], a[128:131], v[232:235]
    ds_read_b64_tr_b16 v[130:131], v6 offset:28672
    v_mul_f32 v96, v96, v22
    v_mfma_f32_16x16x32_bf16 v[240:243], v[72:75], a[128:131], 0
    ds_read_b64_tr_b16 v[68:69], v7 offset:16384
    v_mul_f32 v97, v97, v22
    v_mul_f32 v98, v98, v22
    v_mfma_f32_16x16x32_bf16 v[240:243], v[136:139], a[136:139], v[240:243]
    ds_read_b64_tr_b16 v[70:71], v7 offset:20480
    v_mul_f32 v99, v99, v22
    v_mfma_f32_16x16x32_bf16 v[244:247], v[136:139], a[140:143], 0
    ds_read_b64_tr_b16 v[132:133], v7 offset:24576
    v_mul_f32 v104, v104, v22
    v_mfma_f32_16x16x32_bf16 v[244:247], v[72:75], a[132:135], v[244:247]
    ds_read_b64_tr_b16 v[134:135], v7 offset:28672
    v_mul_f32 v105, v105, v22
    v_mfma_f32_16x16x32_bf16 v[252:255], v[76:79], a[132:135], 0
    ds_read_b64_tr_b16 v[72:73], v8 offset:16384
    v_mul_f32 v106, v106, v22
    v_mfma_f32_16x16x32_bf16 v[252:255], v[140:143], a[140:143], v[252:255]
    ds_read_b64_tr_b16 v[74:75], v8 offset:20480
    v_mul_f32 v107, v107, v22
    v_mfma_f32_16x16x32_bf16 v[248:251], v[140:143], a[136:139], 0
    ds_read_b64_tr_b16 v[136:137], v8 offset:24576
    v_cvt_pk_bf16_f32 v32, v96, v97
    v_mfma_f32_16x16x32_bf16 v[248:251], v[76:79], a[128:131], v[248:251]
    ds_read_b64_tr_b16 v[138:139], v8 offset:28672
    v_cvt_pk_bf16_f32 v33, v98, v99
    s_waitcnt lgkmcnt(12)
    v_mfma_f32_16x16x32_bf16 v[192:195], v[80:83], a[128:131], 0
    ds_read_b64_tr_b16 v[76:77], v9 offset:16384
    v_cvt_pk_bf16_f32 v34, v104, v105
    v_cvt_pk_bf16_f32 v35, v106, v107
    v_mfma_f32_16x16x32_bf16 v[192:195], v[144:147], a[136:139], v[192:195]
    ds_read_b64_tr_b16 v[78:79], v9 offset:20480
    buffer_store_dwordx4 v[32:35], v24, s[4:7], s62 offen offset:0 sc1
    v_mfma_f32_16x16x32_bf16 v[196:199], v[144:147], a[140:143], 0
    ds_read_b64_tr_b16 v[140:141], v9 offset:24576
    v_mul_f32 v100, v100, v22
    v_mfma_f32_16x16x32_bf16 v[196:199], v[80:83], a[132:135], v[196:199]
    ds_read_b64_tr_b16 v[142:143], v9 offset:28672
    v_mul_f32 v101, v101, v22
    v_mfma_f32_16x16x32_bf16 v[204:207], v[84:87], a[132:135], 0
    ds_read_b64_tr_b16 v[80:81], v2 offset:16384
    v_mul_f32 v102, v102, v22
    v_mfma_f32_16x16x32_bf16 v[204:207], v[148:151], a[140:143], v[204:207]
    ds_read_b64_tr_b16 v[82:83], v2 offset:20480
    v_mul_f32 v103, v103, v22
    v_mfma_f32_16x16x32_bf16 v[200:203], v[148:151], a[136:139], 0
    ds_read_b64_tr_b16 v[144:145], v2 offset:24576
    v_mul_f32 v108, v108, v22
    v_mfma_f32_16x16x32_bf16 v[200:203], v[84:87], a[128:131], v[200:203]
    ds_read_b64_tr_b16 v[146:147], v2 offset:28672
    v_mul_f32 v109, v109, v22
    v_mfma_f32_16x16x32_bf16 v[208:211], v[88:91], a[128:131], 0
    ds_read_b64_tr_b16 v[84:85], v3 offset:16384
    v_mul_f32 v110, v110, v22
    v_mul_f32 v111, v111, v22
    v_mfma_f32_16x16x32_bf16 v[208:211], v[152:155], a[136:139], v[208:211]
    ds_read_b64_tr_b16 v[86:87], v3 offset:20480
    v_cvt_pk_bf16_f32 v36, v100, v101
    v_mfma_f32_16x16x32_bf16 v[212:215], v[152:155], a[140:143], 0
    ds_read_b64_tr_b16 v[148:149], v3 offset:24576
    v_cvt_pk_bf16_f32 v37, v102, v103
    v_mfma_f32_16x16x32_bf16 v[212:215], v[88:91], a[132:135], v[212:215]
    ds_read_b64_tr_b16 v[150:151], v3 offset:28672
    v_cvt_pk_bf16_f32 v38, v108, v109
    v_mfma_f32_16x16x32_bf16 v[220:223], v[92:95], a[132:135], 0
    ds_read_b64_tr_b16 v[88:89], v4 offset:16384
    v_cvt_pk_bf16_f32 v39, v110, v111
    v_mfma_f32_16x16x32_bf16 v[220:223], v[156:159], a[140:143], v[220:223]
    ds_read_b64_tr_b16 v[90:91], v4 offset:20480
    buffer_store_dwordx4 v[36:39], v24, s[4:7], s62 offen offset:512 sc1
    v_mfma_f32_16x16x32_bf16 v[216:219], v[156:159], a[136:139], 0
    ds_read_b64_tr_b16 v[152:153], v4 offset:24576
    v_mul_f32 v112, v112, v23
    v_mfma_f32_16x16x32_bf16 v[216:219], v[92:95], a[128:131], v[216:219]
    ds_read_b64_tr_b16 v[154:155], v4 offset:28672
    v_mul_f32 v113, v113, v23
    s_waitcnt vmcnt(50) lgkmcnt(12)
    v_mfma_f32_16x16x32_bf16 v[224:227], v[64:67], a[144:147], v[224:227]
    s_add_u32 s50, s50, 524288
    ds_read_b64_tr_b16 v[92:93], v5 offset:16384
    v_mfma_f32_16x16x32_bf16 v[224:227], v[128:131], a[152:155], v[224:227]
    ds_read_b64_tr_b16 v[94:95], v5 offset:20480
    v_mul_f32 v114, v114, v23
    v_mfma_f32_16x16x32_bf16 v[228:231], v[128:131], a[156:159], v[228:231]
    ds_read_b64_tr_b16 v[156:157], v5 offset:24576
    v_mul_f32 v115, v115, v23
    v_mfma_f32_16x16x32_bf16 v[228:231], v[64:67], a[148:151], v[228:231]
    ds_read_b64_tr_b16 v[158:159], v5 offset:28672
    s_waitcnt vmcnt(42)
    s_barrier
    v_mfma_f32_16x16x32_bf16 v[236:239], v[68:71], a[148:151], v[236:239]
    s_lshl_b32 s3, s24, 3
    ds_read_b64_tr_b16 v[64:65], v6 offset:32768
    v_mul_f32 v120, v120, v23
    v_mfma_f32_16x16x32_bf16 v[236:239], v[132:135], a[156:159], v[236:239]
    s_add_u32 m0, s49, 0
    ds_read_b64_tr_b16 v[66:67], v6 offset:36864
    v_mul_f32 v121, v121, v23
    v_mfma_f32_16x16x32_bf16 v[232:235], v[132:135], a[152:155], v[232:235]
    s_add_u32 s41, s50, s3
    ds_read_b64_tr_b16 v[128:129], v6 offset:40960
    v_mfma_f32_16x16x32_bf16 v[232:235], v[68:71], a[144:147], v[232:235]
    ds_read_b64_tr_b16 v[130:131], v6 offset:45056
    v_mul_f32 v122, v122, v23
    buffer_load_dwordx4 v188, s[8:11], s41 offen  lds
    v_mfma_f32_16x16x32_bf16 v[240:243], v[72:75], a[144:147], v[240:243]
    ds_read_b64_tr_b16 v[68:69], v7 offset:32768
    v_mul_f32 v123, v123, v23
    buffer_load_dwordx4 v190, s[8:11], s41 offen offset:1024  lds
    v_mfma_f32_16x16x32_bf16 v[240:243], v[136:139], a[152:155], v[240:243]
    ds_read_b64_tr_b16 v[70:71], v7 offset:36864
    v_cvt_pk_bf16_f32 v48, v112, v113
    v_mfma_f32_16x16x32_bf16 v[244:247], v[136:139], a[156:159], v[244:247]
    s_lshl_b32 s3, s25, 3
    ds_read_b64_tr_b16 v[132:133], v7 offset:40960
    v_cvt_pk_bf16_f32 v49, v114, v115
    v_mfma_f32_16x16x32_bf16 v[244:247], v[72:75], a[148:151], v[244:247]
    s_add_u32 m0, s49, 8192
    ds_read_b64_tr_b16 v[134:135], v7 offset:45056
    v_cvt_pk_bf16_f32 v50, v120, v121
    v_mfma_f32_16x16x32_bf16 v[252:255], v[76:79], a[148:151], v[252:255]
    s_add_u32 s41, s50, s3
    ds_read_b64_tr_b16 v[72:73], v8 offset:32768
    v_mfma_f32_16x16x32_bf16 v[252:255], v[140:143], a[156:159], v[252:255]
    ds_read_b64_tr_b16 v[74:75], v8 offset:36864
    v_cvt_pk_bf16_f32 v51, v122, v123
    buffer_load_dwordx4 v188, s[8:11], s41 offen  lds
    v_mfma_f32_16x16x32_bf16 v[248:251], v[140:143], a[152:155], v[248:251]
    ds_read_b64_tr_b16 v[136:137], v8 offset:40960
    buffer_store_dwordx4 v[48:51], v24, s[4:7], s62 offen offset:2048 sc1
    buffer_load_dwordx4 v190, s[8:11], s41 offen offset:1024  lds
    v_mfma_f32_16x16x32_bf16 v[248:251], v[76:79], a[144:147], v[248:251]
    ds_read_b64_tr_b16 v[138:139], v8 offset:45056
    v_mul_f32 v116, v116, v23
    s_waitcnt lgkmcnt(12)
    v_mfma_f32_16x16x32_bf16 v[192:195], v[80:83], a[144:147], v[192:195]
    ds_read_b64_tr_b16 v[76:77], v9 offset:32768
    v_mul_f32 v117, v117, v23
    v_mfma_f32_16x16x32_bf16 v[192:195], v[144:147], a[152:155], v[192:195]
    ds_read_b64_tr_b16 v[78:79], v9 offset:36864
    v_mul_f32 v118, v118, v23
    v_mfma_f32_16x16x32_bf16 v[196:199], v[144:147], a[156:159], v[196:199]
    ds_read_b64_tr_b16 v[140:141], v9 offset:40960
    v_mul_f32 v119, v119, v23
    v_mfma_f32_16x16x32_bf16 v[196:199], v[80:83], a[148:151], v[196:199]
    ds_read_b64_tr_b16 v[142:143], v9 offset:45056
    v_mfma_f32_16x16x32_bf16 v[204:207], v[84:87], a[148:151], v[204:207]
    ds_read_b64_tr_b16 v[80:81], v2 offset:32768
    v_mul_f32 v124, v124, v23
    v_mfma_f32_16x16x32_bf16 v[204:207], v[148:151], a[156:159], v[204:207]
    ds_read_b64_tr_b16 v[82:83], v2 offset:36864
    v_mul_f32 v125, v125, v23
    v_mfma_f32_16x16x32_bf16 v[200:203], v[148:151], a[152:155], v[200:203]
    ds_read_b64_tr_b16 v[144:145], v2 offset:40960
    v_mul_f32 v126, v126, v23
    v_mfma_f32_16x16x32_bf16 v[200:203], v[84:87], a[144:147], v[200:203]
    ds_read_b64_tr_b16 v[146:147], v2 offset:45056
    v_mfma_f32_16x16x32_bf16 v[208:211], v[88:91], a[144:147], v[208:211]
    ds_read_b64_tr_b16 v[84:85], v3 offset:32768
    v_mul_f32 v127, v127, v23
    v_mfma_f32_16x16x32_bf16 v[208:211], v[152:155], a[152:155], v[208:211]
    ds_read_b64_tr_b16 v[86:87], v3 offset:36864
    v_cvt_pk_bf16_f32 v52, v116, v117
    v_mfma_f32_16x16x32_bf16 v[212:215], v[152:155], a[156:159], v[212:215]
    ds_read_b64_tr_b16 v[148:149], v3 offset:40960
    v_cvt_pk_bf16_f32 v53, v118, v119
    v_mfma_f32_16x16x32_bf16 v[212:215], v[88:91], a[148:151], v[212:215]
    ds_read_b64_tr_b16 v[150:151], v3 offset:45056
    v_mfma_f32_16x16x32_bf16 v[220:223], v[92:95], a[148:151], v[220:223]
    ds_read_b64_tr_b16 v[88:89], v4 offset:32768
    v_cvt_pk_bf16_f32 v54, v124, v125
    v_mfma_f32_16x16x32_bf16 v[220:223], v[156:159], a[156:159], v[220:223]
    ds_read_b64_tr_b16 v[90:91], v4 offset:36864
    v_cvt_pk_bf16_f32 v55, v126, v127
    v_mfma_f32_16x16x32_bf16 v[216:219], v[156:159], a[152:155], v[216:219]
    ds_read_b64_tr_b16 v[152:153], v4 offset:40960
    buffer_store_dwordx4 v[52:55], v24, s[4:7], s62 offen offset:2560 sc1
    v_mfma_f32_16x16x32_bf16 v[216:219], v[92:95], a[144:147], v[216:219]
    ds_read_b64_tr_b16 v[154:155], v4 offset:45056
    s_waitcnt vmcnt(48) lgkmcnt(12)
    v_mfma_f32_16x16x32_bf16 v[224:227], v[64:67], a[160:163], v[224:227]
    s_lshl_b32 s3, s26, 3
    ds_read_b64_tr_b16 v[92:93], v5 offset:32768
    v_mfma_f32_16x16x32_bf16 v[224:227], v[128:131], a[168:171], v[224:227]
    ds_read_b64_tr_b16 v[94:95], v5 offset:36864
    v_lshrrev_b32 v12, 3, v18
    v_mfma_f32_16x16x32_bf16 v[228:231], v[128:131], a[172:175], v[228:231]
    ds_read_b64_tr_b16 v[156:157], v5 offset:40960
    v_bfe_u32 v13, v18, 1, 2
    v_mfma_f32_16x16x32_bf16 v[228:231], v[64:67], a[164:167], v[228:231]
    ds_read_b64_tr_b16 v[158:159], v5 offset:45056
    s_waitcnt vmcnt(40)
    s_barrier
    v_mfma_f32_16x16x32_bf16 v[236:239], v[68:71], a[164:167], v[236:239]
    s_add_u32 m0, s49, 16384
    ds_read_b64_tr_b16 v[64:65], v6 offset:49152
    v_lshrrev_b32 v15, 4, v18
    v_mfma_f32_16x16x32_bf16 v[236:239], v[132:135], a[172:175], v[236:239]
    s_add_u32 s41, s50, s3
    ds_read_b64_tr_b16 v[66:67], v6 offset:53248
    v_xor_b32 v13, v13, v15
    v_mfma_f32_16x16x32_bf16 v[232:235], v[132:135], a[168:171], v[232:235]
    ds_read_b64_tr_b16 v[128:129], v6 offset:57344
    buffer_load_dwordx4 v188, s[8:11], s41 offen  lds
    v_mfma_f32_16x16x32_bf16 v[232:235], v[68:71], a[160:163], v[232:235]
    ds_read_b64_tr_b16 v[130:131], v6 offset:61440
    v_and_b32 v15, 1, v18
    v_lshlrev_b32 v186, 11, v12
    v_mfma_f32_16x16x32_bf16 v[240:243], v[72:75], a[160:163], v[240:243]
    ds_read_b64_tr_b16 v[68:69], v7 offset:49152
    buffer_load_dwordx4 v190, s[8:11], s41 offen offset:1024  lds
    v_lshl_add_u32 v186, v13, 5, v186
    v_mfma_f32_16x16x32_bf16 v[240:243], v[136:139], a[168:171], v[240:243]
    s_lshl_b32 s3, s27, 3
    ds_read_b64_tr_b16 v[70:71], v7 offset:53248
    v_mfma_f32_16x16x32_bf16 v[244:247], v[136:139], a[172:175], v[244:247]
    ds_read_b64_tr_b16 v[132:133], v7 offset:57344
    v_lshl_add_u32 v186, v15, 4, v186
    s_add_u32 m0, s49, 24576
    v_mfma_f32_16x16x32_bf16 v[244:247], v[72:75], a[164:167], v[244:247]
    ds_read_b64_tr_b16 v[134:135], v7 offset:61440
    v_add_u32 v187, 15360, v186
    s_lshl_b32 s51, s46, 15
    v_mfma_f32_16x16x32_bf16 v[252:255], v[76:79], a[164:167], v[252:255]
    s_add_u32 s41, s50, s3
    ds_read_b64_tr_b16 v[72:73], v8 offset:49152
    v_mfma_f32_16x16x32_bf16 v[252:255], v[140:143], a[172:175], v[252:255]
    s_lshl_b32 s33, s53, 7
    ds_read_b64_tr_b16 v[74:75], v8 offset:53248
    buffer_load_dwordx4 v188, s[8:11], s41 offen  lds
    v_mfma_f32_16x16x32_bf16 v[248:251], v[140:143], a[168:171], v[248:251]
    s_add_u32 s51, s51, s33
    ds_read_b64_tr_b16 v[136:137], v8 offset:57344
    buffer_load_dwordx4 v190, s[8:11], s41 offen offset:1024  lds
    v_mfma_f32_16x16x32_bf16 v[248:251], v[76:79], a[160:163], v[248:251]
    s_add_u32 s63, s63, 4096
    ds_read_b64_tr_b16 v[138:139], v8 offset:61440
    s_waitcnt lgkmcnt(12)
    v_mfma_f32_16x16x32_bf16 v[192:195], v[80:83], a[160:163], v[192:195]
    s_lshl_b32 s3, s24, 4
    ds_read_b64_tr_b16 v[76:77], v9 offset:49152
    v_mfma_f32_16x16x32_bf16 v[192:195], v[144:147], a[168:171], v[192:195]
    ds_read_b64_tr_b16 v[78:79], v9 offset:53248
    v_lshl_add_u32 v12, v10, 7, v11
    v_mfma_f32_16x16x32_bf16 v[196:199], v[144:147], a[172:175], v[196:199]
    s_add_u32 m0, s49, 65536
    ds_read_b64_tr_b16 v[140:141], v9 offset:57344
    v_mfma_f32_16x16x32_bf16 v[196:199], v[80:83], a[164:167], v[196:199]
    ds_read_b64_tr_b16 v[142:143], v9 offset:61440
    v_mfma_f32_16x16x32_bf16 v[204:207], v[84:87], a[164:167], v[204:207]
    s_add_u32 s41, s51, s3
    ds_read_b64_tr_b16 v[80:81], v2 offset:49152
    v_mfma_f32_16x16x32_bf16 v[204:207], v[148:151], a[172:175], v[204:207]
    ds_read_b64_tr_b16 v[82:83], v2 offset:53248
    buffer_load_dwordx4 v186, s[12:15], s41 offen  lds
    v_mfma_f32_16x16x32_bf16 v[200:203], v[148:151], a[168:171], v[200:203]
    ds_read_b64_tr_b16 v[144:145], v2 offset:57344
    buffer_load_dwordx4 v187, s[12:15], s41 offen offset:1024  lds
    v_mfma_f32_16x16x32_bf16 v[200:203], v[84:87], a[160:163], v[200:203]
    ds_read_b64_tr_b16 v[146:147], v2 offset:61440
    v_mfma_f32_16x16x32_bf16 v[208:211], v[88:91], a[160:163], v[208:211]
    s_lshl_b32 s3, s25, 4
    ds_read_b64_tr_b16 v[84:85], v3 offset:49152
    v_mfma_f32_16x16x32_bf16 v[208:211], v[152:155], a[168:171], v[208:211]
    ds_read_b64_tr_b16 v[86:87], v3 offset:53248
    v_add_u32 v12, 65536, v12
    v_mfma_f32_16x16x32_bf16 v[212:215], v[152:155], a[172:175], v[212:215]
    s_add_u32 m0, s49, 73728
    ds_read_b64_tr_b16 v[148:149], v3 offset:57344
    v_mfma_f32_16x16x32_bf16 v[212:215], v[88:91], a[164:167], v[212:215]
    ds_read_b64_tr_b16 v[150:151], v3 offset:61440
    v_mfma_f32_16x16x32_bf16 v[220:223], v[92:95], a[164:167], v[220:223]
    s_add_u32 s41, s51, s3
    ds_read_b64_tr_b16 v[88:89], v4 offset:49152
    v_mfma_f32_16x16x32_bf16 v[220:223], v[156:159], a[172:175], v[220:223]
    ds_read_b64_tr_b16 v[90:91], v4 offset:53248
    buffer_load_dwordx4 v186, s[12:15], s41 offen  lds
    v_mfma_f32_16x16x32_bf16 v[216:219], v[156:159], a[168:171], v[216:219]
    ds_read_b64_tr_b16 v[152:153], v4 offset:57344
    buffer_load_dwordx4 v187, s[12:15], s41 offen offset:1024  lds
    v_mfma_f32_16x16x32_bf16 v[216:219], v[92:95], a[160:163], v[216:219]
    ds_read_b64_tr_b16 v[154:155], v4 offset:61440
    s_waitcnt vmcnt(48) lgkmcnt(12)
    v_mfma_f32_16x16x32_bf16 v[224:227], v[64:67], a[176:179], v[224:227]
    s_lshl_b32 s3, s28, 3
    ds_read_b64_tr_b16 v[92:93], v5 offset:49152
    v_mfma_f32_16x16x32_bf16 v[224:227], v[128:131], a[184:187], v[224:227]
    ds_read_b64_tr_b16 v[94:95], v5 offset:53248
    v_bfe_u32 v13, v18, 3, 2
    v_mfma_f32_16x16x32_bf16 v[228:231], v[128:131], a[188:191], v[228:231]
    s_add_u32 m0, s49, 32768
    ds_read_b64_tr_b16 v[156:157], v5 offset:57344
    v_mfma_f32_16x16x32_bf16 v[228:231], v[64:67], a[180:183], v[228:231]
    ds_read_b64_tr_b16 v[158:159], v5 offset:61440
    s_waitcnt vmcnt(9)
    s_barrier
    v_mfma_f32_16x16x32_bf16 v[236:239], v[68:71], a[180:183], v[236:239]
    s_add_u32 s41, s50, s3
    ds_read_b64_tr_b16 v[64:65], v6 offset:0
    v_mfma_f32_16x16x32_bf16 v[236:239], v[132:135], a[188:191], v[236:239]
    ds_read_b64_tr_b16 v[66:67], v6 offset:4096
    buffer_load_dwordx4 v188, s[8:11], s41 offen  lds
    v_mfma_f32_16x16x32_bf16 v[232:235], v[132:135], a[184:187], v[232:235]
    ds_read_b64_tr_b16 v[128:129], v6 offset:8192
    v_xor_b32 v15, 0, v13
    v_mfma_f32_16x16x32_bf16 v[232:235], v[68:71], a[176:179], v[232:235]
    ds_read_b64_tr_b16 v[130:131], v6 offset:12288
    buffer_load_dwordx4 v190, s[8:11], s41 offen offset:1024  lds
    v_mfma_f32_16x16x32_bf16 v[240:243], v[72:75], a[176:179], v[240:243]
    s_lshl_b32 s3, s29, 3
    ds_read_b64_tr_b16 v[68:69], v7 offset:0
    v_mfma_f32_16x16x32_bf16 v[240:243], v[136:139], a[184:187], v[240:243]
    ds_read_b64_tr_b16 v[70:71], v7 offset:4096
    v_mfma_f32_16x16x32_bf16 v[244:247], v[136:139], a[188:191], v[244:247]
    s_add_u32 m0, s49, 40960
    ds_read_b64_tr_b16 v[132:133], v7 offset:8192
    v_mfma_f32_16x16x32_bf16 v[244:247], v[72:75], a[180:183], v[244:247]
    ds_read_b64_tr_b16 v[134:135], v7 offset:12288
    v_lshl_add_u32 v26, v15, 5, v12
    v_mfma_f32_16x16x32_bf16 v[252:255], v[76:79], a[180:183], v[252:255]
    s_add_u32 s41, s50, s3
    ds_read_b64_tr_b16 v[72:73], v8 offset:0
    v_mfma_f32_16x16x32_bf16 v[252:255], v[140:143], a[188:191], v[252:255]
    ds_read_b64_tr_b16 v[74:75], v8 offset:4096
    buffer_load_dwordx4 v188, s[8:11], s41 offen  lds
    v_mfma_f32_16x16x32_bf16 v[248:251], v[140:143], a[184:187], v[248:251]
    ds_read_b64_tr_b16 v[136:137], v8 offset:8192
    buffer_load_dwordx4 v190, s[8:11], s41 offen offset:1024  lds
    v_mfma_f32_16x16x32_bf16 v[248:251], v[76:79], a[176:179], v[248:251]
    ds_read_b64_tr_b16 v[138:139], v8 offset:12288
    s_waitcnt lgkmcnt(12)
    v_mfma_f32_16x16x32_bf16 v[192:195], v[80:83], a[176:179], v[192:195]
    s_lshl_b32 s3, s26, 4
    ds_read_b64_tr_b16 v[76:77], v9 offset:0
    v_mfma_f32_16x16x32_bf16 v[192:195], v[144:147], a[184:187], v[192:195]
    ds_read_b64_tr_b16 v[78:79], v9 offset:4096
    v_xor_b32 v15, 1, v13
    v_mfma_f32_16x16x32_bf16 v[196:199], v[144:147], a[188:191], v[196:199]
    s_add_u32 m0, s49, 81920
    ds_read_b64_tr_b16 v[140:141], v9 offset:8192
    v_mfma_f32_16x16x32_bf16 v[196:199], v[80:83], a[180:183], v[196:199]
    s_add_u32 s41, s51, s3
    ds_read_b64_tr_b16 v[142:143], v9 offset:12288
    v_mfma_f32_16x16x32_bf16 v[204:207], v[84:87], a[180:183], v[204:207]
    ds_read_b64_tr_b16 v[80:81], v2 offset:0
    buffer_load_dwordx4 v186, s[12:15], s41 offen  lds
    v_mfma_f32_16x16x32_bf16 v[204:207], v[148:151], a[188:191], v[204:207]
    ds_read_b64_tr_b16 v[82:83], v2 offset:4096
    v_mfma_f32_16x16x32_bf16 v[200:203], v[148:151], a[184:187], v[200:203]
    ds_read_b64_tr_b16 v[144:145], v2 offset:8192
    v_lshl_add_u32 v27, v15, 5, v12
    v_mfma_f32_16x16x32_bf16 v[200:203], v[84:87], a[176:179], v[200:203]
    ds_read_b64_tr_b16 v[146:147], v2 offset:12288
    buffer_load_dwordx4 v187, s[12:15], s41 offen offset:1024  lds
    v_mfma_f32_16x16x32_bf16 v[208:211], v[88:91], a[176:179], v[208:211]
    s_lshl_b32 s3, s27, 4
    ds_read_b64_tr_b16 v[84:85], v3 offset:0
    v_mfma_f32_16x16x32_bf16 v[208:211], v[152:155], a[184:187], v[208:211]
    s_add_u32 m0, s49, 90112
    ds_read_b64_tr_b16 v[86:87], v3 offset:4096
    v_mfma_f32_16x16x32_bf16 v[212:215], v[152:155], a[188:191], v[212:215]
    ds_read_b64_tr_b16 v[148:149], v3 offset:8192
    v_mfma_f32_16x16x32_bf16 v[212:215], v[88:91], a[180:183], v[212:215]
    ds_read_b64_tr_b16 v[150:151], v3 offset:12288
    v_xor_b32 v15, 2, v13
    v_mfma_f32_16x16x32_bf16 v[220:223], v[92:95], a[180:183], v[220:223]
    s_add_u32 s41, s51, s3
    ds_read_b64_tr_b16 v[88:89], v4 offset:0
    v_mfma_f32_16x16x32_bf16 v[220:223], v[156:159], a[188:191], v[220:223]
    ds_read_b64_tr_b16 v[90:91], v4 offset:4096
    buffer_load_dwordx4 v186, s[12:15], s41 offen  lds
    v_mfma_f32_16x16x32_bf16 v[216:219], v[156:159], a[184:187], v[216:219]
    ds_read_b64_tr_b16 v[152:153], v4 offset:8192
    buffer_load_dwordx4 v187, s[12:15], s41 offen offset:1024  lds
    v_mfma_f32_16x16x32_bf16 v[216:219], v[92:95], a[176:179], v[216:219]
    ds_read_b64_tr_b16 v[154:155], v4 offset:12288
    s_waitcnt vmcnt(52) lgkmcnt(12)
    v_mfma_f32_16x16x32_bf16 v[224:227], v[64:67], a[0:3], v[224:227]
    s_lshl_b32 s3, s30, 3
    ds_read_b64_tr_b16 v[92:93], v5 offset:0
    v_mfma_f32_16x16x32_bf16 v[224:227], v[128:131], a[8:11], v[224:227]
    ds_read_b64_tr_b16 v[94:95], v5 offset:4096
    v_lshl_add_u32 v28, v15, 5, v12
    v_mfma_f32_16x16x32_bf16 v[228:231], v[128:131], a[12:15], v[228:231]
    s_add_u32 m0, s49, 49152
    ds_read_b64_tr_b16 v[156:157], v5 offset:8192
    v_mfma_f32_16x16x32_bf16 v[228:231], v[64:67], a[4:7], v[228:231]
    ds_read_b64_tr_b16 v[158:159], v5 offset:12288
    s_waitcnt vmcnt(12)
    s_barrier
    v_mfma_f32_16x16x32_bf16 v[236:239], v[68:71], a[4:7], v[236:239]
    s_add_u32 s41, s50, s3
    ds_read_b64_tr_b16 v[64:65], v6 offset:16384
    v_mfma_f32_16x16x32_bf16 v[236:239], v[132:135], a[12:15], v[236:239]
    ds_read_b64_tr_b16 v[66:67], v6 offset:20480
    buffer_load_dwordx4 v188, s[8:11], s41 offen  lds
    v_mfma_f32_16x16x32_bf16 v[232:235], v[132:135], a[8:11], v[232:235]
    ds_read_b64_tr_b16 v[128:129], v6 offset:24576
    v_xor_b32 v15, 3, v13
    v_mfma_f32_16x16x32_bf16 v[232:235], v[68:71], a[0:3], v[232:235]
    ds_read_b64_tr_b16 v[130:131], v6 offset:28672
    buffer_load_dwordx4 v190, s[8:11], s41 offen offset:1024  lds
    v_mfma_f32_16x16x32_bf16 v[240:243], v[72:75], a[0:3], v[240:243]
    s_lshl_b32 s3, s31, 3
    ds_read_b64_tr_b16 v[68:69], v7 offset:16384
    v_mfma_f32_16x16x32_bf16 v[240:243], v[136:139], a[8:11], v[240:243]
    ds_read_b64_tr_b16 v[70:71], v7 offset:20480
    v_mfma_f32_16x16x32_bf16 v[244:247], v[136:139], a[12:15], v[244:247]
    s_add_u32 m0, s49, 57344
    ds_read_b64_tr_b16 v[132:133], v7 offset:24576
    v_mfma_f32_16x16x32_bf16 v[244:247], v[72:75], a[4:7], v[244:247]
    ds_read_b64_tr_b16 v[134:135], v7 offset:28672
    v_lshl_add_u32 v29, v15, 5, v12
    v_mfma_f32_16x16x32_bf16 v[252:255], v[76:79], a[4:7], v[252:255]
    s_add_u32 s41, s50, s3
    ds_read_b64_tr_b16 v[72:73], v8 offset:16384
    v_mfma_f32_16x16x32_bf16 v[252:255], v[140:143], a[12:15], v[252:255]
    ds_read_b64_tr_b16 v[74:75], v8 offset:20480
    buffer_load_dwordx4 v188, s[8:11], s41 offen  lds
    v_mfma_f32_16x16x32_bf16 v[248:251], v[140:143], a[8:11], v[248:251]
    ds_read_b64_tr_b16 v[136:137], v8 offset:24576
    buffer_load_dwordx4 v190, s[8:11], s41 offen offset:1024  lds
    v_mfma_f32_16x16x32_bf16 v[248:251], v[76:79], a[0:3], v[248:251]
    ds_read_b64_tr_b16 v[138:139], v8 offset:28672
    s_waitcnt lgkmcnt(12)
    v_mfma_f32_16x16x32_bf16 v[192:195], v[80:83], a[0:3], v[192:195]
    s_lshl_b32 s3, s28, 4
    ds_read_b64_tr_b16 v[76:77], v9 offset:16384
    v_mfma_f32_16x16x32_bf16 v[192:195], v[144:147], a[8:11], v[192:195]
    ds_read_b64_tr_b16 v[78:79], v9 offset:20480
    v_add_u32 v189, 8192, v1
    v_mfma_f32_16x16x32_bf16 v[196:199], v[144:147], a[12:15], v[196:199]
    s_add_u32 m0, s49, 98304
    ds_read_b64_tr_b16 v[140:141], v9 offset:24576
    v_mfma_f32_16x16x32_bf16 v[196:199], v[80:83], a[4:7], v[196:199]
    s_add_u32 s41, s51, s3
    ds_read_b64_tr_b16 v[142:143], v9 offset:28672
    v_mfma_f32_16x16x32_bf16 v[204:207], v[84:87], a[4:7], v[204:207]
    ds_read_b64_tr_b16 v[80:81], v2 offset:16384
    buffer_load_dwordx4 v186, s[12:15], s41 offen  lds
    v_mfma_f32_16x16x32_bf16 v[204:207], v[148:151], a[12:15], v[204:207]
    ds_read_b64_tr_b16 v[82:83], v2 offset:20480
    v_mfma_f32_16x16x32_bf16 v[200:203], v[148:151], a[8:11], v[200:203]
    ds_read_b64_tr_b16 v[144:145], v2 offset:24576
    v_lshlrev_b32 v24, 2, v18
    v_mfma_f32_16x16x32_bf16 v[200:203], v[84:87], a[0:3], v[200:203]
    ds_read_b64_tr_b16 v[146:147], v2 offset:28672
    buffer_load_dwordx4 v187, s[12:15], s41 offen offset:1024  lds
    v_mfma_f32_16x16x32_bf16 v[208:211], v[88:91], a[0:3], v[208:211]
    s_lshl_b32 s3, s29, 4
    ds_read_b64_tr_b16 v[84:85], v3 offset:16384
    v_mfma_f32_16x16x32_bf16 v[208:211], v[152:155], a[8:11], v[208:211]
    s_add_u32 m0, s49, 106496
    ds_read_b64_tr_b16 v[86:87], v3 offset:20480
    v_mfma_f32_16x16x32_bf16 v[212:215], v[152:155], a[12:15], v[212:215]
    ds_read_b64_tr_b16 v[148:149], v3 offset:24576
    v_mfma_f32_16x16x32_bf16 v[212:215], v[88:91], a[4:7], v[212:215]
    ds_read_b64_tr_b16 v[150:151], v3 offset:28672
    v_and_b32 v19, 127, v24
    v_mfma_f32_16x16x32_bf16 v[220:223], v[92:95], a[4:7], v[220:223]
    s_add_u32 s41, s51, s3
    ds_read_b64_tr_b16 v[88:89], v4 offset:16384
    v_mfma_f32_16x16x32_bf16 v[220:223], v[156:159], a[12:15], v[220:223]
    ds_read_b64_tr_b16 v[90:91], v4 offset:20480
    buffer_load_dwordx4 v186, s[12:15], s41 offen  lds
    v_mfma_f32_16x16x32_bf16 v[216:219], v[156:159], a[8:11], v[216:219]
    ds_read_b64_tr_b16 v[152:153], v4 offset:24576
    buffer_load_dwordx4 v187, s[12:15], s41 offen offset:1024  lds
    v_mfma_f32_16x16x32_bf16 v[216:219], v[92:95], a[0:3], v[216:219]
    ds_read_b64_tr_b16 v[154:155], v4 offset:28672
    s_waitcnt vmcnt(56) lgkmcnt(12)
    v_mfma_f32_16x16x32_bf16 v[224:227], v[64:67], a[16:19], v[224:227]
    s_add_u32 s50, s50, 524288
    ds_read_b64_tr_b16 v[92:93], v5 offset:16384
    v_mfma_f32_16x16x32_bf16 v[224:227], v[128:131], a[24:27], v[224:227]
    s_add_u32 s65, s54, 62939136
    ds_read_b64_tr_b16 v[94:95], v5 offset:20480
    v_mfma_f32_16x16x32_bf16 v[228:231], v[128:131], a[28:31], v[228:231]
    s_lshl_b32 s3, s24, 3
    ds_read_b64_tr_b16 v[156:157], v5 offset:24576
    v_mfma_f32_16x16x32_bf16 v[228:231], v[64:67], a[20:23], v[228:231]
    ds_read_b64_tr_b16 v[158:159], v5 offset:28672
    s_waitcnt vmcnt(12)
    s_barrier
    v_mfma_f32_16x16x32_bf16 v[236:239], v[68:71], a[20:23], v[236:239]
    s_add_u32 m0, s49, 0
    ds_read_b64_tr_b16 v[64:65], v6 offset:32768
    v_mfma_f32_16x16x32_bf16 v[236:239], v[132:135], a[28:31], v[236:239]
    s_add_u32 s41, s50, s3
    ds_read_b64_tr_b16 v[66:67], v6 offset:36864
    v_mfma_f32_16x16x32_bf16 v[232:235], v[132:135], a[24:27], v[232:235]
    s_bitcmp1_b32 s2, 0
    s_cselect_b32 s60, 2, 3
    ds_read_b64_tr_b16 v[128:129], v6 offset:40960
    v_mfma_f32_16x16x32_bf16 v[232:235], v[68:71], a[16:19], v[232:235]
    ds_read_b64_tr_b16 v[130:131], v6 offset:45056
    buffer_load_dwordx4 v188, s[8:11], s41 offen  lds
    v_mfma_f32_16x16x32_bf16 v[240:243], v[72:75], a[16:19], v[240:243]
    ds_read_b64_tr_b16 v[68:69], v7 offset:32768
    buffer_load_dwordx4 v190, s[8:11], s41 offen offset:1024  lds
    v_mfma_f32_16x16x32_bf16 v[240:243], v[136:139], a[24:27], v[240:243]
    s_lshl_b32 s3, s25, 3
    ds_read_b64_tr_b16 v[70:71], v7 offset:36864
    v_mfma_f32_16x16x32_bf16 v[244:247], v[136:139], a[28:31], v[244:247]
    s_add_u32 m0, s49, 8192
    ds_read_b64_tr_b16 v[132:133], v7 offset:40960
    v_mfma_f32_16x16x32_bf16 v[244:247], v[72:75], a[20:23], v[244:247]
    s_mov_b32 s16, s78
    ds_read_b64_tr_b16 v[134:135], v7 offset:45056
    v_mfma_f32_16x16x32_bf16 v[252:255], v[76:79], a[20:23], v[252:255]
    s_add_u32 s41, s50, s3
    ds_read_b64_tr_b16 v[72:73], v8 offset:32768
    v_mfma_f32_16x16x32_bf16 v[252:255], v[140:143], a[28:31], v[252:255]
    ds_read_b64_tr_b16 v[74:75], v8 offset:36864
    buffer_load_dwordx4 v188, s[8:11], s41 offen  lds
    v_mfma_f32_16x16x32_bf16 v[248:251], v[140:143], a[24:27], v[248:251]
    ds_read_b64_tr_b16 v[136:137], v8 offset:40960
    buffer_load_dwordx4 v190, s[8:11], s41 offen offset:1024  lds
    v_mfma_f32_16x16x32_bf16 v[248:251], v[76:79], a[16:19], v[248:251]
    ds_read_b64_tr_b16 v[138:139], v8 offset:45056
    s_waitcnt lgkmcnt(12)
    v_mfma_f32_16x16x32_bf16 v[192:195], v[80:83], a[16:19], v[192:195]
    s_lshl_b32 s3, s30, 4
    ds_read_b64_tr_b16 v[76:77], v9 offset:32768
    v_mfma_f32_16x16x32_bf16 v[192:195], v[144:147], a[24:27], v[192:195]
    s_mov_b32 s17, s79
    ds_read_b64_tr_b16 v[78:79], v9 offset:36864
    v_mfma_f32_16x16x32_bf16 v[196:199], v[144:147], a[28:31], v[196:199]
    s_add_u32 m0, s49, 114688
    ds_read_b64_tr_b16 v[140:141], v9 offset:40960
    v_mfma_f32_16x16x32_bf16 v[196:199], v[80:83], a[20:23], v[196:199]
    s_add_u32 s41, s51, s3
    ds_read_b64_tr_b16 v[142:143], v9 offset:45056
    v_mfma_f32_16x16x32_bf16 v[204:207], v[84:87], a[20:23], v[204:207]
    ds_read_b64_tr_b16 v[80:81], v2 offset:32768
    buffer_load_dwordx4 v186, s[12:15], s41 offen  lds
    v_mfma_f32_16x16x32_bf16 v[204:207], v[148:151], a[28:31], v[204:207]
    ds_read_b64_tr_b16 v[82:83], v2 offset:36864
    v_mfma_f32_16x16x32_bf16 v[200:203], v[148:151], a[24:27], v[200:203]
    s_mov_b32 s18, 4194304
    ds_read_b64_tr_b16 v[144:145], v2 offset:40960
    v_mfma_f32_16x16x32_bf16 v[200:203], v[84:87], a[16:19], v[200:203]
    ds_read_b64_tr_b16 v[146:147], v2 offset:45056
    buffer_load_dwordx4 v187, s[12:15], s41 offen offset:1024  lds
    v_mfma_f32_16x16x32_bf16 v[208:211], v[88:91], a[16:19], v[208:211]
    s_lshl_b32 s3, s31, 4
    ds_read_b64_tr_b16 v[84:85], v3 offset:32768
    v_mfma_f32_16x16x32_bf16 v[208:211], v[152:155], a[24:27], v[208:211]
    s_add_u32 m0, s49, 122880
    ds_read_b64_tr_b16 v[86:87], v3 offset:36864
    v_mfma_f32_16x16x32_bf16 v[212:215], v[152:155], a[28:31], v[212:215]
    ds_read_b64_tr_b16 v[148:149], v3 offset:40960
    v_mfma_f32_16x16x32_bf16 v[212:215], v[88:91], a[20:23], v[212:215]
    s_mov_b32 s19, 0x00020000
    ds_read_b64_tr_b16 v[150:151], v3 offset:45056
    v_mfma_f32_16x16x32_bf16 v[220:223], v[92:95], a[20:23], v[220:223]
    s_add_u32 s41, s51, s3
    ds_read_b64_tr_b16 v[88:89], v4 offset:32768
    v_mfma_f32_16x16x32_bf16 v[220:223], v[156:159], a[28:31], v[220:223]
    ds_read_b64_tr_b16 v[90:91], v4 offset:36864
    buffer_load_dwordx4 v186, s[12:15], s41 offen  lds
    v_mfma_f32_16x16x32_bf16 v[216:219], v[156:159], a[24:27], v[216:219]
    ds_read_b64_tr_b16 v[152:153], v4 offset:40960
    buffer_load_dwordx4 v187, s[12:15], s41 offen offset:1024  lds
    v_mfma_f32_16x16x32_bf16 v[216:219], v[92:95], a[16:19], v[216:219]
    ds_read_b64_tr_b16 v[154:155], v4 offset:45056
    s_waitcnt vmcnt(60) lgkmcnt(12)
    v_mfma_f32_16x16x32_bf16 v[224:227], v[64:67], a[32:35], v[224:227]
    s_lshl_b32 s3, s26, 3
    ds_read_b64_tr_b16 v[92:93], v5 offset:32768
    v_mfma_f32_16x16x32_bf16 v[224:227], v[128:131], a[40:43], v[224:227]
    s_xor_b32 s36, s2, 1
    ds_read_b64_tr_b16 v[94:95], v5 offset:36864
    v_mfma_f32_16x16x32_bf16 v[228:231], v[128:131], a[44:47], v[228:231]
    s_add_u32 m0, s49, 16384
    ds_read_b64_tr_b16 v[156:157], v5 offset:40960
    v_mfma_f32_16x16x32_bf16 v[228:231], v[64:67], a[36:39], v[228:231]
    ds_read_b64_tr_b16 v[158:159], v5 offset:45056
    s_waitcnt vmcnt(12)
    s_barrier
    s_cmp_lg_u32 s46, 0
    s_cbranch_scc1 L_f_noflag
    s_mov_b64 exec, 1
    buffer_store_dword v20, v21, s[4:7], s63 offen sc1
    s_mov_b64 exec, -1
L_f_noflag:
    v_mfma_f32_16x16x32_bf16 v[236:239], v[68:71], a[36:39], v[236:239]
    s_add_u32 s41, s50, s3
    ds_read_b64_tr_b16 v[64:65], v6 offset:49152
    v_mfma_f32_16x16x32_bf16 v[236:239], v[132:135], a[44:47], v[236:239]
    ds_read_b64_tr_b16 v[66:67], v6 offset:53248
    buffer_load_dwordx4 v188, s[8:11], s41 offen  lds
    v_mfma_f32_16x16x32_bf16 v[232:235], v[132:135], a[40:43], v[232:235]
    s_lshl_b32 s36, s36, 2
    ds_read_b64_tr_b16 v[128:129], v6 offset:57344
    v_mfma_f32_16x16x32_bf16 v[232:235], v[68:71], a[32:35], v[232:235]
    ds_read_b64_tr_b16 v[130:131], v6 offset:61440
    buffer_load_dwordx4 v190, s[8:11], s41 offen offset:1024  lds
    v_mfma_f32_16x16x32_bf16 v[240:243], v[72:75], a[32:35], v[240:243]
    s_lshl_b32 s3, s27, 3
    ds_read_b64_tr_b16 v[68:69], v7 offset:49152
    v_mfma_f32_16x16x32_bf16 v[240:243], v[136:139], a[40:43], v[240:243]
    ds_read_b64_tr_b16 v[70:71], v7 offset:53248
    v_mfma_f32_16x16x32_bf16 v[244:247], v[136:139], a[44:47], v[244:247]
    s_add_u32 m0, s49, 24576
    ds_read_b64_tr_b16 v[132:133], v7 offset:57344
    v_mfma_f32_16x16x32_bf16 v[244:247], v[72:75], a[36:39], v[244:247]
    s_add_u32 s36, s36, s46
    ds_read_b64_tr_b16 v[134:135], v7 offset:61440
    v_mfma_f32_16x16x32_bf16 v[252:255], v[76:79], a[36:39], v[252:255]
    s_add_u32 s41, s50, s3
    ds_read_b64_tr_b16 v[72:73], v8 offset:49152
    v_mfma_f32_16x16x32_bf16 v[252:255], v[140:143], a[44:47], v[252:255]
    ds_read_b64_tr_b16 v[74:75], v8 offset:53248
    buffer_load_dwordx4 v188, s[8:11], s41 offen  lds
    v_mfma_f32_16x16x32_bf16 v[248:251], v[140:143], a[40:43], v[248:251]
    ds_read_b64_tr_b16 v[136:137], v8 offset:57344
    buffer_load_dwordx4 v190, s[8:11], s41 offen offset:1024  lds
    v_mfma_f32_16x16x32_bf16 v[248:251], v[76:79], a[32:35], v[248:251]
    ds_read_b64_tr_b16 v[138:139], v8 offset:61440
    s_waitcnt lgkmcnt(12)
    v_mfma_f32_16x16x32_bf16 v[192:195], v[80:83], a[32:35], v[192:195]
    s_add_u32 s51, s51, 1048576
    ds_read_b64_tr_b16 v[76:77], v9 offset:49152
    v_mfma_f32_16x16x32_bf16 v[192:195], v[144:147], a[40:43], v[192:195]
    s_lshl_b32 s37, s36, 6
    ds_read_b64_tr_b16 v[78:79], v9 offset:53248
    v_mfma_f32_16x16x32_bf16 v[196:199], v[144:147], a[44:47], v[196:199]
    s_lshl_b32 s3, s24, 4
    ds_read_b64_tr_b16 v[140:141], v9 offset:57344
    v_mfma_f32_16x16x32_bf16 v[196:199], v[80:83], a[36:39], v[196:199]
    s_add_u32 m0, s49, 131072
    ds_read_b64_tr_b16 v[142:143], v9 offset:61440
    v_mfma_f32_16x16x32_bf16 v[204:207], v[84:87], a[36:39], v[204:207]
    s_add_u32 s41, s51, s3
    ds_read_b64_tr_b16 v[80:81], v2 offset:49152
    v_mfma_f32_16x16x32_bf16 v[204:207], v[148:151], a[44:47], v[204:207]
    s_add_u32 s37, s37, 62980096
    ds_read_b64_tr_b16 v[82:83], v2 offset:53248
    v_mfma_f32_16x16x32_bf16 v[200:203], v[148:151], a[40:43], v[200:203]
    ds_read_b64_tr_b16 v[144:145], v2 offset:57344
    buffer_load_dwordx4 v186, s[12:15], s41 offen  lds
    v_mfma_f32_16x16x32_bf16 v[200:203], v[84:87], a[32:35], v[200:203]
    ds_read_b64_tr_b16 v[146:147], v2 offset:61440
    v_mfma_f32_16x16x32_bf16 v[208:211], v[88:91], a[32:35], v[208:211]
    ds_read_b64_tr_b16 v[84:85], v3 offset:49152
    buffer_load_dwordx4 v187, s[12:15], s41 offen offset:1024  lds
    v_mfma_f32_16x16x32_bf16 v[208:211], v[152:155], a[40:43], v[208:211]
    s_lshl_b32 s3, s25, 4
    ds_read_b64_tr_b16 v[86:87], v3 offset:53248
    v_mfma_f32_16x16x32_bf16 v[212:215], v[152:155], a[44:47], v[212:215]
    s_add_u32 m0, s49, 139264
    ds_read_b64_tr_b16 v[148:149], v3 offset:57344
    v_mfma_f32_16x16x32_bf16 v[212:215], v[88:91], a[36:39], v[212:215]
    s_lshl_b32 s36, s36, 13
    ds_read_b64_tr_b16 v[150:151], v3 offset:61440
    v_mfma_f32_16x16x32_bf16 v[220:223], v[92:95], a[36:39], v[220:223]
    s_add_u32 s41, s51, s3
    ds_read_b64_tr_b16 v[88:89], v4 offset:49152
    v_mfma_f32_16x16x32_bf16 v[220:223], v[156:159], a[44:47], v[220:223]
    ds_read_b64_tr_b16 v[90:91], v4 offset:53248
    buffer_load_dwordx4 v186, s[12:15], s41 offen  lds
    v_mfma_f32_16x16x32_bf16 v[216:219], v[156:159], a[40:43], v[216:219]
    ds_read_b64_tr_b16 v[152:153], v4 offset:57344
    buffer_load_dwordx4 v187, s[12:15], s41 offen offset:1024  lds
    v_mfma_f32_16x16x32_bf16 v[216:219], v[92:95], a[32:35], v[216:219]
    ds_read_b64_tr_b16 v[154:155], v4 offset:61440
    s_waitcnt vmcnt(63) lgkmcnt(12)
    v_mfma_f32_16x16x32_bf16 v[224:227], v[64:67], a[48:51], v[224:227]
    s_lshl_b32 s3, s28, 3
    ds_read_b64_tr_b16 v[92:93], v5 offset:49152
    v_mfma_f32_16x16x32_bf16 v[224:227], v[128:131], a[56:59], v[224:227]
    s_add_u32 s36, s36, 37748736
    ds_read_b64_tr_b16 v[94:95], v5 offset:53248
    v_mfma_f32_16x16x32_bf16 v[228:231], v[128:131], a[60:63], v[228:231]
    s_add_u32 m0, s49, 32768
    ds_read_b64_tr_b16 v[156:157], v5 offset:57344
    v_mfma_f32_16x16x32_bf16 v[228:231], v[64:67], a[52:55], v[228:231]
    ds_read_b64_tr_b16 v[158:159], v5 offset:61440
    s_waitcnt vmcnt(12)
    s_barrier
    v_mfma_f32_16x16x32_bf16 v[236:239], v[68:71], a[52:55], v[236:239]
    s_add_u32 s41, s50, s3
    ds_read_b64_tr_b16 v[64:65], v6 offset:0
    v_mfma_f32_16x16x32_bf16 v[236:239], v[132:135], a[60:63], v[236:239]
    ds_read_b64_tr_b16 v[66:67], v6 offset:4096
    buffer_load_dwordx4 v188, s[8:11], s41 offen  lds
    v_mfma_f32_16x16x32_bf16 v[232:235], v[132:135], a[56:59], v[232:235]
    ds_read_b64_tr_b16 v[128:129], v6 offset:8192
    buffer_load_dwordx4 v190, s[8:11], s41 offen offset:1024  lds
    v_mfma_f32_16x16x32_bf16 v[232:235], v[68:71], a[48:51], v[232:235]
    ds_read_b64_tr_b16 v[130:131], v6 offset:12288
    v_mfma_f32_16x16x32_bf16 v[240:243], v[72:75], a[48:51], v[240:243]
    s_lshl_b32 s3, s29, 3
    ds_read_b64_tr_b16 v[68:69], v7 offset:0
    v_mfma_f32_16x16x32_bf16 v[240:243], v[136:139], a[56:59], v[240:243]
    s_xor_b32 s42, s37, 256
    ds_read_b64_tr_b16 v[70:71], v7 offset:4096
    v_mfma_f32_16x16x32_bf16 v[244:247], v[136:139], a[60:63], v[244:247]
    s_add_u32 m0, s49, 40960
    ds_read_b64_tr_b16 v[132:133], v7 offset:8192
    v_mfma_f32_16x16x32_bf16 v[244:247], v[72:75], a[52:55], v[244:247]
    ds_read_b64_tr_b16 v[134:135], v7 offset:12288
    v_mfma_f32_16x16x32_bf16 v[252:255], v[76:79], a[52:55], v[252:255]
    s_add_u32 s41, s50, s3
    ds_read_b64_tr_b16 v[72:73], v8 offset:0
    v_mfma_f32_16x16x32_bf16 v[252:255], v[140:143], a[60:63], v[252:255]
    ds_read_b64_tr_b16 v[74:75], v8 offset:4096
    buffer_load_dwordx4 v188, s[8:11], s41 offen  lds
    v_mfma_f32_16x16x32_bf16 v[248:251], v[140:143], a[56:59], v[248:251]
    ds_read_b64_tr_b16 v[136:137], v8 offset:8192
    buffer_load_dwordx4 v190, s[8:11], s41 offen offset:1024  lds
    v_mfma_f32_16x16x32_bf16 v[248:251], v[76:79], a[48:51], v[248:251]
    ds_read_b64_tr_b16 v[138:139], v8 offset:12288
    s_waitcnt lgkmcnt(12)
    v_mfma_f32_16x16x32_bf16 v[192:195], v[80:83], a[48:51], v[192:195]
    s_lshl_b32 s3, s26, 4
    ds_read_b64_tr_b16 v[76:77], v9 offset:0
    v_mfma_f32_16x16x32_bf16 v[192:195], v[144:147], a[56:59], v[192:195]
    s_xor_b32 s43, s36, 32768
    ds_read_b64_tr_b16 v[78:79], v9 offset:4096
    v_mfma_f32_16x16x32_bf16 v[196:199], v[144:147], a[60:63], v[196:199]
    s_add_u32 m0, s49, 147456
    ds_read_b64_tr_b16 v[140:141], v9 offset:8192
    v_mfma_f32_16x16x32_bf16 v[196:199], v[80:83], a[52:55], v[196:199]
    s_add_u32 s41, s51, s3
    ds_read_b64_tr_b16 v[142:143], v9 offset:12288
    v_mfma_f32_16x16x32_bf16 v[204:207], v[84:87], a[52:55], v[204:207]
    ds_read_b64_tr_b16 v[80:81], v2 offset:0
    buffer_load_dwordx4 v186, s[12:15], s41 offen  lds
    v_mfma_f32_16x16x32_bf16 v[204:207], v[148:151], a[60:63], v[204:207]
    ds_read_b64_tr_b16 v[82:83], v2 offset:4096
    v_mfma_f32_16x16x32_bf16 v[200:203], v[148:151], a[56:59], v[200:203]
    s_lshl_b32 s39, s52, 18
    ds_read_b64_tr_b16 v[144:145], v2 offset:8192
    v_mfma_f32_16x16x32_bf16 v[200:203], v[84:87], a[48:51], v[200:203]
    ds_read_b64_tr_b16 v[146:147], v2 offset:12288
    buffer_load_dwordx4 v187, s[12:15], s41 offen offset:1024  lds
    v_mfma_f32_16x16x32_bf16 v[208:211], v[88:91], a[48:51], v[208:211]
    s_lshl_b32 s3, s27, 4
    ds_read_b64_tr_b16 v[84:85], v3 offset:0
    v_mfma_f32_16x16x32_bf16 v[208:211], v[152:155], a[56:59], v[208:211]
    s_add_u32 m0, s49, 155648
    ds_read_b64_tr_b16 v[86:87], v3 offset:4096
    v_mfma_f32_16x16x32_bf16 v[212:215], v[152:155], a[60:63], v[212:215]
    ds_read_b64_tr_b16 v[148:149], v3 offset:8192
    v_mfma_f32_16x16x32_bf16 v[212:215], v[88:91], a[52:55], v[212:215]
    s_add_u32 s39, s39, s49
    ds_read_b64_tr_b16 v[150:151], v3 offset:12288
    v_mfma_f32_16x16x32_bf16 v[220:223], v[92:95], a[52:55], v[220:223]
    s_add_u32 s41, s51, s3
    ds_read_b64_tr_b16 v[88:89], v4 offset:0
    v_mfma_f32_16x16x32_bf16 v[220:223], v[156:159], a[60:63], v[220:223]
    ds_read_b64_tr_b16 v[90:91], v4 offset:4096
    buffer_load_dwordx4 v186, s[12:15], s41 offen  lds
    v_mfma_f32_16x16x32_bf16 v[216:219], v[156:159], a[56:59], v[216:219]
    ds_read_b64_tr_b16 v[152:153], v4 offset:8192
    buffer_load_dwordx4 v187, s[12:15], s41 offen offset:1024  lds
    v_mfma_f32_16x16x32_bf16 v[216:219], v[92:95], a[48:51], v[216:219]
    ds_read_b64_tr_b16 v[154:155], v4 offset:12288
    s_waitcnt vmcnt(63) lgkmcnt(12)
    v_mfma_f32_16x16x32_bf16 v[224:227], v[64:67], a[64:67], v[224:227]
    s_lshl_b32 s3, s30, 3
    ds_read_b64_tr_b16 v[92:93], v5 offset:0
    v_mfma_f32_16x16x32_bf16 v[224:227], v[128:131], a[72:75], v[224:227]
    s_add_u32 s39, s39, 33554432
    ds_read_b64_tr_b16 v[94:95], v5 offset:4096
    v_mfma_f32_16x16x32_bf16 v[228:231], v[128:131], a[76:79], v[228:231]
    s_add_u32 m0, s49, 49152
    ds_read_b64_tr_b16 v[156:157], v5 offset:8192
    v_mfma_f32_16x16x32_bf16 v[228:231], v[64:67], a[68:71], v[228:231]
    ds_read_b64_tr_b16 v[158:159], v5 offset:12288
    s_waitcnt vmcnt(12)
    s_barrier
    v_mfma_f32_16x16x32_bf16 v[236:239], v[68:71], a[68:71], v[236:239]
    s_add_u32 s41, s50, s3
    ds_read_b64_tr_b16 v[64:65], v6 offset:16384
    v_mfma_f32_16x16x32_bf16 v[236:239], v[132:135], a[76:79], v[236:239]
    ds_read_b64_tr_b16 v[66:67], v6 offset:20480
    buffer_load_dwordx4 v188, s[8:11], s41 offen  lds
    v_mfma_f32_16x16x32_bf16 v[232:235], v[132:135], a[72:75], v[232:235]
    ds_read_b64_tr_b16 v[128:129], v6 offset:24576
    v_accvgpr_read_b32 v160, a224
    v_mfma_f32_16x16x32_bf16 v[232:235], v[68:71], a[64:67], v[232:235]
    ds_read_b64_tr_b16 v[130:131], v6 offset:28672
    buffer_load_dwordx4 v190, s[8:11], s41 offen offset:1024  lds
    v_mfma_f32_16x16x32_bf16 v[240:243], v[72:75], a[64:67], v[240:243]
    s_lshl_b32 s3, s31, 3
    ds_read_b64_tr_b16 v[68:69], v7 offset:16384
    v_mfma_f32_16x16x32_bf16 v[240:243], v[136:139], a[72:75], v[240:243]
    ds_read_b64_tr_b16 v[70:71], v7 offset:20480
    v_mfma_f32_16x16x32_bf16 v[244:247], v[136:139], a[76:79], v[244:247]
    s_add_u32 m0, s49, 57344
    ds_read_b64_tr_b16 v[132:133], v7 offset:24576
    v_mfma_f32_16x16x32_bf16 v[244:247], v[72:75], a[68:71], v[244:247]
    ds_read_b64_tr_b16 v[134:135], v7 offset:28672
    v_accvgpr_read_b32 v161, a225
    v_mfma_f32_16x16x32_bf16 v[252:255], v[76:79], a[68:71], v[252:255]
    s_add_u32 s41, s50, s3
    ds_read_b64_tr_b16 v[72:73], v8 offset:16384
    v_mfma_f32_16x16x32_bf16 v[252:255], v[140:143], a[76:79], v[252:255]
    ds_read_b64_tr_b16 v[74:75], v8 offset:20480
    buffer_load_dwordx4 v188, s[8:11], s41 offen  lds
    v_mfma_f32_16x16x32_bf16 v[248:251], v[140:143], a[72:75], v[248:251]
    ds_read_b64_tr_b16 v[136:137], v8 offset:24576
    buffer_load_dwordx4 v190, s[8:11], s41 offen offset:1024  lds
    v_mfma_f32_16x16x32_bf16 v[248:251], v[76:79], a[64:67], v[248:251]
    ds_read_b64_tr_b16 v[138:139], v8 offset:28672
    s_waitcnt lgkmcnt(12)
    v_mfma_f32_16x16x32_bf16 v[192:195], v[80:83], a[64:67], v[192:195]
    ds_read_b64_tr_b16 v[76:77], v9 offset:16384
    v_accvgpr_read_b32 v162, a226
    v_mfma_f32_16x16x32_bf16 v[192:195], v[144:147], a[72:75], v[192:195]
    ds_read_b64_tr_b16 v[78:79], v9 offset:20480
    v_mfma_f32_16x16x32_bf16 v[196:199], v[144:147], a[76:79], v[196:199]
    ds_read_b64_tr_b16 v[140:141], v9 offset:24576
    v_mfma_f32_16x16x32_bf16 v[196:199], v[80:83], a[68:71], v[196:199]
    ds_read_b64_tr_b16 v[142:143], v9 offset:28672
    v_mfma_f32_16x16x32_bf16 v[204:207], v[84:87], a[68:71], v[204:207]
    ds_read_b64_tr_b16 v[80:81], v2 offset:16384
    v_mfma_f32_16x16x32_bf16 v[204:207], v[148:151], a[76:79], v[204:207]
    ds_read_b64_tr_b16 v[82:83], v2 offset:20480
    v_accvgpr_read_b32 v163, a227
    v_mfma_f32_16x16x32_bf16 v[200:203], v[148:151], a[72:75], v[200:203]
    ds_read_b64_tr_b16 v[144:145], v2 offset:24576
    v_mfma_f32_16x16x32_bf16 v[200:203], v[84:87], a[64:67], v[200:203]
    ds_read_b64_tr_b16 v[146:147], v2 offset:28672
    v_mfma_f32_16x16x32_bf16 v[208:211], v[88:91], a[64:67], v[208:211]
    ds_read_b64_tr_b16 v[84:85], v3 offset:16384
    v_mfma_f32_16x16x32_bf16 v[208:211], v[152:155], a[72:75], v[208:211]
    ds_read_b64_tr_b16 v[86:87], v3 offset:20480
    v_mfma_f32_16x16x32_bf16 v[212:215], v[152:155], a[76:79], v[212:215]
    ds_read_b64_tr_b16 v[148:149], v3 offset:24576
    v_accvgpr_read_b32 v164, a228
    v_mfma_f32_16x16x32_bf16 v[212:215], v[88:91], a[68:71], v[212:215]
    ds_read_b64_tr_b16 v[150:151], v3 offset:28672
    v_mfma_f32_16x16x32_bf16 v[220:223], v[92:95], a[68:71], v[220:223]
    ds_read_b64_tr_b16 v[88:89], v4 offset:16384
    v_mfma_f32_16x16x32_bf16 v[220:223], v[156:159], a[76:79], v[220:223]
    ds_read_b64_tr_b16 v[90:91], v4 offset:20480
    v_mfma_f32_16x16x32_bf16 v[216:219], v[156:159], a[72:75], v[216:219]
    ds_read_b64_tr_b16 v[152:153], v4 offset:24576
    v_mfma_f32_16x16x32_bf16 v[216:219], v[92:95], a[64:67], v[216:219]
    ds_read_b64_tr_b16 v[154:155], v4 offset:28672
    s_waitcnt vmcnt(63) lgkmcnt(12)
    v_mfma_f32_16x16x32_bf16 v[224:227], v[64:67], a[80:83], v[224:227]
    s_add_u32 s50, s50, 524288
    ds_read_b64_tr_b16 v[92:93], v5 offset:16384
    v_mfma_f32_16x16x32_bf16 v[224:227], v[128:131], a[88:91], v[224:227]
    ds_read_b64_tr_b16 v[94:95], v5 offset:20480
    v_accvgpr_read_b32 v165, a229
    v_mfma_f32_16x16x32_bf16 v[228:231], v[128:131], a[92:95], v[228:231]
    s_lshl_b32 s3, s24, 3
    ds_read_b64_tr_b16 v[156:157], v5 offset:24576
    v_mfma_f32_16x16x32_bf16 v[228:231], v[64:67], a[84:87], v[228:231]
    ds_read_b64_tr_b16 v[158:159], v5 offset:28672
    s_waitcnt vmcnt(8)
    s_barrier
    v_mfma_f32_16x16x32_bf16 v[236:239], v[68:71], a[84:87], v[236:239]
    s_add_u32 m0, s49, 0
    ds_read_b64_tr_b16 v[64:65], v6 offset:32768
    v_mfma_f32_16x16x32_bf16 v[236:239], v[132:135], a[92:95], v[236:239]
    s_add_u32 s41, s50, s3
    ds_read_b64_tr_b16 v[66:67], v6 offset:36864
    v_mfma_f32_16x16x32_bf16 v[232:235], v[132:135], a[88:91], v[232:235]
    ds_read_b64_tr_b16 v[128:129], v6 offset:40960
    v_accvgpr_read_b32 v166, a230
    v_mfma_f32_16x16x32_bf16 v[232:235], v[68:71], a[80:83], v[232:235]
    ds_read_b64_tr_b16 v[130:131], v6 offset:45056
    buffer_load_dwordx4 v188, s[8:11], s41 offen  lds
    v_mfma_f32_16x16x32_bf16 v[240:243], v[72:75], a[80:83], v[240:243]
    ds_read_b64_tr_b16 v[68:69], v7 offset:32768
    buffer_load_dwordx4 v190, s[8:11], s41 offen offset:1024  lds
    v_mfma_f32_16x16x32_bf16 v[240:243], v[136:139], a[88:91], v[240:243]
    s_lshl_b32 s3, s25, 3
    ds_read_b64_tr_b16 v[70:71], v7 offset:36864
    v_mfma_f32_16x16x32_bf16 v[244:247], v[136:139], a[92:95], v[244:247]
    s_add_u32 m0, s49, 8192
    ds_read_b64_tr_b16 v[132:133], v7 offset:40960
    v_mfma_f32_16x16x32_bf16 v[244:247], v[72:75], a[84:87], v[244:247]
    ds_read_b64_tr_b16 v[134:135], v7 offset:45056
    v_accvgpr_read_b32 v167, a231
    v_mfma_f32_16x16x32_bf16 v[252:255], v[76:79], a[84:87], v[252:255]
    s_add_u32 s41, s50, s3
    ds_read_b64_tr_b16 v[72:73], v8 offset:32768
    v_mfma_f32_16x16x32_bf16 v[252:255], v[140:143], a[92:95], v[252:255]
    ds_read_b64_tr_b16 v[74:75], v8 offset:36864
    buffer_load_dwordx4 v188, s[8:11], s41 offen  lds
    v_mfma_f32_16x16x32_bf16 v[248:251], v[140:143], a[88:91], v[248:251]
    ds_read_b64_tr_b16 v[136:137], v8 offset:40960
    buffer_load_dwordx4 v190, s[8:11], s41 offen offset:1024  lds
    v_mfma_f32_16x16x32_bf16 v[248:251], v[76:79], a[80:83], v[248:251]
    ds_read_b64_tr_b16 v[138:139], v8 offset:45056
    s_waitcnt lgkmcnt(12)
    v_mfma_f32_16x16x32_bf16 v[192:195], v[80:83], a[80:83], v[192:195]
    s_add_u32 s48, s48, 65536
    ds_read_b64_tr_b16 v[76:77], v9 offset:32768
    v_mfma_f32_16x16x32_bf16 v[192:195], v[144:147], a[88:91], v[192:195]
    ds_read_b64_tr_b16 v[78:79], v9 offset:36864
    v_accvgpr_read_b32 v168, a232
    v_mfma_f32_16x16x32_bf16 v[196:199], v[144:147], a[92:95], v[196:199]
    ds_read_b64_tr_b16 v[140:141], v9 offset:40960
    v_mfma_f32_16x16x32_bf16 v[196:199], v[80:83], a[84:87], v[196:199]
    s_add_u32 s40, s48, s24
    ds_read_b64_tr_b16 v[142:143], v9 offset:45056
    v_mfma_f32_16x16x32_bf16 v[204:207], v[84:87], a[84:87], v[204:207]
    ds_read_b64_tr_b16 v[80:81], v2 offset:32768
    buffer_load_dwordx4 a[128:131], v1, s[4:7], s40 offen offset:0 sc1
    v_mfma_f32_16x16x32_bf16 v[204:207], v[148:151], a[92:95], v[204:207]
    ds_read_b64_tr_b16 v[82:83], v2 offset:36864
    v_mfma_f32_16x16x32_bf16 v[200:203], v[148:151], a[88:91], v[200:203]
    ds_read_b64_tr_b16 v[144:145], v2 offset:40960
    v_accvgpr_read_b32 v169, a233
    v_mfma_f32_16x16x32_bf16 v[200:203], v[84:87], a[80:83], v[200:203]
    ds_read_b64_tr_b16 v[146:147], v2 offset:45056
    v_mfma_f32_16x16x32_bf16 v[208:211], v[88:91], a[80:83], v[208:211]
    ds_read_b64_tr_b16 v[84:85], v3 offset:32768
    buffer_load_dwordx4 a[132:135], v1, s[4:7], s40 offen offset:1024 sc1
    v_mfma_f32_16x16x32_bf16 v[208:211], v[152:155], a[88:91], v[208:211]
    s_add_u32 s40, s48, s25
    ds_read_b64_tr_b16 v[86:87], v3 offset:36864
    v_mfma_f32_16x16x32_bf16 v[212:215], v[152:155], a[92:95], v[212:215]
    ds_read_b64_tr_b16 v[148:149], v3 offset:40960
    v_mfma_f32_16x16x32_bf16 v[212:215], v[88:91], a[84:87], v[212:215]
    ds_read_b64_tr_b16 v[150:151], v3 offset:45056
    v_accvgpr_read_b32 v170, a234
    v_mfma_f32_16x16x32_bf16 v[220:223], v[92:95], a[84:87], v[220:223]
    ds_read_b64_tr_b16 v[88:89], v4 offset:32768
    buffer_load_dwordx4 a[136:139], v1, s[4:7], s40 offen offset:0 sc1
    v_mfma_f32_16x16x32_bf16 v[220:223], v[156:159], a[92:95], v[220:223]
    ds_read_b64_tr_b16 v[90:91], v4 offset:36864
    v_mfma_f32_16x16x32_bf16 v[216:219], v[156:159], a[88:91], v[216:219]
    ds_read_b64_tr_b16 v[152:153], v4 offset:40960
    buffer_load_dwordx4 a[140:143], v1, s[4:7], s40 offen offset:1024 sc1
    v_mfma_f32_16x16x32_bf16 v[216:219], v[92:95], a[80:83], v[216:219]
    ds_read_b64_tr_b16 v[154:155], v4 offset:45056
    s_waitcnt vmcnt(63) lgkmcnt(12)
    v_mfma_f32_16x16x32_bf16 v[224:227], v[64:67], a[192:195], v[224:227]
    s_lshl_b32 s3, s26, 3
    ds_read_b64_tr_b16 v[92:93], v5 offset:32768
    v_mfma_f32_16x16x32_bf16 v[224:227], v[128:131], a[200:203], v[224:227]
    ds_read_b64_tr_b16 v[94:95], v5 offset:36864
    v_accvgpr_read_b32 v171, a235
    v_mfma_f32_16x16x32_bf16 v[228:231], v[128:131], a[204:207], v[228:231]
    s_add_u32 m0, s49, 16384
    ds_read_b64_tr_b16 v[156:157], v5 offset:40960
    v_mfma_f32_16x16x32_bf16 v[228:231], v[64:67], a[196:199], v[228:231]
    ds_read_b64_tr_b16 v[158:159], v5 offset:45056
    s_waitcnt vmcnt(8)
    s_barrier
    v_mfma_f32_16x16x32_bf16 v[236:239], v[68:71], a[196:199], v[236:239]
    s_add_u32 s41, s50, s3
    ds_read_b64_tr_b16 v[64:65], v6 offset:49152
    v_mfma_f32_16x16x32_bf16 v[236:239], v[132:135], a[204:207], v[236:239]
    ds_read_b64_tr_b16 v[66:67], v6 offset:53248
    buffer_load_dwordx4 v188, s[8:11], s41 offen  lds
    v_mfma_f32_16x16x32_bf16 v[232:235], v[132:135], a[200:203], v[232:235]
    ds_read_b64_tr_b16 v[128:129], v6 offset:57344
    v_accvgpr_read_b32 v172, a236
    v_mfma_f32_16x16x32_bf16 v[232:235], v[68:71], a[192:195], v[232:235]
    ds_read_b64_tr_b16 v[130:131], v6 offset:61440
    buffer_load_dwordx4 v190, s[8:11], s41 offen offset:1024  lds
    v_mfma_f32_16x16x32_bf16 v[240:243], v[72:75], a[192:195], v[240:243]
    s_lshl_b32 s3, s27, 3
    ds_read_b64_tr_b16 v[68:69], v7 offset:49152
    v_mfma_f32_16x16x32_bf16 v[240:243], v[136:139], a[200:203], v[240:243]
    ds_read_b64_tr_b16 v[70:71], v7 offset:53248
    v_mfma_f32_16x16x32_bf16 v[244:247], v[136:139], a[204:207], v[244:247]
    s_add_u32 m0, s49, 24576
    ds_read_b64_tr_b16 v[132:133], v7 offset:57344
    v_mfma_f32_16x16x32_bf16 v[244:247], v[72:75], a[196:199], v[244:247]
    ds_read_b64_tr_b16 v[134:135], v7 offset:61440
    v_accvgpr_read_b32 v173, a237
    v_mfma_f32_16x16x32_bf16 v[252:255], v[76:79], a[196:199], v[252:255]
    s_add_u32 s41, s50, s3
    ds_read_b64_tr_b16 v[72:73], v8 offset:49152
    v_mfma_f32_16x16x32_bf16 v[252:255], v[140:143], a[204:207], v[252:255]
    ds_read_b64_tr_b16 v[74:75], v8 offset:53248
    buffer_load_dwordx4 v188, s[8:11], s41 offen  lds
    v_mfma_f32_16x16x32_bf16 v[248:251], v[140:143], a[200:203], v[248:251]
    ds_read_b64_tr_b16 v[136:137], v8 offset:57344
    buffer_load_dwordx4 v190, s[8:11], s41 offen offset:1024  lds
    v_mfma_f32_16x16x32_bf16 v[248:251], v[76:79], a[192:195], v[248:251]
    ds_read_b64_tr_b16 v[138:139], v8 offset:61440
    s_waitcnt lgkmcnt(12)
    v_mfma_f32_16x16x32_bf16 v[192:195], v[80:83], a[192:195], v[192:195]
    s_add_u32 s40, s48, s26
    ds_read_b64_tr_b16 v[76:77], v9 offset:49152
    v_mfma_f32_16x16x32_bf16 v[192:195], v[144:147], a[200:203], v[192:195]
    ds_read_b64_tr_b16 v[78:79], v9 offset:53248
    v_accvgpr_read_b32 v174, a238
    v_mfma_f32_16x16x32_bf16 v[196:199], v[144:147], a[204:207], v[196:199]
    ds_read_b64_tr_b16 v[140:141], v9 offset:57344
    v_mfma_f32_16x16x32_bf16 v[196:199], v[80:83], a[196:199], v[196:199]
    ds_read_b64_tr_b16 v[142:143], v9 offset:61440
    buffer_load_dwordx4 a[144:147], v1, s[4:7], s40 offen offset:0 sc1
    v_mfma_f32_16x16x32_bf16 v[204:207], v[84:87], a[196:199], v[204:207]
    ds_read_b64_tr_b16 v[80:81], v2 offset:49152
    v_mfma_f32_16x16x32_bf16 v[204:207], v[148:151], a[204:207], v[204:207]
    ds_read_b64_tr_b16 v[82:83], v2 offset:53248
    buffer_load_dwordx4 a[148:151], v1, s[4:7], s40 offen offset:1024 sc1
    v_mfma_f32_16x16x32_bf16 v[200:203], v[148:151], a[200:203], v[200:203]
    ds_read_b64_tr_b16 v[144:145], v2 offset:57344
    v_mfma_f32_16x16x32_bf16 v[200:203], v[84:87], a[192:195], v[200:203]
    ds_read_b64_tr_b16 v[146:147], v2 offset:61440
    v_accvgpr_read_b32 v175, a239
    v_mfma_f32_16x16x32_bf16 v[208:211], v[88:91], a[192:195], v[208:211]
    s_add_u32 s40, s48, s27
    ds_read_b64_tr_b16 v[84:85], v3 offset:49152
    v_mfma_f32_16x16x32_bf16 v[208:211], v[152:155], a[200:203], v[208:211]
    ds_read_b64_tr_b16 v[86:87], v3 offset:53248
    v_mfma_f32_16x16x32_bf16 v[212:215], v[152:155], a[204:207], v[212:215]
    ds_read_b64_tr_b16 v[148:149], v3 offset:57344
    buffer_load_dwordx4 a[152:155], v1, s[4:7], s40 offen offset:0 sc1
    v_mfma_f32_16x16x32_bf16 v[212:215], v[88:91], a[196:199], v[212:215]
    ds_read_b64_tr_b16 v[150:151], v3 offset:61440
    v_mfma_f32_16x16x32_bf16 v[220:223], v[92:95], a[196:199], v[220:223]
    s_and_b32 s44, s24, 0x6000
    ds_read_b64_tr_b16 v[88:89], v4 offset:49152
    v_mfma_f32_16x16x32_bf16 v[220:223], v[156:159], a[204:207], v[220:223]
    ds_read_b64_tr_b16 v[90:91], v4 offset:53248
    v_mfma_f32_16x16x32_bf16 v[216:219], v[156:159], a[200:203], v[216:219]
    ds_read_b64_tr_b16 v[152:153], v4 offset:57344
    buffer_load_dwordx4 a[156:159], v1, s[4:7], s40 offen offset:1024 sc1
    v_mfma_f32_16x16x32_bf16 v[216:219], v[92:95], a[192:195], v[216:219]
    ds_read_b64_tr_b16 v[154:155], v4 offset:61440
    s_waitcnt vmcnt(63) lgkmcnt(12)
    v_mfma_f32_16x16x32_bf16 v[224:227], v[64:67], a[208:211], v[224:227]
    s_lshl_b32 s3, s28, 3
    ds_read_b64_tr_b16 v[92:93], v5 offset:49152
    v_mfma_f32_16x16x32_bf16 v[224:227], v[128:131], a[216:219], v[224:227]
    s_and_b32 s45, s25, 0x6000
    ds_read_b64_tr_b16 v[94:95], v5 offset:53248
    v_mfma_f32_16x16x32_bf16 v[228:231], v[128:131], a[220:223], v[228:231]
    s_add_u32 m0, s49, 32768
    ds_read_b64_tr_b16 v[156:157], v5 offset:57344
    v_mfma_f32_16x16x32_bf16 v[228:231], v[64:67], a[212:215], v[228:231]
    ds_read_b64_tr_b16 v[158:159], v5 offset:61440
    s_waitcnt vmcnt(12)
    s_barrier
    v_mfma_f32_16x16x32_bf16 v[236:239], v[68:71], a[212:215], v[236:239]
    s_add_u32 s41, s50, s3
    ds_read_b64_tr_b16 v[64:65], v6 offset:0
    v_mfma_f32_16x16x32_bf16 v[236:239], v[132:135], a[220:223], v[236:239]
    ds_read_b64_tr_b16 v[66:67], v6 offset:4096
    buffer_load_dwordx4 v188, s[8:11], s41 offen  lds
    v_mfma_f32_16x16x32_bf16 v[232:235], v[132:135], a[216:219], v[232:235]
    s_and_b32 s58, s26, 0x6000
    ds_read_b64_tr_b16 v[128:129], v6 offset:8192
    v_mfma_f32_16x16x32_bf16 v[232:235], v[68:71], a[208:211], v[232:235]
    ds_read_b64_tr_b16 v[130:131], v6 offset:12288
    buffer_load_dwordx4 v190, s[8:11], s41 offen offset:1024  lds
    v_mfma_f32_16x16x32_bf16 v[240:243], v[72:75], a[208:211], v[240:243]
    s_lshl_b32 s3, s29, 3
    ds_read_b64_tr_b16 v[68:69], v7 offset:0
    v_mfma_f32_16x16x32_bf16 v[240:243], v[136:139], a[216:219], v[240:243]
    ds_read_b64_tr_b16 v[70:71], v7 offset:4096
    v_mfma_f32_16x16x32_bf16 v[244:247], v[136:139], a[220:223], v[244:247]
    s_add_u32 m0, s49, 40960
    ds_read_b64_tr_b16 v[132:133], v7 offset:8192
    v_mfma_f32_16x16x32_bf16 v[244:247], v[72:75], a[212:215], v[244:247]
    s_and_b32 s59, s27, 0x6000
    ds_read_b64_tr_b16 v[134:135], v7 offset:12288
    v_mfma_f32_16x16x32_bf16 v[252:255], v[76:79], a[212:215], v[252:255]
    s_add_u32 s41, s50, s3
    ds_read_b64_tr_b16 v[72:73], v8 offset:0
    v_mfma_f32_16x16x32_bf16 v[252:255], v[140:143], a[220:223], v[252:255]
    ds_read_b64_tr_b16 v[74:75], v8 offset:4096
    buffer_load_dwordx4 v188, s[8:11], s41 offen  lds
    v_mfma_f32_16x16x32_bf16 v[248:251], v[140:143], a[216:219], v[248:251]
    ds_read_b64_tr_b16 v[136:137], v8 offset:8192
    buffer_load_dwordx4 v190, s[8:11], s41 offen offset:1024  lds
    v_mfma_f32_16x16x32_bf16 v[248:251], v[76:79], a[208:211], v[248:251]
    ds_read_b64_tr_b16 v[138:139], v8 offset:12288
    s_waitcnt lgkmcnt(12)
    v_mfma_f32_16x16x32_bf16 v[192:195], v[80:83], a[208:211], v[192:195]
    s_add_u32 s40, s48, s28
    ds_read_b64_tr_b16 v[76:77], v9 offset:0
    v_mfma_f32_16x16x32_bf16 v[192:195], v[144:147], a[216:219], v[192:195]
    ds_read_b64_tr_b16 v[78:79], v9 offset:4096
    v_mfma_f32_16x16x32_bf16 v[196:199], v[144:147], a[220:223], v[196:199]
    ds_read_b64_tr_b16 v[140:141], v9 offset:8192
    buffer_load_dwordx4 a[160:163], v1, s[4:7], s40 offen offset:0 sc1
    v_mfma_f32_16x16x32_bf16 v[196:199], v[80:83], a[212:215], v[196:199]
    ds_read_b64_tr_b16 v[142:143], v9 offset:12288
    v_mfma_f32_16x16x32_bf16 v[204:207], v[84:87], a[212:215], v[204:207]
    ds_read_b64_tr_b16 v[80:81], v2 offset:0
    v_mfma_f32_16x16x32_bf16 v[204:207], v[148:151], a[220:223], v[204:207]
    ds_read_b64_tr_b16 v[82:83], v2 offset:4096
    buffer_load_dwordx4 a[164:167], v1, s[4:7], s40 offen offset:1024 sc1
    v_mfma_f32_16x16x32_bf16 v[200:203], v[148:151], a[216:219], v[200:203]
    ds_read_b64_tr_b16 v[144:145], v2 offset:8192
    v_mfma_f32_16x16x32_bf16 v[200:203], v[84:87], a[208:211], v[200:203]
    ds_read_b64_tr_b16 v[146:147], v2 offset:12288
    v_mfma_f32_16x16x32_bf16 v[208:211], v[88:91], a[208:211], v[208:211]
    s_add_u32 s40, s48, s29
    ds_read_b64_tr_b16 v[84:85], v3 offset:0
    v_mfma_f32_16x16x32_bf16 v[208:211], v[152:155], a[216:219], v[208:211]
    ds_read_b64_tr_b16 v[86:87], v3 offset:4096
    v_mfma_f32_16x16x32_bf16 v[212:215], v[152:155], a[220:223], v[212:215]
    ds_read_b64_tr_b16 v[148:149], v3 offset:8192
    buffer_load_dwordx4 a[168:171], v1, s[4:7], s40 offen offset:0 sc1
    v_mfma_f32_16x16x32_bf16 v[212:215], v[88:91], a[212:215], v[212:215]
    ds_read_b64_tr_b16 v[150:151], v3 offset:12288
    v_mfma_f32_16x16x32_bf16 v[220:223], v[92:95], a[212:215], v[220:223]
    ds_read_b64_tr_b16 v[88:89], v4 offset:0
    v_mfma_f32_16x16x32_bf16 v[220:223], v[156:159], a[220:223], v[220:223]
    ds_read_b64_tr_b16 v[90:91], v4 offset:4096
    buffer_load_dwordx4 a[172:175], v1, s[4:7], s40 offen offset:1024 sc1
    v_mfma_f32_16x16x32_bf16 v[216:219], v[156:159], a[216:219], v[216:219]
    ds_read_b64_tr_b16 v[152:153], v4 offset:8192
    v_mfma_f32_16x16x32_bf16 v[216:219], v[92:95], a[208:211], v[216:219]
    ds_read_b64_tr_b16 v[154:155], v4 offset:12288
    s_waitcnt vmcnt(16) lgkmcnt(12)
    v_mfma_f32_16x16x32_bf16 v[224:227], v[64:67], a[128:131], v[224:227]
    s_lshl_b32 s3, s30, 3
    ds_read_b64_tr_b16 v[92:93], v5 offset:0
    v_mfma_f32_16x16x32_bf16 v[224:227], v[128:131], a[136:139], v[224:227]
    s_add_u32 m0, s49, 49152
    ds_read_b64_tr_b16 v[94:95], v5 offset:4096
    v_mfma_f32_16x16x32_bf16 v[228:231], v[128:131], a[140:143], v[228:231]
    s_add_u32 s41, s50, s3
    ds_read_b64_tr_b16 v[156:157], v5 offset:8192
    v_mfma_f32_16x16x32_bf16 v[228:231], v[64:67], a[132:135], v[228:231]
    ds_read_b64_tr_b16 v[158:159], v5 offset:12288
    s_waitcnt vmcnt(12)
    s_barrier
    v_mfma_f32_16x16x32_bf16 v[236:239], v[68:71], a[132:135], v[236:239]
    ds_read_b64_tr_b16 v[64:65], v6 offset:16384
    buffer_load_dwordx4 v188, s[8:11], s41 offen  lds
    v_mfma_f32_16x16x32_bf16 v[236:239], v[132:135], a[140:143], v[236:239]
    ds_read_b64_tr_b16 v[66:67], v6 offset:20480
    buffer_load_dwordx4 v190, s[8:11], s41 offen offset:1024  lds
    v_mfma_f32_16x16x32_bf16 v[232:235], v[132:135], a[136:139], v[232:235]
    ds_read_b64_tr_b16 v[128:129], v6 offset:24576
    v_mfma_f32_16x16x32_bf16 v[232:235], v[68:71], a[128:131], v[232:235]
    s_lshl_b32 s3, s31, 3
    ds_read_b64_tr_b16 v[130:131], v6 offset:28672
    v_mfma_f32_16x16x32_bf16 v[240:243], v[72:75], a[128:131], v[240:243]
    ds_read_b64_tr_b16 v[68:69], v7 offset:16384
    v_mfma_f32_16x16x32_bf16 v[240:243], v[136:139], a[136:139], v[240:243]
    s_add_u32 m0, s49, 57344
    ds_read_b64_tr_b16 v[70:71], v7 offset:20480
    v_mfma_f32_16x16x32_bf16 v[244:247], v[136:139], a[140:143], v[244:247]
    s_add_u32 s41, s50, s3
    ds_read_b64_tr_b16 v[132:133], v7 offset:24576
    v_mfma_f32_16x16x32_bf16 v[244:247], v[72:75], a[132:135], v[244:247]
    ds_read_b64_tr_b16 v[134:135], v7 offset:28672
    v_mfma_f32_16x16x32_bf16 v[252:255], v[76:79], a[132:135], v[252:255]
    ds_read_b64_tr_b16 v[72:73], v8 offset:16384
    buffer_load_dwordx4 v188, s[8:11], s41 offen  lds
    v_mfma_f32_16x16x32_bf16 v[252:255], v[140:143], a[140:143], v[252:255]
    ds_read_b64_tr_b16 v[74:75], v8 offset:20480
    v_mfma_f32_16x16x32_bf16 v[248:251], v[140:143], a[136:139], v[248:251]
    ds_read_b64_tr_b16 v[136:137], v8 offset:24576
    buffer_load_dwordx4 v190, s[8:11], s41 offen offset:1024  lds
    v_mfma_f32_16x16x32_bf16 v[248:251], v[76:79], a[128:131], v[248:251]
    ds_read_b64_tr_b16 v[138:139], v8 offset:28672
    s_waitcnt lgkmcnt(12)
    v_mfma_f32_16x16x32_bf16 v[192:195], v[80:83], a[128:131], v[192:195]
    s_add_u32 s40, s48, s30
    ds_read_b64_tr_b16 v[76:77], v9 offset:16384
    v_mfma_f32_16x16x32_bf16 v[192:195], v[144:147], a[136:139], v[192:195]
    ds_read_b64_tr_b16 v[78:79], v9 offset:20480
    v_mfma_f32_16x16x32_bf16 v[196:199], v[144:147], a[140:143], v[196:199]
    ds_read_b64_tr_b16 v[140:141], v9 offset:24576
    buffer_load_dwordx4 a[176:179], v1, s[4:7], s40 offen offset:0 sc1
    v_mfma_f32_16x16x32_bf16 v[196:199], v[80:83], a[132:135], v[196:199]
    ds_read_b64_tr_b16 v[142:143], v9 offset:28672
    v_mfma_f32_16x16x32_bf16 v[204:207], v[84:87], a[132:135], v[204:207]
    ds_read_b64_tr_b16 v[80:81], v2 offset:16384
    v_mfma_f32_16x16x32_bf16 v[204:207], v[148:151], a[140:143], v[204:207]
    ds_read_b64_tr_b16 v[82:83], v2 offset:20480
    buffer_load_dwordx4 a[180:183], v1, s[4:7], s40 offen offset:1024 sc1
    v_mfma_f32_16x16x32_bf16 v[200:203], v[148:151], a[136:139], v[200:203]
    ds_read_b64_tr_b16 v[144:145], v2 offset:24576
    v_mfma_f32_16x16x32_bf16 v[200:203], v[84:87], a[128:131], v[200:203]
    ds_read_b64_tr_b16 v[146:147], v2 offset:28672
    v_mfma_f32_16x16x32_bf16 v[208:211], v[88:91], a[128:131], v[208:211]
    s_add_u32 s40, s48, s31
    ds_read_b64_tr_b16 v[84:85], v3 offset:16384
    v_mfma_f32_16x16x32_bf16 v[208:211], v[152:155], a[136:139], v[208:211]
    ds_read_b64_tr_b16 v[86:87], v3 offset:20480
    v_mfma_f32_16x16x32_bf16 v[212:215], v[152:155], a[140:143], v[212:215]
    ds_read_b64_tr_b16 v[148:149], v3 offset:24576
    buffer_load_dwordx4 a[184:187], v1, s[4:7], s40 offen offset:0 sc1
    v_mfma_f32_16x16x32_bf16 v[212:215], v[88:91], a[132:135], v[212:215]
    ds_read_b64_tr_b16 v[150:151], v3 offset:28672
    v_mfma_f32_16x16x32_bf16 v[220:223], v[92:95], a[132:135], v[220:223]
    ds_read_b64_tr_b16 v[88:89], v4 offset:16384
    v_mfma_f32_16x16x32_bf16 v[220:223], v[156:159], a[140:143], v[220:223]
    ds_read_b64_tr_b16 v[90:91], v4 offset:20480
    buffer_load_dwordx4 a[188:191], v1, s[4:7], s40 offen offset:1024 sc1
    v_mfma_f32_16x16x32_bf16 v[216:219], v[156:159], a[136:139], v[216:219]
    ds_read_b64_tr_b16 v[152:153], v4 offset:24576
    v_mfma_f32_16x16x32_bf16 v[216:219], v[92:95], a[128:131], v[216:219]
    ds_read_b64_tr_b16 v[154:155], v4 offset:28672
.p2align 6
L_f_loop:
    s_waitcnt vmcnt(16) lgkmcnt(12)
    v_mfma_f32_16x16x32_bf16 v[224:227], v[64:67], a[144:147], v[224:227]
    s_add_u32 s50, s50, 524288
    ds_read_b64_tr_b16 v[92:93], v5 offset:16384
    v_mfma_f32_16x16x32_bf16 v[224:227], v[128:131], a[152:155], v[224:227]
    s_lshl_b32 s3, s24, 3
    ds_read_b64_tr_b16 v[94:95], v5 offset:20480
    v_mfma_f32_16x16x32_bf16 v[228:231], v[128:131], a[156:159], v[228:231]
    s_add_u32 m0, s49, 0
    ds_read_b64_tr_b16 v[156:157], v5 offset:24576
    v_mfma_f32_16x16x32_bf16 v[228:231], v[64:67], a[148:151], v[228:231]
    ds_read_b64_tr_b16 v[158:159], v5 offset:28672
    s_waitcnt vmcnt(12)
    s_barrier
    s_cmp_eq_u32 s60, 1
    s_cbranch_scc1 L_f_oload
L_f_hookback:
    v_mfma_f32_16x16x32_bf16 v[236:239], v[68:71], a[148:151], v[236:239]
    s_add_u32 s41, s50, s3
    ds_read_b64_tr_b16 v[64:65], v6 offset:32768
    v_mfma_f32_16x16x32_bf16 v[236:239], v[132:135], a[156:159], v[236:239]
    ds_read_b64_tr_b16 v[66:67], v6 offset:36864
    buffer_load_dwordx4 v188, s[8:11], s41 offen  lds
    v_mfma_f32_16x16x32_bf16 v[232:235], v[132:135], a[152:155], v[232:235]
    ds_read_b64_tr_b16 v[128:129], v6 offset:40960
    v_mfma_f32_16x16x32_bf16 v[232:235], v[68:71], a[144:147], v[232:235]
    ds_read_b64_tr_b16 v[130:131], v6 offset:45056
    buffer_load_dwordx4 v190, s[8:11], s41 offen offset:1024  lds
    v_mfma_f32_16x16x32_bf16 v[240:243], v[72:75], a[144:147], v[240:243]
    s_lshl_b32 s3, s25, 3
    ds_read_b64_tr_b16 v[68:69], v7 offset:32768
    v_mfma_f32_16x16x32_bf16 v[240:243], v[136:139], a[152:155], v[240:243]
    ds_read_b64_tr_b16 v[70:71], v7 offset:36864
    v_mfma_f32_16x16x32_bf16 v[244:247], v[136:139], a[156:159], v[244:247]
    s_add_u32 m0, s49, 8192
    ds_read_b64_tr_b16 v[132:133], v7 offset:40960
    v_mfma_f32_16x16x32_bf16 v[244:247], v[72:75], a[148:151], v[244:247]
    s_add_u32 s41, s50, s3
    ds_read_b64_tr_b16 v[134:135], v7 offset:45056
    v_mfma_f32_16x16x32_bf16 v[252:255], v[76:79], a[148:151], v[252:255]
    ds_read_b64_tr_b16 v[72:73], v8 offset:32768
    v_mfma_f32_16x16x32_bf16 v[252:255], v[140:143], a[156:159], v[252:255]
    ds_read_b64_tr_b16 v[74:75], v8 offset:36864
    buffer_load_dwordx4 v188, s[8:11], s41 offen  lds
    v_mfma_f32_16x16x32_bf16 v[248:251], v[140:143], a[152:155], v[248:251]
    ds_read_b64_tr_b16 v[136:137], v8 offset:40960
    buffer_load_dwordx4 v190, s[8:11], s41 offen offset:1024  lds
    v_mfma_f32_16x16x32_bf16 v[248:251], v[76:79], a[144:147], v[248:251]
    ds_read_b64_tr_b16 v[138:139], v8 offset:45056
    s_waitcnt lgkmcnt(12)
    v_mfma_f32_16x16x32_bf16 v[192:195], v[80:83], a[144:147], v[192:195]
    s_add_u32 s48, s48, 65536
    ds_read_b64_tr_b16 v[76:77], v9 offset:32768
    v_mfma_f32_16x16x32_bf16 v[192:195], v[144:147], a[152:155], v[192:195]
    ds_read_b64_tr_b16 v[78:79], v9 offset:36864
    v_mfma_f32_16x16x32_bf16 v[196:199], v[144:147], a[156:159], v[196:199]
    s_add_u32 s40, s48, s24
    ds_read_b64_tr_b16 v[140:141], v9 offset:40960
    v_mfma_f32_16x16x32_bf16 v[196:199], v[80:83], a[148:151], v[196:199]
    ds_read_b64_tr_b16 v[142:143], v9 offset:45056
    v_mfma_f32_16x16x32_bf16 v[204:207], v[84:87], a[148:151], v[204:207]
    ds_read_b64_tr_b16 v[80:81], v2 offset:32768
    buffer_load_dwordx4 a[128:131], v1, s[4:7], s40 offen offset:0 sc1
    v_mfma_f32_16x16x32_bf16 v[204:207], v[148:151], a[156:159], v[204:207]
    ds_read_b64_tr_b16 v[82:83], v2 offset:36864
    v_mfma_f32_16x16x32_bf16 v[200:203], v[148:151], a[152:155], v[200:203]
    ds_read_b64_tr_b16 v[144:145], v2 offset:40960
    buffer_load_dwordx4 a[132:135], v1, s[4:7], s40 offen offset:1024 sc1
    v_mfma_f32_16x16x32_bf16 v[200:203], v[84:87], a[144:147], v[200:203]
    ds_read_b64_tr_b16 v[146:147], v2 offset:45056
    v_mfma_f32_16x16x32_bf16 v[208:211], v[88:91], a[144:147], v[208:211]
    ds_read_b64_tr_b16 v[84:85], v3 offset:32768
    v_mfma_f32_16x16x32_bf16 v[208:211], v[152:155], a[152:155], v[208:211]
    s_add_u32 s40, s48, s25
    ds_read_b64_tr_b16 v[86:87], v3 offset:36864
    v_mfma_f32_16x16x32_bf16 v[212:215], v[152:155], a[156:159], v[212:215]
    ds_read_b64_tr_b16 v[148:149], v3 offset:40960
    v_mfma_f32_16x16x32_bf16 v[212:215], v[88:91], a[148:151], v[212:215]
    ds_read_b64_tr_b16 v[150:151], v3 offset:45056
    buffer_load_dwordx4 a[136:139], v1, s[4:7], s40 offen offset:0 sc1
    v_mfma_f32_16x16x32_bf16 v[220:223], v[92:95], a[148:151], v[220:223]
    ds_read_b64_tr_b16 v[88:89], v4 offset:32768
    v_mfma_f32_16x16x32_bf16 v[220:223], v[156:159], a[156:159], v[220:223]
    ds_read_b64_tr_b16 v[90:91], v4 offset:36864
    buffer_load_dwordx4 a[140:143], v1, s[4:7], s40 offen offset:1024 sc1
    v_mfma_f32_16x16x32_bf16 v[216:219], v[156:159], a[152:155], v[216:219]
    ds_read_b64_tr_b16 v[152:153], v4 offset:40960
    v_mfma_f32_16x16x32_bf16 v[216:219], v[92:95], a[144:147], v[216:219]
    ds_read_b64_tr_b16 v[154:155], v4 offset:45056
    s_waitcnt vmcnt(16) lgkmcnt(12)
    v_mfma_f32_16x16x32_bf16 v[224:227], v[64:67], a[160:163], v[224:227]
    s_lshl_b32 s3, s26, 3
    ds_read_b64_tr_b16 v[92:93], v5 offset:32768
    v_mfma_f32_16x16x32_bf16 v[224:227], v[128:131], a[168:171], v[224:227]
    s_add_u32 m0, s49, 16384
    ds_read_b64_tr_b16 v[94:95], v5 offset:36864
    v_mfma_f32_16x16x32_bf16 v[228:231], v[128:131], a[172:175], v[228:231]
    s_add_u32 s41, s50, s3
    ds_read_b64_tr_b16 v[156:157], v5 offset:40960
    v_mfma_f32_16x16x32_bf16 v[228:231], v[64:67], a[164:167], v[228:231]
    ds_read_b64_tr_b16 v[158:159], v5 offset:45056
    s_waitcnt vmcnt(12)
    s_barrier
    v_mfma_f32_16x16x32_bf16 v[236:239], v[68:71], a[164:167], v[236:239]
    ds_read_b64_tr_b16 v[64:65], v6 offset:49152
    buffer_load_dwordx4 v188, s[8:11], s41 offen  lds
    v_mfma_f32_16x16x32_bf16 v[236:239], v[132:135], a[172:175], v[236:239]
    ds_read_b64_tr_b16 v[66:67], v6 offset:53248
    buffer_load_dwordx4 v190, s[8:11], s41 offen offset:1024  lds
    v_mfma_f32_16x16x32_bf16 v[232:235], v[132:135], a[168:171], v[232:235]
    ds_read_b64_tr_b16 v[128:129], v6 offset:57344
    v_mfma_f32_16x16x32_bf16 v[232:235], v[68:71], a[160:163], v[232:235]
    s_lshl_b32 s3, s27, 3
    ds_read_b64_tr_b16 v[130:131], v6 offset:61440
    v_mfma_f32_16x16x32_bf16 v[240:243], v[72:75], a[160:163], v[240:243]
    ds_read_b64_tr_b16 v[68:69], v7 offset:49152
    v_mfma_f32_16x16x32_bf16 v[240:243], v[136:139], a[168:171], v[240:243]
    s_add_u32 m0, s49, 24576
    ds_read_b64_tr_b16 v[70:71], v7 offset:53248
    v_mfma_f32_16x16x32_bf16 v[244:247], v[136:139], a[172:175], v[244:247]
    s_add_u32 s41, s50, s3
    ds_read_b64_tr_b16 v[132:133], v7 offset:57344
    v_mfma_f32_16x16x32_bf16 v[244:247], v[72:75], a[164:167], v[244:247]
    ds_read_b64_tr_b16 v[134:135], v7 offset:61440
    v_mfma_f32_16x16x32_bf16 v[252:255], v[76:79], a[164:167], v[252:255]
    ds_read_b64_tr_b16 v[72:73], v8 offset:49152
    buffer_load_dwordx4 v188, s[8:11], s41 offen  lds
    v_mfma_f32_16x16x32_bf16 v[252:255], v[140:143], a[172:175], v[252:255]
    ds_read_b64_tr_b16 v[74:75], v8 offset:53248
    v_mfma_f32_16x16x32_bf16 v[248:251], v[140:143], a[168:171], v[248:251]
    ds_read_b64_tr_b16 v[136:137], v8 offset:57344
    buffer_load_dwordx4 v190, s[8:11], s41 offen offset:1024  lds
    v_mfma_f32_16x16x32_bf16 v[248:251], v[76:79], a[160:163], v[248:251]
    ds_read_b64_tr_b16 v[138:139], v8 offset:61440
    s_waitcnt lgkmcnt(12)
    v_mfma_f32_16x16x32_bf16 v[192:195], v[80:83], a[160:163], v[192:195]
    s_add_u32 s40, s48, s26
    ds_read_b64_tr_b16 v[76:77], v9 offset:49152
    v_mfma_f32_16x16x32_bf16 v[192:195], v[144:147], a[168:171], v[192:195]
    ds_read_b64_tr_b16 v[78:79], v9 offset:53248
    v_mfma_f32_16x16x32_bf16 v[196:199], v[144:147], a[172:175], v[196:199]
    ds_read_b64_tr_b16 v[140:141], v9 offset:57344
    buffer_load_dwordx4 a[144:147], v1, s[4:7], s40 offen offset:0 sc1
    v_mfma_f32_16x16x32_bf16 v[196:199], v[80:83], a[164:167], v[196:199]
    ds_read_b64_tr_b16 v[142:143], v9 offset:61440
    v_mfma_f32_16x16x32_bf16 v[204:207], v[84:87], a[164:167], v[204:207]
    ds_read_b64_tr_b16 v[80:81], v2 offset:49152
    v_mfma_f32_16x16x32_bf16 v[204:207], v[148:151], a[172:175], v[204:207]
    ds_read_b64_tr_b16 v[82:83], v2 offset:53248
    buffer_load_dwordx4 a[148:151], v1, s[4:7], s40 offen offset:1024 sc1
    v_mfma_f32_16x16x32_bf16 v[200:203], v[148:151], a[168:171], v[200:203]
    ds_read_b64_tr_b16 v[144:145], v2 offset:57344
    v_mfma_f32_16x16x32_bf16 v[200:203], v[84:87], a[160:163], v[200:203]
    ds_read_b64_tr_b16 v[146:147], v2 offset:61440
    v_mfma_f32_16x16x32_bf16 v[208:211], v[88:91], a[160:163], v[208:211]
    s_add_u32 s40, s48, s27
    ds_read_b64_tr_b16 v[84:85], v3 offset:49152
    v_mfma_f32_16x16x32_bf16 v[208:211], v[152:155], a[168:171], v[208:211]
    ds_read_b64_tr_b16 v[86:87], v3 offset:53248
    v_mfma_f32_16x16x32_bf16 v[212:215], v[152:155], a[172:175], v[212:215]
    ds_read_b64_tr_b16 v[148:149], v3 offset:57344
    buffer_load_dwordx4 a[152:155], v1, s[4:7], s40 offen offset:0 sc1
    v_mfma_f32_16x16x32_bf16 v[212:215], v[88:91], a[164:167], v[212:215]
    ds_read_b64_tr_b16 v[150:151], v3 offset:61440
    v_mfma_f32_16x16x32_bf16 v[220:223], v[92:95], a[164:167], v[220:223]
    ds_read_b64_tr_b16 v[88:89], v4 offset:49152
    v_mfma_f32_16x16x32_bf16 v[220:223], v[156:159], a[172:175], v[220:223]
    ds_read_b64_tr_b16 v[90:91], v4 offset:53248
    buffer_load_dwordx4 a[156:159], v1, s[4:7], s40 offen offset:1024 sc1
    v_mfma_f32_16x16x32_bf16 v[216:219], v[156:159], a[168:171], v[216:219]
    ds_read_b64_tr_b16 v[152:153], v4 offset:57344
    v_mfma_f32_16x16x32_bf16 v[216:219], v[92:95], a[160:163], v[216:219]
    ds_read_b64_tr_b16 v[154:155], v4 offset:61440
    s_waitcnt vmcnt(16) lgkmcnt(12)
    v_mfma_f32_16x16x32_bf16 v[224:227], v[64:67], a[176:179], v[224:227]
    s_lshl_b32 s3, s28, 3
    ds_read_b64_tr_b16 v[92:93], v5 offset:49152
    v_mfma_f32_16x16x32_bf16 v[224:227], v[128:131], a[184:187], v[224:227]
    s_add_u32 m0, s49, 32768
    ds_read_b64_tr_b16 v[94:95], v5 offset:53248
    v_mfma_f32_16x16x32_bf16 v[228:231], v[128:131], a[188:191], v[228:231]
    s_add_u32 s41, s50, s3
    ds_read_b64_tr_b16 v[156:157], v5 offset:57344
    v_mfma_f32_16x16x32_bf16 v[228:231], v[64:67], a[180:183], v[228:231]
    ds_read_b64_tr_b16 v[158:159], v5 offset:61440
    s_waitcnt vmcnt(12)
    s_barrier
    v_mfma_f32_16x16x32_bf16 v[236:239], v[68:71], a[180:183], v[236:239]
    ds_read_b64_tr_b16 v[64:65], v6 offset:0
    buffer_load_dwordx4 v188, s[8:11], s41 offen  lds
    v_mfma_f32_16x16x32_bf16 v[236:239], v[132:135], a[188:191], v[236:239]
    ds_read_b64_tr_b16 v[66:67], v6 offset:4096
    buffer_load_dwordx4 v190, s[8:11], s41 offen offset:1024  lds
    v_mfma_f32_16x16x32_bf16 v[232:235], v[132:135], a[184:187], v[232:235]
    ds_read_b64_tr_b16 v[128:129], v6 offset:8192
    v_mfma_f32_16x16x32_bf16 v[232:235], v[68:71], a[176:179], v[232:235]
    s_lshl_b32 s3, s29, 3
    ds_read_b64_tr_b16 v[130:131], v6 offset:12288
    v_mfma_f32_16x16x32_bf16 v[240:243], v[72:75], a[176:179], v[240:243]
    ds_read_b64_tr_b16 v[68:69], v7 offset:0
    v_mfma_f32_16x16x32_bf16 v[240:243], v[136:139], a[184:187], v[240:243]
    s_add_u32 m0, s49, 40960
    ds_read_b64_tr_b16 v[70:71], v7 offset:4096
    v_mfma_f32_16x16x32_bf16 v[244:247], v[136:139], a[188:191], v[244:247]
    s_add_u32 s41, s50, s3
    ds_read_b64_tr_b16 v[132:133], v7 offset:8192
    v_mfma_f32_16x16x32_bf16 v[244:247], v[72:75], a[180:183], v[244:247]
    ds_read_b64_tr_b16 v[134:135], v7 offset:12288
    v_mfma_f32_16x16x32_bf16 v[252:255], v[76:79], a[180:183], v[252:255]
    ds_read_b64_tr_b16 v[72:73], v8 offset:0
    buffer_load_dwordx4 v188, s[8:11], s41 offen  lds
    v_mfma_f32_16x16x32_bf16 v[252:255], v[140:143], a[188:191], v[252:255]
    ds_read_b64_tr_b16 v[74:75], v8 offset:4096
    v_mfma_f32_16x16x32_bf16 v[248:251], v[140:143], a[184:187], v[248:251]
    ds_read_b64_tr_b16 v[136:137], v8 offset:8192
    buffer_load_dwordx4 v190, s[8:11], s41 offen offset:1024  lds
    v_mfma_f32_16x16x32_bf16 v[248:251], v[76:79], a[176:179], v[248:251]
    ds_read_b64_tr_b16 v[138:139], v8 offset:12288
    s_waitcnt lgkmcnt(12)
    v_mfma_f32_16x16x32_bf16 v[192:195], v[80:83], a[176:179], v[192:195]
    s_add_u32 s40, s48, s28
    ds_read_b64_tr_b16 v[76:77], v9 offset:0
    v_mfma_f32_16x16x32_bf16 v[192:195], v[144:147], a[184:187], v[192:195]
    ds_read_b64_tr_b16 v[78:79], v9 offset:4096
    v_mfma_f32_16x16x32_bf16 v[196:199], v[144:147], a[188:191], v[196:199]
    ds_read_b64_tr_b16 v[140:141], v9 offset:8192
    buffer_load_dwordx4 a[160:163], v1, s[4:7], s40 offen offset:0 sc1
    v_mfma_f32_16x16x32_bf16 v[196:199], v[80:83], a[180:183], v[196:199]
    ds_read_b64_tr_b16 v[142:143], v9 offset:12288
    v_mfma_f32_16x16x32_bf16 v[204:207], v[84:87], a[180:183], v[204:207]
    ds_read_b64_tr_b16 v[80:81], v2 offset:0
    v_mfma_f32_16x16x32_bf16 v[204:207], v[148:151], a[188:191], v[204:207]
    ds_read_b64_tr_b16 v[82:83], v2 offset:4096
    buffer_load_dwordx4 a[164:167], v1, s[4:7], s40 offen offset:1024 sc1
    v_mfma_f32_16x16x32_bf16 v[200:203], v[148:151], a[184:187], v[200:203]
    ds_read_b64_tr_b16 v[144:145], v2 offset:8192
    v_mfma_f32_16x16x32_bf16 v[200:203], v[84:87], a[176:179], v[200:203]
    ds_read_b64_tr_b16 v[146:147], v2 offset:12288
    v_mfma_f32_16x16x32_bf16 v[208:211], v[88:91], a[176:179], v[208:211]
    s_add_u32 s40, s48, s29
    ds_read_b64_tr_b16 v[84:85], v3 offset:0
    v_mfma_f32_16x16x32_bf16 v[208:211], v[152:155], a[184:187], v[208:211]
    ds_read_b64_tr_b16 v[86:87], v3 offset:4096
    v_mfma_f32_16x16x32_bf16 v[212:215], v[152:155], a[188:191], v[212:215]
    ds_read_b64_tr_b16 v[148:149], v3 offset:8192
    buffer_load_dwordx4 a[168:171], v1, s[4:7], s40 offen offset:0 sc1
    v_mfma_f32_16x16x32_bf16 v[212:215], v[88:91], a[180:183], v[212:215]
    ds_read_b64_tr_b16 v[150:151], v3 offset:12288
    v_mfma_f32_16x16x32_bf16 v[220:223], v[92:95], a[180:183], v[220:223]
    ds_read_b64_tr_b16 v[88:89], v4 offset:0
    v_mfma_f32_16x16x32_bf16 v[220:223], v[156:159], a[188:191], v[220:223]
    ds_read_b64_tr_b16 v[90:91], v4 offset:4096
    buffer_load_dwordx4 a[172:175], v1, s[4:7], s40 offen offset:1024 sc1
    v_mfma_f32_16x16x32_bf16 v[216:219], v[156:159], a[184:187], v[216:219]
    ds_read_b64_tr_b16 v[152:153], v4 offset:8192
    v_mfma_f32_16x16x32_bf16 v[216:219], v[92:95], a[176:179], v[216:219]
    ds_read_b64_tr_b16 v[154:155], v4 offset:12288
    s_waitcnt vmcnt(16) lgkmcnt(12)
    v_mfma_f32_16x16x32_bf16 v[224:227], v[64:67], a[128:131], v[224:227]
    s_lshl_b32 s3, s30, 3
    ds_read_b64_tr_b16 v[92:93], v5 offset:0
    v_mfma_f32_16x16x32_bf16 v[224:227], v[128:131], a[136:139], v[224:227]
    s_add_u32 m0, s49, 49152
    ds_read_b64_tr_b16 v[94:95], v5 offset:4096
    v_mfma_f32_16x16x32_bf16 v[228:231], v[128:131], a[140:143], v[228:231]
    s_add_u32 s41, s50, s3
    ds_read_b64_tr_b16 v[156:157], v5 offset:8192
    v_mfma_f32_16x16x32_bf16 v[228:231], v[64:67], a[132:135], v[228:231]
    ds_read_b64_tr_b16 v[158:159], v5 offset:12288
    s_waitcnt vmcnt(12)
    s_barrier
    v_mfma_f32_16x16x32_bf16 v[236:239], v[68:71], a[132:135], v[236:239]
    ds_read_b64_tr_b16 v[64:65], v6 offset:16384
    buffer_load_dwordx4 v188, s[8:11], s41 offen  lds
    v_mfma_f32_16x16x32_bf16 v[236:239], v[132:135], a[140:143], v[236:239]
    ds_read_b64_tr_b16 v[66:67], v6 offset:20480
    buffer_load_dwordx4 v190, s[8:11], s41 offen offset:1024  lds
    v_mfma_f32_16x16x32_bf16 v[232:235], v[132:135], a[136:139], v[232:235]
    ds_read_b64_tr_b16 v[128:129], v6 offset:24576
    v_mfma_f32_16x16x32_bf16 v[232:235], v[68:71], a[128:131], v[232:235]
    s_lshl_b32 s3, s31, 3
    ds_read_b64_tr_b16 v[130:131], v6 offset:28672
    v_mfma_f32_16x16x32_bf16 v[240:243], v[72:75], a[128:131], v[240:243]
    ds_read_b64_tr_b16 v[68:69], v7 offset:16384
    v_mfma_f32_16x16x32_bf16 v[240:243], v[136:139], a[136:139], v[240:243]
    s_add_u32 m0, s49, 57344
    ds_read_b64_tr_b16 v[70:71], v7 offset:20480
    v_mfma_f32_16x16x32_bf16 v[244:247], v[136:139], a[140:143], v[244:247]
    s_add_u32 s41, s50, s3
    ds_read_b64_tr_b16 v[132:133], v7 offset:24576
    v_mfma_f32_16x16x32_bf16 v[244:247], v[72:75], a[132:135], v[244:247]
    ds_read_b64_tr_b16 v[134:135], v7 offset:28672
    v_mfma_f32_16x16x32_bf16 v[252:255], v[76:79], a[132:135], v[252:255]
    ds_read_b64_tr_b16 v[72:73], v8 offset:16384
    buffer_load_dwordx4 v188, s[8:11], s41 offen  lds
    v_mfma_f32_16x16x32_bf16 v[252:255], v[140:143], a[140:143], v[252:255]
    ds_read_b64_tr_b16 v[74:75], v8 offset:20480
    v_mfma_f32_16x16x32_bf16 v[248:251], v[140:143], a[136:139], v[248:251]
    ds_read_b64_tr_b16 v[136:137], v8 offset:24576
    buffer_load_dwordx4 v190, s[8:11], s41 offen offset:1024  lds
    v_mfma_f32_16x16x32_bf16 v[248:251], v[76:79], a[128:131], v[248:251]
    ds_read_b64_tr_b16 v[138:139], v8 offset:28672
    s_waitcnt lgkmcnt(12)
    v_mfma_f32_16x16x32_bf16 v[192:195], v[80:83], a[128:131], v[192:195]
    s_add_u32 s40, s48, s30
    ds_read_b64_tr_b16 v[76:77], v9 offset:16384
    v_mfma_f32_16x16x32_bf16 v[192:195], v[144:147], a[136:139], v[192:195]
    ds_read_b64_tr_b16 v[78:79], v9 offset:20480
    v_mfma_f32_16x16x32_bf16 v[196:199], v[144:147], a[140:143], v[196:199]
    ds_read_b64_tr_b16 v[140:141], v9 offset:24576
    buffer_load_dwordx4 a[176:179], v1, s[4:7], s40 offen offset:0 sc1
    v_mfma_f32_16x16x32_bf16 v[196:199], v[80:83], a[132:135], v[196:199]
    ds_read_b64_tr_b16 v[142:143], v9 offset:28672
    v_mfma_f32_16x16x32_bf16 v[204:207], v[84:87], a[132:135], v[204:207]
    ds_read_b64_tr_b16 v[80:81], v2 offset:16384
    buffer_load_dwordx4 a[180:183], v1, s[4:7], s40 offen offset:1024 sc1
    v_mfma_f32_16x16x32_bf16 v[204:207], v[148:151], a[140:143], v[204:207]
    ds_read_b64_tr_b16 v[82:83], v2 offset:20480
    v_mfma_f32_16x16x32_bf16 v[200:203], v[148:151], a[136:139], v[200:203]
    s_add_u32 s40, s48, s31
    ds_read_b64_tr_b16 v[144:145], v2 offset:24576
    v_mfma_f32_16x16x32_bf16 v[200:203], v[84:87], a[128:131], v[200:203]
    ds_read_b64_tr_b16 v[146:147], v2 offset:28672
    v_mfma_f32_16x16x32_bf16 v[208:211], v[88:91], a[128:131], v[208:211]
    ds_read_b64_tr_b16 v[84:85], v3 offset:16384
    buffer_load_dwordx4 a[184:187], v1, s[4:7], s40 offen offset:0 sc1
    v_mfma_f32_16x16x32_bf16 v[208:211], v[152:155], a[136:139], v[208:211]
    ds_read_b64_tr_b16 v[86:87], v3 offset:20480
    v_mfma_f32_16x16x32_bf16 v[212:215], v[152:155], a[140:143], v[212:215]
    ds_read_b64_tr_b16 v[148:149], v3 offset:24576
    buffer_load_dwordx4 a[188:191], v1, s[4:7], s40 offen offset:1024 sc1
    v_mfma_f32_16x16x32_bf16 v[212:215], v[88:91], a[132:135], v[212:215]
    ds_read_b64_tr_b16 v[150:151], v3 offset:28672
    v_mfma_f32_16x16x32_bf16 v[220:223], v[92:95], a[132:135], v[220:223]
    s_sub_u32 s60, s60, 1
    ds_read_b64_tr_b16 v[88:89], v4 offset:16384
    v_mfma_f32_16x16x32_bf16 v[220:223], v[156:159], a[140:143], v[220:223]
    ds_read_b64_tr_b16 v[90:91], v4 offset:20480
    v_mfma_f32_16x16x32_bf16 v[216:219], v[156:159], a[136:139], v[216:219]
    s_cmp_lg_u32 s60, 0
    ds_read_b64_tr_b16 v[152:153], v4 offset:24576
    v_mfma_f32_16x16x32_bf16 v[216:219], v[92:95], a[128:131], v[216:219]
    ds_read_b64_tr_b16 v[154:155], v4 offset:28672
    s_cbranch_scc1 L_f_loop
    v_cmp_ne_u32 vcc, s72, v25
    s_cmp_lg_u64 vcc, 0
    s_cbranch_scc1 L_f_spino
L_f_spinoback:
    s_waitcnt vmcnt(16) lgkmcnt(12)
    v_mfma_f32_16x16x32_bf16 v[224:227], v[64:67], a[144:147], v[224:227]
    s_add_u32 s50, s50, 524288
    ds_read_b64_tr_b16 v[92:93], v5 offset:16384
    v_mfma_f32_16x16x32_bf16 v[224:227], v[128:131], a[152:155], v[224:227]
    s_lshl_b32 s3, s44, 3
    ds_read_b64_tr_b16 v[94:95], v5 offset:20480
    v_mfma_f32_16x16x32_bf16 v[228:231], v[128:131], a[156:159], v[228:231]
    s_add_u32 m0, s49, 0
    ds_read_b64_tr_b16 v[156:157], v5 offset:24576
    v_mfma_f32_16x16x32_bf16 v[228:231], v[64:67], a[148:151], v[228:231]
    ds_read_b64_tr_b16 v[158:159], v5 offset:28672
    s_waitcnt vmcnt(12)
    s_barrier
    v_mfma_f32_16x16x32_bf16 v[236:239], v[68:71], a[148:151], v[236:239]
    s_add_u32 s41, s50, s3
    ds_read_b64_tr_b16 v[64:65], v6 offset:32768
    v_mfma_f32_16x16x32_bf16 v[236:239], v[132:135], a[156:159], v[236:239]
    ds_read_b64_tr_b16 v[66:67], v6 offset:36864
    buffer_load_dwordx4 v188, s[8:11], s41 offen  lds
    v_mfma_f32_16x16x32_bf16 v[232:235], v[132:135], a[152:155], v[232:235]
    ds_read_b64_tr_b16 v[128:129], v6 offset:40960
    v_mfma_f32_16x16x32_bf16 v[232:235], v[68:71], a[144:147], v[232:235]
    ds_read_b64_tr_b16 v[130:131], v6 offset:45056
    buffer_load_dwordx4 v190, s[8:11], s41 offen offset:1024  lds
    v_mfma_f32_16x16x32_bf16 v[240:243], v[72:75], a[144:147], v[240:243]
    s_lshl_b32 s3, s45, 3
    ds_read_b64_tr_b16 v[68:69], v7 offset:32768
    v_mfma_f32_16x16x32_bf16 v[240:243], v[136:139], a[152:155], v[240:243]
    ds_read_b64_tr_b16 v[70:71], v7 offset:36864
    v_mfma_f32_16x16x32_bf16 v[244:247], v[136:139], a[156:159], v[244:247]
    s_add_u32 m0, s49, 8192
    ds_read_b64_tr_b16 v[132:133], v7 offset:40960
    v_mfma_f32_16x16x32_bf16 v[244:247], v[72:75], a[148:151], v[244:247]
    s_add_u32 s41, s50, s3
    ds_read_b64_tr_b16 v[134:135], v7 offset:45056
    v_mfma_f32_16x16x32_bf16 v[252:255], v[76:79], a[148:151], v[252:255]
    ds_read_b64_tr_b16 v[72:73], v8 offset:32768
    v_mfma_f32_16x16x32_bf16 v[252:255], v[140:143], a[156:159], v[252:255]
    ds_read_b64_tr_b16 v[74:75], v8 offset:36864
    buffer_load_dwordx4 v188, s[8:11], s41 offen  lds
    v_mfma_f32_16x16x32_bf16 v[248:251], v[140:143], a[152:155], v[248:251]
    ds_read_b64_tr_b16 v[136:137], v8 offset:40960
    buffer_load_dwordx4 v190, s[8:11], s41 offen offset:1024  lds
    v_mfma_f32_16x16x32_bf16 v[248:251], v[76:79], a[144:147], v[248:251]
    ds_read_b64_tr_b16 v[138:139], v8 offset:45056
    s_waitcnt vmcnt(20) lgkmcnt(12)
    v_mfma_f32_16x16x32_bf16 v[192:195], v[80:83], a[144:147], v[192:195]
    s_add_u32 s48, s48, 65536
    ds_read_b64_tr_b16 v[76:77], v9 offset:32768
    v_mfma_f32_16x16x32_bf16 v[192:195], v[144:147], a[152:155], v[192:195]
    ds_read_b64_tr_b16 v[78:79], v9 offset:36864
    v_mfma_f32_16x16x32_bf16 v[196:199], v[144:147], a[156:159], v[196:199]
    s_add_u32 s40, s48, s44
    ds_read_b64_tr_b16 v[140:141], v9 offset:40960
    v_mfma_f32_16x16x32_bf16 v[196:199], v[80:83], a[148:151], v[196:199]
    ds_read_b64_tr_b16 v[142:143], v9 offset:45056
    v_mfma_f32_16x16x32_bf16 v[204:207], v[84:87], a[148:151], v[204:207]
    ds_read_b64_tr_b16 v[80:81], v2 offset:32768
    buffer_load_dwordx4 a[128:131], v1, s[4:7], s40 offen offset:0 sc1
    v_mfma_f32_16x16x32_bf16 v[204:207], v[148:151], a[156:159], v[204:207]
    ds_read_b64_tr_b16 v[82:83], v2 offset:36864
    v_mfma_f32_16x16x32_bf16 v[200:203], v[148:151], a[152:155], v[200:203]
    ds_read_b64_tr_b16 v[144:145], v2 offset:40960
    buffer_load_dwordx4 a[132:135], v1, s[4:7], s40 offen offset:1024 sc1
    v_mfma_f32_16x16x32_bf16 v[200:203], v[84:87], a[144:147], v[200:203]
    ds_read_b64_tr_b16 v[146:147], v2 offset:45056
    v_mfma_f32_16x16x32_bf16 v[208:211], v[88:91], a[144:147], v[208:211]
    ds_read_b64_tr_b16 v[84:85], v3 offset:32768
    v_mfma_f32_16x16x32_bf16 v[208:211], v[152:155], a[152:155], v[208:211]
    s_add_u32 s40, s48, s45
    ds_read_b64_tr_b16 v[86:87], v3 offset:36864
    v_mfma_f32_16x16x32_bf16 v[212:215], v[152:155], a[156:159], v[212:215]
    ds_read_b64_tr_b16 v[148:149], v3 offset:40960
    v_mfma_f32_16x16x32_bf16 v[212:215], v[88:91], a[148:151], v[212:215]
    ds_read_b64_tr_b16 v[150:151], v3 offset:45056
    buffer_load_dwordx4 a[136:139], v1, s[4:7], s40 offen offset:0 sc1
    v_mfma_f32_16x16x32_bf16 v[220:223], v[92:95], a[148:151], v[220:223]
    ds_read_b64_tr_b16 v[88:89], v4 offset:32768
    v_mfma_f32_16x16x32_bf16 v[220:223], v[156:159], a[156:159], v[220:223]
    ds_read_b64_tr_b16 v[90:91], v4 offset:36864
    buffer_load_dwordx4 a[140:143], v1, s[4:7], s40 offen offset:1024 sc1
    v_mfma_f32_16x16x32_bf16 v[216:219], v[156:159], a[152:155], v[216:219]
    ds_read_b64_tr_b16 v[152:153], v4 offset:40960
    v_mfma_f32_16x16x32_bf16 v[216:219], v[92:95], a[144:147], v[216:219]
    ds_read_b64_tr_b16 v[154:155], v4 offset:45056
    s_waitcnt vmcnt(16) lgkmcnt(12)
    v_mfma_f32_16x16x32_bf16 v[224:227], v[64:67], a[160:163], v[224:227]
    s_lshl_b32 s3, s58, 3
    ds_read_b64_tr_b16 v[92:93], v5 offset:32768
    v_mfma_f32_16x16x32_bf16 v[224:227], v[128:131], a[168:171], v[224:227]
    s_add_u32 m0, s49, 16384
    ds_read_b64_tr_b16 v[94:95], v5 offset:36864
    v_mfma_f32_16x16x32_bf16 v[228:231], v[128:131], a[172:175], v[228:231]
    s_add_u32 s41, s50, s3
    ds_read_b64_tr_b16 v[156:157], v5 offset:40960
    v_mfma_f32_16x16x32_bf16 v[228:231], v[64:67], a[164:167], v[228:231]
    ds_read_b64_tr_b16 v[158:159], v5 offset:45056
    s_waitcnt vmcnt(12)
    s_barrier
    v_mfma_f32_16x16x32_bf16 v[236:239], v[68:71], a[164:167], v[236:239]
    ds_read_b64_tr_b16 v[64:65], v6 offset:49152
    buffer_load_dwordx4 v188, s[8:11], s41 offen  lds
    v_mfma_f32_16x16x32_bf16 v[236:239], v[132:135], a[172:175], v[236:239]
    ds_read_b64_tr_b16 v[66:67], v6 offset:53248
    buffer_load_dwordx4 v190, s[8:11], s41 offen offset:1024  lds
    v_mfma_f32_16x16x32_bf16 v[232:235], v[132:135], a[168:171], v[232:235]
    ds_read_b64_tr_b16 v[128:129], v6 offset:57344
    v_mfma_f32_16x16x32_bf16 v[232:235], v[68:71], a[160:163], v[232:235]
    s_lshl_b32 s3, s59, 3
    ds_read_b64_tr_b16 v[130:131], v6 offset:61440
    v_mfma_f32_16x16x32_bf16 v[240:243], v[72:75], a[160:163], v[240:243]
    ds_read_b64_tr_b16 v[68:69], v7 offset:49152
    v_mfma_f32_16x16x32_bf16 v[240:243], v[136:139], a[168:171], v[240:243]
    s_add_u32 m0, s49, 24576
    ds_read_b64_tr_b16 v[70:71], v7 offset:53248
    v_mfma_f32_16x16x32_bf16 v[244:247], v[136:139], a[172:175], v[244:247]
    s_add_u32 s41, s50, s3
    ds_read_b64_tr_b16 v[132:133], v7 offset:57344
    v_mfma_f32_16x16x32_bf16 v[244:247], v[72:75], a[164:167], v[244:247]
    ds_read_b64_tr_b16 v[134:135], v7 offset:61440
    v_mfma_f32_16x16x32_bf16 v[252:255], v[76:79], a[164:167], v[252:255]
    ds_read_b64_tr_b16 v[72:73], v8 offset:49152
    buffer_load_dwordx4 v188, s[8:11], s41 offen  lds
    v_mfma_f32_16x16x32_bf16 v[252:255], v[140:143], a[172:175], v[252:255]
    ds_read_b64_tr_b16 v[74:75], v8 offset:53248
    v_mfma_f32_16x16x32_bf16 v[248:251], v[140:143], a[168:171], v[248:251]
    ds_read_b64_tr_b16 v[136:137], v8 offset:57344
    buffer_load_dwordx4 v190, s[8:11], s41 offen offset:1024  lds
    v_mfma_f32_16x16x32_bf16 v[248:251], v[76:79], a[160:163], v[248:251]
    ds_read_b64_tr_b16 v[138:139], v8 offset:61440
    s_waitcnt vmcnt(20) lgkmcnt(12)
    v_mfma_f32_16x16x32_bf16 v[192:195], v[80:83], a[160:163], v[192:195]
    s_add_u32 s40, s48, s58
    ds_read_b64_tr_b16 v[76:77], v9 offset:49152
    v_mfma_f32_16x16x32_bf16 v[192:195], v[144:147], a[168:171], v[192:195]
    ds_read_b64_tr_b16 v[78:79], v9 offset:53248
    v_mfma_f32_16x16x32_bf16 v[196:199], v[144:147], a[172:175], v[196:199]
    ds_read_b64_tr_b16 v[140:141], v9 offset:57344
    buffer_load_dwordx4 a[144:147], v1, s[4:7], s40 offen offset:0 sc1
    v_mfma_f32_16x16x32_bf16 v[196:199], v[80:83], a[164:167], v[196:199]
    ds_read_b64_tr_b16 v[142:143], v9 offset:61440
    v_mfma_f32_16x16x32_bf16 v[204:207], v[84:87], a[164:167], v[204:207]
    ds_read_b64_tr_b16 v[80:81], v2 offset:49152
    v_mfma_f32_16x16x32_bf16 v[204:207], v[148:151], a[172:175], v[204:207]
    ds_read_b64_tr_b16 v[82:83], v2 offset:53248
    buffer_load_dwordx4 a[148:151], v1, s[4:7], s40 offen offset:1024 sc1
    v_mfma_f32_16x16x32_bf16 v[200:203], v[148:151], a[168:171], v[200:203]
    ds_read_b64_tr_b16 v[144:145], v2 offset:57344
    v_mfma_f32_16x16x32_bf16 v[200:203], v[84:87], a[160:163], v[200:203]
    ds_read_b64_tr_b16 v[146:147], v2 offset:61440
    v_mfma_f32_16x16x32_bf16 v[208:211], v[88:91], a[160:163], v[208:211]
    s_add_u32 s40, s48, s59
    ds_read_b64_tr_b16 v[84:85], v3 offset:49152
    v_mfma_f32_16x16x32_bf16 v[208:211], v[152:155], a[168:171], v[208:211]
    ds_read_b64_tr_b16 v[86:87], v3 offset:53248
    v_mfma_f32_16x16x32_bf16 v[212:215], v[152:155], a[172:175], v[212:215]
    ds_read_b64_tr_b16 v[148:149], v3 offset:57344
    buffer_load_dwordx4 a[152:155], v1, s[4:7], s40 offen offset:0 sc1
    v_mfma_f32_16x16x32_bf16 v[212:215], v[88:91], a[164:167], v[212:215]
    ds_read_b64_tr_b16 v[150:151], v3 offset:61440
    v_mfma_f32_16x16x32_bf16 v[220:223], v[92:95], a[164:167], v[220:223]
    ds_read_b64_tr_b16 v[88:89], v4 offset:49152
    v_mfma_f32_16x16x32_bf16 v[220:223], v[156:159], a[172:175], v[220:223]
    ds_read_b64_tr_b16 v[90:91], v4 offset:53248
    buffer_load_dwordx4 a[156:159], v1, s[4:7], s40 offen offset:1024 sc1
    v_mfma_f32_16x16x32_bf16 v[216:219], v[156:159], a[168:171], v[216:219]
    ds_read_b64_tr_b16 v[152:153], v4 offset:57344
    v_mfma_f32_16x16x32_bf16 v[216:219], v[92:95], a[160:163], v[216:219]
    ds_read_b64_tr_b16 v[154:155], v4 offset:61440
    s_waitcnt vmcnt(16) lgkmcnt(12)
    v_mfma_f32_16x16x32_bf16 v[224:227], v[64:67], a[176:179], v[224:227]
    s_lshl_b32 s3, s24, 1
    ds_read_b64_tr_b16 v[92:93], v5 offset:49152
    v_mfma_f32_16x16x32_bf16 v[224:227], v[128:131], a[184:187], v[224:227]
    s_add_u32 s40, s39, s3
    ds_read_b64_tr_b16 v[94:95], v5 offset:53248
    v_mfma_f32_16x16x32_bf16 v[228:231], v[128:131], a[188:191], v[228:231]
    ds_read_b64_tr_b16 v[156:157], v5 offset:57344
    v_mfma_f32_16x16x32_bf16 v[228:231], v[64:67], a[180:183], v[228:231]
    ds_read_b64_tr_b16 v[158:159], v5 offset:61440
    s_waitcnt vmcnt(12)
    s_barrier
    v_mfma_f32_16x16x32_bf16 v[236:239], v[68:71], a[180:183], v[236:239]
    ds_read_b64_tr_b16 v[64:65], v6 offset:0
    buffer_load_dwordx4 a[0:3], v1, s[4:7], s40 offen offset:0 sc1
    v_mfma_f32_16x16x32_bf16 v[236:239], v[132:135], a[188:191], v[236:239]
    ds_read_b64_tr_b16 v[66:67], v6 offset:4096
    v_mfma_f32_16x16x32_bf16 v[232:235], v[132:135], a[184:187], v[232:235]
    ds_read_b64_tr_b16 v[128:129], v6 offset:8192
    v_mfma_f32_16x16x32_bf16 v[232:235], v[68:71], a[176:179], v[232:235]
    ds_read_b64_tr_b16 v[130:131], v6 offset:12288
    buffer_load_dwordx4 a[4:7], v1, s[4:7], s40 offen offset:1024 sc1
    v_mfma_f32_16x16x32_bf16 v[240:243], v[72:75], a[176:179], v[240:243]
    ds_read_b64_tr_b16 v[68:69], v7 offset:0
    v_mfma_f32_16x16x32_bf16 v[240:243], v[136:139], a[184:187], v[240:243]
    ds_read_b64_tr_b16 v[70:71], v7 offset:4096
    v_mfma_f32_16x16x32_bf16 v[244:247], v[136:139], a[188:191], v[244:247]
    ds_read_b64_tr_b16 v[132:133], v7 offset:8192
    buffer_load_dwordx4 a[8:11], v189, s[4:7], s40 offen offset:0 sc1
    v_mfma_f32_16x16x32_bf16 v[244:247], v[72:75], a[180:183], v[244:247]
    ds_read_b64_tr_b16 v[134:135], v7 offset:12288
    v_mfma_f32_16x16x32_bf16 v[252:255], v[76:79], a[180:183], v[252:255]
    ds_read_b64_tr_b16 v[72:73], v8 offset:0
    v_mfma_f32_16x16x32_bf16 v[252:255], v[140:143], a[188:191], v[252:255]
    ds_read_b64_tr_b16 v[74:75], v8 offset:4096
    buffer_load_dwordx4 a[12:15], v189, s[4:7], s40 offen offset:1024 sc1
    v_mfma_f32_16x16x32_bf16 v[248:251], v[140:143], a[184:187], v[248:251]
    ds_read_b64_tr_b16 v[136:137], v8 offset:8192
    v_mfma_f32_16x16x32_bf16 v[248:251], v[76:79], a[176:179], v[248:251]
    ds_read_b64_tr_b16 v[138:139], v8 offset:12288
    s_waitcnt vmcnt(20) lgkmcnt(12)
    v_mfma_f32_16x16x32_bf16 v[192:195], v[80:83], a[176:179], v[192:195]
    s_lshl_b32 s3, s25, 1
    ds_read_b64_tr_b16 v[76:77], v9 offset:0
    v_mfma_f32_16x16x32_bf16 v[192:195], v[144:147], a[184:187], v[192:195]
    s_add_u32 s40, s39, s3
    ds_read_b64_tr_b16 v[78:79], v9 offset:4096
    v_mfma_f32_16x16x32_bf16 v[196:199], v[144:147], a[188:191], v[196:199]
    ds_read_b64_tr_b16 v[140:141], v9 offset:8192
    v_mfma_f32_16x16x32_bf16 v[196:199], v[80:83], a[180:183], v[196:199]
    ds_read_b64_tr_b16 v[142:143], v9 offset:12288
    s_waitcnt vmcnt(8)
    s_barrier
    v_mfma_f32_16x16x32_bf16 v[204:207], v[84:87], a[180:183], v[204:207]
    ds_read_b64_tr_b16 v[80:81], v6 offset:16384
    buffer_load_dwordx4 a[16:19], v1, s[4:7], s40 offen offset:0 sc1
    v_mfma_f32_16x16x32_bf16 v[204:207], v[148:151], a[188:191], v[204:207]
    ds_read_b64_tr_b16 v[82:83], v6 offset:20480
    v_mfma_f32_16x16x32_bf16 v[200:203], v[148:151], a[184:187], v[200:203]
    ds_read_b64_tr_b16 v[144:145], v6 offset:24576
    v_mfma_f32_16x16x32_bf16 v[200:203], v[84:87], a[176:179], v[200:203]
    ds_read_b64_tr_b16 v[146:147], v6 offset:28672
    buffer_load_dwordx4 a[20:23], v1, s[4:7], s40 offen offset:1024 sc1
    v_mfma_f32_16x16x32_bf16 v[208:211], v[88:91], a[176:179], v[208:211]
    ds_read_b64_tr_b16 v[84:85], v7 offset:16384
    v_mfma_f32_16x16x32_bf16 v[208:211], v[152:155], a[184:187], v[208:211]
    ds_read_b64_tr_b16 v[86:87], v7 offset:20480
    v_mfma_f32_16x16x32_bf16 v[212:215], v[152:155], a[188:191], v[212:215]
    ds_read_b64_tr_b16 v[148:149], v7 offset:24576
    buffer_load_dwordx4 a[24:27], v189, s[4:7], s40 offen offset:0 sc1
    v_mfma_f32_16x16x32_bf16 v[212:215], v[88:91], a[180:183], v[212:215]
    ds_read_b64_tr_b16 v[150:151], v7 offset:28672
    v_mfma_f32_16x16x32_bf16 v[220:223], v[92:95], a[180:183], v[220:223]
    ds_read_b64_tr_b16 v[88:89], v8 offset:16384
    v_mfma_f32_16x16x32_bf16 v[220:223], v[156:159], a[188:191], v[220:223]
    ds_read_b64_tr_b16 v[90:91], v8 offset:20480
    buffer_load_dwordx4 a[28:31], v189, s[4:7], s40 offen offset:1024 sc1
    v_mfma_f32_16x16x32_bf16 v[216:219], v[156:159], a[184:187], v[216:219]
    ds_read_b64_tr_b16 v[152:153], v8 offset:24576
    v_mfma_f32_16x16x32_bf16 v[216:219], v[92:95], a[176:179], v[216:219]
    ds_read_b64_tr_b16 v[154:155], v8 offset:28672
    s_waitcnt vmcnt(16) lgkmcnt(12)
    v_mfma_f32_16x16x32_bf16 v[224:227], v[64:67], a[128:131], v[224:227]
    s_lshl_b32 s3, s26, 1
    ds_read_b64_tr_b16 v[92:93], v9 offset:16384
    v_mfma_f32_16x16x32_bf16 v[224:227], v[128:131], a[136:139], v[224:227]
    s_add_u32 s40, s39, s3
    ds_read_b64_tr_b16 v[94:95], v9 offset:20480
    v_mfma_f32_16x16x32_bf16 v[228:231], v[128:131], a[140:143], v[228:231]
    ds_read_b64_tr_b16 v[156:157], v9 offset:24576
    v_mfma_f32_16x16x32_bf16 v[228:231], v[64:67], a[132:135], v[228:231]
    ds_read_b64_tr_b16 v[158:159], v9 offset:28672
    s_waitcnt vmcnt(12)
    s_barrier
    v_mfma_f32_16x16x32_bf16 v[236:239], v[68:71], a[132:135], v[236:239]
    ds_read_b64_tr_b16 v[64:65], v2 offset:0
    buffer_load_dwordx4 a[32:35], v1, s[4:7], s40 offen offset:0 sc1
    v_mfma_f32_16x16x32_bf16 v[236:239], v[132:135], a[140:143], v[236:239]
    ds_read_b64_tr_b16 v[66:67], v2 offset:4096
    v_mfma_f32_16x16x32_bf16 v[232:235], v[132:135], a[136:139], v[232:235]
    ds_read_b64_tr_b16 v[128:129], v2 offset:8192
    v_mfma_f32_16x16x32_bf16 v[232:235], v[68:71], a[128:131], v[232:235]
    ds_read_b64_tr_b16 v[130:131], v2 offset:12288
    buffer_load_dwordx4 a[36:39], v1, s[4:7], s40 offen offset:1024 sc1
    v_mfma_f32_16x16x32_bf16 v[240:243], v[72:75], a[128:131], v[240:243]
    ds_read_b64_tr_b16 v[68:69], v3 offset:0
    v_mfma_f32_16x16x32_bf16 v[240:243], v[136:139], a[136:139], v[240:243]
    ds_read_b64_tr_b16 v[70:71], v3 offset:4096
    v_mfma_f32_16x16x32_bf16 v[244:247], v[136:139], a[140:143], v[244:247]
    ds_read_b64_tr_b16 v[132:133], v3 offset:8192
    buffer_load_dwordx4 a[40:43], v189, s[4:7], s40 offen offset:0 sc1
    v_mfma_f32_16x16x32_bf16 v[244:247], v[72:75], a[132:135], v[244:247]
    ds_read_b64_tr_b16 v[134:135], v3 offset:12288
    v_mfma_f32_16x16x32_bf16 v[252:255], v[76:79], a[132:135], v[252:255]
    ds_read_b64_tr_b16 v[72:73], v4 offset:0
    v_mfma_f32_16x16x32_bf16 v[252:255], v[140:143], a[140:143], v[252:255]
    ds_read_b64_tr_b16 v[74:75], v4 offset:4096
    buffer_load_dwordx4 a[44:47], v189, s[4:7], s40 offen offset:1024 sc1
    v_mfma_f32_16x16x32_bf16 v[248:251], v[140:143], a[136:139], v[248:251]
    ds_read_b64_tr_b16 v[136:137], v4 offset:8192
    v_mfma_f32_16x16x32_bf16 v[248:251], v[76:79], a[128:131], v[248:251]
    ds_read_b64_tr_b16 v[138:139], v4 offset:12288
    s_waitcnt vmcnt(12) lgkmcnt(12)
    v_mfma_f32_16x16x32_bf16 v[224:227], v[80:83], a[144:147], v[224:227]
    s_lshl_b32 s3, s27, 1
    ds_read_b64_tr_b16 v[76:77], v5 offset:0
    v_mfma_f32_16x16x32_bf16 v[224:227], v[144:147], a[152:155], v[224:227]
    ds_read_b64_tr_b16 v[78:79], v5 offset:4096
    v_mfma_f32_16x16x32_bf16 v[228:231], v[144:147], a[156:159], v[228:231]
    s_add_u32 s40, s39, s3
    ds_read_b64_tr_b16 v[140:141], v5 offset:8192
    v_mfma_f32_16x16x32_bf16 v[228:231], v[80:83], a[148:151], v[228:231]
    ds_read_b64_tr_b16 v[142:143], v5 offset:12288
    v_mfma_f32_16x16x32_bf16 v[236:239], v[84:87], a[148:151], v[236:239]
    ds_read_b64_tr_b16 v[80:81], v2 offset:16384
    v_mfma_f32_16x16x32_bf16 v[236:239], v[148:151], a[156:159], v[236:239]
    ds_read_b64_tr_b16 v[82:83], v2 offset:20480
    buffer_load_dwordx4 a[48:51], v1, s[4:7], s40 offen offset:0 sc1
    v_mfma_f32_16x16x32_bf16 v[232:235], v[148:151], a[152:155], v[232:235]
    ds_read_b64_tr_b16 v[144:145], v2 offset:24576
    v_mfma_f32_16x16x32_bf16 v[232:235], v[84:87], a[144:147], v[232:235]
    ds_read_b64_tr_b16 v[146:147], v2 offset:28672
    v_mfma_f32_16x16x32_bf16 v[240:243], v[88:91], a[144:147], v[240:243]
    ds_read_b64_tr_b16 v[84:85], v3 offset:16384
    buffer_load_dwordx4 a[52:55], v1, s[4:7], s40 offen offset:1024 sc1
    v_mfma_f32_16x16x32_bf16 v[240:243], v[152:155], a[152:155], v[240:243]
    ds_read_b64_tr_b16 v[86:87], v3 offset:20480
    v_mfma_f32_16x16x32_bf16 v[244:247], v[152:155], a[156:159], v[244:247]
    ds_read_b64_tr_b16 v[148:149], v3 offset:24576
    buffer_load_dwordx4 a[56:59], v189, s[4:7], s40 offen offset:0 sc1
    v_mfma_f32_16x16x32_bf16 v[244:247], v[88:91], a[148:151], v[244:247]
    ds_read_b64_tr_b16 v[150:151], v3 offset:28672
    v_mfma_f32_16x16x32_bf16 v[252:255], v[92:95], a[148:151], v[252:255]
    ds_read_b64_tr_b16 v[88:89], v4 offset:16384
    v_mfma_f32_16x16x32_bf16 v[252:255], v[156:159], a[156:159], v[252:255]
    ds_read_b64_tr_b16 v[90:91], v4 offset:20480
    buffer_load_dwordx4 a[60:63], v189, s[4:7], s40 offen offset:1024 sc1
    v_mfma_f32_16x16x32_bf16 v[248:251], v[156:159], a[152:155], v[248:251]
    ds_read_b64_tr_b16 v[152:153], v4 offset:24576
    v_mfma_f32_16x16x32_bf16 v[248:251], v[92:95], a[144:147], v[248:251]
    ds_read_b64_tr_b16 v[154:155], v4 offset:28672
    s_waitcnt vmcnt(24) lgkmcnt(12)
    v_mfma_f32_16x16x32_bf16 v[192:195], v[64:67], a[128:131], v[192:195]
    ds_read_b64_tr_b16 v[92:93], v5 offset:16384
    v_cvt_pk_bf16_f32 v224, v224, v225
    v_cvt_pk_bf16_f32 v225, v226, v227
    v_mfma_f32_16x16x32_bf16 v[192:195], v[128:131], a[136:139], v[192:195]
    ds_read_b64_tr_b16 v[94:95], v5 offset:20480
    v_cvt_pk_bf16_f32 v226, v228, v229
    v_cvt_pk_bf16_f32 v227, v230, v231
    v_mfma_f32_16x16x32_bf16 v[196:199], v[128:131], a[140:143], v[196:199]
    ds_read_b64_tr_b16 v[156:157], v5 offset:24576
    v_mfma_f32_16x16x32_bf16 v[196:199], v[64:67], a[132:135], v[196:199]
    ds_read_b64_tr_b16 v[158:159], v5 offset:28672
    s_waitcnt vmcnt(20)
    s_barrier
    v_mfma_f32_16x16x32_bf16 v[204:207], v[68:71], a[132:135], v[204:207]
    ds_read_b64_tr_b16 v[64:65], v26 offset:0
    buffer_store_dwordx4 v[224:227], v1, s[4:7], s36 offen offset:0 sc1
    v_mfma_f32_16x16x32_bf16 v[204:207], v[132:135], a[140:143], v[204:207]
    s_lshl_b32 s3, s28, 1
    ds_read_b64_tr_b16 v[66:67], v26 offset:2048
    v_mfma_f32_16x16x32_bf16 v[200:203], v[132:135], a[136:139], v[200:203]
    s_add_u32 s40, s39, s3
    ds_read_b64_tr_b16 v[128:129], v26 offset:4096
    v_mfma_f32_16x16x32_bf16 v[200:203], v[68:71], a[128:131], v[200:203]
    ds_read_b64_tr_b16 v[130:131], v26 offset:6144
    buffer_load_dwordx4 a[64:67], v1, s[4:7], s40 offen offset:0 sc1
    v_mfma_f32_16x16x32_bf16 v[208:211], v[72:75], a[128:131], v[208:211]
    ds_read_b64_tr_b16 v[68:69], v27 offset:0
    buffer_load_dwordx4 a[68:71], v1, s[4:7], s40 offen offset:1024 sc1
    v_mfma_f32_16x16x32_bf16 v[208:211], v[136:139], a[136:139], v[208:211]
    ds_read_b64_tr_b16 v[70:71], v27 offset:2048
    buffer_load_dwordx4 a[72:75], v189, s[4:7], s40 offen offset:0 sc1
    v_mfma_f32_16x16x32_bf16 v[212:215], v[136:139], a[140:143], v[212:215]
    ds_read_b64_tr_b16 v[132:133], v27 offset:4096
    buffer_load_dwordx4 a[76:79], v189, s[4:7], s40 offen offset:1024 sc1
    v_mfma_f32_16x16x32_bf16 v[212:215], v[72:75], a[132:135], v[212:215]
    s_lshl_b32 s3, s28, 4
    ds_read_b64_tr_b16 v[134:135], v27 offset:6144
    v_mfma_f32_16x16x32_bf16 v[220:223], v[76:79], a[132:135], v[220:223]
    s_add_u32 m0, s49, 32768
    ds_read_b64_tr_b16 v[72:73], v28 offset:0
    v_mfma_f32_16x16x32_bf16 v[220:223], v[140:143], a[140:143], v[220:223]
    s_add_u32 s41, s51, s3
    ds_read_b64_tr_b16 v[74:75], v28 offset:2048
    v_mfma_f32_16x16x32_bf16 v[216:219], v[140:143], a[136:139], v[216:219]
    ds_read_b64_tr_b16 v[136:137], v28 offset:4096
    buffer_load_dwordx4 v186, s[12:15], s41 offen  lds
    v_mfma_f32_16x16x32_bf16 v[216:219], v[76:79], a[128:131], v[216:219]
    ds_read_b64_tr_b16 v[138:139], v28 offset:6144
    buffer_load_dwordx4 v187, s[12:15], s41 offen offset:1024  lds
    s_waitcnt vmcnt(23) lgkmcnt(12)
    v_mfma_f32_16x16x32_bf16 v[192:195], v[80:83], a[144:147], v[192:195]
    ds_read_b64_tr_b16 v[76:77], v29 offset:0
    v_cvt_pk_bf16_f32 v232, v232, v233
    v_cvt_pk_bf16_f32 v233, v234, v235
    v_mfma_f32_16x16x32_bf16 v[192:195], v[144:147], a[152:155], v[192:195]
    ds_read_b64_tr_b16 v[78:79], v29 offset:2048
    v_cvt_pk_bf16_f32 v234, v236, v237
    v_cvt_pk_bf16_f32 v235, v238, v239
    v_mfma_f32_16x16x32_bf16 v[196:199], v[144:147], a[156:159], v[196:199]
    ds_read_b64_tr_b16 v[140:141], v29 offset:4096
    buffer_store_dwordx4 v[232:235], v1, s[4:7], s36 offen offset:1024 sc1
    v_mfma_f32_16x16x32_bf16 v[196:199], v[80:83], a[148:151], v[196:199]
    s_lshl_b32 s3, s29, 1
    ds_read_b64_tr_b16 v[142:143], v29 offset:6144
    v_mfma_f32_16x16x32_bf16 v[204:207], v[84:87], a[148:151], v[204:207]
    s_add_u32 s40, s39, s3
    ds_read_b64_tr_b16 v[80:81], v26 offset:8192
    v_mfma_f32_16x16x32_bf16 v[204:207], v[148:151], a[156:159], v[204:207]
    ds_read_b64_tr_b16 v[82:83], v26 offset:10240
    buffer_load_dwordx4 a[80:83], v1, s[4:7], s40 offen offset:0 sc1
    v_mfma_f32_16x16x32_bf16 v[200:203], v[148:151], a[152:155], v[200:203]
    ds_read_b64_tr_b16 v[144:145], v26 offset:12288
    buffer_load_dwordx4 a[84:87], v1, s[4:7], s40 offen offset:1024 sc1
    v_mfma_f32_16x16x32_bf16 v[200:203], v[84:87], a[144:147], v[200:203]
    ds_read_b64_tr_b16 v[146:147], v26 offset:14336
    v_mfma_f32_16x16x32_bf16 v[208:211], v[88:91], a[144:147], v[208:211]
    ds_read_b64_tr_b16 v[84:85], v27 offset:8192
    buffer_load_dwordx4 a[88:91], v189, s[4:7], s40 offen offset:0 sc1
    v_mfma_f32_16x16x32_bf16 v[208:211], v[152:155], a[152:155], v[208:211]
    ds_read_b64_tr_b16 v[86:87], v27 offset:10240
    buffer_load_dwordx4 a[92:95], v189, s[4:7], s40 offen offset:1024 sc1
    v_mfma_f32_16x16x32_bf16 v[212:215], v[152:155], a[156:159], v[212:215]
    s_lshl_b32 s3, s29, 4
    ds_read_b64_tr_b16 v[148:149], v27 offset:12288
    v_mfma_f32_16x16x32_bf16 v[212:215], v[88:91], a[148:151], v[212:215]
    s_add_u32 m0, s49, 40960
    ds_read_b64_tr_b16 v[150:151], v27 offset:14336
    v_mfma_f32_16x16x32_bf16 v[220:223], v[92:95], a[148:151], v[220:223]
    s_add_u32 s41, s51, s3
    ds_read_b64_tr_b16 v[88:89], v28 offset:8192
    v_mfma_f32_16x16x32_bf16 v[220:223], v[156:159], a[156:159], v[220:223]
    ds_read_b64_tr_b16 v[90:91], v28 offset:10240
    buffer_load_dwordx4 v186, s[12:15], s41 offen  lds
    v_mfma_f32_16x16x32_bf16 v[216:219], v[156:159], a[152:155], v[216:219]
    ds_read_b64_tr_b16 v[152:153], v28 offset:12288
    buffer_load_dwordx4 v187, s[12:15], s41 offen offset:1024  lds
    v_mfma_f32_16x16x32_bf16 v[216:219], v[92:95], a[144:147], v[216:219]
    ds_read_b64_tr_b16 v[154:155], v28 offset:14336
    s_waitcnt vmcnt(26) lgkmcnt(12)
    v_mfma_f32_16x16x32_bf16 v[32:35], v[64:67], a[0:3], 0
    ds_read_b64_tr_b16 v[92:93], v29 offset:8192
    v_cvt_pk_bf16_f32 v240, v240, v241
    v_cvt_pk_bf16_f32 v241, v242, v243
    v_mfma_f32_16x16x32_bf16 v[32:35], v[128:131], a[8:11], v[32:35]
    ds_read_b64_tr_b16 v[94:95], v29 offset:10240
    v_cvt_pk_bf16_f32 v242, v244, v245
    v_cvt_pk_bf16_f32 v243, v246, v247
    v_mfma_f32_16x16x32_bf16 v[36:39], v[128:131], a[12:15], 0
    ds_read_b64_tr_b16 v[156:157], v29 offset:12288
    buffer_store_dwordx4 v[240:243], v1, s[4:7], s36 offen offset:2048 sc1
    v_mfma_f32_16x16x32_bf16 v[36:39], v[64:67], a[4:7], v[36:39]
    s_lshl_b32 s3, s30, 1
    ds_read_b64_tr_b16 v[158:159], v29 offset:14336
    v_mfma_f32_16x16x32_bf16 v[44:47], v[68:71], a[4:7], 0
    s_add_u32 s40, s39, s3
    ds_read_b64_tr_b16 v[64:65], v26 offset:16384
    v_mfma_f32_16x16x32_bf16 v[44:47], v[132:135], a[12:15], v[44:47]
    ds_read_b64_tr_b16 v[66:67], v26 offset:18432
    buffer_load_dwordx4 a[96:99], v1, s[4:7], s40 offen offset:0 sc1
    v_mfma_f32_16x16x32_bf16 v[40:43], v[132:135], a[8:11], 0
    ds_read_b64_tr_b16 v[128:129], v26 offset:20480
    buffer_load_dwordx4 a[100:103], v1, s[4:7], s40 offen offset:1024 sc1
    v_mfma_f32_16x16x32_bf16 v[40:43], v[68:71], a[0:3], v[40:43]
    ds_read_b64_tr_b16 v[130:131], v26 offset:22528
    v_mfma_f32_16x16x32_bf16 v[48:51], v[72:75], a[0:3], 0
    ds_read_b64_tr_b16 v[68:69], v27 offset:16384
    buffer_load_dwordx4 a[104:107], v189, s[4:7], s40 offen offset:0 sc1
    v_mfma_f32_16x16x32_bf16 v[48:51], v[136:139], a[8:11], v[48:51]
    ds_read_b64_tr_b16 v[70:71], v27 offset:18432
    buffer_load_dwordx4 a[108:111], v189, s[4:7], s40 offen offset:1024 sc1
    v_mfma_f32_16x16x32_bf16 v[52:55], v[136:139], a[12:15], 0
    s_lshl_b32 s3, s30, 4
    ds_read_b64_tr_b16 v[132:133], v27 offset:20480
    v_mfma_f32_16x16x32_bf16 v[52:55], v[72:75], a[4:7], v[52:55]
    s_add_u32 m0, s49, 49152
    ds_read_b64_tr_b16 v[134:135], v27 offset:22528
    v_mfma_f32_16x16x32_bf16 v[60:63], v[76:79], a[4:7], 0
    s_add_u32 s41, s51, s3
    ds_read_b64_tr_b16 v[72:73], v28 offset:16384
    v_mfma_f32_16x16x32_bf16 v[60:63], v[140:143], a[12:15], v[60:63]
    ds_read_b64_tr_b16 v[74:75], v28 offset:18432
    buffer_load_dwordx4 v186, s[12:15], s41 offen  lds
    v_mfma_f32_16x16x32_bf16 v[56:59], v[140:143], a[8:11], 0
    ds_read_b64_tr_b16 v[136:137], v28 offset:20480
    buffer_load_dwordx4 v187, s[12:15], s41 offen offset:1024  lds
    v_mfma_f32_16x16x32_bf16 v[56:59], v[76:79], a[0:3], v[56:59]
    ds_read_b64_tr_b16 v[138:139], v28 offset:22528
    s_waitcnt vmcnt(29) lgkmcnt(12)
    v_mfma_f32_16x16x32_bf16 v[32:35], v[80:83], a[16:19], v[32:35]
    ds_read_b64_tr_b16 v[76:77], v29 offset:16384
    v_cvt_pk_bf16_f32 v248, v248, v249
    v_cvt_pk_bf16_f32 v249, v250, v251
    v_mfma_f32_16x16x32_bf16 v[32:35], v[144:147], a[24:27], v[32:35]
    ds_read_b64_tr_b16 v[78:79], v29 offset:18432
    v_cvt_pk_bf16_f32 v250, v252, v253
    v_cvt_pk_bf16_f32 v251, v254, v255
    v_mfma_f32_16x16x32_bf16 v[36:39], v[144:147], a[28:31], v[36:39]
    ds_read_b64_tr_b16 v[140:141], v29 offset:20480
    buffer_store_dwordx4 v[248:251], v1, s[4:7], s36 offen offset:3072 sc1
    v_mfma_f32_16x16x32_bf16 v[36:39], v[80:83], a[20:23], v[36:39]
    s_lshl_b32 s3, s31, 1
    ds_read_b64_tr_b16 v[142:143], v29 offset:22528
    v_mfma_f32_16x16x32_bf16 v[44:47], v[84:87], a[20:23], v[44:47]
    s_add_u32 s40, s39, s3
    ds_read_b64_tr_b16 v[80:81], v26 offset:24576
    v_mfma_f32_16x16x32_bf16 v[44:47], v[148:151], a[28:31], v[44:47]
    ds_read_b64_tr_b16 v[82:83], v26 offset:26624
    buffer_load_dwordx4 a[112:115], v1, s[4:7], s40 offen offset:0 sc1
    v_mfma_f32_16x16x32_bf16 v[40:43], v[148:151], a[24:27], v[40:43]
    ds_read_b64_tr_b16 v[144:145], v26 offset:28672
    buffer_load_dwordx4 a[116:119], v1, s[4:7], s40 offen offset:1024 sc1
    v_mfma_f32_16x16x32_bf16 v[40:43], v[84:87], a[16:19], v[40:43]
    ds_read_b64_tr_b16 v[146:147], v26 offset:30720
    v_mfma_f32_16x16x32_bf16 v[48:51], v[88:91], a[16:19], v[48:51]
    ds_read_b64_tr_b16 v[84:85], v27 offset:24576
    buffer_load_dwordx4 a[120:123], v189, s[4:7], s40 offen offset:0 sc1
    v_mfma_f32_16x16x32_bf16 v[48:51], v[152:155], a[24:27], v[48:51]
    ds_read_b64_tr_b16 v[86:87], v27 offset:26624
    buffer_load_dwordx4 a[124:127], v189, s[4:7], s40 offen offset:1024 sc1
    v_mfma_f32_16x16x32_bf16 v[52:55], v[152:155], a[28:31], v[52:55]
    s_lshl_b32 s3, s31, 4
    ds_read_b64_tr_b16 v[148:149], v27 offset:28672
    v_mfma_f32_16x16x32_bf16 v[52:55], v[88:91], a[20:23], v[52:55]
    s_add_u32 m0, s49, 57344
    ds_read_b64_tr_b16 v[150:151], v27 offset:30720
    v_mfma_f32_16x16x32_bf16 v[60:63], v[92:95], a[20:23], v[60:63]
    s_add_u32 s41, s51, s3
    ds_read_b64_tr_b16 v[88:89], v28 offset:24576
    v_mfma_f32_16x16x32_bf16 v[60:63], v[156:159], a[28:31], v[60:63]
    ds_read_b64_tr_b16 v[90:91], v28 offset:26624
    buffer_load_dwordx4 v186, s[12:15], s41 offen  lds
    v_mfma_f32_16x16x32_bf16 v[56:59], v[156:159], a[24:27], v[56:59]
    ds_read_b64_tr_b16 v[152:153], v28 offset:28672
    buffer_load_dwordx4 v187, s[12:15], s41 offen offset:1024  lds
    v_mfma_f32_16x16x32_bf16 v[56:59], v[92:95], a[16:19], v[56:59]
    ds_read_b64_tr_b16 v[154:155], v28 offset:30720
    s_waitcnt vmcnt(32) lgkmcnt(12)
    v_mfma_f32_16x16x32_bf16 v[32:35], v[64:67], a[32:35], v[32:35]
    s_add_u32 s39, s39, 131072
    ds_read_b64_tr_b16 v[92:93], v29 offset:24576
    v_mfma_f32_16x16x32_bf16 v[32:35], v[128:131], a[40:43], v[32:35]
    ds_read_b64_tr_b16 v[94:95], v29 offset:26624
    v_mfma_f32_16x16x32_bf16 v[36:39], v[128:131], a[44:47], v[36:39]
    s_lshl_b32 s3, s24, 1
    ds_read_b64_tr_b16 v[156:157], v29 offset:28672
    v_mfma_f32_16x16x32_bf16 v[36:39], v[64:67], a[36:39], v[36:39]
    ds_read_b64_tr_b16 v[158:159], v29 offset:30720
    v_mfma_f32_16x16x32_bf16 v[44:47], v[68:71], a[36:39], v[44:47]
    s_add_u32 s40, s39, s3
    ds_read_b64_tr_b16 v[64:65], v26 offset:32768
    v_mfma_f32_16x16x32_bf16 v[44:47], v[132:135], a[44:47], v[44:47]
    ds_read_b64_tr_b16 v[66:67], v26 offset:34816
    v_mfma_f32_16x16x32_bf16 v[40:43], v[132:135], a[40:43], v[40:43]
    ds_read_b64_tr_b16 v[128:129], v26 offset:36864
    buffer_load_dwordx4 a[0:3], v1, s[4:7], s40 offen offset:0 sc1
    v_mfma_f32_16x16x32_bf16 v[40:43], v[68:71], a[32:35], v[40:43]
    ds_read_b64_tr_b16 v[130:131], v26 offset:38912
    v_mfma_f32_16x16x32_bf16 v[48:51], v[72:75], a[32:35], v[48:51]
    ds_read_b64_tr_b16 v[68:69], v27 offset:32768
    v_mfma_f32_16x16x32_bf16 v[48:51], v[136:139], a[40:43], v[48:51]
    ds_read_b64_tr_b16 v[70:71], v27 offset:34816
    buffer_load_dwordx4 a[4:7], v1, s[4:7], s40 offen offset:1024 sc1
    v_mfma_f32_16x16x32_bf16 v[52:55], v[136:139], a[44:47], v[52:55]
    ds_read_b64_tr_b16 v[132:133], v27 offset:36864
    v_mfma_f32_16x16x32_bf16 v[52:55], v[72:75], a[36:39], v[52:55]
    ds_read_b64_tr_b16 v[134:135], v27 offset:38912
    buffer_load_dwordx4 a[8:11], v189, s[4:7], s40 offen offset:0 sc1
    v_mfma_f32_16x16x32_bf16 v[60:63], v[76:79], a[36:39], v[60:63]
    ds_read_b64_tr_b16 v[72:73], v28 offset:32768
    v_mfma_f32_16x16x32_bf16 v[60:63], v[140:143], a[44:47], v[60:63]
    ds_read_b64_tr_b16 v[74:75], v28 offset:34816
    buffer_load_dwordx4 a[12:15], v189, s[4:7], s40 offen offset:1024 sc1
    v_mfma_f32_16x16x32_bf16 v[56:59], v[140:143], a[40:43], v[56:59]
    ds_read_b64_tr_b16 v[136:137], v28 offset:36864
    v_mfma_f32_16x16x32_bf16 v[56:59], v[76:79], a[32:35], v[56:59]
    ds_read_b64_tr_b16 v[138:139], v28 offset:38912
    s_waitcnt vmcnt(32) lgkmcnt(12)
    v_mfma_f32_16x16x32_bf16 v[32:35], v[80:83], a[48:51], v[32:35]
    s_lshl_b32 s3, s25, 1
    ds_read_b64_tr_b16 v[76:77], v29 offset:32768
    v_mfma_f32_16x16x32_bf16 v[32:35], v[144:147], a[56:59], v[32:35]
    ds_read_b64_tr_b16 v[78:79], v29 offset:34816
    v_mfma_f32_16x16x32_bf16 v[36:39], v[144:147], a[60:63], v[36:39]
    s_add_u32 s40, s39, s3
    ds_read_b64_tr_b16 v[140:141], v29 offset:36864
    v_mfma_f32_16x16x32_bf16 v[36:39], v[80:83], a[52:55], v[36:39]
    ds_read_b64_tr_b16 v[142:143], v29 offset:38912
    v_mfma_f32_16x16x32_bf16 v[44:47], v[84:87], a[52:55], v[44:47]
    ds_read_b64_tr_b16 v[80:81], v26 offset:40960
    v_mfma_f32_16x16x32_bf16 v[44:47], v[148:151], a[60:63], v[44:47]
    ds_read_b64_tr_b16 v[82:83], v26 offset:43008
    buffer_load_dwordx4 a[16:19], v1, s[4:7], s40 offen offset:0 sc1
    v_mfma_f32_16x16x32_bf16 v[40:43], v[148:151], a[56:59], v[40:43]
    ds_read_b64_tr_b16 v[144:145], v26 offset:45056
    v_mfma_f32_16x16x32_bf16 v[40:43], v[84:87], a[48:51], v[40:43]
    ds_read_b64_tr_b16 v[146:147], v26 offset:47104
    v_mfma_f32_16x16x32_bf16 v[48:51], v[88:91], a[48:51], v[48:51]
    ds_read_b64_tr_b16 v[84:85], v27 offset:40960
    buffer_load_dwordx4 a[20:23], v1, s[4:7], s40 offen offset:1024 sc1
    v_mfma_f32_16x16x32_bf16 v[48:51], v[152:155], a[56:59], v[48:51]
    ds_read_b64_tr_b16 v[86:87], v27 offset:43008
    v_mfma_f32_16x16x32_bf16 v[52:55], v[152:155], a[60:63], v[52:55]
    ds_read_b64_tr_b16 v[148:149], v27 offset:45056
    buffer_load_dwordx4 a[24:27], v189, s[4:7], s40 offen offset:0 sc1
    v_mfma_f32_16x16x32_bf16 v[52:55], v[88:91], a[52:55], v[52:55]
    ds_read_b64_tr_b16 v[150:151], v27 offset:47104
    v_mfma_f32_16x16x32_bf16 v[60:63], v[92:95], a[52:55], v[60:63]
    ds_read_b64_tr_b16 v[88:89], v28 offset:40960
    v_mfma_f32_16x16x32_bf16 v[60:63], v[156:159], a[60:63], v[60:63]
    ds_read_b64_tr_b16 v[90:91], v28 offset:43008
    buffer_load_dwordx4 a[28:31], v189, s[4:7], s40 offen offset:1024 sc1
    v_mfma_f32_16x16x32_bf16 v[56:59], v[156:159], a[56:59], v[56:59]
    ds_read_b64_tr_b16 v[152:153], v28 offset:45056
    v_mfma_f32_16x16x32_bf16 v[56:59], v[92:95], a[48:51], v[56:59]
    ds_read_b64_tr_b16 v[154:155], v28 offset:47104
    s_waitcnt vmcnt(31) lgkmcnt(12)
    v_mfma_f32_16x16x32_bf16 v[32:35], v[64:67], a[64:67], v[32:35]
    s_lshl_b32 s3, s26, 1
    ds_read_b64_tr_b16 v[92:93], v29 offset:40960
    v_mfma_f32_16x16x32_bf16 v[32:35], v[128:131], a[72:75], v[32:35]
    ds_read_b64_tr_b16 v[94:95], v29 offset:43008
    v_mfma_f32_16x16x32_bf16 v[36:39], v[128:131], a[76:79], v[36:39]
    s_add_u32 s40, s39, s3
    ds_read_b64_tr_b16 v[156:157], v29 offset:45056
    v_mfma_f32_16x16x32_bf16 v[36:39], v[64:67], a[68:71], v[36:39]
    ds_read_b64_tr_b16 v[158:159], v29 offset:47104
    v_mfma_f32_16x16x32_bf16 v[44:47], v[68:71], a[68:71], v[44:47]
    ds_read_b64_tr_b16 v[64:65], v26 offset:49152
    v_mfma_f32_16x16x32_bf16 v[44:47], v[132:135], a[76:79], v[44:47]
    ds_read_b64_tr_b16 v[66:67], v26 offset:51200
    buffer_load_dwordx4 a[32:35], v1, s[4:7], s40 offen offset:0 sc1
    v_mfma_f32_16x16x32_bf16 v[40:43], v[132:135], a[72:75], v[40:43]
    ds_read_b64_tr_b16 v[128:129], v26 offset:53248
    v_mfma_f32_16x16x32_bf16 v[40:43], v[68:71], a[64:67], v[40:43]
    ds_read_b64_tr_b16 v[130:131], v26 offset:55296
    v_mfma_f32_16x16x32_bf16 v[48:51], v[72:75], a[64:67], v[48:51]
    ds_read_b64_tr_b16 v[68:69], v27 offset:49152
    buffer_load_dwordx4 a[36:39], v1, s[4:7], s40 offen offset:1024 sc1
    v_mfma_f32_16x16x32_bf16 v[48:51], v[136:139], a[72:75], v[48:51]
    ds_read_b64_tr_b16 v[70:71], v27 offset:51200
    v_mfma_f32_16x16x32_bf16 v[52:55], v[136:139], a[76:79], v[52:55]
    ds_read_b64_tr_b16 v[132:133], v27 offset:53248
    buffer_load_dwordx4 a[40:43], v189, s[4:7], s40 offen offset:0 sc1
    v_mfma_f32_16x16x32_bf16 v[52:55], v[72:75], a[68:71], v[52:55]
    ds_read_b64_tr_b16 v[134:135], v27 offset:55296
    v_mfma_f32_16x16x32_bf16 v[60:63], v[76:79], a[68:71], v[60:63]
    ds_read_b64_tr_b16 v[72:73], v28 offset:49152
    v_mfma_f32_16x16x32_bf16 v[60:63], v[140:143], a[76:79], v[60:63]
    ds_read_b64_tr_b16 v[74:75], v28 offset:51200
    buffer_load_dwordx4 a[44:47], v189, s[4:7], s40 offen offset:1024 sc1
    v_mfma_f32_16x16x32_bf16 v[56:59], v[140:143], a[72:75], v[56:59]
    ds_read_b64_tr_b16 v[136:137], v28 offset:53248
    v_mfma_f32_16x16x32_bf16 v[56:59], v[76:79], a[64:67], v[56:59]
    ds_read_b64_tr_b16 v[138:139], v28 offset:55296
    s_waitcnt vmcnt(28) lgkmcnt(12)
    v_mfma_f32_16x16x32_bf16 v[32:35], v[80:83], a[80:83], v[32:35]
    s_lshl_b32 s3, s27, 1
    ds_read_b64_tr_b16 v[76:77], v29 offset:49152
    v_mfma_f32_16x16x32_bf16 v[32:35], v[144:147], a[88:91], v[32:35]
    ds_read_b64_tr_b16 v[78:79], v29 offset:51200
    v_mfma_f32_16x16x32_bf16 v[36:39], v[144:147], a[92:95], v[36:39]
    s_add_u32 s40, s39, s3
    ds_read_b64_tr_b16 v[140:141], v29 offset:53248
    v_mfma_f32_16x16x32_bf16 v[36:39], v[80:83], a[84:87], v[36:39]
    ds_read_b64_tr_b16 v[142:143], v29 offset:55296
    v_mfma_f32_16x16x32_bf16 v[44:47], v[84:87], a[84:87], v[44:47]
    ds_read_b64_tr_b16 v[80:81], v26 offset:57344
    v_mfma_f32_16x16x32_bf16 v[44:47], v[148:151], a[92:95], v[44:47]
    ds_read_b64_tr_b16 v[82:83], v26 offset:59392
    buffer_load_dwordx4 a[48:51], v1, s[4:7], s40 offen offset:0 sc1
    v_mfma_f32_16x16x32_bf16 v[40:43], v[148:151], a[88:91], v[40:43]
    ds_read_b64_tr_b16 v[144:145], v26 offset:61440
    v_mfma_f32_16x16x32_bf16 v[40:43], v[84:87], a[80:83], v[40:43]
    ds_read_b64_tr_b16 v[146:147], v26 offset:63488
    v_add_u32 v26, 65536, v26
    v_mfma_f32_16x16x32_bf16 v[48:51], v[88:91], a[80:83], v[48:51]
    ds_read_b64_tr_b16 v[84:85], v27 offset:57344
    buffer_load_dwordx4 a[52:55], v1, s[4:7], s40 offen offset:1024 sc1
    v_mfma_f32_16x16x32_bf16 v[48:51], v[152:155], a[88:91], v[48:51]
    ds_read_b64_tr_b16 v[86:87], v27 offset:59392
    v_mfma_f32_16x16x32_bf16 v[52:55], v[152:155], a[92:95], v[52:55]
    ds_read_b64_tr_b16 v[148:149], v27 offset:61440
    buffer_load_dwordx4 a[56:59], v189, s[4:7], s40 offen offset:0 sc1
    v_mfma_f32_16x16x32_bf16 v[52:55], v[88:91], a[84:87], v[52:55]
    ds_read_b64_tr_b16 v[150:151], v27 offset:63488
    v_add_u32 v27, 65536, v27
    v_mfma_f32_16x16x32_bf16 v[60:63], v[92:95], a[84:87], v[60:63]
    ds_read_b64_tr_b16 v[88:89], v28 offset:57344
    v_mfma_f32_16x16x32_bf16 v[60:63], v[156:159], a[92:95], v[60:63]
    ds_read_b64_tr_b16 v[90:91], v28 offset:59392
    buffer_load_dwordx4 a[60:63], v189, s[4:7], s40 offen offset:1024 sc1
    v_mfma_f32_16x16x32_bf16 v[56:59], v[156:159], a[88:91], v[56:59]
    ds_read_b64_tr_b16 v[152:153], v28 offset:61440
    v_mfma_f32_16x16x32_bf16 v[56:59], v[92:95], a[80:83], v[56:59]
    ds_read_b64_tr_b16 v[154:155], v28 offset:63488
    v_add_u32 v28, 65536, v28
    s_waitcnt vmcnt(25) lgkmcnt(12)
    v_mfma_f32_16x16x32_bf16 v[32:35], v[64:67], a[96:99], v[32:35]
    s_lshl_b32 s3, s28, 1
    ds_read_b64_tr_b16 v[92:93], v29 offset:57344
    v_mfma_f32_16x16x32_bf16 v[32:35], v[128:131], a[104:107], v[32:35]
    ds_read_b64_tr_b16 v[94:95], v29 offset:59392
    v_mfma_f32_16x16x32_bf16 v[36:39], v[128:131], a[108:111], v[36:39]
    s_add_u32 s40, s39, s3
    ds_read_b64_tr_b16 v[156:157], v29 offset:61440
    v_mfma_f32_16x16x32_bf16 v[36:39], v[64:67], a[100:103], v[36:39]
    ds_read_b64_tr_b16 v[158:159], v29 offset:63488
    v_add_u32 v29, 65536, v29
    s_waitcnt vmcnt(22)
    s_mov_b64 exec, 1
    buffer_store_dword v20, v21, s[4:7], s37 offen sc1
    s_mov_b64 exec, -1
    v_mfma_f32_16x16x32_bf16 v[44:47], v[68:71], a[100:103], v[44:47]
    ds_read_b64_tr_b16 v[64:65], v26 offset:0
    v_mfma_f32_16x16x32_bf16 v[44:47], v[132:135], a[108:111], v[44:47]
    ds_read_b64_tr_b16 v[66:67], v26 offset:2048
    buffer_load_dwordx4 a[64:67], v1, s[4:7], s40 offen offset:0 sc1
    v_mfma_f32_16x16x32_bf16 v[40:43], v[132:135], a[104:107], v[40:43]
    ds_read_b64_tr_b16 v[128:129], v26 offset:4096
    v_mfma_f32_16x16x32_bf16 v[40:43], v[68:71], a[96:99], v[40:43]
    ds_read_b64_tr_b16 v[130:131], v26 offset:6144
    v_mfma_f32_16x16x32_bf16 v[48:51], v[72:75], a[96:99], v[48:51]
    ds_read_b64_tr_b16 v[68:69], v27 offset:0
    buffer_load_dwordx4 a[68:71], v1, s[4:7], s40 offen offset:1024 sc1
    v_mfma_f32_16x16x32_bf16 v[48:51], v[136:139], a[104:107], v[48:51]
    ds_read_b64_tr_b16 v[70:71], v27 offset:2048
    v_mfma_f32_16x16x32_bf16 v[52:55], v[136:139], a[108:111], v[52:55]
    ds_read_b64_tr_b16 v[132:133], v27 offset:4096
    buffer_load_dwordx4 a[72:75], v189, s[4:7], s40 offen offset:0 sc1
    v_mfma_f32_16x16x32_bf16 v[52:55], v[72:75], a[100:103], v[52:55]
    ds_read_b64_tr_b16 v[134:135], v27 offset:6144
    v_mfma_f32_16x16x32_bf16 v[60:63], v[76:79], a[100:103], v[60:63]
    ds_read_b64_tr_b16 v[72:73], v28 offset:0
    v_mfma_f32_16x16x32_bf16 v[60:63], v[140:143], a[108:111], v[60:63]
    ds_read_b64_tr_b16 v[74:75], v28 offset:2048
    buffer_load_dwordx4 a[76:79], v189, s[4:7], s40 offen offset:1024 sc1
    v_mfma_f32_16x16x32_bf16 v[56:59], v[140:143], a[104:107], v[56:59]
    ds_read_b64_tr_b16 v[136:137], v28 offset:4096
    v_mfma_f32_16x16x32_bf16 v[56:59], v[76:79], a[96:99], v[56:59]
    ds_read_b64_tr_b16 v[138:139], v28 offset:6144
    s_waitcnt vmcnt(23) lgkmcnt(12)
    v_mfma_f32_16x16x32_bf16 v[32:35], v[80:83], a[112:115], v[32:35]
    s_lshl_b32 s3, s29, 1
    ds_read_b64_tr_b16 v[76:77], v29 offset:0
    v_mfma_f32_16x16x32_bf16 v[32:35], v[144:147], a[120:123], v[32:35]
    ds_read_b64_tr_b16 v[78:79], v29 offset:2048
    v_mfma_f32_16x16x32_bf16 v[36:39], v[144:147], a[124:127], v[36:39]
    s_add_u32 s40, s39, s3
    ds_read_b64_tr_b16 v[140:141], v29 offset:4096
    v_mfma_f32_16x16x32_bf16 v[36:39], v[80:83], a[116:119], v[36:39]
    ds_read_b64_tr_b16 v[142:143], v29 offset:6144
    v_mfma_f32_16x16x32_bf16 v[44:47], v[84:87], a[116:119], v[44:47]
    ds_read_b64_tr_b16 v[80:81], v26 offset:8192
    v_mfma_f32_16x16x32_bf16 v[44:47], v[148:151], a[124:127], v[44:47]
    ds_read_b64_tr_b16 v[82:83], v26 offset:10240
    buffer_load_dwordx4 a[80:83], v1, s[4:7], s40 offen offset:0 sc1
    v_mfma_f32_16x16x32_bf16 v[40:43], v[148:151], a[120:123], v[40:43]
    ds_read_b64_tr_b16 v[144:145], v26 offset:12288
    v_mfma_f32_16x16x32_bf16 v[40:43], v[84:87], a[112:115], v[40:43]
    ds_read_b64_tr_b16 v[146:147], v26 offset:14336
    v_mfma_f32_16x16x32_bf16 v[48:51], v[88:91], a[112:115], v[48:51]
    ds_read_b64_tr_b16 v[84:85], v27 offset:8192
    buffer_load_dwordx4 a[84:87], v1, s[4:7], s40 offen offset:1024 sc1
    v_mfma_f32_16x16x32_bf16 v[48:51], v[152:155], a[120:123], v[48:51]
    ds_read_b64_tr_b16 v[86:87], v27 offset:10240
    v_mfma_f32_16x16x32_bf16 v[52:55], v[152:155], a[124:127], v[52:55]
    ds_read_b64_tr_b16 v[148:149], v27 offset:12288
    buffer_load_dwordx4 a[88:91], v189, s[4:7], s40 offen offset:0 sc1
    v_mfma_f32_16x16x32_bf16 v[52:55], v[88:91], a[116:119], v[52:55]
    ds_read_b64_tr_b16 v[150:151], v27 offset:14336
    v_mfma_f32_16x16x32_bf16 v[60:63], v[92:95], a[116:119], v[60:63]
    ds_read_b64_tr_b16 v[88:89], v28 offset:8192
    v_mfma_f32_16x16x32_bf16 v[60:63], v[156:159], a[124:127], v[60:63]
    ds_read_b64_tr_b16 v[90:91], v28 offset:10240
    buffer_load_dwordx4 a[92:95], v189, s[4:7], s40 offen offset:1024 sc1
    v_mfma_f32_16x16x32_bf16 v[56:59], v[156:159], a[120:123], v[56:59]
    ds_read_b64_tr_b16 v[152:153], v28 offset:12288
    v_mfma_f32_16x16x32_bf16 v[56:59], v[92:95], a[112:115], v[56:59]
    ds_read_b64_tr_b16 v[154:155], v28 offset:14336
    s_waitcnt vmcnt(21) lgkmcnt(12)
    v_mfma_f32_16x16x32_bf16 v[32:35], v[64:67], a[0:3], v[32:35]
    s_lshl_b32 s3, s30, 1
    ds_read_b64_tr_b16 v[92:93], v29 offset:8192
    v_mfma_f32_16x16x32_bf16 v[32:35], v[128:131], a[8:11], v[32:35]
    s_add_u32 s40, s39, s3
    ds_read_b64_tr_b16 v[94:95], v29 offset:10240
    v_mfma_f32_16x16x32_bf16 v[36:39], v[128:131], a[12:15], v[36:39]
    ds_read_b64_tr_b16 v[156:157], v29 offset:12288
    v_mfma_f32_16x16x32_bf16 v[36:39], v[64:67], a[4:7], v[36:39]
    ds_read_b64_tr_b16 v[158:159], v29 offset:14336
    s_waitcnt vmcnt(25)
    s_barrier
    v_mfma_f32_16x16x32_bf16 v[44:47], v[68:71], a[4:7], v[44:47]
    ds_read_b64_tr_b16 v[64:65], v26 offset:16384
    buffer_load_dwordx4 a[96:99], v1, s[4:7], s40 offen offset:0 sc1
    v_mfma_f32_16x16x32_bf16 v[44:47], v[132:135], a[12:15], v[44:47]
    ds_read_b64_tr_b16 v[66:67], v26 offset:18432
    v_mfma_f32_16x16x32_bf16 v[40:43], v[132:135], a[8:11], v[40:43]
    ds_read_b64_tr_b16 v[128:129], v26 offset:20480
    v_mfma_f32_16x16x32_bf16 v[40:43], v[68:71], a[0:3], v[40:43]
    ds_read_b64_tr_b16 v[130:131], v26 offset:22528
    buffer_load_dwordx4 a[100:103], v1, s[4:7], s40 offen offset:1024 sc1
    v_mfma_f32_16x16x32_bf16 v[48:51], v[72:75], a[0:3], v[48:51]
    ds_read_b64_tr_b16 v[68:69], v27 offset:16384
    v_mfma_f32_16x16x32_bf16 v[48:51], v[136:139], a[8:11], v[48:51]
    ds_read_b64_tr_b16 v[70:71], v27 offset:18432
    v_mfma_f32_16x16x32_bf16 v[52:55], v[136:139], a[12:15], v[52:55]
    ds_read_b64_tr_b16 v[132:133], v27 offset:20480
    buffer_load_dwordx4 a[104:107], v189, s[4:7], s40 offen offset:0 sc1
    v_mfma_f32_16x16x32_bf16 v[52:55], v[72:75], a[4:7], v[52:55]
    ds_read_b64_tr_b16 v[134:135], v27 offset:22528
    v_mfma_f32_16x16x32_bf16 v[60:63], v[76:79], a[4:7], v[60:63]
    ds_read_b64_tr_b16 v[72:73], v28 offset:16384
    v_mfma_f32_16x16x32_bf16 v[60:63], v[140:143], a[12:15], v[60:63]
    ds_read_b64_tr_b16 v[74:75], v28 offset:18432
    buffer_load_dwordx4 a[108:111], v189, s[4:7], s40 offen offset:1024 sc1
    v_mfma_f32_16x16x32_bf16 v[56:59], v[140:143], a[8:11], v[56:59]
    ds_read_b64_tr_b16 v[136:137], v28 offset:20480
    v_mfma_f32_16x16x32_bf16 v[56:59], v[76:79], a[0:3], v[56:59]
    ds_read_b64_tr_b16 v[138:139], v28 offset:22528
    s_waitcnt vmcnt(21) lgkmcnt(12)
    v_mfma_f32_16x16x32_bf16 v[32:35], v[80:83], a[16:19], v[32:35]
    s_lshl_b32 s3, s31, 1
    ds_read_b64_tr_b16 v[76:77], v29 offset:16384
    v_mfma_f32_16x16x32_bf16 v[32:35], v[144:147], a[24:27], v[32:35]
    ds_read_b64_tr_b16 v[78:79], v29 offset:18432
    v_mfma_f32_16x16x32_bf16 v[36:39], v[144:147], a[28:31], v[36:39]
    s_add_u32 s40, s39, s3
    ds_read_b64_tr_b16 v[140:141], v29 offset:20480
    v_mfma_f32_16x16x32_bf16 v[36:39], v[80:83], a[20:23], v[36:39]
    ds_read_b64_tr_b16 v[142:143], v29 offset:22528
    v_mfma_f32_16x16x32_bf16 v[44:47], v[84:87], a[20:23], v[44:47]
    ds_read_b64_tr_b16 v[80:81], v26 offset:24576
    buffer_load_dwordx4 a[112:115], v1, s[4:7], s40 offen offset:0 sc1
    v_mfma_f32_16x16x32_bf16 v[44:47], v[148:151], a[28:31], v[44:47]
    ds_read_b64_tr_b16 v[82:83], v26 offset:26624
    v_mfma_f32_16x16x32_bf16 v[40:43], v[148:151], a[24:27], v[40:43]
    ds_read_b64_tr_b16 v[144:145], v26 offset:28672
    buffer_load_dwordx4 a[116:119], v1, s[4:7], s40 offen offset:1024 sc1
    v_mfma_f32_16x16x32_bf16 v[40:43], v[84:87], a[16:19], v[40:43]
    ds_read_b64_tr_b16 v[146:147], v26 offset:30720
    v_subrev_u32 v26, 131072, v26
    v_mfma_f32_16x16x32_bf16 v[48:51], v[88:91], a[16:19], v[48:51]
    ds_read_b64_tr_b16 v[84:85], v27 offset:24576
    v_mfma_f32_16x16x32_bf16 v[48:51], v[152:155], a[24:27], v[48:51]
    ds_read_b64_tr_b16 v[86:87], v27 offset:26624
    buffer_load_dwordx4 a[120:123], v189, s[4:7], s40 offen offset:0 sc1
    v_mfma_f32_16x16x32_bf16 v[52:55], v[152:155], a[28:31], v[52:55]
    ds_read_b64_tr_b16 v[148:149], v27 offset:28672
    v_mfma_f32_16x16x32_bf16 v[52:55], v[88:91], a[20:23], v[52:55]
    ds_read_b64_tr_b16 v[150:151], v27 offset:30720
    buffer_load_dwordx4 a[124:127], v189, s[4:7], s40 offen offset:1024 sc1
    v_subrev_u32 v27, 131072, v27
    v_mfma_f32_16x16x32_bf16 v[60:63], v[92:95], a[20:23], v[60:63]
    ds_read_b64_tr_b16 v[88:89], v28 offset:24576
    v_mfma_f32_16x16x32_bf16 v[60:63], v[156:159], a[28:31], v[60:63]
    ds_read_b64_tr_b16 v[90:91], v28 offset:26624
    buffer_load_dword v25, v21, s[4:7], s42 offen sc1
    v_mfma_f32_16x16x32_bf16 v[56:59], v[156:159], a[24:27], v[56:59]
    ds_read_b64_tr_b16 v[152:153], v28 offset:28672
    v_mfma_f32_16x16x32_bf16 v[56:59], v[92:95], a[16:19], v[56:59]
    ds_read_b64_tr_b16 v[154:155], v28 offset:30720
    v_subrev_u32 v28, 131072, v28
    s_waitcnt vmcnt(22) lgkmcnt(12)
    v_mfma_f32_16x16x32_bf16 v[32:35], v[64:67], a[32:35], v[32:35]
    ds_read_b64_tr_b16 v[92:93], v29 offset:24576
    v_mfma_f32_16x16x32_bf16 v[32:35], v[128:131], a[40:43], v[32:35]
    ds_read_b64_tr_b16 v[94:95], v29 offset:26624
    v_mfma_f32_16x16x32_bf16 v[36:39], v[128:131], a[44:47], v[36:39]
    ds_read_b64_tr_b16 v[156:157], v29 offset:28672
    v_mfma_f32_16x16x32_bf16 v[36:39], v[64:67], a[36:39], v[36:39]
    ds_read_b64_tr_b16 v[158:159], v29 offset:30720
    v_subrev_u32 v29, 131072, v29
    v_mfma_f32_16x16x32_bf16 v[44:47], v[68:71], a[36:39], v[44:47]
    ds_read_b64_tr_b16 v[64:65], v26 offset:32768
    v_mfma_f32_16x16x32_bf16 v[44:47], v[132:135], a[44:47], v[44:47]
    ds_read_b64_tr_b16 v[66:67], v26 offset:34816
    v_mfma_f32_16x16x32_bf16 v[40:43], v[132:135], a[40:43], v[40:43]
    ds_read_b64_tr_b16 v[128:129], v26 offset:36864
    v_mfma_f32_16x16x32_bf16 v[40:43], v[68:71], a[32:35], v[40:43]
    ds_read_b64_tr_b16 v[130:131], v26 offset:38912
    v_mfma_f32_16x16x32_bf16 v[48:51], v[72:75], a[32:35], v[48:51]
    ds_read_b64_tr_b16 v[68:69], v27 offset:32768
    v_mfma_f32_16x16x32_bf16 v[48:51], v[136:139], a[40:43], v[48:51]
    ds_read_b64_tr_b16 v[70:71], v27 offset:34816
    v_mfma_f32_16x16x32_bf16 v[52:55], v[136:139], a[44:47], v[52:55]
    ds_read_b64_tr_b16 v[132:133], v27 offset:36864
    v_mfma_f32_16x16x32_bf16 v[52:55], v[72:75], a[36:39], v[52:55]
    ds_read_b64_tr_b16 v[134:135], v27 offset:38912
    v_mfma_f32_16x16x32_bf16 v[60:63], v[76:79], a[36:39], v[60:63]
    ds_read_b64_tr_b16 v[72:73], v28 offset:32768
    v_mfma_f32_16x16x32_bf16 v[60:63], v[140:143], a[44:47], v[60:63]
    ds_read_b64_tr_b16 v[74:75], v28 offset:34816
    v_mfma_f32_16x16x32_bf16 v[56:59], v[140:143], a[40:43], v[56:59]
    ds_read_b64_tr_b16 v[136:137], v28 offset:36864
    v_mfma_f32_16x16x32_bf16 v[56:59], v[76:79], a[32:35], v[56:59]
    ds_read_b64_tr_b16 v[138:139], v28 offset:38912
    s_waitcnt vmcnt(18) lgkmcnt(12)
    v_mfma_f32_16x16x32_bf16 v[32:35], v[80:83], a[48:51], v[32:35]
    ds_read_b64_tr_b16 v[76:77], v29 offset:32768
    v_mfma_f32_16x16x32_bf16 v[32:35], v[144:147], a[56:59], v[32:35]
    ds_read_b64_tr_b16 v[78:79], v29 offset:34816
    v_mfma_f32_16x16x32_bf16 v[36:39], v[144:147], a[60:63], v[36:39]
    ds_read_b64_tr_b16 v[140:141], v29 offset:36864
    v_mfma_f32_16x16x32_bf16 v[36:39], v[80:83], a[52:55], v[36:39]
    ds_read_b64_tr_b16 v[142:143], v29 offset:38912
    v_mfma_f32_16x16x32_bf16 v[44:47], v[84:87], a[52:55], v[44:47]
    ds_read_b64_tr_b16 v[80:81], v26 offset:40960
    v_mfma_f32_16x16x32_bf16 v[44:47], v[148:151], a[60:63], v[44:47]
    ds_read_b64_tr_b16 v[82:83], v26 offset:43008
    v_mfma_f32_16x16x32_bf16 v[40:43], v[148:151], a[56:59], v[40:43]
    ds_read_b64_tr_b16 v[144:145], v26 offset:45056
    v_mfma_f32_16x16x32_bf16 v[40:43], v[84:87], a[48:51], v[40:43]
    ds_read_b64_tr_b16 v[146:147], v26 offset:47104
    v_mfma_f32_16x16x32_bf16 v[48:51], v[88:91], a[48:51], v[48:51]
    ds_read_b64_tr_b16 v[84:85], v27 offset:40960
    v_mfma_f32_16x16x32_bf16 v[48:51], v[152:155], a[56:59], v[48:51]
    ds_read_b64_tr_b16 v[86:87], v27 offset:43008
    v_mfma_f32_16x16x32_bf16 v[52:55], v[152:155], a[60:63], v[52:55]
    ds_read_b64_tr_b16 v[148:149], v27 offset:45056
    v_mfma_f32_16x16x32_bf16 v[52:55], v[88:91], a[52:55], v[52:55]
    ds_read_b64_tr_b16 v[150:151], v27 offset:47104
    v_mfma_f32_16x16x32_bf16 v[60:63], v[92:95], a[52:55], v[60:63]
    ds_read_b64_tr_b16 v[88:89], v28 offset:40960
    v_mfma_f32_16x16x32_bf16 v[60:63], v[156:159], a[60:63], v[60:63]
    ds_read_b64_tr_b16 v[90:91], v28 offset:43008
    v_mfma_f32_16x16x32_bf16 v[56:59], v[156:159], a[56:59], v[56:59]
    ds_read_b64_tr_b16 v[152:153], v28 offset:45056
    v_mfma_f32_16x16x32_bf16 v[56:59], v[92:95], a[48:51], v[56:59]
    ds_read_b64_tr_b16 v[154:155], v28 offset:47104
    s_waitcnt vmcnt(13) lgkmcnt(12)
    v_mfma_f32_16x16x32_bf16 v[32:35], v[64:67], a[64:67], v[32:35]
    ds_read_b64_tr_b16 v[92:93], v29 offset:40960
    v_mfma_f32_16x16x32_bf16 v[32:35], v[128:131], a[72:75], v[32:35]
    ds_read_b64_tr_b16 v[94:95], v29 offset:43008
    v_mfma_f32_16x16x32_bf16 v[36:39], v[128:131], a[76:79], v[36:39]
    ds_read_b64_tr_b16 v[156:157], v29 offset:45056
    v_mfma_f32_16x16x32_bf16 v[36:39], v[64:67], a[68:71], v[36:39]
    ds_read_b64_tr_b16 v[158:159], v29 offset:47104
    s_waitcnt vmcnt(0)
    v_cmp_ne_u32 vcc, s72, v25
    s_cmp_lg_u64 vcc, 0
    s_cbranch_scc1 L_f_sping
L_f_spingback:
    buffer_load_dwordx4 v[96:99], v1, s[4:7], s43 offen offset:0 sc1
    buffer_load_dwordx4 v[100:103], v1, s[4:7], s43 offen offset:1024 sc1
    buffer_load_dwordx4 v[104:107], v1, s[4:7], s43 offen offset:2048 sc1
    buffer_load_dwordx4 v[108:111], v1, s[4:7], s43 offen offset:3072 sc1
    v_mfma_f32_16x16x32_bf16 v[44:47], v[68:71], a[68:71], v[44:47]
    ds_read_b64_tr_b16 v[64:65], v26 offset:49152
    v_mfma_f32_16x16x32_bf16 v[44:47], v[132:135], a[76:79], v[44:47]
    ds_read_b64_tr_b16 v[66:67], v26 offset:51200
    v_mfma_f32_16x16x32_bf16 v[40:43], v[132:135], a[72:75], v[40:43]
    ds_read_b64_tr_b16 v[128:129], v26 offset:53248
    v_mfma_f32_16x16x32_bf16 v[40:43], v[68:71], a[64:67], v[40:43]
    ds_read_b64_tr_b16 v[130:131], v26 offset:55296
    v_mfma_f32_16x16x32_bf16 v[48:51], v[72:75], a[64:67], v[48:51]
    ds_read_b64_tr_b16 v[68:69], v27 offset:49152
    v_mfma_f32_16x16x32_bf16 v[48:51], v[136:139], a[72:75], v[48:51]
    ds_read_b64_tr_b16 v[70:71], v27 offset:51200
    v_mfma_f32_16x16x32_bf16 v[52:55], v[136:139], a[76:79], v[52:55]
    ds_read_b64_tr_b16 v[132:133], v27 offset:53248
    v_mfma_f32_16x16x32_bf16 v[52:55], v[72:75], a[68:71], v[52:55]
    ds_read_b64_tr_b16 v[134:135], v27 offset:55296
    v_mfma_f32_16x16x32_bf16 v[60:63], v[76:79], a[68:71], v[60:63]
    ds_read_b64_tr_b16 v[72:73], v28 offset:49152
    v_mfma_f32_16x16x32_bf16 v[60:63], v[140:143], a[76:79], v[60:63]
    ds_read_b64_tr_b16 v[74:75], v28 offset:51200
    v_mfma_f32_16x16x32_bf16 v[56:59], v[140:143], a[72:75], v[56:59]
    ds_read_b64_tr_b16 v[136:137], v28 offset:53248
    v_mfma_f32_16x16x32_bf16 v[56:59], v[76:79], a[64:67], v[56:59]
    ds_read_b64_tr_b16 v[138:139], v28 offset:55296
    s_waitcnt vmcnt(13) lgkmcnt(12)
    v_mfma_f32_16x16x32_bf16 v[32:35], v[80:83], a[80:83], v[32:35]
    ds_read_b64_tr_b16 v[76:77], v29 offset:49152
    v_mfma_f32_16x16x32_bf16 v[32:35], v[144:147], a[88:91], v[32:35]
    ds_read_b64_tr_b16 v[78:79], v29 offset:51200
    v_mfma_f32_16x16x32_bf16 v[36:39], v[144:147], a[92:95], v[36:39]
    ds_read_b64_tr_b16 v[140:141], v29 offset:53248
    v_mfma_f32_16x16x32_bf16 v[36:39], v[80:83], a[84:87], v[36:39]
    ds_read_b64_tr_b16 v[142:143], v29 offset:55296
    v_mfma_f32_16x16x32_bf16 v[44:47], v[84:87], a[84:87], v[44:47]
    ds_read_b64_tr_b16 v[80:81], v26 offset:57344
    v_mfma_f32_16x16x32_bf16 v[44:47], v[148:151], a[92:95], v[44:47]
    ds_read_b64_tr_b16 v[82:83], v26 offset:59392
    v_mfma_f32_16x16x32_bf16 v[40:43], v[148:151], a[88:91], v[40:43]
    ds_read_b64_tr_b16 v[144:145], v26 offset:61440
    v_mfma_f32_16x16x32_bf16 v[40:43], v[84:87], a[80:83], v[40:43]
    ds_read_b64_tr_b16 v[146:147], v26 offset:63488
    v_mfma_f32_16x16x32_bf16 v[48:51], v[88:91], a[80:83], v[48:51]
    ds_read_b64_tr_b16 v[84:85], v27 offset:57344
    v_mfma_f32_16x16x32_bf16 v[48:51], v[152:155], a[88:91], v[48:51]
    ds_read_b64_tr_b16 v[86:87], v27 offset:59392
    v_mfma_f32_16x16x32_bf16 v[52:55], v[152:155], a[92:95], v[52:55]
    ds_read_b64_tr_b16 v[148:149], v27 offset:61440
    v_mfma_f32_16x16x32_bf16 v[52:55], v[88:91], a[84:87], v[52:55]
    ds_read_b64_tr_b16 v[150:151], v27 offset:63488
    v_mfma_f32_16x16x32_bf16 v[60:63], v[92:95], a[84:87], v[60:63]
    ds_read_b64_tr_b16 v[88:89], v28 offset:57344
    v_mfma_f32_16x16x32_bf16 v[60:63], v[156:159], a[92:95], v[60:63]
    ds_read_b64_tr_b16 v[90:91], v28 offset:59392
    v_mfma_f32_16x16x32_bf16 v[56:59], v[156:159], a[88:91], v[56:59]
    ds_read_b64_tr_b16 v[152:153], v28 offset:61440
    v_mfma_f32_16x16x32_bf16 v[56:59], v[92:95], a[80:83], v[56:59]
    ds_read_b64_tr_b16 v[154:155], v28 offset:63488
    s_waitcnt vmcnt(9) lgkmcnt(12)
    v_mfma_f32_16x16x32_bf16 v[32:35], v[64:67], a[96:99], v[32:35]
    ds_read_b64_tr_b16 v[92:93], v29 offset:57344
    v_mfma_f32_16x16x32_bf16 v[32:35], v[128:131], a[104:107], v[32:35]
    ds_read_b64_tr_b16 v[94:95], v29 offset:59392
    v_mfma_f32_16x16x32_bf16 v[36:39], v[128:131], a[108:111], v[36:39]
    ds_read_b64_tr_b16 v[156:157], v29 offset:61440
    v_mfma_f32_16x16x32_bf16 v[36:39], v[64:67], a[100:103], v[36:39]
    ds_read_b64_tr_b16 v[158:159], v29 offset:63488
    v_mfma_f32_16x16x32_bf16 v[44:47], v[68:71], a[100:103], v[44:47]
    v_mfma_f32_16x16x32_bf16 v[44:47], v[132:135], a[108:111], v[44:47]
    v_mfma_f32_16x16x32_bf16 v[40:43], v[132:135], a[104:107], v[40:43]
    v_mfma_f32_16x16x32_bf16 v[40:43], v[68:71], a[96:99], v[40:43]
    v_mfma_f32_16x16x32_bf16 v[48:51], v[72:75], a[96:99], v[48:51]
    v_mfma_f32_16x16x32_bf16 v[48:51], v[136:139], a[104:107], v[48:51]
    v_mfma_f32_16x16x32_bf16 v[52:55], v[136:139], a[108:111], v[52:55]
    v_mfma_f32_16x16x32_bf16 v[52:55], v[72:75], a[100:103], v[52:55]
    v_mfma_f32_16x16x32_bf16 v[60:63], v[76:79], a[100:103], v[60:63]
    v_mfma_f32_16x16x32_bf16 v[60:63], v[140:143], a[108:111], v[60:63]
    v_mfma_f32_16x16x32_bf16 v[56:59], v[140:143], a[104:107], v[56:59]
    v_mfma_f32_16x16x32_bf16 v[56:59], v[76:79], a[96:99], v[56:59]
    s_waitcnt vmcnt(5) lgkmcnt(0)
    v_mfma_f32_16x16x32_bf16 v[32:35], v[80:83], a[112:115], v[32:35]
    v_mfma_f32_16x16x32_bf16 v[32:35], v[144:147], a[120:123], v[32:35]
    v_mfma_f32_16x16x32_bf16 v[36:39], v[144:147], a[124:127], v[36:39]
    v_mfma_f32_16x16x32_bf16 v[36:39], v[80:83], a[116:119], v[36:39]
    v_mfma_f32_16x16x32_bf16 v[44:47], v[84:87], a[116:119], v[44:47]
    v_mfma_f32_16x16x32_bf16 v[44:47], v[148:151], a[124:127], v[44:47]
    v_mfma_f32_16x16x32_bf16 v[40:43], v[148:151], a[120:123], v[40:43]
    v_mfma_f32_16x16x32_bf16 v[40:43], v[84:87], a[112:115], v[40:43]
    v_mfma_f32_16x16x32_bf16 v[48:51], v[88:91], a[112:115], v[48:51]
    v_mfma_f32_16x16x32_bf16 v[48:51], v[152:155], a[120:123], v[48:51]
    v_mfma_f32_16x16x32_bf16 v[52:55], v[152:155], a[124:127], v[52:55]
    v_mfma_f32_16x16x32_bf16 v[52:55], v[88:91], a[116:119], v[52:55]
    v_mfma_f32_16x16x32_bf16 v[60:63], v[92:95], a[116:119], v[60:63]
    v_mfma_f32_16x16x32_bf16 v[60:63], v[156:159], a[124:127], v[60:63]
    v_mfma_f32_16x16x32_bf16 v[56:59], v[156:159], a[120:123], v[56:59]
    v_mfma_f32_16x16x32_bf16 v[56:59], v[92:95], a[112:115], v[56:59]
    s_mov_b32 s66, 0xbfb8aa3b
    s_mov_b32 s67, 0xbfb8aa3b
    s_waitcnt vmcnt(0)
    v_lshlrev_b32 v112, 16, v96
    v_and_b32 v113, 0xffff0000, v96
    v_lshlrev_b32 v114, 16, v97
    v_and_b32 v115, 0xffff0000, v97
    v_lshlrev_b32 v116, 16, v100
    v_and_b32 v117, 0xffff0000, v100
    v_lshlrev_b32 v118, 16, v101
    v_and_b32 v119, 0xffff0000, v101
    v_pk_add_f32 v[192:193], v[192:193], v[112:113]
    v_pk_add_f32 v[194:195], v[194:195], v[114:115]
    v_pk_add_f32 v[200:201], v[200:201], v[116:117]
    v_pk_add_f32 v[202:203], v[202:203], v[118:119]
    v_pk_mul_f32 v[64:65], v[192:193], s[66:67]
    v_pk_mul_f32 v[66:67], v[194:195], s[66:67]
    v_pk_mul_f32 v[68:69], v[200:201], s[66:67]
    v_pk_mul_f32 v[70:71], v[202:203], s[66:67]
    v_exp_f32 v64, v64
    v_exp_f32 v65, v65
    v_exp_f32 v66, v66
    v_exp_f32 v67, v67
    v_exp_f32 v68, v68
    v_exp_f32 v69, v69
    v_exp_f32 v70, v70
    v_exp_f32 v71, v71
    v_lshlrev_b32 v72, 16, v160
    v_and_b32 v73, 0xffff0000, v160
    v_lshlrev_b32 v74, 16, v161
    v_and_b32 v75, 0xffff0000, v161
    v_lshlrev_b32 v76, 16, v162
    v_and_b32 v77, 0xffff0000, v162
    v_lshlrev_b32 v78, 16, v163
    v_and_b32 v79, 0xffff0000, v163
    v_pk_add_f32 v[64:65], v[64:65], 1.0 op_sel_hi:[1,0]
    v_pk_add_f32 v[66:67], v[66:67], 1.0 op_sel_hi:[1,0]
    v_pk_add_f32 v[68:69], v[68:69], 1.0 op_sel_hi:[1,0]
    v_pk_add_f32 v[70:71], v[70:71], 1.0 op_sel_hi:[1,0]
    v_rcp_f32 v64, v64
    v_rcp_f32 v65, v65
    v_rcp_f32 v66, v66
    v_rcp_f32 v67, v67
    v_rcp_f32 v68, v68
    v_rcp_f32 v69, v69
    v_rcp_f32 v70, v70
    v_rcp_f32 v71, v71
    v_pk_mul_f32 v[192:193], v[192:193], v[32:33]
    v_pk_mul_f32 v[194:195], v[194:195], v[34:35]
    v_pk_mul_f32 v[200:201], v[200:201], v[40:41]
    v_pk_mul_f32 v[202:203], v[202:203], v[42:43]
    v_pk_mul_f32 v[64:65], v[192:193], v[64:65]
    v_pk_mul_f32 v[66:67], v[194:195], v[66:67]
    v_pk_mul_f32 v[68:69], v[200:201], v[68:69]
    v_pk_mul_f32 v[70:71], v[202:203], v[70:71]
    s_nop 1
    v_permlane16_swap_b32 v64, v68
    v_permlane16_swap_b32 v65, v69
    v_permlane16_swap_b32 v66, v70
    v_permlane16_swap_b32 v67, v71
    v_pk_add_f32 v[72:73], v[72:73], v[64:65]
    v_pk_add_f32 v[74:75], v[74:75], v[66:67]
    v_pk_add_f32 v[76:77], v[76:77], v[68:69]
    v_pk_add_f32 v[78:79], v[78:79], v[70:71]
    v_cvt_pk_bf16_f32 v160, v72, v73
    v_cvt_pk_bf16_f32 v161, v74, v75
    v_cvt_pk_bf16_f32 v162, v76, v77
    v_cvt_pk_bf16_f32 v163, v78, v79
    buffer_store_dwordx4 v[160:163], v191, s[16:19], s68 offen offset:0 sc1
    v_lshlrev_b32 v112, 16, v98
    v_and_b32 v113, 0xffff0000, v98
    v_lshlrev_b32 v114, 16, v99
    v_and_b32 v115, 0xffff0000, v99
    v_lshlrev_b32 v116, 16, v102
    v_and_b32 v117, 0xffff0000, v102
    v_lshlrev_b32 v118, 16, v103
    v_and_b32 v119, 0xffff0000, v103
    v_pk_add_f32 v[196:197], v[196:197], v[112:113]
    v_pk_add_f32 v[198:199], v[198:199], v[114:115]
    v_pk_add_f32 v[204:205], v[204:205], v[116:117]
    v_pk_add_f32 v[206:207], v[206:207], v[118:119]
    v_pk_mul_f32 v[80:81], v[196:197], s[66:67]
    v_pk_mul_f32 v[82:83], v[198:199], s[66:67]
    v_pk_mul_f32 v[84:85], v[204:205], s[66:67]
    v_pk_mul_f32 v[86:87], v[206:207], s[66:67]
    v_exp_f32 v80, v80
    v_exp_f32 v81, v81
    v_exp_f32 v82, v82
    v_exp_f32 v83, v83
    v_exp_f32 v84, v84
    v_exp_f32 v85, v85
    v_exp_f32 v86, v86
    v_exp_f32 v87, v87
    v_lshlrev_b32 v88, 16, v164
    v_and_b32 v89, 0xffff0000, v164
    v_lshlrev_b32 v90, 16, v165
    v_and_b32 v91, 0xffff0000, v165
    v_lshlrev_b32 v92, 16, v166
    v_and_b32 v93, 0xffff0000, v166
    v_lshlrev_b32 v94, 16, v167
    v_and_b32 v95, 0xffff0000, v167
    v_pk_add_f32 v[80:81], v[80:81], 1.0 op_sel_hi:[1,0]
    v_pk_add_f32 v[82:83], v[82:83], 1.0 op_sel_hi:[1,0]
    v_pk_add_f32 v[84:85], v[84:85], 1.0 op_sel_hi:[1,0]
    v_pk_add_f32 v[86:87], v[86:87], 1.0 op_sel_hi:[1,0]
    v_rcp_f32 v80, v80
    v_rcp_f32 v81, v81
    v_rcp_f32 v82, v82
    v_rcp_f32 v83, v83
    v_rcp_f32 v84, v84
    v_rcp_f32 v85, v85
    v_rcp_f32 v86, v86
    v_rcp_f32 v87, v87
    v_pk_mul_f32 v[196:197], v[196:197], v[36:37]
    v_pk_mul_f32 v[198:199], v[198:199], v[38:39]
    v_pk_mul_f32 v[204:205], v[204:205], v[44:45]
    v_pk_mul_f32 v[206:207], v[206:207], v[46:47]
    v_pk_mul_f32 v[80:81], v[196:197], v[80:81]
    v_pk_mul_f32 v[82:83], v[198:199], v[82:83]
    v_pk_mul_f32 v[84:85], v[204:205], v[84:85]
    v_pk_mul_f32 v[86:87], v[206:207], v[86:87]
    s_nop 1
    v_permlane16_swap_b32 v80, v84
    v_permlane16_swap_b32 v81, v85
    v_permlane16_swap_b32 v82, v86
    v_permlane16_swap_b32 v83, v87
    v_pk_add_f32 v[88:89], v[88:89], v[80:81]
    v_pk_add_f32 v[90:91], v[90:91], v[82:83]
    v_pk_add_f32 v[92:93], v[92:93], v[84:85]
    v_pk_add_f32 v[94:95], v[94:95], v[86:87]
    v_cvt_pk_bf16_f32 v164, v88, v89
    v_cvt_pk_bf16_f32 v165, v90, v91
    v_cvt_pk_bf16_f32 v166, v92, v93
    v_cvt_pk_bf16_f32 v167, v94, v95
    buffer_store_dwordx4 v[164:167], v191, s[16:19], s69 offen offset:0 sc1
    v_lshlrev_b32 v112, 16, v104
    v_and_b32 v113, 0xffff0000, v104
    v_lshlrev_b32 v114, 16, v105
    v_and_b32 v115, 0xffff0000, v105
    v_lshlrev_b32 v116, 16, v108
    v_and_b32 v117, 0xffff0000, v108
    v_lshlrev_b32 v118, 16, v109
    v_and_b32 v119, 0xffff0000, v109
    v_pk_add_f32 v[208:209], v[208:209], v[112:113]
    v_pk_add_f32 v[210:211], v[210:211], v[114:115]
    v_pk_add_f32 v[216:217], v[216:217], v[116:117]
    v_pk_add_f32 v[218:219], v[218:219], v[118:119]
    v_pk_mul_f32 v[128:129], v[208:209], s[66:67]
    v_pk_mul_f32 v[130:131], v[210:211], s[66:67]
    v_pk_mul_f32 v[132:133], v[216:217], s[66:67]
    v_pk_mul_f32 v[134:135], v[218:219], s[66:67]
    v_exp_f32 v128, v128
    v_exp_f32 v129, v129
    v_exp_f32 v130, v130
    v_exp_f32 v131, v131
    v_exp_f32 v132, v132
    v_exp_f32 v133, v133
    v_exp_f32 v134, v134
    v_exp_f32 v135, v135
    v_lshlrev_b32 v136, 16, v168
    v_and_b32 v137, 0xffff0000, v168
    v_lshlrev_b32 v138, 16, v169
    v_and_b32 v139, 0xffff0000, v169
    v_lshlrev_b32 v140, 16, v170
    v_and_b32 v141, 0xffff0000, v170
    v_lshlrev_b32 v142, 16, v171
    v_and_b32 v143, 0xffff0000, v171
    v_pk_add_f32 v[128:129], v[128:129], 1.0 op_sel_hi:[1,0]
    v_pk_add_f32 v[130:131], v[130:131], 1.0 op_sel_hi:[1,0]
    v_pk_add_f32 v[132:133], v[132:133], 1.0 op_sel_hi:[1,0]
    v_pk_add_f32 v[134:135], v[134:135], 1.0 op_sel_hi:[1,0]
    v_rcp_f32 v128, v128
    v_rcp_f32 v129, v129
    v_rcp_f32 v130, v130
    v_rcp_f32 v131, v131
    v_rcp_f32 v132, v132
    v_rcp_f32 v133, v133
    v_rcp_f32 v134, v134
    v_rcp_f32 v135, v135
    v_pk_mul_f32 v[208:209], v[208:209], v[48:49]
    v_pk_mul_f32 v[210:211], v[210:211], v[50:51]
    v_pk_mul_f32 v[216:217], v[216:217], v[56:57]
    v_pk_mul_f32 v[218:219], v[218:219], v[58:59]
    v_pk_mul_f32 v[128:129], v[208:209], v[128:129]
    v_pk_mul_f32 v[130:131], v[210:211], v[130:131]
    v_pk_mul_f32 v[132:133], v[216:217], v[132:133]
    v_pk_mul_f32 v[134:135], v[218:219], v[134:135]
    s_nop 1
    v_permlane16_swap_b32 v128, v132
    v_permlane16_swap_b32 v129, v133
    v_permlane16_swap_b32 v130, v134
    v_permlane16_swap_b32 v131, v135
    v_pk_add_f32 v[136:137], v[136:137], v[128:129]
    v_pk_add_f32 v[138:139], v[138:139], v[130:131]
    v_pk_add_f32 v[140:141], v[140:141], v[132:133]
    v_pk_add_f32 v[142:143], v[142:143], v[134:135]
    v_cvt_pk_bf16_f32 v168, v136, v137
    v_cvt_pk_bf16_f32 v169, v138, v139
    v_cvt_pk_bf16_f32 v170, v140, v141
    v_cvt_pk_bf16_f32 v171, v142, v143
    buffer_store_dwordx4 v[168:171], v191, s[16:19], s68 offen offset:64 sc1
    v_lshlrev_b32 v112, 16, v106
    v_and_b32 v113, 0xffff0000, v106
    v_lshlrev_b32 v114, 16, v107
    v_and_b32 v115, 0xffff0000, v107
    v_lshlrev_b32 v116, 16, v110
    v_and_b32 v117, 0xffff0000, v110
    v_lshlrev_b32 v118, 16, v111
    v_and_b32 v119, 0xffff0000, v111
    v_pk_add_f32 v[212:213], v[212:213], v[112:113]
    v_pk_add_f32 v[214:215], v[214:215], v[114:115]
    v_pk_add_f32 v[220:221], v[220:221], v[116:117]
    v_pk_add_f32 v[222:223], v[222:223], v[118:119]
    v_pk_mul_f32 v[144:145], v[212:213], s[66:67]
    v_pk_mul_f32 v[146:147], v[214:215], s[66:67]
    v_pk_mul_f32 v[148:149], v[220:221], s[66:67]
    v_pk_mul_f32 v[150:151], v[222:223], s[66:67]
    v_exp_f32 v144, v144
    v_exp_f32 v145, v145
    v_exp_f32 v146, v146
    v_exp_f32 v147, v147
    v_exp_f32 v148, v148
    v_exp_f32 v149, v149
    v_exp_f32 v150, v150
    v_exp_f32 v151, v151
    v_lshlrev_b32 v152, 16, v172
    v_and_b32 v153, 0xffff0000, v172
    v_lshlrev_b32 v154, 16, v173
    v_and_b32 v155, 0xffff0000, v173
    v_lshlrev_b32 v156, 16, v174
    v_and_b32 v157, 0xffff0000, v174
    v_lshlrev_b32 v158, 16, v175
    v_and_b32 v159, 0xffff0000, v175
    v_pk_add_f32 v[144:145], v[144:145], 1.0 op_sel_hi:[1,0]
    v_pk_add_f32 v[146:147], v[146:147], 1.0 op_sel_hi:[1,0]
    v_pk_add_f32 v[148:149], v[148:149], 1.0 op_sel_hi:[1,0]
    v_pk_add_f32 v[150:151], v[150:151], 1.0 op_sel_hi:[1,0]
    v_rcp_f32 v144, v144
    v_rcp_f32 v145, v145
    v_rcp_f32 v146, v146
    v_rcp_f32 v147, v147
    v_rcp_f32 v148, v148
    v_rcp_f32 v149, v149
    v_rcp_f32 v150, v150
    v_rcp_f32 v151, v151
    v_pk_mul_f32 v[212:213], v[212:213], v[52:53]
    v_pk_mul_f32 v[214:215], v[214:215], v[54:55]
    v_pk_mul_f32 v[220:221], v[220:221], v[60:61]
    v_pk_mul_f32 v[222:223], v[222:223], v[62:63]
    v_pk_mul_f32 v[144:145], v[212:213], v[144:145]
    v_pk_mul_f32 v[146:147], v[214:215], v[146:147]
    v_pk_mul_f32 v[148:149], v[220:221], v[148:149]
    v_pk_mul_f32 v[150:151], v[222:223], v[150:151]
    s_nop 1
    v_permlane16_swap_b32 v144, v148
    v_permlane16_swap_b32 v145, v149
    v_permlane16_swap_b32 v146, v150
    v_permlane16_swap_b32 v147, v151
    v_pk_add_f32 v[152:153], v[152:153], v[144:145]
    v_pk_add_f32 v[154:155], v[154:155], v[146:147]
    v_pk_add_f32 v[156:157], v[156:157], v[148:149]
    v_pk_add_f32 v[158:159], v[158:159], v[150:151]
    v_cvt_pk_bf16_f32 v172, v152, v153
    v_cvt_pk_bf16_f32 v173, v154, v155
    v_cvt_pk_bf16_f32 v174, v156, v157
    v_cvt_pk_bf16_f32 v175, v158, v159
    buffer_store_dwordx4 v[172:175], v191, s[16:19], s69 offen offset:64 sc1
    s_or_b32 s3, s2, s46
    s_cmp_lg_u32 s3, 0
    s_cbranch_scc1 L_f_noepoch
    s_mov_b32 s3, 62914560
    v_mov_b32 v20, s72
    v_mov_b32 v21, 0
    s_mov_b64 exec, 1
    buffer_store_dword v20, v21, s[4:7], s3 offen sc1
    s_mov_b64 exec, -1
L_f_noepoch:
    s_endpgm
L_f_oload:
    buffer_load_dword v25, v19, s[4:7], s65 offen sc1
    s_branch L_f_hookback
L_f_spino:
    v_and_b32 v22, 127, v24
    s_mov_b32 s73, 0x40000
L_poll8:
    buffer_load_dword v23, v22, s[4:7], s65 offen sc1
    s_waitcnt vmcnt(0)
    v_cmp_ne_u32 vcc, s72, v23
    s_cmp_eq_u64 vcc, 0
    s_cbranch_scc1 L_poll8_done
    s_sub_u32 s73, s73, 1
    s_cbranch_scc1 L_poll8_done
    s_sleep 1
    s_branch L_poll8
L_poll8_done:
    s_branch L_f_spinoback
L_f_sping:
    v_and_b32 v22, 3, v24
    s_mov_b32 s73, 0x40000
L_poll9:
    buffer_load_dword v23, v22, s[4:7], s42 offen sc1
    s_waitcnt vmcnt(0)
    v_cmp_ne_u32 vcc, s72, v23
    s_cmp_eq_u64 vcc, 0
    s_cbranch_scc1 L_poll9_done
    s_sub_u32 s73, s73, 1
    s_cbranch_scc1 L_poll9_done
    s_sleep 1
    s_branch L_poll9
L_poll9_done:
    s_branch L_f_spingback
L_end:
    s_endpgm
.section .rodata,"a"
.p2align 6
.amdhsa_kernel recurrent_scan__softmax_full_mha__glu_gated_glu__prompt_kernel
  .amdhsa_next_free_vgpr 512
  .amdhsa_next_free_sgpr 102
  .amdhsa_accum_offset 256
  .amdhsa_group_segment_fixed_size 0
  .amdhsa_kernarg_size 80
  .amdhsa_user_sgpr_count 2
  .amdhsa_user_sgpr_kernarg_segment_ptr 1
  .amdhsa_system_sgpr_workgroup_id_x 1
  .amdhsa_float_denorm_mode_32 3
  .amdhsa_float_denorm_mode_16_64 3
.end_amdhsa_kernel
```
